```python
import torch

def _softmax(x, axis=-1):
    return torch.softmax(x, dim=axis)
def _gelu(x):
    return torch.nn.functional.gelu(x, approximate="tanh")
def _silu(x):
    return torch.nn.functional.silu(x)
def _sigmoid(x):
    return torch.sigmoid(x)
def _layernorm(x, axis=-1, eps=1e-5):
    m = x.mean(dim=axis, keepdim=True)
    v = x.var(dim=axis, keepdim=True, unbiased=False)
    return (x - m) / torch.sqrt(v + eps)
def _scatter_add(tgt, idx, src, axis=0):
    return tgt.clone().index_add_(axis, idx, src)
def _segment_sum(src, seg, n):
    out = torch.zeros((n,) + src.shape[1:], dtype=src.dtype)
    return out.index_add_(0, seg, src)
def _pad(x, pw):
    flat = tuple(v for pair in reversed(pw) for v in pair)
    return torch.nn.functional.pad(x, flat)

kernel_name = 'parallel_sum__sliding_local_dilated__geglu_ffn__prompt'

def setup_inputs():

    _w = (lambda a: (lambda t: t.to(torch.bfloat16) if t.is_floating_point() else t)(torch.as_tensor(a)))
    def _A_setup():
        B, S, D = 1, 2048, 1024
        return {
            "x": _w((lambda *s: torch.randn(*s, dtype=torch.bfloat16) * 0.05)(B, S, D)),
            "wqkv": _w((lambda *s: torch.randn(*s, dtype=torch.bfloat16) * 0.05)(D, 3 * D)),
            "wo": _w((lambda *s: torch.randn(*s, dtype=torch.bfloat16) * 0.05)(D, D)),
        }
    _A_in = _A_setup()

    def _B_setup():
        B, S, D, F = 1, 2048, 1024, 3584
        return {
            "x": _w((lambda *s: torch.randn(*s, dtype=torch.bfloat16) * 0.05)(B, S, D)),
            "w_gate": _w((lambda *s: torch.randn(*s, dtype=torch.bfloat16) * 0.05)(D, F)),
            "w_up": _w((lambda *s: torch.randn(*s, dtype=torch.bfloat16) * 0.05)(D, F)),
            "w_down": _w((lambda *s: torch.randn(*s, dtype=torch.bfloat16) * 0.05)(F, D)),
        }
    _B_in = _B_setup()

    return {
        "A_x": _A_in["x"],
        "A_wqkv": _A_in["wqkv"],
        "A_wo": _A_in["wo"],
        "B_x": _B_in["x"],
        "B_w_gate": _B_in["w_gate"],
        "B_w_up": _B_in["w_up"],
        "B_w_down": _B_in["w_down"],
    }

def reference(A_x, A_wqkv, A_wo, B_x, B_w_gate, B_w_up, B_w_down):
    def _A_ref(x, wqkv, wo):
        B, S, D = x.shape
        H = 32; Dh = D // H
        W, dil = 8, 2
        qkv = (lambda x, *d: x.permute(*d))((x @ wqkv).reshape(B, S, 3, H, Dh), 2, 0, 3, 1, 4)
        q, k, v = qkv[0], qkv[1], qkv[2]
        scale = Dh ** -0.5
        pos = torch.arange(S)
        off = torch.arange(W) * dil
        idx = pos[:, None] - off[None, :]
        mask = idx >= 0
        idx_c = torch.where(mask, idx, 0).reshape(-1)
        kg = k[:, :, idx_c, :].reshape(B, H, S, W, Dh)
        vg = v[:, :, idx_c, :].reshape(B, H, S, W, Dh)
        logits = torch.einsum("bhsd,bhswd->bhsw", q, kg) * scale
        logits = torch.where(mask[None, None, :, :], logits, -1e9)
        attn = _softmax(logits, axis=-1)
        o = torch.einsum("bhsw,bhswd->bhsd", attn, vg)
        return (lambda x, *d: x.permute(*d))(o, 0, 2, 1, 3).reshape(B, S, D) @ wo

    def _B_ref(x, w_gate, w_up, w_down):
        return (_gelu(x @ w_gate) * (x @ w_up)) @ w_down

    x = A_x
    xn = _layernorm(x, axis=-1)
    return x + _A_ref(xn, A_wqkv, A_wo) + _B_ref(xn, B_w_gate, B_w_up, B_w_down)
```

```asm
; @launch grid=(256,1,1) block=(512,1,1) lds=163840
.amdgcn_target "amdgcn-amd-amdhsa--gfx950"
.text
.globl parallel_sum__sliding_local_dilated__geglu_ffn__prompt_kernel
.p2align 8
.type parallel_sum__sliding_local_dilated__geglu_ffn__prompt_kernel,@function
parallel_sum__sliding_local_dilated__geglu_ffn__prompt_kernel:
 s_cmp_ge_u32 s2, 256
 s_cbranch_scc1 L_k1_end
 s_load_dwordx2 s[4:5], s[0:1], 8
 s_load_dwordx4 s[8:11], s[0:1], 32
 s_load_dwordx2 s[6:7], s[0:1], 72
 s_load_dwordx2 s[94:95], s[0:1], 0
 s_load_dwordx2 s[100:101], s[0:1], 64
 v_lshrrev_b32 v12, 6, v0
 v_and_b32 v0, 63, v0
 s_nop 0
 v_readfirstlane_b32 s28, v12
 s_and_b32 s46, s2, 7
 s_lshr_b32 s47, s2, 3
 s_lshr_b32 s31, s47, 2
 s_and_b32 s47, s47, 3
 s_lshl_b32 s46, s46, 2
 s_add_u32 s46, s46, s47
 s_lshr_b32 s32, s46, 1
 s_and_b32 s48, s46, 1
 s_and_b32 s29, s28, 3
 s_lshr_b32 s30, s28, 2
 s_waitcnt lgkmcnt(0)
 s_add_u32 s12, s6, 0
 s_addc_u32 s13, s7, 0
 s_and_b32 s13, s13, 0xffff
 s_mov_b32 s14, 0x400000
 s_mov_b32 s15, 0x20000
 s_add_u32 s24, s6, 4194304
 s_addc_u32 s25, s7, 0
 s_and_b32 s25, s25, 0xffff
 s_mov_b32 s26, 18874368
 s_mov_b32 s27, 0x20000
 s_mov_b32 s96, s100
 s_and_b32 s97, s101, 0xffff
 s_mov_b32 s98, 256
 s_mov_b32 s99, 0x20000
 v_and_b32 v43, 7, v0
 v_lshrrev_b32 v44, 3, v0
 s_lshl_b32 s46, s28, 3
 v_add_u32 v45, s46, v44
 s_lshl_b32 s46, s2, 3
 v_add_u32 v46, s46, v43
 v_lshlrev_b32 v47, 11, v46
 v_lshl_add_u32 v47, v45, 4, v47
 s_mov_b32 s80, s94
 s_and_b32 s81, s95, 0xffff
 s_mov_b32 s82, 0x400000
 s_mov_b32 s83, 0x20000
 buffer_load_dwordx4 v[48:51], v47, s[80:83], 0 offen nt
 buffer_load_dwordx4 v[52:55], v47, s[80:83], 0 offen offset:1024 nt
 v_lshlrev_b32 v42, 11, v46
 buffer_load_ushort v41, v42, s[80:83], 0 offen
 v_lshrrev_b32 v56, 5, v46
 v_lshlrev_b32 v56, 16, v56
 v_bfe_u32 v57, v46, 4, 1
 v_lshl_add_u32 v56, v57, 10, v56
 v_and_b32 v57, 15, v46
 v_lshl_add_u32 v56, v57, 4, v56
 v_lshrrev_b32 v57, 2, v45
 v_lshl_add_u32 v56, v57, 11, v56
 v_and_b32 v57, 3, v45
 v_lshl_add_u32 v56, v57, 8, v56
 v_lshlrev_b32 v58, 5, v43
 v_add_u32 v58, 151552, v58
 s_lshl_b32 s46, s28, 2
 v_add_u32 v59, s46, v58
 s_mov_b32 s95, s48
 s_lshl_b32 s49, s31, 3
 s_add_u32 s49, s49, s28
 s_lshl_b32 s49, s49, 16
 v_lshlrev_b32 v12, 4, v0
 v_add_u32 v1, s49, v12
 s_lshl_b32 s39, s28, 11
 s_mov_b32 s33, 0
 s_lshl_b32 s49, s29, 12
 v_add_u32 v4, s49, v12
 v_add_u32 v5, 16384, v12
 v_lshrrev_b32 v13, 4, v0
 v_bfe_u32 v15, v0, 2, 2
 v_and_b32 v16, 3, v0
 v_lshlrev_b32 v17, 10, v13
 v_lshl_add_u32 v17, v15, 7, v17
 v_lshl_add_u32 v17, v16, 3, v17
 v_add_u32 v17, 69632, v17
 v_lshrrev_b32 v18, 1, v15
 v_and_b32 v14, 1, v13
 v_lshl_or_b32 v18, v14, 1, v18
 v_lshrrev_b32 v19, 3, v0
 v_bfe_u32 v20, v0, 1, 2
 v_bfe_u32 v21, v19, 1, 1
 v_xor_b32 v20, v20, v21
 v_and_b32 v21, 1, v0
 s_cmp_eq_u32 s48, 1
 s_cbranch_scc1 L_k1_setupY
 s_lshr_b32 s49, s28, 1
 s_and_b32 s50, s28, 1
 s_lshl_b32 s51, s32, 7
 s_cmp_eq_u32 s49, 3
 s_cbranch_scc1 L_k1_Xgate
 s_mov_b32 s16, s4
 s_and_b32 s17, s5, 0xffff
 s_mov_b32 s18, 6291456
 s_mov_b32 s19, 0x20000
 s_lshl_b32 s52, s49, 11
 s_add_u32 s51, s51, s52
 s_mov_b32 s53, 6144
 s_branch L_k1_Xg2
L_k1_Xgate:
 s_mov_b32 s16, s8
 s_and_b32 s17, s9, 0xffff
 s_mov_b32 s18, 7340032
 s_mov_b32 s19, 0x20000
 s_mov_b32 s53, 7168
L_k1_Xg2:
 s_lshl_b32 s54, s50, 3
 v_add_u32 v22, s54, v19
 v_mul_lo_u32 v22, v22, s53
 s_and_b32 s54, s50, 1
 s_lshl_b32 s54, s54, 1
 v_xor_b32 v23, s54, v20
 v_lshl_add_u32 v22, v23, 5, v22
 v_lshl_add_u32 v22, v21, 4, v22
 v_add_u32 v2, s51, v22
 s_lshl_b32 s37, s53, 5
 s_mov_b32 s34, 0
 s_lshl_b32 s35, s53, 4
 s_lshl_b32 s52, s49, 14
 s_lshl_b32 s54, s50, 10
 s_add_u32 s52, s52, s54
 s_add_u32 s40, s52, 69632
 s_and_b32 s50, s28, 3
 s_mov_b32 s20, s10
 s_and_b32 s21, s11, 0xffff
 s_mov_b32 s22, 7340032
 s_mov_b32 s23, 0x20000
 s_lshl_b32 s51, s32, 7
 s_mov_b32 s53, 7168
 s_lshl_b32 s54, s50, 3
 v_add_u32 v22, s54, v19
 v_mul_lo_u32 v22, v22, s53
 s_and_b32 s54, s50, 1
 s_lshl_b32 s54, s54, 1
 v_xor_b32 v23, s54, v20
 v_lshl_add_u32 v22, v23, 5, v22
 v_lshl_add_u32 v22, v21, 4, v22
 v_add_u32 v3, s51, v22
 s_mov_b32 s38, 229376
 s_mov_b32 s36, 0
 s_lshl_b32 s54, s50, 10
 s_add_u32 s41, s54, 135168
 s_add_u32 s42, s54, 139264
 s_add_u32 s43, s54, 143360
 s_add_u32 s44, s54, 147456
 s_branch L_k1_Xrd
L_k1_Xhalo:
 s_mov_b32 s20, s12
 s_mov_b32 s21, s13
 s_mov_b32 s22, s14
 s_mov_b32 s23, s15
 s_lshl_b32 s51, s31, 3
 s_sub_u32 s51, s51, 1
 s_max_i32 s51, s51, 0
 s_lshl_b32 s51, s51, 16
 s_add_u32 s51, s51, 1024
 v_add_u32 v3, s51, v12
 s_mov_b32 s38, 2048
 s_mov_b32 s36, 0
 s_mov_b32 s41, 16384
 s_mov_b32 s42, 33792
 s_mov_b32 s43, 51200
 s_mov_b32 s44, 68608
L_k1_Xrd:
 s_lshl_b32 s49, s30, 1
 s_add_u32 s50, s49, 0
 v_xor_b32 v21, s50, v18
 v_lshl_add_u32 v6, v21, 5, v17
 v_add_u32 v8, 65536, v6
 s_add_u32 s50, s49, 1
 v_xor_b32 v21, s50, v18
 v_lshl_add_u32 v7, v21, 5, v17
 v_add_u32 v9, 65536, v7
 s_lshl_b32 s70, s32, 1
 s_add_u32 s70, s70, s30
 s_add_u32 s70, s70, 32
 s_lshl_b32 s70, s70, 11
 s_mov_b32 s49, 0
 s_cmp_lt_u32 s28, 4
 s_cselect_b32 s49, 1, 0
 s_mov_b32 s59, s49
 s_cmp_lg_u32 s28, 0
 s_cbranch_scc1 L_w0_1
 s_add_u32 m0, s40, 0
 s_nop 0
 buffer_load_dwordx4 v2, s[16:19], s34 offen nt lds
 s_add_u32 s34, s34, s37
 s_add_u32 m0, s40, 2048
 s_nop 0
 buffer_load_dwordx4 v2, s[16:19], s35 offen nt lds
 s_add_u32 s35, s35, s37
 s_cmp_lg_u32 s59, 1
 s_cbranch_scc1 L_now_4
 s_mov_b32 m0, s41
 s_nop 0
 buffer_load_dwordx4 v3, s[20:23], s36 offen sc1 nt lds
 s_add_u32 s36, s36, s38
L_now_4:
 s_add_u32 m0, s40, 4096
 s_nop 0
 buffer_load_dwordx4 v2, s[16:19], s34 offen nt lds
 s_add_u32 s34, s34, s37
 s_add_u32 m0, s40, 6144
 s_nop 0
 buffer_load_dwordx4 v2, s[16:19], s35 offen nt lds
 s_add_u32 s35, s35, s37
 s_cmp_lg_u32 s59, 1
 s_cbranch_scc1 L_now_5
 s_mov_b32 m0, s42
 s_nop 0
 buffer_load_dwordx4 v3, s[20:23], s36 offen sc1 nt lds
 s_add_u32 s36, s36, s38
L_now_5:
 s_add_u32 m0, s40, 8192
 s_nop 0
 buffer_load_dwordx4 v2, s[16:19], s34 offen nt lds
 s_add_u32 s34, s34, s37
 s_add_u32 m0, s40, 10240
 s_nop 0
 buffer_load_dwordx4 v2, s[16:19], s35 offen nt lds
 s_add_u32 s35, s35, s37
 s_cmp_lg_u32 s59, 1
 s_cbranch_scc1 L_now_6
 s_mov_b32 m0, s43
 s_nop 0
 buffer_load_dwordx4 v3, s[20:23], s36 offen sc1 nt lds
 s_add_u32 s36, s36, s38
L_now_6:
 s_waitcnt vmcnt(6)
 s_branch L_w1_2
L_w0_1:
 s_waitcnt vmcnt(0)
L_w1_2:
 s_waitcnt vmcnt(9)
 v_lshlrev_b32 v41, 16, v41
 v_lshlrev_b32 v60, 16, v48
 v_and_b32 v61, 0xffff0000, v48
 v_lshlrev_b32 v62, 16, v49
 v_and_b32 v63, 0xffff0000, v49
 v_lshlrev_b32 v64, 16, v50
 v_and_b32 v65, 0xffff0000, v50
 v_lshlrev_b32 v66, 16, v51
 v_and_b32 v67, 0xffff0000, v51
 v_lshlrev_b32 v68, 16, v52
 v_and_b32 v69, 0xffff0000, v52
 v_lshlrev_b32 v70, 16, v53
 v_and_b32 v71, 0xffff0000, v53
 v_lshlrev_b32 v72, 16, v54
 v_and_b32 v73, 0xffff0000, v54
 v_lshlrev_b32 v74, 16, v55
 v_and_b32 v75, 0xffff0000, v55
 v_sub_f32 v42, 0, v41
 v_mov_b32 v43, v42
 v_pk_add_f32 v[80:81], v[60:61], v[42:43]
 v_pk_mul_f32 v[82:83], v[80:81], v[80:81]
 v_pk_add_f32 v[86:87], v[62:63], v[42:43]
 v_pk_add_f32 v[80:81], v[80:81], v[86:87]
 v_pk_fma_f32 v[82:83], v[86:87], v[86:87], v[82:83]
 v_pk_add_f32 v[84:85], v[64:65], v[42:43]
 v_pk_add_f32 v[80:81], v[80:81], v[84:85]
 v_pk_fma_f32 v[82:83], v[84:85], v[84:85], v[82:83]
 v_pk_add_f32 v[86:87], v[66:67], v[42:43]
 v_pk_add_f32 v[80:81], v[80:81], v[86:87]
 v_pk_fma_f32 v[82:83], v[86:87], v[86:87], v[82:83]
 v_pk_add_f32 v[84:85], v[68:69], v[42:43]
 v_pk_add_f32 v[80:81], v[80:81], v[84:85]
 v_pk_fma_f32 v[82:83], v[84:85], v[84:85], v[82:83]
 v_pk_add_f32 v[86:87], v[70:71], v[42:43]
 v_pk_add_f32 v[80:81], v[80:81], v[86:87]
 v_pk_fma_f32 v[82:83], v[86:87], v[86:87], v[82:83]
 v_pk_add_f32 v[84:85], v[72:73], v[42:43]
 v_pk_add_f32 v[80:81], v[80:81], v[84:85]
 v_pk_fma_f32 v[82:83], v[84:85], v[84:85], v[82:83]
 v_pk_add_f32 v[86:87], v[74:75], v[42:43]
 v_pk_add_f32 v[80:81], v[80:81], v[86:87]
 v_pk_fma_f32 v[82:83], v[86:87], v[86:87], v[82:83]
 v_add_f32 v80, v80, v81
 v_add_f32 v81, v82, v83
 s_nop 1
 v_add_f32_dpp v80, v80, v80 row_ror:8 row_mask:0xf bank_mask:0xf
 v_add_f32_dpp v81, v81, v81 row_ror:8 row_mask:0xf bank_mask:0xf
 v_mov_b32 v84, v80
 v_mov_b32 v86, v81
 v_mov_b32 v85, v80
 v_mov_b32 v87, v81
 s_nop 1
 v_permlane16_swap_b32 v84, v85
 v_permlane16_swap_b32 v86, v87
 s_nop 1
 v_add_f32 v80, v84, v85
 v_add_f32 v81, v86, v87
 v_mov_b32 v84, v80
 v_mov_b32 v86, v81
 v_mov_b32 v85, v80
 v_mov_b32 v87, v81
 s_nop 1
 v_permlane32_swap_b32 v84, v85
 v_permlane32_swap_b32 v86, v87
 s_nop 1
 v_add_f32 v80, v84, v85
 v_add_f32 v81, v86, v87
 v_cmp_gt_u32 vcc, 8, v0
 s_and_saveexec_b64 s[84:85], vcc
 ds_write_b32 v59, v80
 ds_write_b32 v59, v81 offset:256
 s_mov_b64 exec, s[84:85]
 s_waitcnt lgkmcnt(0)
 s_barrier
 ds_read_b128 v[84:87], v58
 ds_read_b128 v[88:91], v58 offset:16
 ds_read_b128 v[92:95], v58 offset:256
 ds_read_b128 v[96:99], v58 offset:272
 s_waitcnt lgkmcnt(2)
 v_add_f32 v84, v84, v88
 v_add_f32 v85, v85, v89
 v_add_f32 v86, v86, v90
 v_add_f32 v87, v87, v91
 v_add_f32 v84, v84, v85
 v_add_f32 v86, v86, v87
 v_add_f32 v80, v84, v86
 s_waitcnt lgkmcnt(0)
 v_add_f32 v92, v92, v96
 v_add_f32 v93, v93, v97
 v_add_f32 v94, v94, v98
 v_add_f32 v95, v95, v99
 v_add_f32 v92, v92, v93
 v_add_f32 v94, v94, v95
 v_add_f32 v83, v92, v94
 v_mul_f32 v80, 0x3a800000, v80
 v_mul_f32 v83, 0x3a800000, v83
 v_fma_f32 v83, -v80, v80, v83
 v_max_f32 v83, 0, v83
 v_add_f32 v80, v80, v41
 v_cvt_pk_bf16_f32 v80, v80, v80
 v_lshlrev_b32 v80, 16, v80
 v_cvt_pk_bf16_f32 v83, v83, v83
 v_lshlrev_b32 v83, 16, v83
 v_add_f32 v83, 0x3727c5ac, v83
 v_cvt_pk_bf16_f32 v83, v83, v83
 v_lshlrev_b32 v83, 16, v83
 v_sqrt_f32 v83, v83
 v_sub_f32 v42, 0, v80
 v_mov_b32 v43, v42
 v_pk_add_f32 v[60:61], v[60:61], v[42:43]
 v_pk_add_f32 v[62:63], v[62:63], v[42:43]
 v_pk_add_f32 v[64:65], v[64:65], v[42:43]
 v_pk_add_f32 v[66:67], v[66:67], v[42:43]
 v_pk_add_f32 v[68:69], v[68:69], v[42:43]
 v_pk_add_f32 v[70:71], v[70:71], v[42:43]
 v_pk_add_f32 v[72:73], v[72:73], v[42:43]
 v_pk_add_f32 v[74:75], v[74:75], v[42:43]
 v_cvt_pk_bf16_f32 v83, v83, v83
 v_lshlrev_b32 v83, 16, v83
 v_rcp_f32 v83, v83
 v_cvt_pk_bf16_f32 v48, v60, v61
 v_cvt_pk_bf16_f32 v49, v62, v63
 v_cvt_pk_bf16_f32 v50, v64, v65
 v_cvt_pk_bf16_f32 v51, v66, v67
 v_cvt_pk_bf16_f32 v52, v68, v69
 v_cvt_pk_bf16_f32 v53, v70, v71
 v_cvt_pk_bf16_f32 v54, v72, v73
 v_cvt_pk_bf16_f32 v55, v74, v75
 v_lshlrev_b32 v60, 16, v48
 v_and_b32 v61, 0xffff0000, v48
 v_lshlrev_b32 v62, 16, v49
 v_and_b32 v63, 0xffff0000, v49
 v_lshlrev_b32 v64, 16, v50
 v_and_b32 v65, 0xffff0000, v50
 v_lshlrev_b32 v66, 16, v51
 v_and_b32 v67, 0xffff0000, v51
 v_lshlrev_b32 v68, 16, v52
 v_and_b32 v69, 0xffff0000, v52
 v_lshlrev_b32 v70, 16, v53
 v_and_b32 v71, 0xffff0000, v53
 v_lshlrev_b32 v72, 16, v54
 v_and_b32 v73, 0xffff0000, v54
 v_lshlrev_b32 v74, 16, v55
 v_and_b32 v75, 0xffff0000, v55
 v_mov_b32 v82, v83
 v_pk_mul_f32 v[60:61], v[60:61], v[82:83]
 v_pk_mul_f32 v[62:63], v[62:63], v[82:83]
 v_pk_mul_f32 v[64:65], v[64:65], v[82:83]
 v_pk_mul_f32 v[66:67], v[66:67], v[82:83]
 v_pk_mul_f32 v[68:69], v[68:69], v[82:83]
 v_pk_mul_f32 v[70:71], v[70:71], v[82:83]
 v_pk_mul_f32 v[72:73], v[72:73], v[82:83]
 v_pk_mul_f32 v[74:75], v[74:75], v[82:83]
 v_cvt_pk_bf16_f32 v48, v60, v61
 v_cvt_pk_bf16_f32 v49, v62, v63
 v_cvt_pk_bf16_f32 v50, v64, v65
 v_cvt_pk_bf16_f32 v51, v66, v67
 v_cvt_pk_bf16_f32 v52, v68, v69
 v_cvt_pk_bf16_f32 v53, v70, v71
 v_cvt_pk_bf16_f32 v54, v72, v73
 v_cvt_pk_bf16_f32 v55, v74, v75
 v_add_u32 v57, 0x8000, v56
 buffer_store_dwordx4 v[48:51], v56, s[12:15], 0 offen sc1
 buffer_store_dwordx4 v[52:55], v57, s[12:15], 0 offen sc1
 s_cmp_ge_u32 s28, 4
 s_cbranch_scc1 L_hf_7
 s_cmp_eq_u32 s31, 7
 s_cbranch_scc1 L_hf_7
 s_add_u32 s84, s6, 24117248
 s_addc_u32 s85, s7, 0
 s_and_b32 s85, s85, 0xffff
 s_mov_b32 s86, 524288
 s_mov_b32 s87, 0x20000
 s_add_u32 s88, s31, 1
 s_lshl_b32 s88, s88, 4
 s_add_u32 s88, s88, s32
 s_lshl_b32 s88, s88, 12
 s_lshl_b32 s89, s28, 10
 s_add_u32 s88, s88, s89
 v_lshlrev_b32 v30, 4, v0
 v_mov_b32 v24, -1
 v_mov_b32 v25, -1
 v_mov_b32 v26, -1
 v_mov_b32 v27, -1
 buffer_store_dwordx4 v[24:27], v30, s[84:87], s88 offen sc1
L_hf_7:
 s_waitcnt vmcnt(0)
 s_barrier
 s_cmp_lg_u32 s28, 0
 s_cbranch_scc1 L_arr_8
 s_lshl_b32 s46, s31, 5
 s_add_u32 s46, s46, 0
 v_mov_b32 v27, s46
 v_mov_b32 v28, 1
 v_cmp_eq_u32 vcc, 0, v0
 s_and_saveexec_b64 s[46:47], vcc
 buffer_atomic_add v28, v27, s[96:99], 0 offen sc1
 s_mov_b64 exec, s[46:47]
L_arr_8:
 s_cmp_eq_u32 s28, 0
 s_cbranch_scc1 L_w2_3
 s_add_u32 m0, s40, 0
 s_nop 0
 buffer_load_dwordx4 v2, s[16:19], s34 offen nt lds
 s_add_u32 s34, s34, s37
 s_add_u32 m0, s40, 2048
 s_nop 0
 buffer_load_dwordx4 v2, s[16:19], s35 offen nt lds
 s_add_u32 s35, s35, s37
 s_cmp_lg_u32 s59, 1
 s_cbranch_scc1 L_now_9
 s_mov_b32 m0, s41
 s_nop 0
 buffer_load_dwordx4 v3, s[20:23], s36 offen sc1 nt lds
 s_add_u32 s36, s36, s38
L_now_9:
 s_add_u32 m0, s40, 4096
 s_nop 0
 buffer_load_dwordx4 v2, s[16:19], s34 offen nt lds
 s_add_u32 s34, s34, s37
 s_add_u32 m0, s40, 6144
 s_nop 0
 buffer_load_dwordx4 v2, s[16:19], s35 offen nt lds
 s_add_u32 s35, s35, s37
 s_cmp_lg_u32 s59, 1
 s_cbranch_scc1 L_now_10
 s_mov_b32 m0, s42
 s_nop 0
 buffer_load_dwordx4 v3, s[20:23], s36 offen sc1 nt lds
 s_add_u32 s36, s36, s38
L_now_10:
 s_add_u32 m0, s40, 8192
 s_nop 0
 buffer_load_dwordx4 v2, s[16:19], s34 offen nt lds
 s_add_u32 s34, s34, s37
 s_add_u32 m0, s40, 10240
 s_nop 0
 buffer_load_dwordx4 v2, s[16:19], s35 offen nt lds
 s_add_u32 s35, s35, s37
 s_cmp_lg_u32 s59, 1
 s_cbranch_scc1 L_now_11
 s_mov_b32 m0, s43
 s_nop 0
 buffer_load_dwordx4 v3, s[20:23], s36 offen sc1 nt lds
 s_add_u32 s36, s36, s38
L_now_11:
L_w2_3:
 s_cmp_lt_u32 s28, 4
 s_cbranch_scc1 L_sb_12
 s_add_u32 s84, s6, 25165824
 s_addc_u32 s85, s7, 0
 s_and_b32 s85, s85, 0xffff
 s_mov_b32 s86, 4194304
 s_mov_b32 s87, 0x20000
 s_lshl_b32 s88, s2, 14
 s_and_b32 s89, s28, 3
 s_lshl_b32 s89, s89, 12
 s_add_u32 s88, s88, s89
 v_lshlrev_b32 v30, 4, v0
 v_mov_b32 v24, -1
 v_mov_b32 v25, -1
 v_mov_b32 v26, -1
 v_mov_b32 v27, -1
 s_add_u32 s89, s88, 0
 buffer_store_dwordx4 v[24:27], v30, s[84:87], s89 offen sc1
 s_add_u32 s89, s88, 1024
 buffer_store_dwordx4 v[24:27], v30, s[84:87], s89 offen sc1
 s_add_u32 s89, s88, 2048
 buffer_store_dwordx4 v[24:27], v30, s[84:87], s89 offen sc1
 s_add_u32 s89, s88, 3072
 buffer_store_dwordx4 v[24:27], v30, s[84:87], s89 offen sc1
L_sb_12:
 s_load_dwordx2 s[80:81], s[0:1], 16
 s_load_dwordx2 s[84:85], s[0:1], 48
 s_and_b32 s88, s2, 7
 s_lshr_b32 s89, s88, 2
 s_lshr_b32 s90, s2, 3
 s_bfe_u32 s91, s88, 0x10001
 s_lshl_b32 s91, s91, 3
 s_and_b32 s92, s90, 7
 s_add_u32 s92, s92, s91
 s_and_b32 s91, s88, 1
 s_lshl_b32 s91, s91, 2
 s_lshr_b32 s90, s90, 3
 s_add_u32 s90, s90, s91
 v_and_b32 v17, 1, v0
 v_lshlrev_b32 v17, 7, v17
 s_lshl_b32 s91, s90, 8
 v_add_u32 v17, s91, v17
 v_mov_b32 v14, 0x7ffffff0
 s_mul_i32 s91, s89, 512
 s_mul_i32 s93, s92, 32
 s_add_u32 s91, s91, s93
 s_mul_i32 s93, s28, 4
 s_add_u32 s91, s91, s93
 v_subrev_u32 v16, 0, v0
 v_lshrrev_b32 v16, 1, v16
 v_add_u32 v12, s91, v16
 v_lshl_add_u32 v12, v12, 11, v17
 s_mul_i32 s91, s89, 1280
 s_mul_i32 s93, s92, 80
 s_add_u32 s91, s91, s93
 s_mul_i32 s93, s28, 10
 s_add_u32 s91, s91, s93
 s_add_u32 s91, s91, 1024
 v_subrev_u32 v16, 8, v0
 v_lshrrev_b32 v16, 1, v16
 v_add_u32 v15, s91, v16
 v_lshl_add_u32 v15, v15, 11, v17
 v_cmp_gt_u32 vcc, 8, v0
 s_nop 1
 v_cndmask_b32 v12, v15, v12, vcc
 v_cmp_gt_u32 vcc, 28, v0
 s_nop 1
 v_cndmask_b32 v12, v14, v12, vcc
 s_mul_i32 s91, s89, 512
 s_mul_i32 s93, s92, 32
 s_add_u32 s91, s91, s93
 s_mul_i32 s93, s28, 4
 s_add_u32 s91, s91, s93
 v_subrev_u32 v16, 0, v0
 v_lshrrev_b32 v16, 1, v16
 v_add_u32 v13, s91, v16
 v_lshl_add_u32 v13, v13, 11, v17
 v_cmp_gt_u32 vcc, 8, v0
 s_nop 1
 v_cndmask_b32 v13, v14, v13, vcc
 s_mul_i32 s88, s28, 43
 s_lshr_b32 s88, s88, 8
 s_mul_i32 s88, s88, 6
 s_sub_u32 s88, s28, s88
 s_add_u32 s89, s88, 3
 s_cmp_ge_u32 s89, 6
 s_cselect_b32 s93, 6, 0
 s_sub_u32 s89, s89, s93
 s_add_u32 s88, s88, 1
 s_add_u32 s89, s89, 1
 s_waitcnt lgkmcnt(0)
 s_and_b32 s81, s81, 0xffff
 s_mov_b32 s82, 2097152
 s_mov_b32 s83, 0x20000
 s_and_b32 s85, s85, 0xffff
 s_mov_b32 s86, 7340032
 s_mov_b32 s87, 0x20000
 v_mov_b32 v36, 0
 v_mov_b32 v37, 0
 v_mov_b32 v38, 0
 v_mov_b32 v39, 0
 v_mov_b32 v40, 0
 v_mov_b32 v41, 0
 v_mov_b32 v42, 0
 v_mov_b32 v43, 0
 v_mov_b32 v44, 0
 v_mov_b32 v45, 0
 v_mov_b32 v46, 0
 v_mov_b32 v47, 0
 v_mov_b32 v48, 0
 v_mov_b32 v49, 0
 v_mov_b32 v50, 0
 v_mov_b32 v51, 0
 v_mov_b32 v52, 0
 v_mov_b32 v53, 0
 v_mov_b32 v54, 0
 v_mov_b32 v55, 0
 v_mov_b32 v56, 0
 v_mov_b32 v57, 0
 v_mov_b32 v58, 0
 v_mov_b32 v59, 0
 v_mov_b32 v60, 0
 v_mov_b32 v61, 0
 v_mov_b32 v62, 0
 v_mov_b32 v63, 0
 v_mov_b32 v64, 0
 v_mov_b32 v65, 0
 v_mov_b32 v66, 0
 v_mov_b32 v67, 0
 v_mov_b32 v68, 0
 v_mov_b32 v69, 0
 v_mov_b32 v70, 0
 v_mov_b32 v71, 0
 v_mov_b32 v72, 0
 v_mov_b32 v73, 0
 v_mov_b32 v74, 0
 v_mov_b32 v75, 0
 v_mov_b32 v76, 0
 v_mov_b32 v77, 0
 v_mov_b32 v78, 0
 v_mov_b32 v79, 0
 v_mov_b32 v80, 0
 v_mov_b32 v81, 0
 v_mov_b32 v82, 0
 v_mov_b32 v83, 0
 v_mov_b32 v84, 0
 v_mov_b32 v85, 0
 v_mov_b32 v86, 0
 v_mov_b32 v87, 0
 v_mov_b32 v88, 0
 v_mov_b32 v89, 0
 v_mov_b32 v90, 0
 v_mov_b32 v91, 0
 v_mov_b32 v92, 0
 v_mov_b32 v93, 0
 v_mov_b32 v94, 0
 v_mov_b32 v95, 0
 v_mov_b32 v96, 0
 v_mov_b32 v97, 0
 v_mov_b32 v98, 0
 v_mov_b32 v99, 0
 v_mov_b32 v100, 0
 v_mov_b32 v101, 0
 v_mov_b32 v102, 0
 v_mov_b32 v103, 0
 v_mov_b32 v104, 0
 v_mov_b32 v105, 0
 v_mov_b32 v106, 0
 v_mov_b32 v107, 0
 v_mov_b32 v108, 0
 v_mov_b32 v109, 0
 v_mov_b32 v110, 0
 v_mov_b32 v111, 0
 v_mov_b32 v112, 0
 v_mov_b32 v113, 0
 v_mov_b32 v114, 0
 v_mov_b32 v115, 0
 v_mov_b32 v116, 0
 v_mov_b32 v117, 0
 v_mov_b32 v118, 0
 v_mov_b32 v119, 0
 v_mov_b32 v120, 0
 v_mov_b32 v121, 0
 v_mov_b32 v122, 0
 v_mov_b32 v123, 0
 v_mov_b32 v124, 0
 v_mov_b32 v125, 0
 v_mov_b32 v126, 0
 v_mov_b32 v127, 0
 v_mov_b32 v128, 0
 v_mov_b32 v129, 0
 v_mov_b32 v130, 0
 v_mov_b32 v131, 0
 v_mov_b32 v132, 0
 v_mov_b32 v133, 0
 v_mov_b32 v134, 0
 v_mov_b32 v135, 0
 v_mov_b32 v136, 0
 v_mov_b32 v137, 0
 v_mov_b32 v138, 0
 v_mov_b32 v139, 0
 v_mov_b32 v140, 0
 v_mov_b32 v141, 0
 v_mov_b32 v142, 0
 v_mov_b32 v143, 0
 v_mov_b32 v144, 0
 v_mov_b32 v145, 0
 v_mov_b32 v146, 0
 v_mov_b32 v147, 0
 v_mov_b32 v148, 0
 v_mov_b32 v149, 0
 v_mov_b32 v150, 0
 v_mov_b32 v151, 0
 v_mov_b32 v152, 0
 v_mov_b32 v153, 0
 v_mov_b32 v154, 0
 v_mov_b32 v155, 0
 v_mov_b32 v156, 0
 v_mov_b32 v157, 0
 v_mov_b32 v158, 0
 v_mov_b32 v159, 0
 v_mov_b32 v160, 0
 v_mov_b32 v161, 0
 v_mov_b32 v162, 0
 v_mov_b32 v163, 0
 v_mov_b32 v164, 0
 v_mov_b32 v165, 0
 v_mov_b32 v166, 0
 v_mov_b32 v167, 0
 v_mov_b32 v168, 0
 v_mov_b32 v169, 0
 v_mov_b32 v170, 0
 v_mov_b32 v171, 0
 v_mov_b32 v172, 0
 v_mov_b32 v173, 0
 v_mov_b32 v174, 0
 v_mov_b32 v175, 0
 v_mov_b32 v176, 0
 v_mov_b32 v177, 0
 v_mov_b32 v178, 0
 v_mov_b32 v179, 0
 v_mov_b32 v180, 0
 v_mov_b32 v181, 0
 v_mov_b32 v182, 0
 v_mov_b32 v183, 0
 v_mov_b32 v184, 0
 v_mov_b32 v185, 0
 v_mov_b32 v186, 0
 v_mov_b32 v187, 0
 v_mov_b32 v188, 0
 v_mov_b32 v189, 0
 v_mov_b32 v190, 0
 v_mov_b32 v191, 0
 v_mov_b32 v192, 0
 v_mov_b32 v193, 0
 v_mov_b32 v194, 0
 v_mov_b32 v195, 0
 v_mov_b32 v196, 0
 v_mov_b32 v197, 0
 v_mov_b32 v198, 0
 v_mov_b32 v199, 0
 s_cmp_lg_u32 s28, 0
 s_cbranch_scc1 L_wd_13
 s_lshl_b32 s46, s31, 5
 s_add_u32 s46, s46, 0
 s_sub_u32 s47, s31, 1
 s_max_i32 s47, s47, 0
 s_lshl_b32 s47, s47, 5
 s_add_u32 s47, s47, 0
 v_mov_b32 v27, s47
 v_mov_b32 v28, s46
 v_cmp_eq_u32 vcc, 0, v0
 s_nop 1
 v_cndmask_b32 v27, v27, v28, vcc
 s_mov_b32 s48, 0
L_wp_14:
 buffer_load_dword v28, v27, s[96:99], 0 offen sc1
 s_waitcnt vmcnt(0)
 v_cmp_gt_u32 vcc, 32, v28
 s_add_u32 s48, s48, 1
 s_cbranch_vccz L_wd_13
 s_cmp_lt_u32 s48, 0x20000
 s_cbranch_scc0 L_wd_13
 s_sleep 8
 s_branch L_wp_14
L_wd_13:
 s_barrier
 s_add_u32 m0, s39, 0
 s_nop 0
 buffer_load_dwordx4 v1, s[12:15], s33 offen sc1 lds
 buffer_load_dwordx4 v1, s[12:15], s33 offen offset:1024 sc1 lds
 s_add_u32 s33, s33, 2048
 s_cmp_lg_u32 s59, 2
 s_cbranch_scc1 L_noh_15
 s_mov_b32 m0, s41
 s_nop 0
 buffer_load_dwordx4 v3, s[20:23], s36 offen sc1 nt lds
 s_add_u32 s36, s36, s38
L_noh_15:
 s_add_u32 m0, s39, 17408
 s_nop 0
 buffer_load_dwordx4 v1, s[12:15], s33 offen sc1 lds
 buffer_load_dwordx4 v1, s[12:15], s33 offen offset:1024 sc1 lds
 s_add_u32 s33, s33, 2048
 s_cmp_lg_u32 s59, 2
 s_cbranch_scc1 L_noh_16
 s_mov_b32 m0, s42
 s_nop 0
 buffer_load_dwordx4 v3, s[20:23], s36 offen sc1 nt lds
 s_add_u32 s36, s36, s38
L_noh_16:
 s_add_u32 m0, s39, 34816
 s_nop 0
 buffer_load_dwordx4 v1, s[12:15], s33 offen sc1 lds
 buffer_load_dwordx4 v1, s[12:15], s33 offen offset:1024 sc1 lds
 s_add_u32 s33, s33, 2048
 s_cmp_lg_u32 s59, 2
 s_cbranch_scc1 L_noh_17
 s_mov_b32 m0, s43
 s_nop 0
 buffer_load_dwordx4 v3, s[20:23], s36 offen sc1 nt lds
 s_add_u32 s36, s36, s38
L_noh_17:
 s_cmp_eq_u32 s28, 0
 s_cbranch_scc1 L_k1_X_None_1
 s_cmp_eq_u32 s28, 1
 s_cbranch_scc1 L_k1_X_None_1
 s_cmp_eq_u32 s28, 2
 s_cbranch_scc1 L_k1_X_None_1
 s_cmp_eq_u32 s28, 3
 s_cbranch_scc1 L_k1_X_None_1
 s_cmp_eq_u32 s28, 4
 s_cbranch_scc1 L_k1_X_None_0
 s_cmp_eq_u32 s28, 5
 s_cbranch_scc1 L_k1_X_None_0
 s_cmp_eq_u32 s28, 6
 s_cbranch_scc1 L_k1_X_None_0
 s_cmp_eq_u32 s28, 7
 s_cbranch_scc1 L_k1_X_None_0
L_k1_X_None_1:
 s_waitcnt vmcnt(4)
 s_barrier
 s_mov_b32 s45, 6
 ds_read_b128 a[16:19], v4 offset:0
 ds_read_b128 a[20:23], v4 offset:1024
 ds_read_b128 a[24:27], v4 offset:2048
 ds_read_b128 a[28:31], v4 offset:3072
 ds_read_b64_tr_b16 a[0:1], v6 offset:0
 ds_read_b64_tr_b16 a[2:3], v6 offset:512
 ds_read_b64_tr_b16 a[4:5], v7 offset:0
 ds_read_b64_tr_b16 a[6:7], v7 offset:512
 ds_read_b64_tr_b16 a[8:9], v6 offset:16384
 ds_read_b64_tr_b16 a[10:11], v6 offset:16896
 s_waitcnt vmcnt(2)
 s_barrier
 s_waitcnt lgkmcnt(4)
 v_mfma_f32_16x16x32_bf16 v[40:43], a[0:3], a[16:19], v[40:43]
 ds_read_b64_tr_b16 a[12:13], v7 offset:16384
 v_mfma_f32_16x16x32_bf16 v[44:47], a[0:3], a[20:23], v[44:47]
 ds_read_b64_tr_b16 a[14:15], v7 offset:16896
 v_mfma_f32_16x16x32_bf16 v[48:51], a[0:3], a[24:27], v[48:51]
 s_add_u32 m0, s39, 52224
 v_mfma_f32_16x16x32_bf16 v[52:55], a[0:3], a[28:31], v[52:55]
 buffer_load_dwordx4 v1, s[12:15], s33 offen sc1 lds
 s_waitcnt lgkmcnt(4)
 v_mfma_f32_16x16x32_bf16 v[68:71], a[4:7], a[28:31], v[68:71]
 ds_read_b64_tr_b16 a[0:1], v6 offset:32768
 v_mfma_f32_16x16x32_bf16 v[64:67], a[4:7], a[24:27], v[64:67]
 ds_read_b64_tr_b16 a[2:3], v6 offset:33280
 v_mfma_f32_16x16x32_bf16 v[60:63], a[4:7], a[20:23], v[60:63]
 v_mfma_f32_16x16x32_bf16 v[56:59], a[4:7], a[16:19], v[56:59]
 buffer_load_dwordx4 v1, s[12:15], s33 offen offset:1024 sc1 lds
 s_add_u32 s33, s33, 2048
 s_waitcnt lgkmcnt(4)
 v_mfma_f32_16x16x32_bf16 v[72:75], a[8:11], a[16:19], v[72:75]
 ds_read_b64_tr_b16 a[4:5], v7 offset:32768
 v_mfma_f32_16x16x32_bf16 v[76:79], a[8:11], a[20:23], v[76:79]
 ds_read_b64_tr_b16 a[6:7], v7 offset:33280
 v_mfma_f32_16x16x32_bf16 v[80:83], a[8:11], a[24:27], v[80:83]
 s_add_u32 m0, s40, 12288
 v_mfma_f32_16x16x32_bf16 v[84:87], a[8:11], a[28:31], v[84:87]
 buffer_load_dwordx4 v2, s[16:19], s34 offen nt lds
 s_add_u32 s34, s34, s37
 s_waitcnt lgkmcnt(4)
 v_mfma_f32_16x16x32_bf16 v[100:103], a[12:15], a[28:31], v[100:103]
 ds_read_b64_tr_b16 a[8:9], v6 offset:49152
 v_mfma_f32_16x16x32_bf16 v[96:99], a[12:15], a[24:27], v[96:99]
 ds_read_b64_tr_b16 a[10:11], v6 offset:49664
 v_mfma_f32_16x16x32_bf16 v[92:95], a[12:15], a[20:23], v[92:95]
 ds_read_b128 a[32:35], v4 offset:17408
 s_add_u32 m0, s40, 14336
 v_mfma_f32_16x16x32_bf16 v[88:91], a[12:15], a[16:19], v[88:91]
 buffer_load_dwordx4 v2, s[16:19], s35 offen nt lds
 s_add_u32 s35, s35, s37
 s_waitcnt lgkmcnt(5)
 v_mfma_f32_16x16x32_bf16 v[104:107], a[16:19], a[0:3], v[104:107]
 ds_read_b64_tr_b16 a[12:13], v7 offset:49152
 v_mfma_f32_16x16x32_bf16 v[108:111], a[20:23], a[0:3], v[108:111]
 ds_read_b64_tr_b16 a[14:15], v7 offset:49664
 v_mfma_f32_16x16x32_bf16 v[112:115], a[24:27], a[0:3], v[112:115]
 ds_read_b128 a[36:39], v4 offset:18432
 s_mov_b32 m0, s44
 v_mfma_f32_16x16x32_bf16 v[116:119], a[28:31], a[0:3], v[116:119]
 buffer_load_dwordx4 v3, s[20:23], s36 offen sc1 nt lds
 s_add_u32 s36, s36, s38
 s_waitcnt lgkmcnt(6)
 v_mfma_f32_16x16x32_bf16 v[132:135], a[28:31], a[4:7], v[132:135]
 ds_read_b64_tr_b16 a[0:1], v8 offset:0
 v_mfma_f32_16x16x32_bf16 v[128:131], a[24:27], a[4:7], v[128:131]
 ds_read_b64_tr_b16 a[2:3], v8 offset:512
 v_mfma_f32_16x16x32_bf16 v[124:127], a[20:23], a[4:7], v[124:127]
 ds_read_b128 a[40:43], v4 offset:19456
 v_mfma_f32_16x16x32_bf16 v[120:123], a[16:19], a[4:7], v[120:123]
 s_waitcnt lgkmcnt(7)
 v_mfma_f32_16x16x32_bf16 v[136:139], a[8:11], a[16:19], v[136:139]
 ds_read_b64_tr_b16 a[4:5], v9 offset:0
 v_mfma_f32_16x16x32_bf16 v[140:143], a[8:11], a[20:23], v[140:143]
 ds_read_b64_tr_b16 a[6:7], v9 offset:512
 v_mfma_f32_16x16x32_bf16 v[144:147], a[8:11], a[24:27], v[144:147]
 ds_read_b128 a[44:47], v4 offset:20480
 v_mfma_f32_16x16x32_bf16 v[148:151], a[8:11], a[28:31], v[148:151]
 s_waitcnt lgkmcnt(7)
 v_mfma_f32_16x16x32_bf16 v[164:167], a[12:15], a[28:31], v[164:167]
 ds_read_b64_tr_b16 a[8:9], v6 offset:4096
 v_mfma_f32_16x16x32_bf16 v[160:163], a[12:15], a[24:27], v[160:163]
 ds_read_b64_tr_b16 a[10:11], v6 offset:4608
 v_mfma_f32_16x16x32_bf16 v[156:159], a[12:15], a[20:23], v[156:159]
 v_mfma_f32_16x16x32_bf16 v[152:155], a[12:15], a[16:19], v[152:155]
 s_waitcnt lgkmcnt(6)
 v_mfma_f32_16x16x32_bf16 v[168:171], a[0:3], a[16:19], v[168:171]
 ds_read_b64_tr_b16 a[12:13], v7 offset:4096
 v_mfma_f32_16x16x32_bf16 v[172:175], a[0:3], a[20:23], v[172:175]
 ds_read_b64_tr_b16 a[14:15], v7 offset:4608
 v_mfma_f32_16x16x32_bf16 v[176:179], a[0:3], a[24:27], v[176:179]
 v_mfma_f32_16x16x32_bf16 v[180:183], a[0:3], a[28:31], v[180:183]
 s_waitcnt lgkmcnt(5)
 v_mfma_f32_16x16x32_bf16 v[196:199], a[4:7], a[28:31], v[196:199]
 ds_read_b64_tr_b16 a[0:1], v6 offset:20480
 v_mfma_f32_16x16x32_bf16 v[192:195], a[4:7], a[24:27], v[192:195]
 ds_read_b64_tr_b16 a[2:3], v6 offset:20992
 v_mfma_f32_16x16x32_bf16 v[188:191], a[4:7], a[20:23], v[188:191]
 v_mfma_f32_16x16x32_bf16 v[184:187], a[4:7], a[16:19], v[184:187]
 s_waitcnt vmcnt(5)
 s_barrier
 s_waitcnt lgkmcnt(4)
 v_mfma_f32_16x16x32_bf16 v[40:43], a[8:11], a[32:35], v[40:43]
 ds_read_b64_tr_b16 a[4:5], v7 offset:20480
 v_mfma_f32_16x16x32_bf16 v[44:47], a[8:11], a[36:39], v[44:47]
 ds_read_b64_tr_b16 a[6:7], v7 offset:20992
 v_mfma_f32_16x16x32_bf16 v[48:51], a[8:11], a[40:43], v[48:51]
 s_add_u32 m0, s39, 0
 v_mfma_f32_16x16x32_bf16 v[52:55], a[8:11], a[44:47], v[52:55]
 buffer_load_dwordx4 v1, s[12:15], s33 offen sc1 lds
 s_waitcnt lgkmcnt(4)
 v_mfma_f32_16x16x32_bf16 v[68:71], a[12:15], a[44:47], v[68:71]
 ds_read_b64_tr_b16 a[8:9], v6 offset:36864
 v_mfma_f32_16x16x32_bf16 v[64:67], a[12:15], a[40:43], v[64:67]
 ds_read_b64_tr_b16 a[10:11], v6 offset:37376
 v_mfma_f32_16x16x32_bf16 v[60:63], a[12:15], a[36:39], v[60:63]
 v_mfma_f32_16x16x32_bf16 v[56:59], a[12:15], a[32:35], v[56:59]
 buffer_load_dwordx4 v1, s[12:15], s33 offen offset:1024 sc1 lds
 s_add_u32 s33, s33, 2048
 s_waitcnt lgkmcnt(4)
 v_mfma_f32_16x16x32_bf16 v[72:75], a[0:3], a[32:35], v[72:75]
 ds_read_b64_tr_b16 a[12:13], v7 offset:36864
 v_mfma_f32_16x16x32_bf16 v[76:79], a[0:3], a[36:39], v[76:79]
 ds_read_b64_tr_b16 a[14:15], v7 offset:37376
 v_mfma_f32_16x16x32_bf16 v[80:83], a[0:3], a[40:43], v[80:83]
 s_add_u32 m0, s40, 0
 v_mfma_f32_16x16x32_bf16 v[84:87], a[0:3], a[44:47], v[84:87]
 buffer_load_dwordx4 v2, s[16:19], s34 offen nt lds
 s_add_u32 s34, s34, s37
 s_waitcnt lgkmcnt(4)
 v_mfma_f32_16x16x32_bf16 v[100:103], a[4:7], a[44:47], v[100:103]
 ds_read_b64_tr_b16 a[0:1], v6 offset:53248
 v_mfma_f32_16x16x32_bf16 v[96:99], a[4:7], a[40:43], v[96:99]
 ds_read_b64_tr_b16 a[2:3], v6 offset:53760
 v_mfma_f32_16x16x32_bf16 v[92:95], a[4:7], a[36:39], v[92:95]
 ds_read_b128 a[16:19], v4 offset:34816
 s_add_u32 m0, s40, 2048
 v_mfma_f32_16x16x32_bf16 v[88:91], a[4:7], a[32:35], v[88:91]
 buffer_load_dwordx4 v2, s[16:19], s35 offen nt lds
 s_add_u32 s35, s35, s37
 s_waitcnt lgkmcnt(5)
 v_mfma_f32_16x16x32_bf16 v[104:107], a[32:35], a[8:11], v[104:107]
 ds_read_b64_tr_b16 a[4:5], v7 offset:53248
 v_mfma_f32_16x16x32_bf16 v[108:111], a[36:39], a[8:11], v[108:111]
 ds_read_b64_tr_b16 a[6:7], v7 offset:53760
 v_mfma_f32_16x16x32_bf16 v[112:115], a[40:43], a[8:11], v[112:115]
 ds_read_b128 a[20:23], v4 offset:35840
 s_mov_b32 m0, s41
 v_mfma_f32_16x16x32_bf16 v[116:119], a[44:47], a[8:11], v[116:119]
 buffer_load_dwordx4 v3, s[20:23], s36 offen sc1 nt lds
 s_add_u32 s36, s36, s38
 s_waitcnt lgkmcnt(6)
 v_mfma_f32_16x16x32_bf16 v[132:135], a[44:47], a[12:15], v[132:135]
 ds_read_b64_tr_b16 a[8:9], v8 offset:4096
 v_mfma_f32_16x16x32_bf16 v[128:131], a[40:43], a[12:15], v[128:131]
 ds_read_b64_tr_b16 a[10:11], v8 offset:4608
 v_mfma_f32_16x16x32_bf16 v[124:127], a[36:39], a[12:15], v[124:127]
 ds_read_b128 a[24:27], v4 offset:36864
 v_mfma_f32_16x16x32_bf16 v[120:123], a[32:35], a[12:15], v[120:123]
 s_cmp_eq_u32 s45, s88
 s_cselect_b64 vcc, -1, 0
 v_cndmask_b32 v15, v14, v12, vcc
 buffer_load_dword v31, v15, s[84:87], 0 offen
 s_waitcnt lgkmcnt(7)
 v_mfma_f32_16x16x32_bf16 v[136:139], a[0:3], a[32:35], v[136:139]
 ds_read_b64_tr_b16 a[12:13], v9 offset:4096
 v_mfma_f32_16x16x32_bf16 v[140:143], a[0:3], a[36:39], v[140:143]
 ds_read_b64_tr_b16 a[14:15], v9 offset:4608
 v_mfma_f32_16x16x32_bf16 v[144:147], a[0:3], a[40:43], v[144:147]
 ds_read_b128 a[28:31], v4 offset:37888
 v_mfma_f32_16x16x32_bf16 v[148:151], a[0:3], a[44:47], v[148:151]
 s_waitcnt lgkmcnt(7)
 v_mfma_f32_16x16x32_bf16 v[164:167], a[4:7], a[44:47], v[164:167]
 ds_read_b64_tr_b16 a[0:1], v6 offset:8192
 v_mfma_f32_16x16x32_bf16 v[160:163], a[4:7], a[40:43], v[160:163]
 ds_read_b64_tr_b16 a[2:3], v6 offset:8704
 v_mfma_f32_16x16x32_bf16 v[156:159], a[4:7], a[36:39], v[156:159]
 v_mfma_f32_16x16x32_bf16 v[152:155], a[4:7], a[32:35], v[152:155]
 s_waitcnt lgkmcnt(6)
 v_mfma_f32_16x16x32_bf16 v[168:171], a[8:11], a[32:35], v[168:171]
 ds_read_b64_tr_b16 a[4:5], v7 offset:8192
 v_mfma_f32_16x16x32_bf16 v[172:175], a[8:11], a[36:39], v[172:175]
 ds_read_b64_tr_b16 a[6:7], v7 offset:8704
 v_mfma_f32_16x16x32_bf16 v[176:179], a[8:11], a[40:43], v[176:179]
 v_mfma_f32_16x16x32_bf16 v[180:183], a[8:11], a[44:47], v[180:183]
 s_waitcnt lgkmcnt(5)
 v_mfma_f32_16x16x32_bf16 v[196:199], a[12:15], a[44:47], v[196:199]
 ds_read_b64_tr_b16 a[8:9], v6 offset:24576
 v_mfma_f32_16x16x32_bf16 v[192:195], a[12:15], a[40:43], v[192:195]
 ds_read_b64_tr_b16 a[10:11], v6 offset:25088
 v_mfma_f32_16x16x32_bf16 v[188:191], a[12:15], a[36:39], v[188:191]
 v_mfma_f32_16x16x32_bf16 v[184:187], a[12:15], a[32:35], v[184:187]
 s_waitcnt vmcnt(6)
 s_barrier
 s_waitcnt lgkmcnt(4)
 v_mfma_f32_16x16x32_bf16 v[40:43], a[0:3], a[16:19], v[40:43]
 ds_read_b64_tr_b16 a[12:13], v7 offset:24576
 v_mfma_f32_16x16x32_bf16 v[44:47], a[0:3], a[20:23], v[44:47]
 ds_read_b64_tr_b16 a[14:15], v7 offset:25088
 v_mfma_f32_16x16x32_bf16 v[48:51], a[0:3], a[24:27], v[48:51]
 s_add_u32 m0, s39, 17408
 v_mfma_f32_16x16x32_bf16 v[52:55], a[0:3], a[28:31], v[52:55]
 buffer_load_dwordx4 v1, s[12:15], s33 offen sc1 lds
 s_waitcnt lgkmcnt(4)
 v_mfma_f32_16x16x32_bf16 v[68:71], a[4:7], a[28:31], v[68:71]
 ds_read_b64_tr_b16 a[0:1], v6 offset:40960
 v_mfma_f32_16x16x32_bf16 v[64:67], a[4:7], a[24:27], v[64:67]
 ds_read_b64_tr_b16 a[2:3], v6 offset:41472
 v_mfma_f32_16x16x32_bf16 v[60:63], a[4:7], a[20:23], v[60:63]
 v_mfma_f32_16x16x32_bf16 v[56:59], a[4:7], a[16:19], v[56:59]
 buffer_load_dwordx4 v1, s[12:15], s33 offen offset:1024 sc1 lds
 s_add_u32 s33, s33, 2048
 s_waitcnt lgkmcnt(4)
 v_mfma_f32_16x16x32_bf16 v[72:75], a[8:11], a[16:19], v[72:75]
 ds_read_b64_tr_b16 a[4:5], v7 offset:40960
 v_mfma_f32_16x16x32_bf16 v[76:79], a[8:11], a[20:23], v[76:79]
 ds_read_b64_tr_b16 a[6:7], v7 offset:41472
 v_mfma_f32_16x16x32_bf16 v[80:83], a[8:11], a[24:27], v[80:83]
 s_add_u32 m0, s40, 4096
 v_mfma_f32_16x16x32_bf16 v[84:87], a[8:11], a[28:31], v[84:87]
 buffer_load_dwordx4 v2, s[16:19], s34 offen nt lds
 s_add_u32 s34, s34, s37
 s_waitcnt lgkmcnt(4)
 v_mfma_f32_16x16x32_bf16 v[100:103], a[12:15], a[28:31], v[100:103]
 ds_read_b64_tr_b16 a[8:9], v6 offset:57344
 v_mfma_f32_16x16x32_bf16 v[96:99], a[12:15], a[24:27], v[96:99]
 ds_read_b64_tr_b16 a[10:11], v6 offset:57856
 v_mfma_f32_16x16x32_bf16 v[92:95], a[12:15], a[20:23], v[92:95]
 ds_read_b128 a[32:35], v4 offset:52224
 s_add_u32 m0, s40, 6144
 v_mfma_f32_16x16x32_bf16 v[88:91], a[12:15], a[16:19], v[88:91]
 buffer_load_dwordx4 v2, s[16:19], s35 offen nt lds
 s_add_u32 s35, s35, s37
 s_waitcnt lgkmcnt(5)
 v_mfma_f32_16x16x32_bf16 v[104:107], a[16:19], a[0:3], v[104:107]
 ds_read_b64_tr_b16 a[12:13], v7 offset:57344
 v_mfma_f32_16x16x32_bf16 v[108:111], a[20:23], a[0:3], v[108:111]
 ds_read_b64_tr_b16 a[14:15], v7 offset:57856
 v_mfma_f32_16x16x32_bf16 v[112:115], a[24:27], a[0:3], v[112:115]
 ds_read_b128 a[36:39], v4 offset:53248
 s_mov_b32 m0, s42
 v_mfma_f32_16x16x32_bf16 v[116:119], a[28:31], a[0:3], v[116:119]
 buffer_load_dwordx4 v3, s[20:23], s36 offen sc1 nt lds
 s_add_u32 s36, s36, s38
 s_waitcnt lgkmcnt(6)
 v_mfma_f32_16x16x32_bf16 v[132:135], a[28:31], a[4:7], v[132:135]
 ds_read_b64_tr_b16 a[0:1], v8 offset:8192
 v_mfma_f32_16x16x32_bf16 v[128:131], a[24:27], a[4:7], v[128:131]
 ds_read_b64_tr_b16 a[2:3], v8 offset:8704
 v_mfma_f32_16x16x32_bf16 v[124:127], a[20:23], a[4:7], v[124:127]
 ds_read_b128 a[40:43], v4 offset:54272
 v_mfma_f32_16x16x32_bf16 v[120:123], a[16:19], a[4:7], v[120:123]
 s_waitcnt lgkmcnt(7)
 v_mfma_f32_16x16x32_bf16 v[136:139], a[8:11], a[16:19], v[136:139]
 ds_read_b64_tr_b16 a[4:5], v9 offset:8192
 v_mfma_f32_16x16x32_bf16 v[140:143], a[8:11], a[20:23], v[140:143]
 ds_read_b64_tr_b16 a[6:7], v9 offset:8704
 v_mfma_f32_16x16x32_bf16 v[144:147], a[8:11], a[24:27], v[144:147]
 ds_read_b128 a[44:47], v4 offset:55296
 v_mfma_f32_16x16x32_bf16 v[148:151], a[8:11], a[28:31], v[148:151]
 s_waitcnt lgkmcnt(7)
 v_mfma_f32_16x16x32_bf16 v[164:167], a[12:15], a[28:31], v[164:167]
 ds_read_b64_tr_b16 a[8:9], v6 offset:12288
 v_mfma_f32_16x16x32_bf16 v[160:163], a[12:15], a[24:27], v[160:163]
 ds_read_b64_tr_b16 a[10:11], v6 offset:12800
 v_mfma_f32_16x16x32_bf16 v[156:159], a[12:15], a[20:23], v[156:159]
 v_mfma_f32_16x16x32_bf16 v[152:155], a[12:15], a[16:19], v[152:155]
 s_waitcnt lgkmcnt(6)
 v_mfma_f32_16x16x32_bf16 v[168:171], a[0:3], a[16:19], v[168:171]
 ds_read_b64_tr_b16 a[12:13], v7 offset:12288
 v_mfma_f32_16x16x32_bf16 v[172:175], a[0:3], a[20:23], v[172:175]
 ds_read_b64_tr_b16 a[14:15], v7 offset:12800
 v_mfma_f32_16x16x32_bf16 v[176:179], a[0:3], a[24:27], v[176:179]
 v_mfma_f32_16x16x32_bf16 v[180:183], a[0:3], a[28:31], v[180:183]
 s_waitcnt lgkmcnt(5)
 v_mfma_f32_16x16x32_bf16 v[196:199], a[4:7], a[28:31], v[196:199]
 ds_read_b64_tr_b16 a[0:1], v6 offset:28672
 v_mfma_f32_16x16x32_bf16 v[192:195], a[4:7], a[24:27], v[192:195]
 ds_read_b64_tr_b16 a[2:3], v6 offset:29184
 v_mfma_f32_16x16x32_bf16 v[188:191], a[4:7], a[20:23], v[188:191]
 v_mfma_f32_16x16x32_bf16 v[184:187], a[4:7], a[16:19], v[184:187]
 s_waitcnt vmcnt(6)
 s_barrier
 s_waitcnt lgkmcnt(4)
 v_mfma_f32_16x16x32_bf16 v[40:43], a[8:11], a[32:35], v[40:43]
 ds_read_b64_tr_b16 a[4:5], v7 offset:28672
 v_mfma_f32_16x16x32_bf16 v[44:47], a[8:11], a[36:39], v[44:47]
 ds_read_b64_tr_b16 a[6:7], v7 offset:29184
 v_mfma_f32_16x16x32_bf16 v[48:51], a[8:11], a[40:43], v[48:51]
 s_add_u32 m0, s39, 34816
 v_mfma_f32_16x16x32_bf16 v[52:55], a[8:11], a[44:47], v[52:55]
 buffer_load_dwordx4 v1, s[12:15], s33 offen sc1 lds
 s_waitcnt lgkmcnt(4)
 v_mfma_f32_16x16x32_bf16 v[68:71], a[12:15], a[44:47], v[68:71]
 ds_read_b64_tr_b16 a[8:9], v6 offset:45056
 v_mfma_f32_16x16x32_bf16 v[64:67], a[12:15], a[40:43], v[64:67]
 ds_read_b64_tr_b16 a[10:11], v6 offset:45568
 v_mfma_f32_16x16x32_bf16 v[60:63], a[12:15], a[36:39], v[60:63]
 v_mfma_f32_16x16x32_bf16 v[56:59], a[12:15], a[32:35], v[56:59]
 buffer_load_dwordx4 v1, s[12:15], s33 offen offset:1024 sc1 lds
 s_add_u32 s33, s33, 2048
 s_waitcnt lgkmcnt(4)
 v_mfma_f32_16x16x32_bf16 v[72:75], a[0:3], a[32:35], v[72:75]
 ds_read_b64_tr_b16 a[12:13], v7 offset:45056
 v_mfma_f32_16x16x32_bf16 v[76:79], a[0:3], a[36:39], v[76:79]
 ds_read_b64_tr_b16 a[14:15], v7 offset:45568
 v_mfma_f32_16x16x32_bf16 v[80:83], a[0:3], a[40:43], v[80:83]
 s_add_u32 m0, s40, 8192
 v_mfma_f32_16x16x32_bf16 v[84:87], a[0:3], a[44:47], v[84:87]
 buffer_load_dwordx4 v2, s[16:19], s34 offen nt lds
 s_add_u32 s34, s34, s37
 s_waitcnt lgkmcnt(4)
 v_mfma_f32_16x16x32_bf16 v[100:103], a[4:7], a[44:47], v[100:103]
 ds_read_b64_tr_b16 a[0:1], v6 offset:61440
 v_mfma_f32_16x16x32_bf16 v[96:99], a[4:7], a[40:43], v[96:99]
 ds_read_b64_tr_b16 a[2:3], v6 offset:61952
 v_mfma_f32_16x16x32_bf16 v[92:95], a[4:7], a[36:39], v[92:95]
 ds_read_b128 a[16:19], v4 offset:0
 s_add_u32 m0, s40, 10240
 v_mfma_f32_16x16x32_bf16 v[88:91], a[4:7], a[32:35], v[88:91]
 buffer_load_dwordx4 v2, s[16:19], s35 offen nt lds
 s_add_u32 s35, s35, s37
 s_waitcnt lgkmcnt(5)
 v_mfma_f32_16x16x32_bf16 v[104:107], a[32:35], a[8:11], v[104:107]
 ds_read_b64_tr_b16 a[4:5], v7 offset:61440
 v_mfma_f32_16x16x32_bf16 v[108:111], a[36:39], a[8:11], v[108:111]
 ds_read_b64_tr_b16 a[6:7], v7 offset:61952
 v_mfma_f32_16x16x32_bf16 v[112:115], a[40:43], a[8:11], v[112:115]
 ds_read_b128 a[20:23], v4 offset:1024
 s_mov_b32 m0, s43
 v_mfma_f32_16x16x32_bf16 v[116:119], a[44:47], a[8:11], v[116:119]
 buffer_load_dwordx4 v3, s[20:23], s36 offen sc1 nt lds
 s_add_u32 s36, s36, s38
 s_waitcnt lgkmcnt(6)
 v_mfma_f32_16x16x32_bf16 v[132:135], a[44:47], a[12:15], v[132:135]
 ds_read_b64_tr_b16 a[8:9], v8 offset:12288
 v_mfma_f32_16x16x32_bf16 v[128:131], a[40:43], a[12:15], v[128:131]
 ds_read_b64_tr_b16 a[10:11], v8 offset:12800
 v_mfma_f32_16x16x32_bf16 v[124:127], a[36:39], a[12:15], v[124:127]
 ds_read_b128 a[24:27], v4 offset:2048
 v_mfma_f32_16x16x32_bf16 v[120:123], a[32:35], a[12:15], v[120:123]
 s_cmp_eq_u32 s45, s89
 s_cselect_b64 vcc, -1, 0
 v_cndmask_b32 v15, v14, v13, vcc
 buffer_load_dword v31, v15, s[80:83], 0 offen
 s_waitcnt lgkmcnt(7)
 v_mfma_f32_16x16x32_bf16 v[136:139], a[0:3], a[32:35], v[136:139]
 ds_read_b64_tr_b16 a[12:13], v9 offset:12288
 v_mfma_f32_16x16x32_bf16 v[140:143], a[0:3], a[36:39], v[140:143]
 ds_read_b64_tr_b16 a[14:15], v9 offset:12800
 v_mfma_f32_16x16x32_bf16 v[144:147], a[0:3], a[40:43], v[144:147]
 ds_read_b128 a[28:31], v4 offset:3072
 v_mfma_f32_16x16x32_bf16 v[148:151], a[0:3], a[44:47], v[148:151]
 s_waitcnt lgkmcnt(7)
 v_mfma_f32_16x16x32_bf16 v[164:167], a[4:7], a[44:47], v[164:167]
 ds_read_b64_tr_b16 a[0:1], v6 offset:0
 v_mfma_f32_16x16x32_bf16 v[160:163], a[4:7], a[40:43], v[160:163]
 ds_read_b64_tr_b16 a[2:3], v6 offset:512
 v_mfma_f32_16x16x32_bf16 v[156:159], a[4:7], a[36:39], v[156:159]
 v_mfma_f32_16x16x32_bf16 v[152:155], a[4:7], a[32:35], v[152:155]
 s_waitcnt lgkmcnt(6)
 v_mfma_f32_16x16x32_bf16 v[168:171], a[8:11], a[32:35], v[168:171]
 ds_read_b64_tr_b16 a[4:5], v7 offset:0
 v_mfma_f32_16x16x32_bf16 v[172:175], a[8:11], a[36:39], v[172:175]
 ds_read_b64_tr_b16 a[6:7], v7 offset:512
 v_mfma_f32_16x16x32_bf16 v[176:179], a[8:11], a[40:43], v[176:179]
 v_mfma_f32_16x16x32_bf16 v[180:183], a[8:11], a[44:47], v[180:183]
 s_waitcnt lgkmcnt(5)
 v_mfma_f32_16x16x32_bf16 v[196:199], a[12:15], a[44:47], v[196:199]
 ds_read_b64_tr_b16 a[8:9], v6 offset:16384
 v_mfma_f32_16x16x32_bf16 v[192:195], a[12:15], a[40:43], v[192:195]
 ds_read_b64_tr_b16 a[10:11], v6 offset:16896
 v_mfma_f32_16x16x32_bf16 v[188:191], a[12:15], a[36:39], v[188:191]
 v_mfma_f32_16x16x32_bf16 v[184:187], a[12:15], a[32:35], v[184:187]
 s_waitcnt vmcnt(6)
 s_barrier
 s_mov_b32 s45, 5
.p2align 3
L_loop_X_n_1:
 s_waitcnt lgkmcnt(4)
 v_mfma_f32_16x16x32_bf16 v[40:43], a[0:3], a[16:19], v[40:43]
 ds_read_b64_tr_b16 a[12:13], v7 offset:16384
 v_mfma_f32_16x16x32_bf16 v[44:47], a[0:3], a[20:23], v[44:47]
 ds_read_b64_tr_b16 a[14:15], v7 offset:16896
 v_mfma_f32_16x16x32_bf16 v[48:51], a[0:3], a[24:27], v[48:51]
 s_add_u32 m0, s39, 52224
 v_mfma_f32_16x16x32_bf16 v[52:55], a[0:3], a[28:31], v[52:55]
 buffer_load_dwordx4 v1, s[12:15], s33 offen sc1 lds
 s_waitcnt lgkmcnt(4)
 v_mfma_f32_16x16x32_bf16 v[68:71], a[4:7], a[28:31], v[68:71]
 ds_read_b64_tr_b16 a[0:1], v6 offset:32768
 v_mfma_f32_16x16x32_bf16 v[64:67], a[4:7], a[24:27], v[64:67]
 ds_read_b64_tr_b16 a[2:3], v6 offset:33280
 v_mfma_f32_16x16x32_bf16 v[60:63], a[4:7], a[20:23], v[60:63]
 v_mfma_f32_16x16x32_bf16 v[56:59], a[4:7], a[16:19], v[56:59]
 buffer_load_dwordx4 v1, s[12:15], s33 offen offset:1024 sc1 lds
 s_add_u32 s33, s33, 2048
 s_waitcnt lgkmcnt(4)
 v_mfma_f32_16x16x32_bf16 v[72:75], a[8:11], a[16:19], v[72:75]
 ds_read_b64_tr_b16 a[4:5], v7 offset:32768
 v_mfma_f32_16x16x32_bf16 v[76:79], a[8:11], a[20:23], v[76:79]
 ds_read_b64_tr_b16 a[6:7], v7 offset:33280
 v_mfma_f32_16x16x32_bf16 v[80:83], a[8:11], a[24:27], v[80:83]
 s_add_u32 m0, s40, 12288
 v_mfma_f32_16x16x32_bf16 v[84:87], a[8:11], a[28:31], v[84:87]
 buffer_load_dwordx4 v2, s[16:19], s34 offen nt lds
 s_add_u32 s34, s34, s37
 s_waitcnt lgkmcnt(4)
 v_mfma_f32_16x16x32_bf16 v[100:103], a[12:15], a[28:31], v[100:103]
 ds_read_b64_tr_b16 a[8:9], v6 offset:49152
 v_mfma_f32_16x16x32_bf16 v[96:99], a[12:15], a[24:27], v[96:99]
 ds_read_b64_tr_b16 a[10:11], v6 offset:49664
 v_mfma_f32_16x16x32_bf16 v[92:95], a[12:15], a[20:23], v[92:95]
 ds_read_b128 a[32:35], v4 offset:17408
 s_add_u32 m0, s40, 14336
 v_mfma_f32_16x16x32_bf16 v[88:91], a[12:15], a[16:19], v[88:91]
 buffer_load_dwordx4 v2, s[16:19], s35 offen nt lds
 s_add_u32 s35, s35, s37
 s_waitcnt lgkmcnt(5)
 v_mfma_f32_16x16x32_bf16 v[104:107], a[16:19], a[0:3], v[104:107]
 ds_read_b64_tr_b16 a[12:13], v7 offset:49152
 v_mfma_f32_16x16x32_bf16 v[108:111], a[20:23], a[0:3], v[108:111]
 ds_read_b64_tr_b16 a[14:15], v7 offset:49664
 v_mfma_f32_16x16x32_bf16 v[112:115], a[24:27], a[0:3], v[112:115]
 ds_read_b128 a[36:39], v4 offset:18432
 s_mov_b32 m0, s44
 v_mfma_f32_16x16x32_bf16 v[116:119], a[28:31], a[0:3], v[116:119]
 buffer_load_dwordx4 v3, s[20:23], s36 offen sc1 nt lds
 s_add_u32 s36, s36, s38
 s_waitcnt lgkmcnt(6)
 v_mfma_f32_16x16x32_bf16 v[132:135], a[28:31], a[4:7], v[132:135]
 ds_read_b64_tr_b16 a[0:1], v8 offset:0
 v_mfma_f32_16x16x32_bf16 v[128:131], a[24:27], a[4:7], v[128:131]
 ds_read_b64_tr_b16 a[2:3], v8 offset:512
 v_mfma_f32_16x16x32_bf16 v[124:127], a[20:23], a[4:7], v[124:127]
 ds_read_b128 a[40:43], v4 offset:19456
 v_mfma_f32_16x16x32_bf16 v[120:123], a[16:19], a[4:7], v[120:123]
 s_waitcnt lgkmcnt(7)
 v_mfma_f32_16x16x32_bf16 v[136:139], a[8:11], a[16:19], v[136:139]
 ds_read_b64_tr_b16 a[4:5], v9 offset:0
 v_mfma_f32_16x16x32_bf16 v[140:143], a[8:11], a[20:23], v[140:143]
 ds_read_b64_tr_b16 a[6:7], v9 offset:512
 v_mfma_f32_16x16x32_bf16 v[144:147], a[8:11], a[24:27], v[144:147]
 ds_read_b128 a[44:47], v4 offset:20480
 v_mfma_f32_16x16x32_bf16 v[148:151], a[8:11], a[28:31], v[148:151]
 s_waitcnt lgkmcnt(7)
 v_mfma_f32_16x16x32_bf16 v[164:167], a[12:15], a[28:31], v[164:167]
 ds_read_b64_tr_b16 a[8:9], v6 offset:4096
 v_mfma_f32_16x16x32_bf16 v[160:163], a[12:15], a[24:27], v[160:163]
 ds_read_b64_tr_b16 a[10:11], v6 offset:4608
 v_mfma_f32_16x16x32_bf16 v[156:159], a[12:15], a[20:23], v[156:159]
 v_mfma_f32_16x16x32_bf16 v[152:155], a[12:15], a[16:19], v[152:155]
 s_waitcnt lgkmcnt(6)
 v_mfma_f32_16x16x32_bf16 v[168:171], a[0:3], a[16:19], v[168:171]
 ds_read_b64_tr_b16 a[12:13], v7 offset:4096
 v_mfma_f32_16x16x32_bf16 v[172:175], a[0:3], a[20:23], v[172:175]
 ds_read_b64_tr_b16 a[14:15], v7 offset:4608
 v_mfma_f32_16x16x32_bf16 v[176:179], a[0:3], a[24:27], v[176:179]
 v_mfma_f32_16x16x32_bf16 v[180:183], a[0:3], a[28:31], v[180:183]
 s_waitcnt lgkmcnt(5)
 v_mfma_f32_16x16x32_bf16 v[196:199], a[4:7], a[28:31], v[196:199]
 ds_read_b64_tr_b16 a[0:1], v6 offset:20480
 v_mfma_f32_16x16x32_bf16 v[192:195], a[4:7], a[24:27], v[192:195]
 ds_read_b64_tr_b16 a[2:3], v6 offset:20992
 v_mfma_f32_16x16x32_bf16 v[188:191], a[4:7], a[20:23], v[188:191]
 v_mfma_f32_16x16x32_bf16 v[184:187], a[4:7], a[16:19], v[184:187]
 s_waitcnt vmcnt(6)
 s_barrier
 s_waitcnt lgkmcnt(4)
 v_mfma_f32_16x16x32_bf16 v[40:43], a[8:11], a[32:35], v[40:43]
 ds_read_b64_tr_b16 a[4:5], v7 offset:20480
 v_mfma_f32_16x16x32_bf16 v[44:47], a[8:11], a[36:39], v[44:47]
 ds_read_b64_tr_b16 a[6:7], v7 offset:20992
 v_mfma_f32_16x16x32_bf16 v[48:51], a[8:11], a[40:43], v[48:51]
 s_add_u32 m0, s39, 0
 v_mfma_f32_16x16x32_bf16 v[52:55], a[8:11], a[44:47], v[52:55]
 buffer_load_dwordx4 v1, s[12:15], s33 offen sc1 lds
 s_waitcnt lgkmcnt(4)
 v_mfma_f32_16x16x32_bf16 v[68:71], a[12:15], a[44:47], v[68:71]
 ds_read_b64_tr_b16 a[8:9], v6 offset:36864
 v_mfma_f32_16x16x32_bf16 v[64:67], a[12:15], a[40:43], v[64:67]
 ds_read_b64_tr_b16 a[10:11], v6 offset:37376
 v_mfma_f32_16x16x32_bf16 v[60:63], a[12:15], a[36:39], v[60:63]
 v_mfma_f32_16x16x32_bf16 v[56:59], a[12:15], a[32:35], v[56:59]
 buffer_load_dwordx4 v1, s[12:15], s33 offen offset:1024 sc1 lds
 s_add_u32 s33, s33, 2048
 s_waitcnt lgkmcnt(4)
 v_mfma_f32_16x16x32_bf16 v[72:75], a[0:3], a[32:35], v[72:75]
 ds_read_b64_tr_b16 a[12:13], v7 offset:36864
 v_mfma_f32_16x16x32_bf16 v[76:79], a[0:3], a[36:39], v[76:79]
 ds_read_b64_tr_b16 a[14:15], v7 offset:37376
 v_mfma_f32_16x16x32_bf16 v[80:83], a[0:3], a[40:43], v[80:83]
 s_add_u32 m0, s40, 0
 v_mfma_f32_16x16x32_bf16 v[84:87], a[0:3], a[44:47], v[84:87]
 buffer_load_dwordx4 v2, s[16:19], s34 offen nt lds
 s_add_u32 s34, s34, s37
 s_waitcnt lgkmcnt(4)
 v_mfma_f32_16x16x32_bf16 v[100:103], a[4:7], a[44:47], v[100:103]
 ds_read_b64_tr_b16 a[0:1], v6 offset:53248
 v_mfma_f32_16x16x32_bf16 v[96:99], a[4:7], a[40:43], v[96:99]
 ds_read_b64_tr_b16 a[2:3], v6 offset:53760
 v_mfma_f32_16x16x32_bf16 v[92:95], a[4:7], a[36:39], v[92:95]
 ds_read_b128 a[16:19], v4 offset:34816
 s_add_u32 m0, s40, 2048
 v_mfma_f32_16x16x32_bf16 v[88:91], a[4:7], a[32:35], v[88:91]
 buffer_load_dwordx4 v2, s[16:19], s35 offen nt lds
 s_add_u32 s35, s35, s37
 s_waitcnt lgkmcnt(5)
 v_mfma_f32_16x16x32_bf16 v[104:107], a[32:35], a[8:11], v[104:107]
 ds_read_b64_tr_b16 a[4:5], v7 offset:53248
 v_mfma_f32_16x16x32_bf16 v[108:111], a[36:39], a[8:11], v[108:111]
 ds_read_b64_tr_b16 a[6:7], v7 offset:53760
 v_mfma_f32_16x16x32_bf16 v[112:115], a[40:43], a[8:11], v[112:115]
 ds_read_b128 a[20:23], v4 offset:35840
 s_mov_b32 m0, s41
 v_mfma_f32_16x16x32_bf16 v[116:119], a[44:47], a[8:11], v[116:119]
 buffer_load_dwordx4 v3, s[20:23], s36 offen sc1 nt lds
 s_add_u32 s36, s36, s38
 s_waitcnt lgkmcnt(6)
 v_mfma_f32_16x16x32_bf16 v[132:135], a[44:47], a[12:15], v[132:135]
 ds_read_b64_tr_b16 a[8:9], v8 offset:4096
 v_mfma_f32_16x16x32_bf16 v[128:131], a[40:43], a[12:15], v[128:131]
 ds_read_b64_tr_b16 a[10:11], v8 offset:4608
 v_mfma_f32_16x16x32_bf16 v[124:127], a[36:39], a[12:15], v[124:127]
 ds_read_b128 a[24:27], v4 offset:36864
 v_mfma_f32_16x16x32_bf16 v[120:123], a[32:35], a[12:15], v[120:123]
 s_cmp_eq_u32 s45, s88
 s_cselect_b64 vcc, -1, 0
 v_cndmask_b32 v15, v14, v12, vcc
 buffer_load_dword v31, v15, s[84:87], 0 offen
 s_waitcnt lgkmcnt(7)
 v_mfma_f32_16x16x32_bf16 v[136:139], a[0:3], a[32:35], v[136:139]
 ds_read_b64_tr_b16 a[12:13], v9 offset:4096
 v_mfma_f32_16x16x32_bf16 v[140:143], a[0:3], a[36:39], v[140:143]
 ds_read_b64_tr_b16 a[14:15], v9 offset:4608
 v_mfma_f32_16x16x32_bf16 v[144:147], a[0:3], a[40:43], v[144:147]
 ds_read_b128 a[28:31], v4 offset:37888
 v_mfma_f32_16x16x32_bf16 v[148:151], a[0:3], a[44:47], v[148:151]
 s_waitcnt lgkmcnt(7)
 v_mfma_f32_16x16x32_bf16 v[164:167], a[4:7], a[44:47], v[164:167]
 ds_read_b64_tr_b16 a[0:1], v6 offset:8192
 v_mfma_f32_16x16x32_bf16 v[160:163], a[4:7], a[40:43], v[160:163]
 ds_read_b64_tr_b16 a[2:3], v6 offset:8704
 v_mfma_f32_16x16x32_bf16 v[156:159], a[4:7], a[36:39], v[156:159]
 v_mfma_f32_16x16x32_bf16 v[152:155], a[4:7], a[32:35], v[152:155]
 s_waitcnt lgkmcnt(6)
 v_mfma_f32_16x16x32_bf16 v[168:171], a[8:11], a[32:35], v[168:171]
 ds_read_b64_tr_b16 a[4:5], v7 offset:8192
 v_mfma_f32_16x16x32_bf16 v[172:175], a[8:11], a[36:39], v[172:175]
 ds_read_b64_tr_b16 a[6:7], v7 offset:8704
 v_mfma_f32_16x16x32_bf16 v[176:179], a[8:11], a[40:43], v[176:179]
 v_mfma_f32_16x16x32_bf16 v[180:183], a[8:11], a[44:47], v[180:183]
 s_waitcnt lgkmcnt(5)
 v_mfma_f32_16x16x32_bf16 v[196:199], a[12:15], a[44:47], v[196:199]
 ds_read_b64_tr_b16 a[8:9], v6 offset:24576
 v_mfma_f32_16x16x32_bf16 v[192:195], a[12:15], a[40:43], v[192:195]
 ds_read_b64_tr_b16 a[10:11], v6 offset:25088
 v_mfma_f32_16x16x32_bf16 v[188:191], a[12:15], a[36:39], v[188:191]
 v_mfma_f32_16x16x32_bf16 v[184:187], a[12:15], a[32:35], v[184:187]
 s_waitcnt vmcnt(6)
 s_barrier
 s_waitcnt lgkmcnt(4)
 v_mfma_f32_16x16x32_bf16 v[40:43], a[0:3], a[16:19], v[40:43]
 ds_read_b64_tr_b16 a[12:13], v7 offset:24576
 v_mfma_f32_16x16x32_bf16 v[44:47], a[0:3], a[20:23], v[44:47]
 ds_read_b64_tr_b16 a[14:15], v7 offset:25088
 v_mfma_f32_16x16x32_bf16 v[48:51], a[0:3], a[24:27], v[48:51]
 s_add_u32 m0, s39, 17408
 v_mfma_f32_16x16x32_bf16 v[52:55], a[0:3], a[28:31], v[52:55]
 buffer_load_dwordx4 v1, s[12:15], s33 offen sc1 lds
 s_waitcnt lgkmcnt(4)
 v_mfma_f32_16x16x32_bf16 v[68:71], a[4:7], a[28:31], v[68:71]
 ds_read_b64_tr_b16 a[0:1], v6 offset:40960
 v_mfma_f32_16x16x32_bf16 v[64:67], a[4:7], a[24:27], v[64:67]
 ds_read_b64_tr_b16 a[2:3], v6 offset:41472
 v_mfma_f32_16x16x32_bf16 v[60:63], a[4:7], a[20:23], v[60:63]
 v_mfma_f32_16x16x32_bf16 v[56:59], a[4:7], a[16:19], v[56:59]
 buffer_load_dwordx4 v1, s[12:15], s33 offen offset:1024 sc1 lds
 s_add_u32 s33, s33, 2048
 s_waitcnt lgkmcnt(4)
 v_mfma_f32_16x16x32_bf16 v[72:75], a[8:11], a[16:19], v[72:75]
 ds_read_b64_tr_b16 a[4:5], v7 offset:40960
 v_mfma_f32_16x16x32_bf16 v[76:79], a[8:11], a[20:23], v[76:79]
 ds_read_b64_tr_b16 a[6:7], v7 offset:41472
 v_mfma_f32_16x16x32_bf16 v[80:83], a[8:11], a[24:27], v[80:83]
 s_add_u32 m0, s40, 4096
 v_mfma_f32_16x16x32_bf16 v[84:87], a[8:11], a[28:31], v[84:87]
 buffer_load_dwordx4 v2, s[16:19], s34 offen nt lds
 s_add_u32 s34, s34, s37
 s_waitcnt lgkmcnt(4)
 v_mfma_f32_16x16x32_bf16 v[100:103], a[12:15], a[28:31], v[100:103]
 ds_read_b64_tr_b16 a[8:9], v6 offset:57344
 v_mfma_f32_16x16x32_bf16 v[96:99], a[12:15], a[24:27], v[96:99]
 ds_read_b64_tr_b16 a[10:11], v6 offset:57856
 v_mfma_f32_16x16x32_bf16 v[92:95], a[12:15], a[20:23], v[92:95]
 ds_read_b128 a[32:35], v4 offset:52224
 s_add_u32 m0, s40, 6144
 v_mfma_f32_16x16x32_bf16 v[88:91], a[12:15], a[16:19], v[88:91]
 buffer_load_dwordx4 v2, s[16:19], s35 offen nt lds
 s_add_u32 s35, s35, s37
 s_waitcnt lgkmcnt(5)
 v_mfma_f32_16x16x32_bf16 v[104:107], a[16:19], a[0:3], v[104:107]
 ds_read_b64_tr_b16 a[12:13], v7 offset:57344
 v_mfma_f32_16x16x32_bf16 v[108:111], a[20:23], a[0:3], v[108:111]
 ds_read_b64_tr_b16 a[14:15], v7 offset:57856
 v_mfma_f32_16x16x32_bf16 v[112:115], a[24:27], a[0:3], v[112:115]
 ds_read_b128 a[36:39], v4 offset:53248
 s_mov_b32 m0, s42
 v_mfma_f32_16x16x32_bf16 v[116:119], a[28:31], a[0:3], v[116:119]
 buffer_load_dwordx4 v3, s[20:23], s36 offen sc1 nt lds
 s_add_u32 s36, s36, s38
 s_waitcnt lgkmcnt(6)
 v_mfma_f32_16x16x32_bf16 v[132:135], a[28:31], a[4:7], v[132:135]
 ds_read_b64_tr_b16 a[0:1], v8 offset:8192
 v_mfma_f32_16x16x32_bf16 v[128:131], a[24:27], a[4:7], v[128:131]
 ds_read_b64_tr_b16 a[2:3], v8 offset:8704
 v_mfma_f32_16x16x32_bf16 v[124:127], a[20:23], a[4:7], v[124:127]
 ds_read_b128 a[40:43], v4 offset:54272
 v_mfma_f32_16x16x32_bf16 v[120:123], a[16:19], a[4:7], v[120:123]
 s_waitcnt lgkmcnt(7)
 v_mfma_f32_16x16x32_bf16 v[136:139], a[8:11], a[16:19], v[136:139]
 ds_read_b64_tr_b16 a[4:5], v9 offset:8192
 v_mfma_f32_16x16x32_bf16 v[140:143], a[8:11], a[20:23], v[140:143]
 ds_read_b64_tr_b16 a[6:7], v9 offset:8704
 v_mfma_f32_16x16x32_bf16 v[144:147], a[8:11], a[24:27], v[144:147]
 ds_read_b128 a[44:47], v4 offset:55296
 v_mfma_f32_16x16x32_bf16 v[148:151], a[8:11], a[28:31], v[148:151]
 s_waitcnt lgkmcnt(7)
 v_mfma_f32_16x16x32_bf16 v[164:167], a[12:15], a[28:31], v[164:167]
 ds_read_b64_tr_b16 a[8:9], v6 offset:12288
 v_mfma_f32_16x16x32_bf16 v[160:163], a[12:15], a[24:27], v[160:163]
 ds_read_b64_tr_b16 a[10:11], v6 offset:12800
 v_mfma_f32_16x16x32_bf16 v[156:159], a[12:15], a[20:23], v[156:159]
 v_mfma_f32_16x16x32_bf16 v[152:155], a[12:15], a[16:19], v[152:155]
 s_waitcnt lgkmcnt(6)
 v_mfma_f32_16x16x32_bf16 v[168:171], a[0:3], a[16:19], v[168:171]
 ds_read_b64_tr_b16 a[12:13], v7 offset:12288
 v_mfma_f32_16x16x32_bf16 v[172:175], a[0:3], a[20:23], v[172:175]
 ds_read_b64_tr_b16 a[14:15], v7 offset:12800
 v_mfma_f32_16x16x32_bf16 v[176:179], a[0:3], a[24:27], v[176:179]
 v_mfma_f32_16x16x32_bf16 v[180:183], a[0:3], a[28:31], v[180:183]
 s_waitcnt lgkmcnt(5)
 v_mfma_f32_16x16x32_bf16 v[196:199], a[4:7], a[28:31], v[196:199]
 ds_read_b64_tr_b16 a[0:1], v6 offset:28672
 v_mfma_f32_16x16x32_bf16 v[192:195], a[4:7], a[24:27], v[192:195]
 ds_read_b64_tr_b16 a[2:3], v6 offset:29184
 v_mfma_f32_16x16x32_bf16 v[188:191], a[4:7], a[20:23], v[188:191]
 v_mfma_f32_16x16x32_bf16 v[184:187], a[4:7], a[16:19], v[184:187]
 s_waitcnt vmcnt(6)
 s_barrier
 s_waitcnt lgkmcnt(4)
 v_mfma_f32_16x16x32_bf16 v[40:43], a[8:11], a[32:35], v[40:43]
 ds_read_b64_tr_b16 a[4:5], v7 offset:28672
 v_mfma_f32_16x16x32_bf16 v[44:47], a[8:11], a[36:39], v[44:47]
 ds_read_b64_tr_b16 a[6:7], v7 offset:29184
 v_mfma_f32_16x16x32_bf16 v[48:51], a[8:11], a[40:43], v[48:51]
 s_add_u32 m0, s39, 34816
 v_mfma_f32_16x16x32_bf16 v[52:55], a[8:11], a[44:47], v[52:55]
 buffer_load_dwordx4 v1, s[12:15], s33 offen sc1 lds
 s_waitcnt lgkmcnt(4)
 v_mfma_f32_16x16x32_bf16 v[68:71], a[12:15], a[44:47], v[68:71]
 ds_read_b64_tr_b16 a[8:9], v6 offset:45056
 v_mfma_f32_16x16x32_bf16 v[64:67], a[12:15], a[40:43], v[64:67]
 ds_read_b64_tr_b16 a[10:11], v6 offset:45568
 v_mfma_f32_16x16x32_bf16 v[60:63], a[12:15], a[36:39], v[60:63]
 v_mfma_f32_16x16x32_bf16 v[56:59], a[12:15], a[32:35], v[56:59]
 buffer_load_dwordx4 v1, s[12:15], s33 offen offset:1024 sc1 lds
 s_add_u32 s33, s33, 2048
 s_waitcnt lgkmcnt(4)
 v_mfma_f32_16x16x32_bf16 v[72:75], a[0:3], a[32:35], v[72:75]
 ds_read_b64_tr_b16 a[12:13], v7 offset:45056
 v_mfma_f32_16x16x32_bf16 v[76:79], a[0:3], a[36:39], v[76:79]
 ds_read_b64_tr_b16 a[14:15], v7 offset:45568
 v_mfma_f32_16x16x32_bf16 v[80:83], a[0:3], a[40:43], v[80:83]
 s_add_u32 m0, s40, 8192
 v_mfma_f32_16x16x32_bf16 v[84:87], a[0:3], a[44:47], v[84:87]
 buffer_load_dwordx4 v2, s[16:19], s34 offen nt lds
 s_add_u32 s34, s34, s37
 s_waitcnt lgkmcnt(4)
 v_mfma_f32_16x16x32_bf16 v[100:103], a[4:7], a[44:47], v[100:103]
 ds_read_b64_tr_b16 a[0:1], v6 offset:61440
 v_mfma_f32_16x16x32_bf16 v[96:99], a[4:7], a[40:43], v[96:99]
 ds_read_b64_tr_b16 a[2:3], v6 offset:61952
 v_mfma_f32_16x16x32_bf16 v[92:95], a[4:7], a[36:39], v[92:95]
 ds_read_b128 a[16:19], v4 offset:0
 s_add_u32 m0, s40, 10240
 v_mfma_f32_16x16x32_bf16 v[88:91], a[4:7], a[32:35], v[88:91]
 buffer_load_dwordx4 v2, s[16:19], s35 offen nt lds
 s_add_u32 s35, s35, s37
 s_waitcnt lgkmcnt(5)
 v_mfma_f32_16x16x32_bf16 v[104:107], a[32:35], a[8:11], v[104:107]
 ds_read_b64_tr_b16 a[4:5], v7 offset:61440
 v_mfma_f32_16x16x32_bf16 v[108:111], a[36:39], a[8:11], v[108:111]
 ds_read_b64_tr_b16 a[6:7], v7 offset:61952
 v_mfma_f32_16x16x32_bf16 v[112:115], a[40:43], a[8:11], v[112:115]
 ds_read_b128 a[20:23], v4 offset:1024
 s_mov_b32 m0, s43
 v_mfma_f32_16x16x32_bf16 v[116:119], a[44:47], a[8:11], v[116:119]
 buffer_load_dwordx4 v3, s[20:23], s36 offen sc1 nt lds
 s_add_u32 s36, s36, s38
 s_waitcnt lgkmcnt(6)
 v_mfma_f32_16x16x32_bf16 v[132:135], a[44:47], a[12:15], v[132:135]
 ds_read_b64_tr_b16 a[8:9], v8 offset:12288
 v_mfma_f32_16x16x32_bf16 v[128:131], a[40:43], a[12:15], v[128:131]
 ds_read_b64_tr_b16 a[10:11], v8 offset:12800
 v_mfma_f32_16x16x32_bf16 v[124:127], a[36:39], a[12:15], v[124:127]
 ds_read_b128 a[24:27], v4 offset:2048
 v_mfma_f32_16x16x32_bf16 v[120:123], a[32:35], a[12:15], v[120:123]
 s_cmp_eq_u32 s45, s89
 s_cselect_b64 vcc, -1, 0
 v_cndmask_b32 v15, v14, v13, vcc
 buffer_load_dword v31, v15, s[80:83], 0 offen
 s_waitcnt lgkmcnt(7)
 v_mfma_f32_16x16x32_bf16 v[136:139], a[0:3], a[32:35], v[136:139]
 ds_read_b64_tr_b16 a[12:13], v9 offset:12288
 v_mfma_f32_16x16x32_bf16 v[140:143], a[0:3], a[36:39], v[140:143]
 ds_read_b64_tr_b16 a[14:15], v9 offset:12800
 v_mfma_f32_16x16x32_bf16 v[144:147], a[0:3], a[40:43], v[144:147]
 ds_read_b128 a[28:31], v4 offset:3072
 v_mfma_f32_16x16x32_bf16 v[148:151], a[0:3], a[44:47], v[148:151]
 s_waitcnt lgkmcnt(7)
 v_mfma_f32_16x16x32_bf16 v[164:167], a[4:7], a[44:47], v[164:167]
 ds_read_b64_tr_b16 a[0:1], v6 offset:0
 v_mfma_f32_16x16x32_bf16 v[160:163], a[4:7], a[40:43], v[160:163]
 ds_read_b64_tr_b16 a[2:3], v6 offset:512
 v_mfma_f32_16x16x32_bf16 v[156:159], a[4:7], a[36:39], v[156:159]
 v_mfma_f32_16x16x32_bf16 v[152:155], a[4:7], a[32:35], v[152:155]
 s_waitcnt lgkmcnt(6)
 v_mfma_f32_16x16x32_bf16 v[168:171], a[8:11], a[32:35], v[168:171]
 ds_read_b64_tr_b16 a[4:5], v7 offset:0
 v_mfma_f32_16x16x32_bf16 v[172:175], a[8:11], a[36:39], v[172:175]
 ds_read_b64_tr_b16 a[6:7], v7 offset:512
 v_mfma_f32_16x16x32_bf16 v[176:179], a[8:11], a[40:43], v[176:179]
 v_mfma_f32_16x16x32_bf16 v[180:183], a[8:11], a[44:47], v[180:183]
 s_waitcnt lgkmcnt(5)
 v_mfma_f32_16x16x32_bf16 v[196:199], a[12:15], a[44:47], v[196:199]
 ds_read_b64_tr_b16 a[8:9], v6 offset:16384
 v_mfma_f32_16x16x32_bf16 v[192:195], a[12:15], a[40:43], v[192:195]
 ds_read_b64_tr_b16 a[10:11], v6 offset:16896
 v_mfma_f32_16x16x32_bf16 v[188:191], a[12:15], a[36:39], v[188:191]
 v_mfma_f32_16x16x32_bf16 v[184:187], a[12:15], a[32:35], v[184:187]
 s_waitcnt vmcnt(6)
 s_barrier
 s_sub_u32 s45, s45, 1
 s_cmp_lg_u32 s45, 0
 s_cbranch_scc1 L_loop_X_n_1
 s_waitcnt lgkmcnt(4)
 v_mfma_f32_16x16x32_bf16 v[40:43], a[0:3], a[16:19], v[40:43]
 ds_read_b64_tr_b16 a[12:13], v7 offset:16384
 v_mfma_f32_16x16x32_bf16 v[44:47], a[0:3], a[20:23], v[44:47]
 ds_read_b64_tr_b16 a[14:15], v7 offset:16896
 v_mfma_f32_16x16x32_bf16 v[48:51], a[0:3], a[24:27], v[48:51]
 s_add_u32 m0, s39, 52224
 v_mfma_f32_16x16x32_bf16 v[52:55], a[0:3], a[28:31], v[52:55]
 buffer_load_dwordx4 v1, s[12:15], s33 offen sc1 lds
 s_waitcnt lgkmcnt(4)
 v_mfma_f32_16x16x32_bf16 v[68:71], a[4:7], a[28:31], v[68:71]
 ds_read_b64_tr_b16 a[0:1], v6 offset:32768
 v_mfma_f32_16x16x32_bf16 v[64:67], a[4:7], a[24:27], v[64:67]
 ds_read_b64_tr_b16 a[2:3], v6 offset:33280
 v_mfma_f32_16x16x32_bf16 v[60:63], a[4:7], a[20:23], v[60:63]
 v_mfma_f32_16x16x32_bf16 v[56:59], a[4:7], a[16:19], v[56:59]
 buffer_load_dwordx4 v1, s[12:15], s33 offen offset:1024 sc1 lds
 s_add_u32 s33, s33, 2048
 s_waitcnt lgkmcnt(4)
 v_mfma_f32_16x16x32_bf16 v[72:75], a[8:11], a[16:19], v[72:75]
 ds_read_b64_tr_b16 a[4:5], v7 offset:32768
 v_mfma_f32_16x16x32_bf16 v[76:79], a[8:11], a[20:23], v[76:79]
 ds_read_b64_tr_b16 a[6:7], v7 offset:33280
 v_mfma_f32_16x16x32_bf16 v[80:83], a[8:11], a[24:27], v[80:83]
 s_add_u32 m0, s40, 12288
 v_mfma_f32_16x16x32_bf16 v[84:87], a[8:11], a[28:31], v[84:87]
 buffer_load_dwordx4 v2, s[16:19], s34 offen nt lds
 s_add_u32 s34, s34, s37
 s_waitcnt lgkmcnt(4)
 v_mfma_f32_16x16x32_bf16 v[100:103], a[12:15], a[28:31], v[100:103]
 ds_read_b64_tr_b16 a[8:9], v6 offset:49152
 v_mfma_f32_16x16x32_bf16 v[96:99], a[12:15], a[24:27], v[96:99]
 ds_read_b64_tr_b16 a[10:11], v6 offset:49664
 v_mfma_f32_16x16x32_bf16 v[92:95], a[12:15], a[20:23], v[92:95]
 ds_read_b128 a[32:35], v4 offset:17408
 s_add_u32 m0, s40, 14336
 v_mfma_f32_16x16x32_bf16 v[88:91], a[12:15], a[16:19], v[88:91]
 buffer_load_dwordx4 v2, s[16:19], s35 offen nt lds
 s_add_u32 s35, s35, s37
 s_waitcnt lgkmcnt(5)
 v_mfma_f32_16x16x32_bf16 v[104:107], a[16:19], a[0:3], v[104:107]
 ds_read_b64_tr_b16 a[12:13], v7 offset:49152
 v_mfma_f32_16x16x32_bf16 v[108:111], a[20:23], a[0:3], v[108:111]
 ds_read_b64_tr_b16 a[14:15], v7 offset:49664
 v_mfma_f32_16x16x32_bf16 v[112:115], a[24:27], a[0:3], v[112:115]
 ds_read_b128 a[36:39], v4 offset:18432
 s_mov_b32 m0, s44
 v_mfma_f32_16x16x32_bf16 v[116:119], a[28:31], a[0:3], v[116:119]
 buffer_load_dwordx4 v3, s[20:23], s36 offen sc1 nt lds
 s_add_u32 s36, s36, s38
 s_waitcnt lgkmcnt(6)
 v_mfma_f32_16x16x32_bf16 v[132:135], a[28:31], a[4:7], v[132:135]
 ds_read_b64_tr_b16 a[0:1], v8 offset:0
 v_mfma_f32_16x16x32_bf16 v[128:131], a[24:27], a[4:7], v[128:131]
 ds_read_b64_tr_b16 a[2:3], v8 offset:512
 v_mfma_f32_16x16x32_bf16 v[124:127], a[20:23], a[4:7], v[124:127]
 ds_read_b128 a[40:43], v4 offset:19456
 v_mfma_f32_16x16x32_bf16 v[120:123], a[16:19], a[4:7], v[120:123]
 s_waitcnt lgkmcnt(7)
 v_mfma_f32_16x16x32_bf16 v[136:139], a[8:11], a[16:19], v[136:139]
 ds_read_b64_tr_b16 a[4:5], v9 offset:0
 v_mfma_f32_16x16x32_bf16 v[140:143], a[8:11], a[20:23], v[140:143]
 ds_read_b64_tr_b16 a[6:7], v9 offset:512
 v_mfma_f32_16x16x32_bf16 v[144:147], a[8:11], a[24:27], v[144:147]
 ds_read_b128 a[44:47], v4 offset:20480
 v_mfma_f32_16x16x32_bf16 v[148:151], a[8:11], a[28:31], v[148:151]
 s_waitcnt lgkmcnt(7)
 v_mfma_f32_16x16x32_bf16 v[164:167], a[12:15], a[28:31], v[164:167]
 ds_read_b64_tr_b16 a[8:9], v6 offset:4096
 v_mfma_f32_16x16x32_bf16 v[160:163], a[12:15], a[24:27], v[160:163]
 ds_read_b64_tr_b16 a[10:11], v6 offset:4608
 v_mfma_f32_16x16x32_bf16 v[156:159], a[12:15], a[20:23], v[156:159]
 v_mfma_f32_16x16x32_bf16 v[152:155], a[12:15], a[16:19], v[152:155]
 s_waitcnt lgkmcnt(6)
 v_mfma_f32_16x16x32_bf16 v[168:171], a[0:3], a[16:19], v[168:171]
 ds_read_b64_tr_b16 a[12:13], v7 offset:4096
 v_mfma_f32_16x16x32_bf16 v[172:175], a[0:3], a[20:23], v[172:175]
 ds_read_b64_tr_b16 a[14:15], v7 offset:4608
 v_mfma_f32_16x16x32_bf16 v[176:179], a[0:3], a[24:27], v[176:179]
 v_mfma_f32_16x16x32_bf16 v[180:183], a[0:3], a[28:31], v[180:183]
 s_waitcnt lgkmcnt(5)
 v_mfma_f32_16x16x32_bf16 v[196:199], a[4:7], a[28:31], v[196:199]
 ds_read_b64_tr_b16 a[0:1], v6 offset:20480
 v_mfma_f32_16x16x32_bf16 v[192:195], a[4:7], a[24:27], v[192:195]
 ds_read_b64_tr_b16 a[2:3], v6 offset:20992
 v_mfma_f32_16x16x32_bf16 v[188:191], a[4:7], a[20:23], v[188:191]
 v_mfma_f32_16x16x32_bf16 v[184:187], a[4:7], a[16:19], v[184:187]
 s_waitcnt vmcnt(6)
 s_barrier
 s_waitcnt lgkmcnt(4)
 v_mfma_f32_16x16x32_bf16 v[40:43], a[8:11], a[32:35], v[40:43]
 ds_read_b64_tr_b16 a[4:5], v7 offset:20480
 v_mfma_f32_16x16x32_bf16 v[44:47], a[8:11], a[36:39], v[44:47]
 ds_read_b64_tr_b16 a[6:7], v7 offset:20992
 v_mfma_f32_16x16x32_bf16 v[48:51], a[8:11], a[40:43], v[48:51]
 s_add_u32 m0, s39, 0
 v_mfma_f32_16x16x32_bf16 v[52:55], a[8:11], a[44:47], v[52:55]
 buffer_load_dwordx4 v1, s[12:15], s33 offen sc1 lds
 s_waitcnt lgkmcnt(4)
 v_mfma_f32_16x16x32_bf16 v[68:71], a[12:15], a[44:47], v[68:71]
 ds_read_b64_tr_b16 a[8:9], v6 offset:36864
 v_mfma_f32_16x16x32_bf16 v[64:67], a[12:15], a[40:43], v[64:67]
 ds_read_b64_tr_b16 a[10:11], v6 offset:37376
 v_mfma_f32_16x16x32_bf16 v[60:63], a[12:15], a[36:39], v[60:63]
 v_mfma_f32_16x16x32_bf16 v[56:59], a[12:15], a[32:35], v[56:59]
 buffer_load_dwordx4 v1, s[12:15], s33 offen offset:1024 sc1 lds
 s_add_u32 s33, s33, 2048
 s_waitcnt lgkmcnt(4)
 v_mfma_f32_16x16x32_bf16 v[72:75], a[0:3], a[32:35], v[72:75]
 ds_read_b64_tr_b16 a[12:13], v7 offset:36864
 v_mfma_f32_16x16x32_bf16 v[76:79], a[0:3], a[36:39], v[76:79]
 ds_read_b64_tr_b16 a[14:15], v7 offset:37376
 v_mfma_f32_16x16x32_bf16 v[80:83], a[0:3], a[40:43], v[80:83]
 s_add_u32 m0, s40, 0
 v_mfma_f32_16x16x32_bf16 v[84:87], a[0:3], a[44:47], v[84:87]
 buffer_load_dwordx4 v2, s[16:19], s34 offen nt lds
 s_add_u32 s34, s34, s37
 s_waitcnt lgkmcnt(4)
 v_mfma_f32_16x16x32_bf16 v[100:103], a[4:7], a[44:47], v[100:103]
 ds_read_b64_tr_b16 a[0:1], v6 offset:53248
 v_mfma_f32_16x16x32_bf16 v[96:99], a[4:7], a[40:43], v[96:99]
 ds_read_b64_tr_b16 a[2:3], v6 offset:53760
 v_mfma_f32_16x16x32_bf16 v[92:95], a[4:7], a[36:39], v[92:95]
 ds_read_b128 a[16:19], v4 offset:34816
 s_add_u32 m0, s40, 2048
 v_mfma_f32_16x16x32_bf16 v[88:91], a[4:7], a[32:35], v[88:91]
 buffer_load_dwordx4 v2, s[16:19], s35 offen nt lds
 s_add_u32 s35, s35, s37
 s_waitcnt lgkmcnt(5)
 v_mfma_f32_16x16x32_bf16 v[104:107], a[32:35], a[8:11], v[104:107]
 ds_read_b64_tr_b16 a[4:5], v7 offset:53248
 v_mfma_f32_16x16x32_bf16 v[108:111], a[36:39], a[8:11], v[108:111]
 ds_read_b64_tr_b16 a[6:7], v7 offset:53760
 v_mfma_f32_16x16x32_bf16 v[112:115], a[40:43], a[8:11], v[112:115]
 ds_read_b128 a[20:23], v4 offset:35840
 s_mov_b32 m0, s41
 v_mfma_f32_16x16x32_bf16 v[116:119], a[44:47], a[8:11], v[116:119]
 buffer_load_dwordx4 v3, s[20:23], s36 offen sc1 nt lds
 s_add_u32 s36, s36, s38
 s_waitcnt lgkmcnt(6)
 v_mfma_f32_16x16x32_bf16 v[132:135], a[44:47], a[12:15], v[132:135]
 ds_read_b64_tr_b16 a[8:9], v8 offset:4096
 v_mfma_f32_16x16x32_bf16 v[128:131], a[40:43], a[12:15], v[128:131]
 ds_read_b64_tr_b16 a[10:11], v8 offset:4608
 v_mfma_f32_16x16x32_bf16 v[124:127], a[36:39], a[12:15], v[124:127]
 ds_read_b128 a[24:27], v4 offset:36864
 v_mfma_f32_16x16x32_bf16 v[120:123], a[32:35], a[12:15], v[120:123]
 s_waitcnt lgkmcnt(7)
 v_mfma_f32_16x16x32_bf16 v[136:139], a[0:3], a[32:35], v[136:139]
 ds_read_b64_tr_b16 a[12:13], v9 offset:4096
 v_mfma_f32_16x16x32_bf16 v[140:143], a[0:3], a[36:39], v[140:143]
 ds_read_b64_tr_b16 a[14:15], v9 offset:4608
 v_mfma_f32_16x16x32_bf16 v[144:147], a[0:3], a[40:43], v[144:147]
 ds_read_b128 a[28:31], v4 offset:37888
 v_mfma_f32_16x16x32_bf16 v[148:151], a[0:3], a[44:47], v[148:151]
 s_waitcnt lgkmcnt(7)
 v_mfma_f32_16x16x32_bf16 v[164:167], a[4:7], a[44:47], v[164:167]
 ds_read_b64_tr_b16 a[0:1], v6 offset:8192
 v_mfma_f32_16x16x32_bf16 v[160:163], a[4:7], a[40:43], v[160:163]
 ds_read_b64_tr_b16 a[2:3], v6 offset:8704
 v_mfma_f32_16x16x32_bf16 v[156:159], a[4:7], a[36:39], v[156:159]
 v_mfma_f32_16x16x32_bf16 v[152:155], a[4:7], a[32:35], v[152:155]
 s_waitcnt lgkmcnt(6)
 v_mfma_f32_16x16x32_bf16 v[168:171], a[8:11], a[32:35], v[168:171]
 ds_read_b64_tr_b16 a[4:5], v7 offset:8192
 v_mfma_f32_16x16x32_bf16 v[172:175], a[8:11], a[36:39], v[172:175]
 ds_read_b64_tr_b16 a[6:7], v7 offset:8704
 v_mfma_f32_16x16x32_bf16 v[176:179], a[8:11], a[40:43], v[176:179]
 v_mfma_f32_16x16x32_bf16 v[180:183], a[8:11], a[44:47], v[180:183]
 s_waitcnt lgkmcnt(5)
 v_mfma_f32_16x16x32_bf16 v[196:199], a[12:15], a[44:47], v[196:199]
 ds_read_b64_tr_b16 a[8:9], v6 offset:24576
 v_mfma_f32_16x16x32_bf16 v[192:195], a[12:15], a[40:43], v[192:195]
 ds_read_b64_tr_b16 a[10:11], v6 offset:25088
 v_mfma_f32_16x16x32_bf16 v[188:191], a[12:15], a[36:39], v[188:191]
 v_mfma_f32_16x16x32_bf16 v[184:187], a[12:15], a[32:35], v[184:187]
 s_waitcnt vmcnt(5)
 s_barrier
 s_waitcnt lgkmcnt(4)
 v_mfma_f32_16x16x32_bf16 v[40:43], a[0:3], a[16:19], v[40:43]
 ds_read_b64_tr_b16 a[12:13], v7 offset:24576
 v_mfma_f32_16x16x32_bf16 v[44:47], a[0:3], a[20:23], v[44:47]
 ds_read_b64_tr_b16 a[14:15], v7 offset:25088
 v_mfma_f32_16x16x32_bf16 v[48:51], a[0:3], a[24:27], v[48:51]
 s_add_u32 m0, s39, 17408
 v_mfma_f32_16x16x32_bf16 v[52:55], a[0:3], a[28:31], v[52:55]
 buffer_load_dwordx4 v1, s[12:15], s33 offen sc1 lds
 s_waitcnt lgkmcnt(4)
 v_mfma_f32_16x16x32_bf16 v[68:71], a[4:7], a[28:31], v[68:71]
 ds_read_b64_tr_b16 a[0:1], v6 offset:40960
 v_mfma_f32_16x16x32_bf16 v[64:67], a[4:7], a[24:27], v[64:67]
 ds_read_b64_tr_b16 a[2:3], v6 offset:41472
 v_mfma_f32_16x16x32_bf16 v[60:63], a[4:7], a[20:23], v[60:63]
 v_mfma_f32_16x16x32_bf16 v[56:59], a[4:7], a[16:19], v[56:59]
 buffer_load_dwordx4 v1, s[12:15], s33 offen offset:1024 sc1 lds
 s_add_u32 s33, s33, 2048
 s_waitcnt lgkmcnt(4)
 v_mfma_f32_16x16x32_bf16 v[72:75], a[8:11], a[16:19], v[72:75]
 ds_read_b64_tr_b16 a[4:5], v7 offset:40960
 v_mfma_f32_16x16x32_bf16 v[76:79], a[8:11], a[20:23], v[76:79]
 ds_read_b64_tr_b16 a[6:7], v7 offset:41472
 v_mfma_f32_16x16x32_bf16 v[80:83], a[8:11], a[24:27], v[80:83]
 s_add_u32 m0, s40, 4096
 v_mfma_f32_16x16x32_bf16 v[84:87], a[8:11], a[28:31], v[84:87]
 buffer_load_dwordx4 v2, s[16:19], s34 offen nt lds
 s_add_u32 s34, s34, s37
 s_waitcnt lgkmcnt(4)
 v_mfma_f32_16x16x32_bf16 v[100:103], a[12:15], a[28:31], v[100:103]
 ds_read_b64_tr_b16 a[8:9], v6 offset:57344
 v_mfma_f32_16x16x32_bf16 v[96:99], a[12:15], a[24:27], v[96:99]
 ds_read_b64_tr_b16 a[10:11], v6 offset:57856
 v_mfma_f32_16x16x32_bf16 v[92:95], a[12:15], a[20:23], v[92:95]
 ds_read_b128 a[32:35], v4 offset:52224
 s_add_u32 m0, s40, 6144
 v_mfma_f32_16x16x32_bf16 v[88:91], a[12:15], a[16:19], v[88:91]
 buffer_load_dwordx4 v2, s[16:19], s35 offen nt lds
 s_add_u32 s35, s35, s37
 s_waitcnt lgkmcnt(5)
 v_mfma_f32_16x16x32_bf16 v[104:107], a[16:19], a[0:3], v[104:107]
 ds_read_b64_tr_b16 a[12:13], v7 offset:57344
 v_mfma_f32_16x16x32_bf16 v[108:111], a[20:23], a[0:3], v[108:111]
 ds_read_b64_tr_b16 a[14:15], v7 offset:57856
 v_mfma_f32_16x16x32_bf16 v[112:115], a[24:27], a[0:3], v[112:115]
 ds_read_b128 a[36:39], v4 offset:53248
 s_mov_b32 m0, s42
 v_mfma_f32_16x16x32_bf16 v[116:119], a[28:31], a[0:3], v[116:119]
 buffer_load_dwordx4 v3, s[20:23], s36 offen sc1 nt lds
 s_add_u32 s36, s36, s38
 s_waitcnt lgkmcnt(6)
 v_mfma_f32_16x16x32_bf16 v[132:135], a[28:31], a[4:7], v[132:135]
 ds_read_b64_tr_b16 a[0:1], v8 offset:8192
 v_mfma_f32_16x16x32_bf16 v[128:131], a[24:27], a[4:7], v[128:131]
 ds_read_b64_tr_b16 a[2:3], v8 offset:8704
 v_mfma_f32_16x16x32_bf16 v[124:127], a[20:23], a[4:7], v[124:127]
 ds_read_b128 a[40:43], v4 offset:54272
 v_mfma_f32_16x16x32_bf16 v[120:123], a[16:19], a[4:7], v[120:123]
 s_waitcnt lgkmcnt(7)
 v_mfma_f32_16x16x32_bf16 v[136:139], a[8:11], a[16:19], v[136:139]
 ds_read_b64_tr_b16 a[4:5], v9 offset:8192
 v_mfma_f32_16x16x32_bf16 v[140:143], a[8:11], a[20:23], v[140:143]
 ds_read_b64_tr_b16 a[6:7], v9 offset:8704
 v_mfma_f32_16x16x32_bf16 v[144:147], a[8:11], a[24:27], v[144:147]
 ds_read_b128 a[44:47], v4 offset:55296
 v_mfma_f32_16x16x32_bf16 v[148:151], a[8:11], a[28:31], v[148:151]
 s_waitcnt lgkmcnt(7)
 v_mfma_f32_16x16x32_bf16 v[164:167], a[12:15], a[28:31], v[164:167]
 ds_read_b64_tr_b16 a[8:9], v6 offset:12288
 v_mfma_f32_16x16x32_bf16 v[160:163], a[12:15], a[24:27], v[160:163]
 ds_read_b64_tr_b16 a[10:11], v6 offset:12800
 v_mfma_f32_16x16x32_bf16 v[156:159], a[12:15], a[20:23], v[156:159]
 v_mfma_f32_16x16x32_bf16 v[152:155], a[12:15], a[16:19], v[152:155]
 s_waitcnt lgkmcnt(6)
 v_mfma_f32_16x16x32_bf16 v[168:171], a[0:3], a[16:19], v[168:171]
 ds_read_b64_tr_b16 a[12:13], v7 offset:12288
 v_mfma_f32_16x16x32_bf16 v[172:175], a[0:3], a[20:23], v[172:175]
 ds_read_b64_tr_b16 a[14:15], v7 offset:12800
 v_mfma_f32_16x16x32_bf16 v[176:179], a[0:3], a[24:27], v[176:179]
 v_mfma_f32_16x16x32_bf16 v[180:183], a[0:3], a[28:31], v[180:183]
 s_waitcnt lgkmcnt(5)
 v_mfma_f32_16x16x32_bf16 v[196:199], a[4:7], a[28:31], v[196:199]
 ds_read_b64_tr_b16 a[0:1], v6 offset:28672
 v_mfma_f32_16x16x32_bf16 v[192:195], a[4:7], a[24:27], v[192:195]
 ds_read_b64_tr_b16 a[2:3], v6 offset:29184
 v_mfma_f32_16x16x32_bf16 v[188:191], a[4:7], a[20:23], v[188:191]
 v_mfma_f32_16x16x32_bf16 v[184:187], a[4:7], a[16:19], v[184:187]
 s_waitcnt vmcnt(5)
 s_barrier
 s_waitcnt lgkmcnt(4)
 v_mfma_f32_16x16x32_bf16 v[40:43], a[8:11], a[32:35], v[40:43]
 ds_read_b64_tr_b16 a[4:5], v7 offset:28672
 v_mfma_f32_16x16x32_bf16 v[44:47], a[8:11], a[36:39], v[44:47]
 ds_read_b64_tr_b16 a[6:7], v7 offset:29184
 v_mfma_f32_16x16x32_bf16 v[48:51], a[8:11], a[40:43], v[48:51]
 s_add_u32 m0, s39, 34816
 v_mfma_f32_16x16x32_bf16 v[52:55], a[8:11], a[44:47], v[52:55]
 buffer_load_dwordx4 v1, s[12:15], s33 offen sc1 lds
 s_waitcnt lgkmcnt(4)
 v_mfma_f32_16x16x32_bf16 v[68:71], a[12:15], a[44:47], v[68:71]
 ds_read_b64_tr_b16 a[8:9], v6 offset:45056
 v_mfma_f32_16x16x32_bf16 v[64:67], a[12:15], a[40:43], v[64:67]
 ds_read_b64_tr_b16 a[10:11], v6 offset:45568
 v_mfma_f32_16x16x32_bf16 v[60:63], a[12:15], a[36:39], v[60:63]
 v_mfma_f32_16x16x32_bf16 v[56:59], a[12:15], a[32:35], v[56:59]
 buffer_load_dwordx4 v1, s[12:15], s33 offen offset:1024 sc1 lds
 s_add_u32 s33, s33, 2048
 s_waitcnt lgkmcnt(4)
 v_mfma_f32_16x16x32_bf16 v[72:75], a[0:3], a[32:35], v[72:75]
 ds_read_b64_tr_b16 a[12:13], v7 offset:45056
 v_mfma_f32_16x16x32_bf16 v[76:79], a[0:3], a[36:39], v[76:79]
 ds_read_b64_tr_b16 a[14:15], v7 offset:45568
 v_mfma_f32_16x16x32_bf16 v[80:83], a[0:3], a[40:43], v[80:83]
 s_add_u32 m0, s40, 8192
 v_mfma_f32_16x16x32_bf16 v[84:87], a[0:3], a[44:47], v[84:87]
 buffer_load_dwordx4 v2, s[16:19], s34 offen nt lds
 s_add_u32 s34, s34, s37
 s_waitcnt lgkmcnt(4)
 v_mfma_f32_16x16x32_bf16 v[100:103], a[4:7], a[44:47], v[100:103]
 ds_read_b64_tr_b16 a[0:1], v6 offset:61440
 v_mfma_f32_16x16x32_bf16 v[96:99], a[4:7], a[40:43], v[96:99]
 ds_read_b64_tr_b16 a[2:3], v6 offset:61952
 v_mfma_f32_16x16x32_bf16 v[92:95], a[4:7], a[36:39], v[92:95]
 ds_read_b128 a[16:19], v4 offset:0
 s_add_u32 m0, s40, 10240
 v_mfma_f32_16x16x32_bf16 v[88:91], a[4:7], a[32:35], v[88:91]
 buffer_load_dwordx4 v2, s[16:19], s35 offen nt lds
 s_add_u32 s35, s35, s37
 s_waitcnt lgkmcnt(5)
 v_mfma_f32_16x16x32_bf16 v[104:107], a[32:35], a[8:11], v[104:107]
 ds_read_b64_tr_b16 a[4:5], v7 offset:61440
 v_mfma_f32_16x16x32_bf16 v[108:111], a[36:39], a[8:11], v[108:111]
 ds_read_b64_tr_b16 a[6:7], v7 offset:61952
 v_mfma_f32_16x16x32_bf16 v[112:115], a[40:43], a[8:11], v[112:115]
 ds_read_b128 a[20:23], v4 offset:1024
 s_mov_b32 m0, s43
 v_mfma_f32_16x16x32_bf16 v[116:119], a[44:47], a[8:11], v[116:119]
 buffer_load_dwordx4 v3, s[20:23], s36 offen sc1 nt lds
 s_add_u32 s36, s36, s38
 s_waitcnt lgkmcnt(6)
 v_mfma_f32_16x16x32_bf16 v[132:135], a[44:47], a[12:15], v[132:135]
 ds_read_b64_tr_b16 a[8:9], v8 offset:12288
 v_mfma_f32_16x16x32_bf16 v[128:131], a[40:43], a[12:15], v[128:131]
 ds_read_b64_tr_b16 a[10:11], v8 offset:12800
 v_mfma_f32_16x16x32_bf16 v[124:127], a[36:39], a[12:15], v[124:127]
 ds_read_b128 a[24:27], v4 offset:2048
 v_mfma_f32_16x16x32_bf16 v[120:123], a[32:35], a[12:15], v[120:123]
 s_waitcnt lgkmcnt(7)
 v_mfma_f32_16x16x32_bf16 v[136:139], a[0:3], a[32:35], v[136:139]
 ds_read_b64_tr_b16 a[12:13], v9 offset:12288
 v_mfma_f32_16x16x32_bf16 v[140:143], a[0:3], a[36:39], v[140:143]
 ds_read_b64_tr_b16 a[14:15], v9 offset:12800
 v_mfma_f32_16x16x32_bf16 v[144:147], a[0:3], a[40:43], v[144:147]
 ds_read_b128 a[28:31], v4 offset:3072
 v_mfma_f32_16x16x32_bf16 v[148:151], a[0:3], a[44:47], v[148:151]
 s_waitcnt lgkmcnt(7)
 v_mfma_f32_16x16x32_bf16 v[164:167], a[4:7], a[44:47], v[164:167]
 ds_read_b64_tr_b16 a[0:1], v6 offset:0
 v_mfma_f32_16x16x32_bf16 v[160:163], a[4:7], a[40:43], v[160:163]
 ds_read_b64_tr_b16 a[2:3], v6 offset:512
 v_mfma_f32_16x16x32_bf16 v[156:159], a[4:7], a[36:39], v[156:159]
 v_mfma_f32_16x16x32_bf16 v[152:155], a[4:7], a[32:35], v[152:155]
 s_waitcnt lgkmcnt(6)
 v_mfma_f32_16x16x32_bf16 v[168:171], a[8:11], a[32:35], v[168:171]
 ds_read_b64_tr_b16 a[4:5], v7 offset:0
 v_mfma_f32_16x16x32_bf16 v[172:175], a[8:11], a[36:39], v[172:175]
 ds_read_b64_tr_b16 a[6:7], v7 offset:512
 v_mfma_f32_16x16x32_bf16 v[176:179], a[8:11], a[40:43], v[176:179]
 v_mfma_f32_16x16x32_bf16 v[180:183], a[8:11], a[44:47], v[180:183]
 s_waitcnt lgkmcnt(5)
 v_mfma_f32_16x16x32_bf16 v[196:199], a[12:15], a[44:47], v[196:199]
 ds_read_b64_tr_b16 a[8:9], v6 offset:16384
 v_mfma_f32_16x16x32_bf16 v[192:195], a[12:15], a[40:43], v[192:195]
 ds_read_b64_tr_b16 a[10:11], v6 offset:16896
 v_mfma_f32_16x16x32_bf16 v[188:191], a[12:15], a[36:39], v[188:191]
 v_mfma_f32_16x16x32_bf16 v[184:187], a[12:15], a[32:35], v[184:187]
 s_waitcnt vmcnt(5)
 s_barrier
 s_waitcnt lgkmcnt(4)
 v_mfma_f32_16x16x32_bf16 v[40:43], a[0:3], a[16:19], v[40:43]
 ds_read_b64_tr_b16 a[12:13], v7 offset:16384
 v_mfma_f32_16x16x32_bf16 v[44:47], a[0:3], a[20:23], v[44:47]
 ds_read_b64_tr_b16 a[14:15], v7 offset:16896
 v_mfma_f32_16x16x32_bf16 v[48:51], a[0:3], a[24:27], v[48:51]
 s_add_u32 m0, s39, 52224
 v_mfma_f32_16x16x32_bf16 v[52:55], a[0:3], a[28:31], v[52:55]
 buffer_load_dwordx4 v1, s[12:15], s33 offen sc1 lds
 s_waitcnt lgkmcnt(4)
 v_mfma_f32_16x16x32_bf16 v[68:71], a[4:7], a[28:31], v[68:71]
 ds_read_b64_tr_b16 a[0:1], v6 offset:32768
 v_mfma_f32_16x16x32_bf16 v[64:67], a[4:7], a[24:27], v[64:67]
 ds_read_b64_tr_b16 a[2:3], v6 offset:33280
 v_mfma_f32_16x16x32_bf16 v[60:63], a[4:7], a[20:23], v[60:63]
 v_mfma_f32_16x16x32_bf16 v[56:59], a[4:7], a[16:19], v[56:59]
 buffer_load_dwordx4 v1, s[12:15], s33 offen offset:1024 sc1 lds
 s_add_u32 s33, s33, 2048
 s_waitcnt lgkmcnt(4)
 v_mfma_f32_16x16x32_bf16 v[72:75], a[8:11], a[16:19], v[72:75]
 ds_read_b64_tr_b16 a[4:5], v7 offset:32768
 v_mfma_f32_16x16x32_bf16 v[76:79], a[8:11], a[20:23], v[76:79]
 ds_read_b64_tr_b16 a[6:7], v7 offset:33280
 v_mfma_f32_16x16x32_bf16 v[80:83], a[8:11], a[24:27], v[80:83]
 s_add_u32 m0, s40, 12288
 v_mfma_f32_16x16x32_bf16 v[84:87], a[8:11], a[28:31], v[84:87]
 buffer_load_dwordx4 v2, s[16:19], s34 offen nt lds
 s_add_u32 s34, s34, s37
 s_waitcnt lgkmcnt(4)
 v_mfma_f32_16x16x32_bf16 v[100:103], a[12:15], a[28:31], v[100:103]
 ds_read_b64_tr_b16 a[8:9], v6 offset:49152
 v_mfma_f32_16x16x32_bf16 v[96:99], a[12:15], a[24:27], v[96:99]
 ds_read_b64_tr_b16 a[10:11], v6 offset:49664
 v_mfma_f32_16x16x32_bf16 v[92:95], a[12:15], a[20:23], v[92:95]
 ds_read_b128 a[32:35], v4 offset:17408
 s_add_u32 m0, s40, 14336
 v_mfma_f32_16x16x32_bf16 v[88:91], a[12:15], a[16:19], v[88:91]
 buffer_load_dwordx4 v2, s[16:19], s35 offen nt lds
 s_add_u32 s35, s35, s37
 s_waitcnt lgkmcnt(5)
 v_mfma_f32_16x16x32_bf16 v[104:107], a[16:19], a[0:3], v[104:107]
 ds_read_b64_tr_b16 a[12:13], v7 offset:49152
 v_mfma_f32_16x16x32_bf16 v[108:111], a[20:23], a[0:3], v[108:111]
 ds_read_b64_tr_b16 a[14:15], v7 offset:49664
 v_mfma_f32_16x16x32_bf16 v[112:115], a[24:27], a[0:3], v[112:115]
 ds_read_b128 a[36:39], v4 offset:18432
 s_mov_b32 m0, s44
 v_mfma_f32_16x16x32_bf16 v[116:119], a[28:31], a[0:3], v[116:119]
 buffer_load_dwordx4 v3, s[20:23], s36 offen sc1 nt lds
 s_add_u32 s36, s36, s38
 s_waitcnt lgkmcnt(6)
 v_mfma_f32_16x16x32_bf16 v[132:135], a[28:31], a[4:7], v[132:135]
 ds_read_b64_tr_b16 a[0:1], v8 offset:0
 v_mfma_f32_16x16x32_bf16 v[128:131], a[24:27], a[4:7], v[128:131]
 ds_read_b64_tr_b16 a[2:3], v8 offset:512
 v_mfma_f32_16x16x32_bf16 v[124:127], a[20:23], a[4:7], v[124:127]
 ds_read_b128 a[40:43], v4 offset:19456
 v_mfma_f32_16x16x32_bf16 v[120:123], a[16:19], a[4:7], v[120:123]
 s_waitcnt lgkmcnt(7)
 v_mfma_f32_16x16x32_bf16 v[136:139], a[8:11], a[16:19], v[136:139]
 ds_read_b64_tr_b16 a[4:5], v9 offset:0
 v_mfma_f32_16x16x32_bf16 v[140:143], a[8:11], a[20:23], v[140:143]
 ds_read_b64_tr_b16 a[6:7], v9 offset:512
 v_mfma_f32_16x16x32_bf16 v[144:147], a[8:11], a[24:27], v[144:147]
 ds_read_b128 a[44:47], v4 offset:20480
 v_mfma_f32_16x16x32_bf16 v[148:151], a[8:11], a[28:31], v[148:151]
 s_waitcnt lgkmcnt(7)
 v_mfma_f32_16x16x32_bf16 v[164:167], a[12:15], a[28:31], v[164:167]
 ds_read_b64_tr_b16 a[8:9], v6 offset:4096
 v_mfma_f32_16x16x32_bf16 v[160:163], a[12:15], a[24:27], v[160:163]
 ds_read_b64_tr_b16 a[10:11], v6 offset:4608
 v_mfma_f32_16x16x32_bf16 v[156:159], a[12:15], a[20:23], v[156:159]
 v_mfma_f32_16x16x32_bf16 v[152:155], a[12:15], a[16:19], v[152:155]
 s_waitcnt lgkmcnt(6)
 v_mfma_f32_16x16x32_bf16 v[168:171], a[0:3], a[16:19], v[168:171]
 ds_read_b64_tr_b16 a[12:13], v7 offset:4096
 v_mfma_f32_16x16x32_bf16 v[172:175], a[0:3], a[20:23], v[172:175]
 ds_read_b64_tr_b16 a[14:15], v7 offset:4608
 v_mfma_f32_16x16x32_bf16 v[176:179], a[0:3], a[24:27], v[176:179]
 v_mfma_f32_16x16x32_bf16 v[180:183], a[0:3], a[28:31], v[180:183]
 s_waitcnt lgkmcnt(5)
 v_mfma_f32_16x16x32_bf16 v[196:199], a[4:7], a[28:31], v[196:199]
 ds_read_b64_tr_b16 a[0:1], v6 offset:20480
 v_mfma_f32_16x16x32_bf16 v[192:195], a[4:7], a[24:27], v[192:195]
 ds_read_b64_tr_b16 a[2:3], v6 offset:20992
 v_mfma_f32_16x16x32_bf16 v[188:191], a[4:7], a[20:23], v[188:191]
 v_mfma_f32_16x16x32_bf16 v[184:187], a[4:7], a[16:19], v[184:187]
 s_waitcnt vmcnt(5)
 s_barrier
 s_waitcnt lgkmcnt(4)
 v_mfma_f32_16x16x32_bf16 v[40:43], a[8:11], a[32:35], v[40:43]
 ds_read_b64_tr_b16 a[4:5], v7 offset:20480
 v_mfma_f32_16x16x32_bf16 v[44:47], a[8:11], a[36:39], v[44:47]
 ds_read_b64_tr_b16 a[6:7], v7 offset:20992
 v_mfma_f32_16x16x32_bf16 v[48:51], a[8:11], a[40:43], v[48:51]
 v_mfma_f32_16x16x32_bf16 v[52:55], a[8:11], a[44:47], v[52:55]
 s_waitcnt lgkmcnt(4)
 v_mfma_f32_16x16x32_bf16 v[68:71], a[12:15], a[44:47], v[68:71]
 ds_read_b64_tr_b16 a[8:9], v6 offset:36864
 v_mfma_f32_16x16x32_bf16 v[64:67], a[12:15], a[40:43], v[64:67]
 ds_read_b64_tr_b16 a[10:11], v6 offset:37376
 v_mfma_f32_16x16x32_bf16 v[60:63], a[12:15], a[36:39], v[60:63]
 v_mfma_f32_16x16x32_bf16 v[56:59], a[12:15], a[32:35], v[56:59]
 s_waitcnt lgkmcnt(4)
 v_mfma_f32_16x16x32_bf16 v[72:75], a[0:3], a[32:35], v[72:75]
 ds_read_b64_tr_b16 a[12:13], v7 offset:36864
 v_mfma_f32_16x16x32_bf16 v[76:79], a[0:3], a[36:39], v[76:79]
 ds_read_b64_tr_b16 a[14:15], v7 offset:37376
 v_mfma_f32_16x16x32_bf16 v[80:83], a[0:3], a[40:43], v[80:83]
 v_mfma_f32_16x16x32_bf16 v[84:87], a[0:3], a[44:47], v[84:87]
 s_waitcnt lgkmcnt(4)
 v_mfma_f32_16x16x32_bf16 v[100:103], a[4:7], a[44:47], v[100:103]
 ds_read_b64_tr_b16 a[0:1], v6 offset:53248
 v_mfma_f32_16x16x32_bf16 v[96:99], a[4:7], a[40:43], v[96:99]
 ds_read_b64_tr_b16 a[2:3], v6 offset:53760
 v_mfma_f32_16x16x32_bf16 v[92:95], a[4:7], a[36:39], v[92:95]
 ds_read_b128 a[16:19], v4 offset:34816
 v_mfma_f32_16x16x32_bf16 v[88:91], a[4:7], a[32:35], v[88:91]
 s_waitcnt lgkmcnt(5)
 v_mfma_f32_16x16x32_bf16 v[104:107], a[32:35], a[8:11], v[104:107]
 ds_read_b64_tr_b16 a[4:5], v7 offset:53248
 v_mfma_f32_16x16x32_bf16 v[108:111], a[36:39], a[8:11], v[108:111]
 ds_read_b64_tr_b16 a[6:7], v7 offset:53760
 v_mfma_f32_16x16x32_bf16 v[112:115], a[40:43], a[8:11], v[112:115]
 ds_read_b128 a[20:23], v4 offset:35840
 v_mfma_f32_16x16x32_bf16 v[116:119], a[44:47], a[8:11], v[116:119]
 s_waitcnt lgkmcnt(6)
 v_mfma_f32_16x16x32_bf16 v[132:135], a[44:47], a[12:15], v[132:135]
 ds_read_b64_tr_b16 a[8:9], v8 offset:4096
 v_mfma_f32_16x16x32_bf16 v[128:131], a[40:43], a[12:15], v[128:131]
 ds_read_b64_tr_b16 a[10:11], v8 offset:4608
 v_mfma_f32_16x16x32_bf16 v[124:127], a[36:39], a[12:15], v[124:127]
 ds_read_b128 a[24:27], v4 offset:36864
 v_mfma_f32_16x16x32_bf16 v[120:123], a[32:35], a[12:15], v[120:123]
 s_waitcnt lgkmcnt(7)
 v_mfma_f32_16x16x32_bf16 v[136:139], a[0:3], a[32:35], v[136:139]
 ds_read_b64_tr_b16 a[12:13], v9 offset:4096
 v_mfma_f32_16x16x32_bf16 v[140:143], a[0:3], a[36:39], v[140:143]
 ds_read_b64_tr_b16 a[14:15], v9 offset:4608
 v_mfma_f32_16x16x32_bf16 v[144:147], a[0:3], a[40:43], v[144:147]
 ds_read_b128 a[28:31], v4 offset:37888
 v_mfma_f32_16x16x32_bf16 v[148:151], a[0:3], a[44:47], v[148:151]
 s_waitcnt lgkmcnt(7)
 v_mfma_f32_16x16x32_bf16 v[164:167], a[4:7], a[44:47], v[164:167]
 ds_read_b64_tr_b16 a[0:1], v6 offset:8192
 v_mfma_f32_16x16x32_bf16 v[160:163], a[4:7], a[40:43], v[160:163]
 ds_read_b64_tr_b16 a[2:3], v6 offset:8704
 v_mfma_f32_16x16x32_bf16 v[156:159], a[4:7], a[36:39], v[156:159]
 v_mfma_f32_16x16x32_bf16 v[152:155], a[4:7], a[32:35], v[152:155]
 s_waitcnt lgkmcnt(6)
 v_mfma_f32_16x16x32_bf16 v[168:171], a[8:11], a[32:35], v[168:171]
 ds_read_b64_tr_b16 a[4:5], v7 offset:8192
 v_mfma_f32_16x16x32_bf16 v[172:175], a[8:11], a[36:39], v[172:175]
 ds_read_b64_tr_b16 a[6:7], v7 offset:8704
 v_mfma_f32_16x16x32_bf16 v[176:179], a[8:11], a[40:43], v[176:179]
 v_mfma_f32_16x16x32_bf16 v[180:183], a[8:11], a[44:47], v[180:183]
 s_waitcnt lgkmcnt(5)
 v_mfma_f32_16x16x32_bf16 v[196:199], a[12:15], a[44:47], v[196:199]
 ds_read_b64_tr_b16 a[8:9], v6 offset:24576
 v_mfma_f32_16x16x32_bf16 v[192:195], a[12:15], a[40:43], v[192:195]
 ds_read_b64_tr_b16 a[10:11], v6 offset:25088
 v_mfma_f32_16x16x32_bf16 v[188:191], a[12:15], a[36:39], v[188:191]
 v_mfma_f32_16x16x32_bf16 v[184:187], a[12:15], a[32:35], v[184:187]
 s_waitcnt vmcnt(0)
 s_barrier
 s_load_dwordx2 s[12:13], s[0:1], 16
 s_load_dwordx2 s[16:17], s[0:1], 48
 s_load_dwordx2 s[8:9], s[0:1], 0
 s_load_dwordx2 s[40:41], s[0:1], 56
 s_and_b32 s56, s2, 7
 s_lshr_b32 s34, s56, 2
 s_lshr_b32 s57, s2, 3
 s_bfe_u32 s58, s56, 0x10001
 s_lshl_b32 s58, s58, 3
 s_and_b32 s39, s57, 7
 s_add_u32 s39, s39, s58
 s_and_b32 s58, s56, 1
 s_lshl_b32 s58, s58, 2
 s_lshr_b32 s57, s57, 3
 s_add_u32 s33, s57, s58
 s_lshr_b32 s94, s39, 1
 s_waitcnt lgkmcnt(0)
 s_and_b32 s13, s13, 0xffff
 s_mov_b32 s14, 2097152
 s_mov_b32 s15, 0x20000
 s_and_b32 s17, s17, 0xffff
 s_mov_b32 s18, 7340032
 s_mov_b32 s19, 0x20000
 s_and_b32 s9, s9, 0xffff
 s_mov_b32 s10, 4194304
 s_mov_b32 s11, 0x20000
 s_and_b32 s41, s41, 0xffff
 s_mov_b32 s42, 4194304
 s_mov_b32 s43, 0x20000
 s_add_u32 s20, s6, 25165824
 s_addc_u32 s21, s7, 0
 s_and_b32 s21, s21, 0xffff
 s_mov_b32 s22, 4194304
 s_mov_b32 s23, 0x20000
 s_waitcnt lgkmcnt(4)
 v_mfma_f32_16x16x32_bf16 v[40:43], a[0:3], a[16:19], v[40:43]
 ds_read_b64_tr_b16 a[12:13], v7 offset:24576
 v_mfma_f32_16x16x32_bf16 v[44:47], a[0:3], a[20:23], v[44:47]
 ds_read_b64_tr_b16 a[14:15], v7 offset:25088
 v_mfma_f32_16x16x32_bf16 v[48:51], a[0:3], a[24:27], v[48:51]
 v_mfma_f32_16x16x32_bf16 v[52:55], a[0:3], a[28:31], v[52:55]
 s_waitcnt lgkmcnt(4)
 v_mfma_f32_16x16x32_bf16 v[68:71], a[4:7], a[28:31], v[68:71]
 ds_read_b64_tr_b16 a[0:1], v6 offset:40960
 v_mfma_f32_16x16x32_bf16 v[64:67], a[4:7], a[24:27], v[64:67]
 ds_read_b64_tr_b16 a[2:3], v6 offset:41472
 v_mfma_f32_16x16x32_bf16 v[60:63], a[4:7], a[20:23], v[60:63]
 v_mfma_f32_16x16x32_bf16 v[56:59], a[4:7], a[16:19], v[56:59]
 s_waitcnt lgkmcnt(4)
 v_mfma_f32_16x16x32_bf16 v[72:75], a[8:11], a[16:19], v[72:75]
 ds_read_b64_tr_b16 a[4:5], v7 offset:40960
 v_mfma_f32_16x16x32_bf16 v[76:79], a[8:11], a[20:23], v[76:79]
 ds_read_b64_tr_b16 a[6:7], v7 offset:41472
 v_mfma_f32_16x16x32_bf16 v[80:83], a[8:11], a[24:27], v[80:83]
 v_mfma_f32_16x16x32_bf16 v[84:87], a[8:11], a[28:31], v[84:87]
 s_waitcnt lgkmcnt(4)
 v_mfma_f32_16x16x32_bf16 v[100:103], a[12:15], a[28:31], v[100:103]
 ds_read_b64_tr_b16 a[8:9], v6 offset:57344
 v_mfma_f32_16x16x32_bf16 v[96:99], a[12:15], a[24:27], v[96:99]
 ds_read_b64_tr_b16 a[10:11], v6 offset:57856
 v_mfma_f32_16x16x32_bf16 v[92:95], a[12:15], a[20:23], v[92:95]
 ds_read_b128 a[32:35], v4 offset:52224
 v_mfma_f32_16x16x32_bf16 v[88:91], a[12:15], a[16:19], v[88:91]
 s_waitcnt lgkmcnt(5)
 v_mfma_f32_16x16x32_bf16 v[104:107], a[16:19], a[0:3], v[104:107]
 ds_read_b64_tr_b16 a[12:13], v7 offset:57344
 v_mfma_f32_16x16x32_bf16 v[108:111], a[20:23], a[0:3], v[108:111]
 ds_read_b64_tr_b16 a[14:15], v7 offset:57856
 v_mfma_f32_16x16x32_bf16 v[112:115], a[24:27], a[0:3], v[112:115]
 ds_read_b128 a[36:39], v4 offset:53248
 v_mfma_f32_16x16x32_bf16 v[116:119], a[28:31], a[0:3], v[116:119]
 s_waitcnt lgkmcnt(6)
 v_mfma_f32_16x16x32_bf16 v[132:135], a[28:31], a[4:7], v[132:135]
 ds_read_b64_tr_b16 a[0:1], v8 offset:8192
 v_mfma_f32_16x16x32_bf16 v[128:131], a[24:27], a[4:7], v[128:131]
 ds_read_b64_tr_b16 a[2:3], v8 offset:8704
 v_mfma_f32_16x16x32_bf16 v[124:127], a[20:23], a[4:7], v[124:127]
 ds_read_b128 a[40:43], v4 offset:54272
 v_mfma_f32_16x16x32_bf16 v[120:123], a[16:19], a[4:7], v[120:123]
 s_waitcnt lgkmcnt(7)
 v_mfma_f32_16x16x32_bf16 v[136:139], a[8:11], a[16:19], v[136:139]
 ds_read_b64_tr_b16 a[4:5], v9 offset:8192
 v_mfma_f32_16x16x32_bf16 v[140:143], a[8:11], a[20:23], v[140:143]
 ds_read_b64_tr_b16 a[6:7], v9 offset:8704
 v_mfma_f32_16x16x32_bf16 v[144:147], a[8:11], a[24:27], v[144:147]
 ds_read_b128 a[44:47], v4 offset:55296
 v_mfma_f32_16x16x32_bf16 v[148:151], a[8:11], a[28:31], v[148:151]
 s_waitcnt lgkmcnt(7)
 v_mfma_f32_16x16x32_bf16 v[164:167], a[12:15], a[28:31], v[164:167]
 ds_read_b64_tr_b16 a[8:9], v6 offset:12288
 v_mfma_f32_16x16x32_bf16 v[160:163], a[12:15], a[24:27], v[160:163]
 ds_read_b64_tr_b16 a[10:11], v6 offset:12800
 v_mfma_f32_16x16x32_bf16 v[156:159], a[12:15], a[20:23], v[156:159]
 v_mfma_f32_16x16x32_bf16 v[152:155], a[12:15], a[16:19], v[152:155]
 s_waitcnt lgkmcnt(6)
 v_mfma_f32_16x16x32_bf16 v[168:171], a[0:3], a[16:19], v[168:171]
 ds_read_b64_tr_b16 a[12:13], v7 offset:12288
 v_mfma_f32_16x16x32_bf16 v[172:175], a[0:3], a[20:23], v[172:175]
 ds_read_b64_tr_b16 a[14:15], v7 offset:12800
 v_mfma_f32_16x16x32_bf16 v[176:179], a[0:3], a[24:27], v[176:179]
 v_mfma_f32_16x16x32_bf16 v[180:183], a[0:3], a[28:31], v[180:183]
 s_waitcnt lgkmcnt(5)
 v_mfma_f32_16x16x32_bf16 v[196:199], a[4:7], a[28:31], v[196:199]
 ds_read_b64_tr_b16 a[0:1], v6 offset:28672
 v_mfma_f32_16x16x32_bf16 v[192:195], a[4:7], a[24:27], v[192:195]
 ds_read_b64_tr_b16 a[2:3], v6 offset:29184
 v_mfma_f32_16x16x32_bf16 v[188:191], a[4:7], a[20:23], v[188:191]
 v_mfma_f32_16x16x32_bf16 v[184:187], a[4:7], a[16:19], v[184:187]
 s_barrier
 s_waitcnt lgkmcnt(4)
 v_mfma_f32_16x16x32_bf16 v[40:43], a[8:11], a[32:35], v[40:43]
 ds_read_b64_tr_b16 a[4:5], v7 offset:28672
 v_mfma_f32_16x16x32_bf16 v[44:47], a[8:11], a[36:39], v[44:47]
 ds_read_b64_tr_b16 a[6:7], v7 offset:29184
 v_mfma_f32_16x16x32_bf16 v[48:51], a[8:11], a[40:43], v[48:51]
 v_mfma_f32_16x16x32_bf16 v[52:55], a[8:11], a[44:47], v[52:55]
 s_waitcnt lgkmcnt(4)
 v_mfma_f32_16x16x32_bf16 v[68:71], a[12:15], a[44:47], v[68:71]
 ds_read_b64_tr_b16 a[8:9], v6 offset:45056
 v_mfma_f32_16x16x32_bf16 v[64:67], a[12:15], a[40:43], v[64:67]
 ds_read_b64_tr_b16 a[10:11], v6 offset:45568
 v_mfma_f32_16x16x32_bf16 v[60:63], a[12:15], a[36:39], v[60:63]
 v_mfma_f32_16x16x32_bf16 v[56:59], a[12:15], a[32:35], v[56:59]
 s_waitcnt lgkmcnt(4)
 v_mfma_f32_16x16x32_bf16 v[72:75], a[0:3], a[32:35], v[72:75]
 ds_read_b64_tr_b16 a[12:13], v7 offset:45056
 v_mfma_f32_16x16x32_bf16 v[76:79], a[0:3], a[36:39], v[76:79]
 ds_read_b64_tr_b16 a[14:15], v7 offset:45568
 v_mfma_f32_16x16x32_bf16 v[80:83], a[0:3], a[40:43], v[80:83]
 v_mfma_f32_16x16x32_bf16 v[84:87], a[0:3], a[44:47], v[84:87]
 s_waitcnt lgkmcnt(4)
 v_mfma_f32_16x16x32_bf16 v[100:103], a[4:7], a[44:47], v[100:103]
 ds_read_b64_tr_b16 a[0:1], v6 offset:61440
 v_mfma_f32_16x16x32_bf16 v[96:99], a[4:7], a[40:43], v[96:99]
 ds_read_b64_tr_b16 a[2:3], v6 offset:61952
 v_mfma_f32_16x16x32_bf16 v[92:95], a[4:7], a[36:39], v[92:95]
 v_mfma_f32_16x16x32_bf16 v[88:91], a[4:7], a[32:35], v[88:91]
 s_waitcnt lgkmcnt(4)
 v_mfma_f32_16x16x32_bf16 v[104:107], a[32:35], a[8:11], v[104:107]
 ds_read_b64_tr_b16 a[4:5], v7 offset:61440
 v_mfma_f32_16x16x32_bf16 v[108:111], a[36:39], a[8:11], v[108:111]
 ds_read_b64_tr_b16 a[6:7], v7 offset:61952
 v_mfma_f32_16x16x32_bf16 v[112:115], a[40:43], a[8:11], v[112:115]
 v_mfma_f32_16x16x32_bf16 v[116:119], a[44:47], a[8:11], v[116:119]
 s_waitcnt lgkmcnt(4)
 v_mfma_f32_16x16x32_bf16 v[132:135], a[44:47], a[12:15], v[132:135]
 ds_read_b64_tr_b16 a[8:9], v8 offset:12288
 v_mfma_f32_16x16x32_bf16 v[128:131], a[40:43], a[12:15], v[128:131]
 ds_read_b64_tr_b16 a[10:11], v8 offset:12800
 v_mfma_f32_16x16x32_bf16 v[124:127], a[36:39], a[12:15], v[124:127]
 v_mfma_f32_16x16x32_bf16 v[120:123], a[32:35], a[12:15], v[120:123]
 s_waitcnt lgkmcnt(4)
 v_mfma_f32_16x16x32_bf16 v[136:139], a[0:3], a[32:35], v[136:139]
 ds_read_b64_tr_b16 a[12:13], v9 offset:12288
 v_mfma_f32_16x16x32_bf16 v[140:143], a[0:3], a[36:39], v[140:143]
 ds_read_b64_tr_b16 a[14:15], v9 offset:12800
 v_mfma_f32_16x16x32_bf16 v[144:147], a[0:3], a[40:43], v[144:147]
 v_mfma_f32_16x16x32_bf16 v[148:151], a[0:3], a[44:47], v[148:151]
 s_waitcnt lgkmcnt(4)
 v_mfma_f32_16x16x32_bf16 v[164:167], a[4:7], a[44:47], v[164:167]
 v_mfma_f32_16x16x32_bf16 v[160:163], a[4:7], a[40:43], v[160:163]
 v_mfma_f32_16x16x32_bf16 v[156:159], a[4:7], a[36:39], v[156:159]
 v_mfma_f32_16x16x32_bf16 v[152:155], a[4:7], a[32:35], v[152:155]
 s_waitcnt lgkmcnt(2)
 v_mfma_f32_16x16x32_bf16 v[168:171], a[8:11], a[32:35], v[168:171]
 v_mfma_f32_16x16x32_bf16 v[172:175], a[8:11], a[36:39], v[172:175]
 v_mfma_f32_16x16x32_bf16 v[176:179], a[8:11], a[40:43], v[176:179]
 v_mfma_f32_16x16x32_bf16 v[180:183], a[8:11], a[44:47], v[180:183]
 s_waitcnt lgkmcnt(0)
 v_mfma_f32_16x16x32_bf16 v[196:199], a[12:15], a[44:47], v[196:199]
 v_mfma_f32_16x16x32_bf16 v[192:195], a[12:15], a[40:43], v[192:195]
 v_mfma_f32_16x16x32_bf16 v[188:191], a[12:15], a[36:39], v[188:191]
 v_mfma_f32_16x16x32_bf16 v[184:187], a[12:15], a[32:35], v[184:187]
 s_barrier
 s_branch L_k1_epiX
L_k1_X_None_0:
 s_waitcnt vmcnt(4)
 s_barrier
 s_mov_b32 s45, 6
 ds_read_b128 a[16:19], v4 offset:0
 ds_read_b128 a[20:23], v4 offset:1024
 ds_read_b128 a[24:27], v4 offset:2048
 ds_read_b128 a[28:31], v4 offset:3072
 ds_read_b64_tr_b16 a[0:1], v6 offset:0
 ds_read_b64_tr_b16 a[2:3], v6 offset:512
 ds_read_b64_tr_b16 a[4:5], v7 offset:0
 ds_read_b64_tr_b16 a[6:7], v7 offset:512
 ds_read_b64_tr_b16 a[8:9], v6 offset:16384
 ds_read_b64_tr_b16 a[10:11], v6 offset:16896
 s_waitcnt vmcnt(2)
 s_barrier
 s_waitcnt lgkmcnt(4)
 v_mfma_f32_16x16x32_bf16 v[40:43], a[0:3], a[16:19], v[40:43]
 ds_read_b64_tr_b16 a[12:13], v7 offset:16384
 v_mfma_f32_16x16x32_bf16 v[44:47], a[0:3], a[20:23], v[44:47]
 ds_read_b64_tr_b16 a[14:15], v7 offset:16896
 v_mfma_f32_16x16x32_bf16 v[48:51], a[0:3], a[24:27], v[48:51]
 s_add_u32 m0, s39, 52224
 v_mfma_f32_16x16x32_bf16 v[52:55], a[0:3], a[28:31], v[52:55]
 buffer_load_dwordx4 v1, s[12:15], s33 offen sc1 lds
 s_waitcnt lgkmcnt(4)
 v_mfma_f32_16x16x32_bf16 v[68:71], a[4:7], a[28:31], v[68:71]
 ds_read_b64_tr_b16 a[0:1], v6 offset:32768
 v_mfma_f32_16x16x32_bf16 v[64:67], a[4:7], a[24:27], v[64:67]
 ds_read_b64_tr_b16 a[2:3], v6 offset:33280
 v_mfma_f32_16x16x32_bf16 v[60:63], a[4:7], a[20:23], v[60:63]
 v_mfma_f32_16x16x32_bf16 v[56:59], a[4:7], a[16:19], v[56:59]
 buffer_load_dwordx4 v1, s[12:15], s33 offen offset:1024 sc1 lds
 s_add_u32 s33, s33, 2048
 s_waitcnt lgkmcnt(4)
 v_mfma_f32_16x16x32_bf16 v[72:75], a[8:11], a[16:19], v[72:75]
 ds_read_b64_tr_b16 a[4:5], v7 offset:32768
 v_mfma_f32_16x16x32_bf16 v[76:79], a[8:11], a[20:23], v[76:79]
 ds_read_b64_tr_b16 a[6:7], v7 offset:33280
 v_mfma_f32_16x16x32_bf16 v[80:83], a[8:11], a[24:27], v[80:83]
 s_add_u32 m0, s40, 12288
 v_mfma_f32_16x16x32_bf16 v[84:87], a[8:11], a[28:31], v[84:87]
 buffer_load_dwordx4 v2, s[16:19], s34 offen nt lds
 s_add_u32 s34, s34, s37
 s_waitcnt lgkmcnt(4)
 v_mfma_f32_16x16x32_bf16 v[100:103], a[12:15], a[28:31], v[100:103]
 ds_read_b64_tr_b16 a[8:9], v6 offset:49152
 v_mfma_f32_16x16x32_bf16 v[96:99], a[12:15], a[24:27], v[96:99]
 ds_read_b64_tr_b16 a[10:11], v6 offset:49664
 v_mfma_f32_16x16x32_bf16 v[92:95], a[12:15], a[20:23], v[92:95]
 ds_read_b128 a[32:35], v4 offset:17408
 s_add_u32 m0, s40, 14336
 v_mfma_f32_16x16x32_bf16 v[88:91], a[12:15], a[16:19], v[88:91]
 buffer_load_dwordx4 v2, s[16:19], s35 offen nt lds
 s_add_u32 s35, s35, s37
 s_waitcnt lgkmcnt(5)
 v_mfma_f32_16x16x32_bf16 v[104:107], a[16:19], a[0:3], v[104:107]
 ds_read_b64_tr_b16 a[12:13], v7 offset:49152
 v_mfma_f32_16x16x32_bf16 v[108:111], a[20:23], a[0:3], v[108:111]
 ds_read_b64_tr_b16 a[14:15], v7 offset:49664
 v_mfma_f32_16x16x32_bf16 v[112:115], a[24:27], a[0:3], v[112:115]
 ds_read_b128 a[36:39], v4 offset:18432
 v_mfma_f32_16x16x32_bf16 v[116:119], a[28:31], a[0:3], v[116:119]
 s_waitcnt lgkmcnt(6)
 v_mfma_f32_16x16x32_bf16 v[132:135], a[28:31], a[4:7], v[132:135]
 ds_read_b64_tr_b16 a[0:1], v8 offset:0
 v_mfma_f32_16x16x32_bf16 v[128:131], a[24:27], a[4:7], v[128:131]
 ds_read_b64_tr_b16 a[2:3], v8 offset:512
 v_mfma_f32_16x16x32_bf16 v[124:127], a[20:23], a[4:7], v[124:127]
 ds_read_b128 a[40:43], v4 offset:19456
 v_mfma_f32_16x16x32_bf16 v[120:123], a[16:19], a[4:7], v[120:123]
 s_waitcnt lgkmcnt(7)
 v_mfma_f32_16x16x32_bf16 v[136:139], a[8:11], a[16:19], v[136:139]
 ds_read_b64_tr_b16 a[4:5], v9 offset:0
 v_mfma_f32_16x16x32_bf16 v[140:143], a[8:11], a[20:23], v[140:143]
 ds_read_b64_tr_b16 a[6:7], v9 offset:512
 v_mfma_f32_16x16x32_bf16 v[144:147], a[8:11], a[24:27], v[144:147]
 ds_read_b128 a[44:47], v4 offset:20480
 v_mfma_f32_16x16x32_bf16 v[148:151], a[8:11], a[28:31], v[148:151]
 s_waitcnt lgkmcnt(7)
 v_mfma_f32_16x16x32_bf16 v[164:167], a[12:15], a[28:31], v[164:167]
 ds_read_b64_tr_b16 a[8:9], v6 offset:4096
 v_mfma_f32_16x16x32_bf16 v[160:163], a[12:15], a[24:27], v[160:163]
 ds_read_b64_tr_b16 a[10:11], v6 offset:4608
 v_mfma_f32_16x16x32_bf16 v[156:159], a[12:15], a[20:23], v[156:159]
 v_mfma_f32_16x16x32_bf16 v[152:155], a[12:15], a[16:19], v[152:155]
 s_waitcnt lgkmcnt(6)
 v_mfma_f32_16x16x32_bf16 v[168:171], a[0:3], a[16:19], v[168:171]
 ds_read_b64_tr_b16 a[12:13], v7 offset:4096
 v_mfma_f32_16x16x32_bf16 v[172:175], a[0:3], a[20:23], v[172:175]
 ds_read_b64_tr_b16 a[14:15], v7 offset:4608
 v_mfma_f32_16x16x32_bf16 v[176:179], a[0:3], a[24:27], v[176:179]
 v_mfma_f32_16x16x32_bf16 v[180:183], a[0:3], a[28:31], v[180:183]
 s_waitcnt lgkmcnt(5)
 v_mfma_f32_16x16x32_bf16 v[196:199], a[4:7], a[28:31], v[196:199]
 ds_read_b64_tr_b16 a[0:1], v6 offset:20480
 v_mfma_f32_16x16x32_bf16 v[192:195], a[4:7], a[24:27], v[192:195]
 ds_read_b64_tr_b16 a[2:3], v6 offset:20992
 v_mfma_f32_16x16x32_bf16 v[188:191], a[4:7], a[20:23], v[188:191]
 v_mfma_f32_16x16x32_bf16 v[184:187], a[4:7], a[16:19], v[184:187]
 s_waitcnt vmcnt(4)
 s_barrier
 s_waitcnt lgkmcnt(4)
 v_mfma_f32_16x16x32_bf16 v[40:43], a[8:11], a[32:35], v[40:43]
 ds_read_b64_tr_b16 a[4:5], v7 offset:20480
 v_mfma_f32_16x16x32_bf16 v[44:47], a[8:11], a[36:39], v[44:47]
 ds_read_b64_tr_b16 a[6:7], v7 offset:20992
 v_mfma_f32_16x16x32_bf16 v[48:51], a[8:11], a[40:43], v[48:51]
 s_add_u32 m0, s39, 0
 v_mfma_f32_16x16x32_bf16 v[52:55], a[8:11], a[44:47], v[52:55]
 buffer_load_dwordx4 v1, s[12:15], s33 offen sc1 lds
 s_waitcnt lgkmcnt(4)
 v_mfma_f32_16x16x32_bf16 v[68:71], a[12:15], a[44:47], v[68:71]
 ds_read_b64_tr_b16 a[8:9], v6 offset:36864
 v_mfma_f32_16x16x32_bf16 v[64:67], a[12:15], a[40:43], v[64:67]
 ds_read_b64_tr_b16 a[10:11], v6 offset:37376
 v_mfma_f32_16x16x32_bf16 v[60:63], a[12:15], a[36:39], v[60:63]
 v_mfma_f32_16x16x32_bf16 v[56:59], a[12:15], a[32:35], v[56:59]
 buffer_load_dwordx4 v1, s[12:15], s33 offen offset:1024 sc1 lds
 s_add_u32 s33, s33, 2048
 s_waitcnt lgkmcnt(4)
 v_mfma_f32_16x16x32_bf16 v[72:75], a[0:3], a[32:35], v[72:75]
 ds_read_b64_tr_b16 a[12:13], v7 offset:36864
 v_mfma_f32_16x16x32_bf16 v[76:79], a[0:3], a[36:39], v[76:79]
 ds_read_b64_tr_b16 a[14:15], v7 offset:37376
 v_mfma_f32_16x16x32_bf16 v[80:83], a[0:3], a[40:43], v[80:83]
 s_add_u32 m0, s40, 0
 v_mfma_f32_16x16x32_bf16 v[84:87], a[0:3], a[44:47], v[84:87]
 buffer_load_dwordx4 v2, s[16:19], s34 offen nt lds
 s_add_u32 s34, s34, s37
 s_waitcnt lgkmcnt(4)
 v_mfma_f32_16x16x32_bf16 v[100:103], a[4:7], a[44:47], v[100:103]
 ds_read_b64_tr_b16 a[0:1], v6 offset:53248
 v_mfma_f32_16x16x32_bf16 v[96:99], a[4:7], a[40:43], v[96:99]
 ds_read_b64_tr_b16 a[2:3], v6 offset:53760
 v_mfma_f32_16x16x32_bf16 v[92:95], a[4:7], a[36:39], v[92:95]
 ds_read_b128 a[16:19], v4 offset:34816
 s_add_u32 m0, s40, 2048
 v_mfma_f32_16x16x32_bf16 v[88:91], a[4:7], a[32:35], v[88:91]
 buffer_load_dwordx4 v2, s[16:19], s35 offen nt lds
 s_add_u32 s35, s35, s37
 s_waitcnt lgkmcnt(5)
 v_mfma_f32_16x16x32_bf16 v[104:107], a[32:35], a[8:11], v[104:107]
 ds_read_b64_tr_b16 a[4:5], v7 offset:53248
 v_mfma_f32_16x16x32_bf16 v[108:111], a[36:39], a[8:11], v[108:111]
 ds_read_b64_tr_b16 a[6:7], v7 offset:53760
 v_mfma_f32_16x16x32_bf16 v[112:115], a[40:43], a[8:11], v[112:115]
 ds_read_b128 a[20:23], v4 offset:35840
 v_mfma_f32_16x16x32_bf16 v[116:119], a[44:47], a[8:11], v[116:119]
 s_waitcnt lgkmcnt(6)
 v_mfma_f32_16x16x32_bf16 v[132:135], a[44:47], a[12:15], v[132:135]
 ds_read_b64_tr_b16 a[8:9], v8 offset:4096
 v_mfma_f32_16x16x32_bf16 v[128:131], a[40:43], a[12:15], v[128:131]
 ds_read_b64_tr_b16 a[10:11], v8 offset:4608
 v_mfma_f32_16x16x32_bf16 v[124:127], a[36:39], a[12:15], v[124:127]
 ds_read_b128 a[24:27], v4 offset:36864
 v_mfma_f32_16x16x32_bf16 v[120:123], a[32:35], a[12:15], v[120:123]
 s_cmp_eq_u32 s45, s88
 s_cselect_b64 vcc, -1, 0
 v_cndmask_b32 v15, v14, v12, vcc
 buffer_load_dword v31, v15, s[84:87], 0 offen
 s_waitcnt lgkmcnt(7)
 v_mfma_f32_16x16x32_bf16 v[136:139], a[0:3], a[32:35], v[136:139]
 ds_read_b64_tr_b16 a[12:13], v9 offset:4096
 v_mfma_f32_16x16x32_bf16 v[140:143], a[0:3], a[36:39], v[140:143]
 ds_read_b64_tr_b16 a[14:15], v9 offset:4608
 v_mfma_f32_16x16x32_bf16 v[144:147], a[0:3], a[40:43], v[144:147]
 ds_read_b128 a[28:31], v4 offset:37888
 v_mfma_f32_16x16x32_bf16 v[148:151], a[0:3], a[44:47], v[148:151]
 s_waitcnt lgkmcnt(7)
 v_mfma_f32_16x16x32_bf16 v[164:167], a[4:7], a[44:47], v[164:167]
 ds_read_b64_tr_b16 a[0:1], v6 offset:8192
 v_mfma_f32_16x16x32_bf16 v[160:163], a[4:7], a[40:43], v[160:163]
 ds_read_b64_tr_b16 a[2:3], v6 offset:8704
 v_mfma_f32_16x16x32_bf16 v[156:159], a[4:7], a[36:39], v[156:159]
 v_mfma_f32_16x16x32_bf16 v[152:155], a[4:7], a[32:35], v[152:155]
 s_waitcnt lgkmcnt(6)
 v_mfma_f32_16x16x32_bf16 v[168:171], a[8:11], a[32:35], v[168:171]
 ds_read_b64_tr_b16 a[4:5], v7 offset:8192
 v_mfma_f32_16x16x32_bf16 v[172:175], a[8:11], a[36:39], v[172:175]
 ds_read_b64_tr_b16 a[6:7], v7 offset:8704
 v_mfma_f32_16x16x32_bf16 v[176:179], a[8:11], a[40:43], v[176:179]
 v_mfma_f32_16x16x32_bf16 v[180:183], a[8:11], a[44:47], v[180:183]
 s_waitcnt lgkmcnt(5)
 v_mfma_f32_16x16x32_bf16 v[196:199], a[12:15], a[44:47], v[196:199]
 ds_read_b64_tr_b16 a[8:9], v6 offset:24576
 v_mfma_f32_16x16x32_bf16 v[192:195], a[12:15], a[40:43], v[192:195]
 ds_read_b64_tr_b16 a[10:11], v6 offset:25088
 v_mfma_f32_16x16x32_bf16 v[188:191], a[12:15], a[36:39], v[188:191]
 v_mfma_f32_16x16x32_bf16 v[184:187], a[12:15], a[32:35], v[184:187]
 s_waitcnt vmcnt(5)
 s_barrier
 s_waitcnt lgkmcnt(4)
 v_mfma_f32_16x16x32_bf16 v[40:43], a[0:3], a[16:19], v[40:43]
 ds_read_b64_tr_b16 a[12:13], v7 offset:24576
 v_mfma_f32_16x16x32_bf16 v[44:47], a[0:3], a[20:23], v[44:47]
 ds_read_b64_tr_b16 a[14:15], v7 offset:25088
 v_mfma_f32_16x16x32_bf16 v[48:51], a[0:3], a[24:27], v[48:51]
 s_add_u32 m0, s39, 17408
 v_mfma_f32_16x16x32_bf16 v[52:55], a[0:3], a[28:31], v[52:55]
 buffer_load_dwordx4 v1, s[12:15], s33 offen sc1 lds
 s_waitcnt lgkmcnt(4)
 v_mfma_f32_16x16x32_bf16 v[68:71], a[4:7], a[28:31], v[68:71]
 ds_read_b64_tr_b16 a[0:1], v6 offset:40960
 v_mfma_f32_16x16x32_bf16 v[64:67], a[4:7], a[24:27], v[64:67]
 ds_read_b64_tr_b16 a[2:3], v6 offset:41472
 v_mfma_f32_16x16x32_bf16 v[60:63], a[4:7], a[20:23], v[60:63]
 v_mfma_f32_16x16x32_bf16 v[56:59], a[4:7], a[16:19], v[56:59]
 buffer_load_dwordx4 v1, s[12:15], s33 offen offset:1024 sc1 lds
 s_add_u32 s33, s33, 2048
 s_waitcnt lgkmcnt(4)
 v_mfma_f32_16x16x32_bf16 v[72:75], a[8:11], a[16:19], v[72:75]
 ds_read_b64_tr_b16 a[4:5], v7 offset:40960
 v_mfma_f32_16x16x32_bf16 v[76:79], a[8:11], a[20:23], v[76:79]
 ds_read_b64_tr_b16 a[6:7], v7 offset:41472
 v_mfma_f32_16x16x32_bf16 v[80:83], a[8:11], a[24:27], v[80:83]
 s_add_u32 m0, s40, 4096
 v_mfma_f32_16x16x32_bf16 v[84:87], a[8:11], a[28:31], v[84:87]
 buffer_load_dwordx4 v2, s[16:19], s34 offen nt lds
 s_add_u32 s34, s34, s37
 s_waitcnt lgkmcnt(4)
 v_mfma_f32_16x16x32_bf16 v[100:103], a[12:15], a[28:31], v[100:103]
 ds_read_b64_tr_b16 a[8:9], v6 offset:57344
 v_mfma_f32_16x16x32_bf16 v[96:99], a[12:15], a[24:27], v[96:99]
 ds_read_b64_tr_b16 a[10:11], v6 offset:57856
 v_mfma_f32_16x16x32_bf16 v[92:95], a[12:15], a[20:23], v[92:95]
 ds_read_b128 a[32:35], v4 offset:52224
 s_add_u32 m0, s40, 6144
 v_mfma_f32_16x16x32_bf16 v[88:91], a[12:15], a[16:19], v[88:91]
 buffer_load_dwordx4 v2, s[16:19], s35 offen nt lds
 s_add_u32 s35, s35, s37
 s_waitcnt lgkmcnt(5)
 v_mfma_f32_16x16x32_bf16 v[104:107], a[16:19], a[0:3], v[104:107]
 ds_read_b64_tr_b16 a[12:13], v7 offset:57344
 v_mfma_f32_16x16x32_bf16 v[108:111], a[20:23], a[0:3], v[108:111]
 ds_read_b64_tr_b16 a[14:15], v7 offset:57856
 v_mfma_f32_16x16x32_bf16 v[112:115], a[24:27], a[0:3], v[112:115]
 ds_read_b128 a[36:39], v4 offset:53248
 v_mfma_f32_16x16x32_bf16 v[116:119], a[28:31], a[0:3], v[116:119]
 s_waitcnt lgkmcnt(6)
 v_mfma_f32_16x16x32_bf16 v[132:135], a[28:31], a[4:7], v[132:135]
 ds_read_b64_tr_b16 a[0:1], v8 offset:8192
 v_mfma_f32_16x16x32_bf16 v[128:131], a[24:27], a[4:7], v[128:131]
 ds_read_b64_tr_b16 a[2:3], v8 offset:8704
 v_mfma_f32_16x16x32_bf16 v[124:127], a[20:23], a[4:7], v[124:127]
 ds_read_b128 a[40:43], v4 offset:54272
 v_mfma_f32_16x16x32_bf16 v[120:123], a[16:19], a[4:7], v[120:123]
 s_waitcnt lgkmcnt(7)
 v_mfma_f32_16x16x32_bf16 v[136:139], a[8:11], a[16:19], v[136:139]
 ds_read_b64_tr_b16 a[4:5], v9 offset:8192
 v_mfma_f32_16x16x32_bf16 v[140:143], a[8:11], a[20:23], v[140:143]
 ds_read_b64_tr_b16 a[6:7], v9 offset:8704
 v_mfma_f32_16x16x32_bf16 v[144:147], a[8:11], a[24:27], v[144:147]
 ds_read_b128 a[44:47], v4 offset:55296
 v_mfma_f32_16x16x32_bf16 v[148:151], a[8:11], a[28:31], v[148:151]
 s_waitcnt lgkmcnt(7)
 v_mfma_f32_16x16x32_bf16 v[164:167], a[12:15], a[28:31], v[164:167]
 ds_read_b64_tr_b16 a[8:9], v6 offset:12288
 v_mfma_f32_16x16x32_bf16 v[160:163], a[12:15], a[24:27], v[160:163]
 ds_read_b64_tr_b16 a[10:11], v6 offset:12800
 v_mfma_f32_16x16x32_bf16 v[156:159], a[12:15], a[20:23], v[156:159]
 v_mfma_f32_16x16x32_bf16 v[152:155], a[12:15], a[16:19], v[152:155]
 s_waitcnt lgkmcnt(6)
 v_mfma_f32_16x16x32_bf16 v[168:171], a[0:3], a[16:19], v[168:171]
 ds_read_b64_tr_b16 a[12:13], v7 offset:12288
 v_mfma_f32_16x16x32_bf16 v[172:175], a[0:3], a[20:23], v[172:175]
 ds_read_b64_tr_b16 a[14:15], v7 offset:12800
 v_mfma_f32_16x16x32_bf16 v[176:179], a[0:3], a[24:27], v[176:179]
 v_mfma_f32_16x16x32_bf16 v[180:183], a[0:3], a[28:31], v[180:183]
 s_waitcnt lgkmcnt(5)
 v_mfma_f32_16x16x32_bf16 v[196:199], a[4:7], a[28:31], v[196:199]
 ds_read_b64_tr_b16 a[0:1], v6 offset:28672
 v_mfma_f32_16x16x32_bf16 v[192:195], a[4:7], a[24:27], v[192:195]
 ds_read_b64_tr_b16 a[2:3], v6 offset:29184
 v_mfma_f32_16x16x32_bf16 v[188:191], a[4:7], a[20:23], v[188:191]
 v_mfma_f32_16x16x32_bf16 v[184:187], a[4:7], a[16:19], v[184:187]
 s_waitcnt vmcnt(5)
 s_barrier
 s_waitcnt lgkmcnt(4)
 v_mfma_f32_16x16x32_bf16 v[40:43], a[8:11], a[32:35], v[40:43]
 ds_read_b64_tr_b16 a[4:5], v7 offset:28672
 v_mfma_f32_16x16x32_bf16 v[44:47], a[8:11], a[36:39], v[44:47]
 ds_read_b64_tr_b16 a[6:7], v7 offset:29184
 v_mfma_f32_16x16x32_bf16 v[48:51], a[8:11], a[40:43], v[48:51]
 s_add_u32 m0, s39, 34816
 v_mfma_f32_16x16x32_bf16 v[52:55], a[8:11], a[44:47], v[52:55]
 buffer_load_dwordx4 v1, s[12:15], s33 offen sc1 lds
 s_waitcnt lgkmcnt(4)
 v_mfma_f32_16x16x32_bf16 v[68:71], a[12:15], a[44:47], v[68:71]
 ds_read_b64_tr_b16 a[8:9], v6 offset:45056
 v_mfma_f32_16x16x32_bf16 v[64:67], a[12:15], a[40:43], v[64:67]
 ds_read_b64_tr_b16 a[10:11], v6 offset:45568
 v_mfma_f32_16x16x32_bf16 v[60:63], a[12:15], a[36:39], v[60:63]
 v_mfma_f32_16x16x32_bf16 v[56:59], a[12:15], a[32:35], v[56:59]
 buffer_load_dwordx4 v1, s[12:15], s33 offen offset:1024 sc1 lds
 s_add_u32 s33, s33, 2048
 s_waitcnt lgkmcnt(4)
 v_mfma_f32_16x16x32_bf16 v[72:75], a[0:3], a[32:35], v[72:75]
 ds_read_b64_tr_b16 a[12:13], v7 offset:45056
 v_mfma_f32_16x16x32_bf16 v[76:79], a[0:3], a[36:39], v[76:79]
 ds_read_b64_tr_b16 a[14:15], v7 offset:45568
 v_mfma_f32_16x16x32_bf16 v[80:83], a[0:3], a[40:43], v[80:83]
 s_add_u32 m0, s40, 8192
 v_mfma_f32_16x16x32_bf16 v[84:87], a[0:3], a[44:47], v[84:87]
 buffer_load_dwordx4 v2, s[16:19], s34 offen nt lds
 s_add_u32 s34, s34, s37
 s_waitcnt lgkmcnt(4)
 v_mfma_f32_16x16x32_bf16 v[100:103], a[4:7], a[44:47], v[100:103]
 ds_read_b64_tr_b16 a[0:1], v6 offset:61440
 v_mfma_f32_16x16x32_bf16 v[96:99], a[4:7], a[40:43], v[96:99]
 ds_read_b64_tr_b16 a[2:3], v6 offset:61952
 v_mfma_f32_16x16x32_bf16 v[92:95], a[4:7], a[36:39], v[92:95]
 ds_read_b128 a[16:19], v4 offset:0
 s_add_u32 m0, s40, 10240
 v_mfma_f32_16x16x32_bf16 v[88:91], a[4:7], a[32:35], v[88:91]
 buffer_load_dwordx4 v2, s[16:19], s35 offen nt lds
 s_add_u32 s35, s35, s37
 s_waitcnt lgkmcnt(5)
 v_mfma_f32_16x16x32_bf16 v[104:107], a[32:35], a[8:11], v[104:107]
 ds_read_b64_tr_b16 a[4:5], v7 offset:61440
 v_mfma_f32_16x16x32_bf16 v[108:111], a[36:39], a[8:11], v[108:111]
 ds_read_b64_tr_b16 a[6:7], v7 offset:61952
 v_mfma_f32_16x16x32_bf16 v[112:115], a[40:43], a[8:11], v[112:115]
 ds_read_b128 a[20:23], v4 offset:1024
 v_mfma_f32_16x16x32_bf16 v[116:119], a[44:47], a[8:11], v[116:119]
 s_waitcnt lgkmcnt(6)
 v_mfma_f32_16x16x32_bf16 v[132:135], a[44:47], a[12:15], v[132:135]
 ds_read_b64_tr_b16 a[8:9], v8 offset:12288
 v_mfma_f32_16x16x32_bf16 v[128:131], a[40:43], a[12:15], v[128:131]
 ds_read_b64_tr_b16 a[10:11], v8 offset:12800
 v_mfma_f32_16x16x32_bf16 v[124:127], a[36:39], a[12:15], v[124:127]
 ds_read_b128 a[24:27], v4 offset:2048
 v_mfma_f32_16x16x32_bf16 v[120:123], a[32:35], a[12:15], v[120:123]
 s_cmp_eq_u32 s45, s89
 s_cselect_b64 vcc, -1, 0
 v_cndmask_b32 v15, v14, v13, vcc
 buffer_load_dword v31, v15, s[80:83], 0 offen
 s_waitcnt lgkmcnt(7)
 v_mfma_f32_16x16x32_bf16 v[136:139], a[0:3], a[32:35], v[136:139]
 ds_read_b64_tr_b16 a[12:13], v9 offset:12288
 v_mfma_f32_16x16x32_bf16 v[140:143], a[0:3], a[36:39], v[140:143]
 ds_read_b64_tr_b16 a[14:15], v9 offset:12800
 v_mfma_f32_16x16x32_bf16 v[144:147], a[0:3], a[40:43], v[144:147]
 ds_read_b128 a[28:31], v4 offset:3072
 v_mfma_f32_16x16x32_bf16 v[148:151], a[0:3], a[44:47], v[148:151]
 s_waitcnt lgkmcnt(7)
 v_mfma_f32_16x16x32_bf16 v[164:167], a[4:7], a[44:47], v[164:167]
 ds_read_b64_tr_b16 a[0:1], v6 offset:0
 v_mfma_f32_16x16x32_bf16 v[160:163], a[4:7], a[40:43], v[160:163]
 ds_read_b64_tr_b16 a[2:3], v6 offset:512
 v_mfma_f32_16x16x32_bf16 v[156:159], a[4:7], a[36:39], v[156:159]
 v_mfma_f32_16x16x32_bf16 v[152:155], a[4:7], a[32:35], v[152:155]
 s_waitcnt lgkmcnt(6)
 v_mfma_f32_16x16x32_bf16 v[168:171], a[8:11], a[32:35], v[168:171]
 ds_read_b64_tr_b16 a[4:5], v7 offset:0
 v_mfma_f32_16x16x32_bf16 v[172:175], a[8:11], a[36:39], v[172:175]
 ds_read_b64_tr_b16 a[6:7], v7 offset:512
 v_mfma_f32_16x16x32_bf16 v[176:179], a[8:11], a[40:43], v[176:179]
 v_mfma_f32_16x16x32_bf16 v[180:183], a[8:11], a[44:47], v[180:183]
 s_waitcnt lgkmcnt(5)
 v_mfma_f32_16x16x32_bf16 v[196:199], a[12:15], a[44:47], v[196:199]
 ds_read_b64_tr_b16 a[8:9], v6 offset:16384
 v_mfma_f32_16x16x32_bf16 v[192:195], a[12:15], a[40:43], v[192:195]
 ds_read_b64_tr_b16 a[10:11], v6 offset:16896
 v_mfma_f32_16x16x32_bf16 v[188:191], a[12:15], a[36:39], v[188:191]
 v_mfma_f32_16x16x32_bf16 v[184:187], a[12:15], a[32:35], v[184:187]
 s_waitcnt vmcnt(5)
 s_barrier
 s_mov_b32 s45, 5
.p2align 3
L_loop_X_n_0:
 s_waitcnt lgkmcnt(4)
 v_mfma_f32_16x16x32_bf16 v[40:43], a[0:3], a[16:19], v[40:43]
 ds_read_b64_tr_b16 a[12:13], v7 offset:16384
 v_mfma_f32_16x16x32_bf16 v[44:47], a[0:3], a[20:23], v[44:47]
 ds_read_b64_tr_b16 a[14:15], v7 offset:16896
 v_mfma_f32_16x16x32_bf16 v[48:51], a[0:3], a[24:27], v[48:51]
 s_add_u32 m0, s39, 52224
 v_mfma_f32_16x16x32_bf16 v[52:55], a[0:3], a[28:31], v[52:55]
 buffer_load_dwordx4 v1, s[12:15], s33 offen sc1 lds
 s_waitcnt lgkmcnt(4)
 v_mfma_f32_16x16x32_bf16 v[68:71], a[4:7], a[28:31], v[68:71]
 ds_read_b64_tr_b16 a[0:1], v6 offset:32768
 v_mfma_f32_16x16x32_bf16 v[64:67], a[4:7], a[24:27], v[64:67]
 ds_read_b64_tr_b16 a[2:3], v6 offset:33280
 v_mfma_f32_16x16x32_bf16 v[60:63], a[4:7], a[20:23], v[60:63]
 v_mfma_f32_16x16x32_bf16 v[56:59], a[4:7], a[16:19], v[56:59]
 buffer_load_dwordx4 v1, s[12:15], s33 offen offset:1024 sc1 lds
 s_add_u32 s33, s33, 2048
 s_waitcnt lgkmcnt(4)
 v_mfma_f32_16x16x32_bf16 v[72:75], a[8:11], a[16:19], v[72:75]
 ds_read_b64_tr_b16 a[4:5], v7 offset:32768
 v_mfma_f32_16x16x32_bf16 v[76:79], a[8:11], a[20:23], v[76:79]
 ds_read_b64_tr_b16 a[6:7], v7 offset:33280
 v_mfma_f32_16x16x32_bf16 v[80:83], a[8:11], a[24:27], v[80:83]
 s_add_u32 m0, s40, 12288
 v_mfma_f32_16x16x32_bf16 v[84:87], a[8:11], a[28:31], v[84:87]
 buffer_load_dwordx4 v2, s[16:19], s34 offen nt lds
 s_add_u32 s34, s34, s37
 s_waitcnt lgkmcnt(4)
 v_mfma_f32_16x16x32_bf16 v[100:103], a[12:15], a[28:31], v[100:103]
 ds_read_b64_tr_b16 a[8:9], v6 offset:49152
 v_mfma_f32_16x16x32_bf16 v[96:99], a[12:15], a[24:27], v[96:99]
 ds_read_b64_tr_b16 a[10:11], v6 offset:49664
 v_mfma_f32_16x16x32_bf16 v[92:95], a[12:15], a[20:23], v[92:95]
 ds_read_b128 a[32:35], v4 offset:17408
 s_add_u32 m0, s40, 14336
 v_mfma_f32_16x16x32_bf16 v[88:91], a[12:15], a[16:19], v[88:91]
 buffer_load_dwordx4 v2, s[16:19], s35 offen nt lds
 s_add_u32 s35, s35, s37
 s_waitcnt lgkmcnt(5)
 v_mfma_f32_16x16x32_bf16 v[104:107], a[16:19], a[0:3], v[104:107]
 ds_read_b64_tr_b16 a[12:13], v7 offset:49152
 v_mfma_f32_16x16x32_bf16 v[108:111], a[20:23], a[0:3], v[108:111]
 ds_read_b64_tr_b16 a[14:15], v7 offset:49664
 v_mfma_f32_16x16x32_bf16 v[112:115], a[24:27], a[0:3], v[112:115]
 ds_read_b128 a[36:39], v4 offset:18432
 v_mfma_f32_16x16x32_bf16 v[116:119], a[28:31], a[0:3], v[116:119]
 s_waitcnt lgkmcnt(6)
 v_mfma_f32_16x16x32_bf16 v[132:135], a[28:31], a[4:7], v[132:135]
 ds_read_b64_tr_b16 a[0:1], v8 offset:0
 v_mfma_f32_16x16x32_bf16 v[128:131], a[24:27], a[4:7], v[128:131]
 ds_read_b64_tr_b16 a[2:3], v8 offset:512
 v_mfma_f32_16x16x32_bf16 v[124:127], a[20:23], a[4:7], v[124:127]
 ds_read_b128 a[40:43], v4 offset:19456
 v_mfma_f32_16x16x32_bf16 v[120:123], a[16:19], a[4:7], v[120:123]
 s_waitcnt lgkmcnt(7)
 v_mfma_f32_16x16x32_bf16 v[136:139], a[8:11], a[16:19], v[136:139]
 ds_read_b64_tr_b16 a[4:5], v9 offset:0
 v_mfma_f32_16x16x32_bf16 v[140:143], a[8:11], a[20:23], v[140:143]
 ds_read_b64_tr_b16 a[6:7], v9 offset:512
 v_mfma_f32_16x16x32_bf16 v[144:147], a[8:11], a[24:27], v[144:147]
 ds_read_b128 a[44:47], v4 offset:20480
 v_mfma_f32_16x16x32_bf16 v[148:151], a[8:11], a[28:31], v[148:151]
 s_waitcnt lgkmcnt(7)
 v_mfma_f32_16x16x32_bf16 v[164:167], a[12:15], a[28:31], v[164:167]
 ds_read_b64_tr_b16 a[8:9], v6 offset:4096
 v_mfma_f32_16x16x32_bf16 v[160:163], a[12:15], a[24:27], v[160:163]
 ds_read_b64_tr_b16 a[10:11], v6 offset:4608
 v_mfma_f32_16x16x32_bf16 v[156:159], a[12:15], a[20:23], v[156:159]
 v_mfma_f32_16x16x32_bf16 v[152:155], a[12:15], a[16:19], v[152:155]
 s_waitcnt lgkmcnt(6)
 v_mfma_f32_16x16x32_bf16 v[168:171], a[0:3], a[16:19], v[168:171]
 ds_read_b64_tr_b16 a[12:13], v7 offset:4096
 v_mfma_f32_16x16x32_bf16 v[172:175], a[0:3], a[20:23], v[172:175]
 ds_read_b64_tr_b16 a[14:15], v7 offset:4608
 v_mfma_f32_16x16x32_bf16 v[176:179], a[0:3], a[24:27], v[176:179]
 v_mfma_f32_16x16x32_bf16 v[180:183], a[0:3], a[28:31], v[180:183]
 s_waitcnt lgkmcnt(5)
 v_mfma_f32_16x16x32_bf16 v[196:199], a[4:7], a[28:31], v[196:199]
 ds_read_b64_tr_b16 a[0:1], v6 offset:20480
 v_mfma_f32_16x16x32_bf16 v[192:195], a[4:7], a[24:27], v[192:195]
 ds_read_b64_tr_b16 a[2:3], v6 offset:20992
 v_mfma_f32_16x16x32_bf16 v[188:191], a[4:7], a[20:23], v[188:191]
 v_mfma_f32_16x16x32_bf16 v[184:187], a[4:7], a[16:19], v[184:187]
 s_waitcnt vmcnt(5)
 s_barrier
 s_waitcnt lgkmcnt(4)
 v_mfma_f32_16x16x32_bf16 v[40:43], a[8:11], a[32:35], v[40:43]
 ds_read_b64_tr_b16 a[4:5], v7 offset:20480
 v_mfma_f32_16x16x32_bf16 v[44:47], a[8:11], a[36:39], v[44:47]
 ds_read_b64_tr_b16 a[6:7], v7 offset:20992
 v_mfma_f32_16x16x32_bf16 v[48:51], a[8:11], a[40:43], v[48:51]
 s_add_u32 m0, s39, 0
 v_mfma_f32_16x16x32_bf16 v[52:55], a[8:11], a[44:47], v[52:55]
 buffer_load_dwordx4 v1, s[12:15], s33 offen sc1 lds
 s_waitcnt lgkmcnt(4)
 v_mfma_f32_16x16x32_bf16 v[68:71], a[12:15], a[44:47], v[68:71]
 ds_read_b64_tr_b16 a[8:9], v6 offset:36864
 v_mfma_f32_16x16x32_bf16 v[64:67], a[12:15], a[40:43], v[64:67]
 ds_read_b64_tr_b16 a[10:11], v6 offset:37376
 v_mfma_f32_16x16x32_bf16 v[60:63], a[12:15], a[36:39], v[60:63]
 v_mfma_f32_16x16x32_bf16 v[56:59], a[12:15], a[32:35], v[56:59]
 buffer_load_dwordx4 v1, s[12:15], s33 offen offset:1024 sc1 lds
 s_add_u32 s33, s33, 2048
 s_waitcnt lgkmcnt(4)
 v_mfma_f32_16x16x32_bf16 v[72:75], a[0:3], a[32:35], v[72:75]
 ds_read_b64_tr_b16 a[12:13], v7 offset:36864
 v_mfma_f32_16x16x32_bf16 v[76:79], a[0:3], a[36:39], v[76:79]
 ds_read_b64_tr_b16 a[14:15], v7 offset:37376
 v_mfma_f32_16x16x32_bf16 v[80:83], a[0:3], a[40:43], v[80:83]
 s_add_u32 m0, s40, 0
 v_mfma_f32_16x16x32_bf16 v[84:87], a[0:3], a[44:47], v[84:87]
 buffer_load_dwordx4 v2, s[16:19], s34 offen nt lds
 s_add_u32 s34, s34, s37
 s_waitcnt lgkmcnt(4)
 v_mfma_f32_16x16x32_bf16 v[100:103], a[4:7], a[44:47], v[100:103]
 ds_read_b64_tr_b16 a[0:1], v6 offset:53248
 v_mfma_f32_16x16x32_bf16 v[96:99], a[4:7], a[40:43], v[96:99]
 ds_read_b64_tr_b16 a[2:3], v6 offset:53760
 v_mfma_f32_16x16x32_bf16 v[92:95], a[4:7], a[36:39], v[92:95]
 ds_read_b128 a[16:19], v4 offset:34816
 s_add_u32 m0, s40, 2048
 v_mfma_f32_16x16x32_bf16 v[88:91], a[4:7], a[32:35], v[88:91]
 buffer_load_dwordx4 v2, s[16:19], s35 offen nt lds
 s_add_u32 s35, s35, s37
 s_waitcnt lgkmcnt(5)
 v_mfma_f32_16x16x32_bf16 v[104:107], a[32:35], a[8:11], v[104:107]
 ds_read_b64_tr_b16 a[4:5], v7 offset:53248
 v_mfma_f32_16x16x32_bf16 v[108:111], a[36:39], a[8:11], v[108:111]
 ds_read_b64_tr_b16 a[6:7], v7 offset:53760
 v_mfma_f32_16x16x32_bf16 v[112:115], a[40:43], a[8:11], v[112:115]
 ds_read_b128 a[20:23], v4 offset:35840
 v_mfma_f32_16x16x32_bf16 v[116:119], a[44:47], a[8:11], v[116:119]
 s_waitcnt lgkmcnt(6)
 v_mfma_f32_16x16x32_bf16 v[132:135], a[44:47], a[12:15], v[132:135]
 ds_read_b64_tr_b16 a[8:9], v8 offset:4096
 v_mfma_f32_16x16x32_bf16 v[128:131], a[40:43], a[12:15], v[128:131]
 ds_read_b64_tr_b16 a[10:11], v8 offset:4608
 v_mfma_f32_16x16x32_bf16 v[124:127], a[36:39], a[12:15], v[124:127]
 ds_read_b128 a[24:27], v4 offset:36864
 v_mfma_f32_16x16x32_bf16 v[120:123], a[32:35], a[12:15], v[120:123]
 s_cmp_eq_u32 s45, s88
 s_cselect_b64 vcc, -1, 0
 v_cndmask_b32 v15, v14, v12, vcc
 buffer_load_dword v31, v15, s[84:87], 0 offen
 s_waitcnt lgkmcnt(7)
 v_mfma_f32_16x16x32_bf16 v[136:139], a[0:3], a[32:35], v[136:139]
 ds_read_b64_tr_b16 a[12:13], v9 offset:4096
 v_mfma_f32_16x16x32_bf16 v[140:143], a[0:3], a[36:39], v[140:143]
 ds_read_b64_tr_b16 a[14:15], v9 offset:4608
 v_mfma_f32_16x16x32_bf16 v[144:147], a[0:3], a[40:43], v[144:147]
 ds_read_b128 a[28:31], v4 offset:37888
 v_mfma_f32_16x16x32_bf16 v[148:151], a[0:3], a[44:47], v[148:151]
 s_waitcnt lgkmcnt(7)
 v_mfma_f32_16x16x32_bf16 v[164:167], a[4:7], a[44:47], v[164:167]
 ds_read_b64_tr_b16 a[0:1], v6 offset:8192
 v_mfma_f32_16x16x32_bf16 v[160:163], a[4:7], a[40:43], v[160:163]
 ds_read_b64_tr_b16 a[2:3], v6 offset:8704
 v_mfma_f32_16x16x32_bf16 v[156:159], a[4:7], a[36:39], v[156:159]
 v_mfma_f32_16x16x32_bf16 v[152:155], a[4:7], a[32:35], v[152:155]
 s_waitcnt lgkmcnt(6)
 v_mfma_f32_16x16x32_bf16 v[168:171], a[8:11], a[32:35], v[168:171]
 ds_read_b64_tr_b16 a[4:5], v7 offset:8192
 v_mfma_f32_16x16x32_bf16 v[172:175], a[8:11], a[36:39], v[172:175]
 ds_read_b64_tr_b16 a[6:7], v7 offset:8704
 v_mfma_f32_16x16x32_bf16 v[176:179], a[8:11], a[40:43], v[176:179]
 v_mfma_f32_16x16x32_bf16 v[180:183], a[8:11], a[44:47], v[180:183]
 s_waitcnt lgkmcnt(5)
 v_mfma_f32_16x16x32_bf16 v[196:199], a[12:15], a[44:47], v[196:199]
 ds_read_b64_tr_b16 a[8:9], v6 offset:24576
 v_mfma_f32_16x16x32_bf16 v[192:195], a[12:15], a[40:43], v[192:195]
 ds_read_b64_tr_b16 a[10:11], v6 offset:25088
 v_mfma_f32_16x16x32_bf16 v[188:191], a[12:15], a[36:39], v[188:191]
 v_mfma_f32_16x16x32_bf16 v[184:187], a[12:15], a[32:35], v[184:187]
 s_waitcnt vmcnt(5)
 s_barrier
 s_waitcnt lgkmcnt(4)
 v_mfma_f32_16x16x32_bf16 v[40:43], a[0:3], a[16:19], v[40:43]
 ds_read_b64_tr_b16 a[12:13], v7 offset:24576
 v_mfma_f32_16x16x32_bf16 v[44:47], a[0:3], a[20:23], v[44:47]
 ds_read_b64_tr_b16 a[14:15], v7 offset:25088
 v_mfma_f32_16x16x32_bf16 v[48:51], a[0:3], a[24:27], v[48:51]
 s_add_u32 m0, s39, 17408
 v_mfma_f32_16x16x32_bf16 v[52:55], a[0:3], a[28:31], v[52:55]
 buffer_load_dwordx4 v1, s[12:15], s33 offen sc1 lds
 s_waitcnt lgkmcnt(4)
 v_mfma_f32_16x16x32_bf16 v[68:71], a[4:7], a[28:31], v[68:71]
 ds_read_b64_tr_b16 a[0:1], v6 offset:40960
 v_mfma_f32_16x16x32_bf16 v[64:67], a[4:7], a[24:27], v[64:67]
 ds_read_b64_tr_b16 a[2:3], v6 offset:41472
 v_mfma_f32_16x16x32_bf16 v[60:63], a[4:7], a[20:23], v[60:63]
 v_mfma_f32_16x16x32_bf16 v[56:59], a[4:7], a[16:19], v[56:59]
 buffer_load_dwordx4 v1, s[12:15], s33 offen offset:1024 sc1 lds
 s_add_u32 s33, s33, 2048
 s_waitcnt lgkmcnt(4)
 v_mfma_f32_16x16x32_bf16 v[72:75], a[8:11], a[16:19], v[72:75]
 ds_read_b64_tr_b16 a[4:5], v7 offset:40960
 v_mfma_f32_16x16x32_bf16 v[76:79], a[8:11], a[20:23], v[76:79]
 ds_read_b64_tr_b16 a[6:7], v7 offset:41472
 v_mfma_f32_16x16x32_bf16 v[80:83], a[8:11], a[24:27], v[80:83]
 s_add_u32 m0, s40, 4096
 v_mfma_f32_16x16x32_bf16 v[84:87], a[8:11], a[28:31], v[84:87]
 buffer_load_dwordx4 v2, s[16:19], s34 offen nt lds
 s_add_u32 s34, s34, s37
 s_waitcnt lgkmcnt(4)
 v_mfma_f32_16x16x32_bf16 v[100:103], a[12:15], a[28:31], v[100:103]
 ds_read_b64_tr_b16 a[8:9], v6 offset:57344
 v_mfma_f32_16x16x32_bf16 v[96:99], a[12:15], a[24:27], v[96:99]
 ds_read_b64_tr_b16 a[10:11], v6 offset:57856
 v_mfma_f32_16x16x32_bf16 v[92:95], a[12:15], a[20:23], v[92:95]
 ds_read_b128 a[32:35], v4 offset:52224
 s_add_u32 m0, s40, 6144
 v_mfma_f32_16x16x32_bf16 v[88:91], a[12:15], a[16:19], v[88:91]
 buffer_load_dwordx4 v2, s[16:19], s35 offen nt lds
 s_add_u32 s35, s35, s37
 s_waitcnt lgkmcnt(5)
 v_mfma_f32_16x16x32_bf16 v[104:107], a[16:19], a[0:3], v[104:107]
 ds_read_b64_tr_b16 a[12:13], v7 offset:57344
 v_mfma_f32_16x16x32_bf16 v[108:111], a[20:23], a[0:3], v[108:111]
 ds_read_b64_tr_b16 a[14:15], v7 offset:57856
 v_mfma_f32_16x16x32_bf16 v[112:115], a[24:27], a[0:3], v[112:115]
 ds_read_b128 a[36:39], v4 offset:53248
 v_mfma_f32_16x16x32_bf16 v[116:119], a[28:31], a[0:3], v[116:119]
 s_waitcnt lgkmcnt(6)
 v_mfma_f32_16x16x32_bf16 v[132:135], a[28:31], a[4:7], v[132:135]
 ds_read_b64_tr_b16 a[0:1], v8 offset:8192
 v_mfma_f32_16x16x32_bf16 v[128:131], a[24:27], a[4:7], v[128:131]
 ds_read_b64_tr_b16 a[2:3], v8 offset:8704
 v_mfma_f32_16x16x32_bf16 v[124:127], a[20:23], a[4:7], v[124:127]
 ds_read_b128 a[40:43], v4 offset:54272
 v_mfma_f32_16x16x32_bf16 v[120:123], a[16:19], a[4:7], v[120:123]
 s_waitcnt lgkmcnt(7)
 v_mfma_f32_16x16x32_bf16 v[136:139], a[8:11], a[16:19], v[136:139]
 ds_read_b64_tr_b16 a[4:5], v9 offset:8192
 v_mfma_f32_16x16x32_bf16 v[140:143], a[8:11], a[20:23], v[140:143]
 ds_read_b64_tr_b16 a[6:7], v9 offset:8704
 v_mfma_f32_16x16x32_bf16 v[144:147], a[8:11], a[24:27], v[144:147]
 ds_read_b128 a[44:47], v4 offset:55296
 v_mfma_f32_16x16x32_bf16 v[148:151], a[8:11], a[28:31], v[148:151]
 s_waitcnt lgkmcnt(7)
 v_mfma_f32_16x16x32_bf16 v[164:167], a[12:15], a[28:31], v[164:167]
 ds_read_b64_tr_b16 a[8:9], v6 offset:12288
 v_mfma_f32_16x16x32_bf16 v[160:163], a[12:15], a[24:27], v[160:163]
 ds_read_b64_tr_b16 a[10:11], v6 offset:12800
 v_mfma_f32_16x16x32_bf16 v[156:159], a[12:15], a[20:23], v[156:159]
 v_mfma_f32_16x16x32_bf16 v[152:155], a[12:15], a[16:19], v[152:155]
 s_waitcnt lgkmcnt(6)
 v_mfma_f32_16x16x32_bf16 v[168:171], a[0:3], a[16:19], v[168:171]
 ds_read_b64_tr_b16 a[12:13], v7 offset:12288
 v_mfma_f32_16x16x32_bf16 v[172:175], a[0:3], a[20:23], v[172:175]
 ds_read_b64_tr_b16 a[14:15], v7 offset:12800
 v_mfma_f32_16x16x32_bf16 v[176:179], a[0:3], a[24:27], v[176:179]
 v_mfma_f32_16x16x32_bf16 v[180:183], a[0:3], a[28:31], v[180:183]
 s_waitcnt lgkmcnt(5)
 v_mfma_f32_16x16x32_bf16 v[196:199], a[4:7], a[28:31], v[196:199]
 ds_read_b64_tr_b16 a[0:1], v6 offset:28672
 v_mfma_f32_16x16x32_bf16 v[192:195], a[4:7], a[24:27], v[192:195]
 ds_read_b64_tr_b16 a[2:3], v6 offset:29184
 v_mfma_f32_16x16x32_bf16 v[188:191], a[4:7], a[20:23], v[188:191]
 v_mfma_f32_16x16x32_bf16 v[184:187], a[4:7], a[16:19], v[184:187]
 s_waitcnt vmcnt(5)
 s_barrier
 s_waitcnt lgkmcnt(4)
 v_mfma_f32_16x16x32_bf16 v[40:43], a[8:11], a[32:35], v[40:43]
 ds_read_b64_tr_b16 a[4:5], v7 offset:28672
 v_mfma_f32_16x16x32_bf16 v[44:47], a[8:11], a[36:39], v[44:47]
 ds_read_b64_tr_b16 a[6:7], v7 offset:29184
 v_mfma_f32_16x16x32_bf16 v[48:51], a[8:11], a[40:43], v[48:51]
 s_add_u32 m0, s39, 34816
 v_mfma_f32_16x16x32_bf16 v[52:55], a[8:11], a[44:47], v[52:55]
 buffer_load_dwordx4 v1, s[12:15], s33 offen sc1 lds
 s_waitcnt lgkmcnt(4)
 v_mfma_f32_16x16x32_bf16 v[68:71], a[12:15], a[44:47], v[68:71]
 ds_read_b64_tr_b16 a[8:9], v6 offset:45056
 v_mfma_f32_16x16x32_bf16 v[64:67], a[12:15], a[40:43], v[64:67]
 ds_read_b64_tr_b16 a[10:11], v6 offset:45568
 v_mfma_f32_16x16x32_bf16 v[60:63], a[12:15], a[36:39], v[60:63]
 v_mfma_f32_16x16x32_bf16 v[56:59], a[12:15], a[32:35], v[56:59]
 buffer_load_dwordx4 v1, s[12:15], s33 offen offset:1024 sc1 lds
 s_add_u32 s33, s33, 2048
 s_waitcnt lgkmcnt(4)
 v_mfma_f32_16x16x32_bf16 v[72:75], a[0:3], a[32:35], v[72:75]
 ds_read_b64_tr_b16 a[12:13], v7 offset:45056
 v_mfma_f32_16x16x32_bf16 v[76:79], a[0:3], a[36:39], v[76:79]
 ds_read_b64_tr_b16 a[14:15], v7 offset:45568
 v_mfma_f32_16x16x32_bf16 v[80:83], a[0:3], a[40:43], v[80:83]
 s_add_u32 m0, s40, 8192
 v_mfma_f32_16x16x32_bf16 v[84:87], a[0:3], a[44:47], v[84:87]
 buffer_load_dwordx4 v2, s[16:19], s34 offen nt lds
 s_add_u32 s34, s34, s37
 s_waitcnt lgkmcnt(4)
 v_mfma_f32_16x16x32_bf16 v[100:103], a[4:7], a[44:47], v[100:103]
 ds_read_b64_tr_b16 a[0:1], v6 offset:61440
 v_mfma_f32_16x16x32_bf16 v[96:99], a[4:7], a[40:43], v[96:99]
 ds_read_b64_tr_b16 a[2:3], v6 offset:61952
 v_mfma_f32_16x16x32_bf16 v[92:95], a[4:7], a[36:39], v[92:95]
 ds_read_b128 a[16:19], v4 offset:0
 s_add_u32 m0, s40, 10240
 v_mfma_f32_16x16x32_bf16 v[88:91], a[4:7], a[32:35], v[88:91]
 buffer_load_dwordx4 v2, s[16:19], s35 offen nt lds
 s_add_u32 s35, s35, s37
 s_waitcnt lgkmcnt(5)
 v_mfma_f32_16x16x32_bf16 v[104:107], a[32:35], a[8:11], v[104:107]
 ds_read_b64_tr_b16 a[4:5], v7 offset:61440
 v_mfma_f32_16x16x32_bf16 v[108:111], a[36:39], a[8:11], v[108:111]
 ds_read_b64_tr_b16 a[6:7], v7 offset:61952
 v_mfma_f32_16x16x32_bf16 v[112:115], a[40:43], a[8:11], v[112:115]
 ds_read_b128 a[20:23], v4 offset:1024
 v_mfma_f32_16x16x32_bf16 v[116:119], a[44:47], a[8:11], v[116:119]
 s_waitcnt lgkmcnt(6)
 v_mfma_f32_16x16x32_bf16 v[132:135], a[44:47], a[12:15], v[132:135]
 ds_read_b64_tr_b16 a[8:9], v8 offset:12288
 v_mfma_f32_16x16x32_bf16 v[128:131], a[40:43], a[12:15], v[128:131]
 ds_read_b64_tr_b16 a[10:11], v8 offset:12800
 v_mfma_f32_16x16x32_bf16 v[124:127], a[36:39], a[12:15], v[124:127]
 ds_read_b128 a[24:27], v4 offset:2048
 v_mfma_f32_16x16x32_bf16 v[120:123], a[32:35], a[12:15], v[120:123]
 s_cmp_eq_u32 s45, s89
 s_cselect_b64 vcc, -1, 0
 v_cndmask_b32 v15, v14, v13, vcc
 buffer_load_dword v31, v15, s[80:83], 0 offen
 s_waitcnt lgkmcnt(7)
 v_mfma_f32_16x16x32_bf16 v[136:139], a[0:3], a[32:35], v[136:139]
 ds_read_b64_tr_b16 a[12:13], v9 offset:12288
 v_mfma_f32_16x16x32_bf16 v[140:143], a[0:3], a[36:39], v[140:143]
 ds_read_b64_tr_b16 a[14:15], v9 offset:12800
 v_mfma_f32_16x16x32_bf16 v[144:147], a[0:3], a[40:43], v[144:147]
 ds_read_b128 a[28:31], v4 offset:3072
 v_mfma_f32_16x16x32_bf16 v[148:151], a[0:3], a[44:47], v[148:151]
 s_waitcnt lgkmcnt(7)
 v_mfma_f32_16x16x32_bf16 v[164:167], a[4:7], a[44:47], v[164:167]
 ds_read_b64_tr_b16 a[0:1], v6 offset:0
 v_mfma_f32_16x16x32_bf16 v[160:163], a[4:7], a[40:43], v[160:163]
 ds_read_b64_tr_b16 a[2:3], v6 offset:512
 v_mfma_f32_16x16x32_bf16 v[156:159], a[4:7], a[36:39], v[156:159]
 v_mfma_f32_16x16x32_bf16 v[152:155], a[4:7], a[32:35], v[152:155]
 s_waitcnt lgkmcnt(6)
 v_mfma_f32_16x16x32_bf16 v[168:171], a[8:11], a[32:35], v[168:171]
 ds_read_b64_tr_b16 a[4:5], v7 offset:0
 v_mfma_f32_16x16x32_bf16 v[172:175], a[8:11], a[36:39], v[172:175]
 ds_read_b64_tr_b16 a[6:7], v7 offset:512
 v_mfma_f32_16x16x32_bf16 v[176:179], a[8:11], a[40:43], v[176:179]
 v_mfma_f32_16x16x32_bf16 v[180:183], a[8:11], a[44:47], v[180:183]
 s_waitcnt lgkmcnt(5)
 v_mfma_f32_16x16x32_bf16 v[196:199], a[12:15], a[44:47], v[196:199]
 ds_read_b64_tr_b16 a[8:9], v6 offset:16384
 v_mfma_f32_16x16x32_bf16 v[192:195], a[12:15], a[40:43], v[192:195]
 ds_read_b64_tr_b16 a[10:11], v6 offset:16896
 v_mfma_f32_16x16x32_bf16 v[188:191], a[12:15], a[36:39], v[188:191]
 v_mfma_f32_16x16x32_bf16 v[184:187], a[12:15], a[32:35], v[184:187]
 s_waitcnt vmcnt(5)
 s_barrier
 s_sub_u32 s45, s45, 1
 s_cmp_lg_u32 s45, 0
 s_cbranch_scc1 L_loop_X_n_0
 s_waitcnt lgkmcnt(4)
 v_mfma_f32_16x16x32_bf16 v[40:43], a[0:3], a[16:19], v[40:43]
 ds_read_b64_tr_b16 a[12:13], v7 offset:16384
 v_mfma_f32_16x16x32_bf16 v[44:47], a[0:3], a[20:23], v[44:47]
 ds_read_b64_tr_b16 a[14:15], v7 offset:16896
 v_mfma_f32_16x16x32_bf16 v[48:51], a[0:3], a[24:27], v[48:51]
 s_add_u32 m0, s39, 52224
 v_mfma_f32_16x16x32_bf16 v[52:55], a[0:3], a[28:31], v[52:55]
 buffer_load_dwordx4 v1, s[12:15], s33 offen sc1 lds
 s_waitcnt lgkmcnt(4)
 v_mfma_f32_16x16x32_bf16 v[68:71], a[4:7], a[28:31], v[68:71]
 ds_read_b64_tr_b16 a[0:1], v6 offset:32768
 v_mfma_f32_16x16x32_bf16 v[64:67], a[4:7], a[24:27], v[64:67]
 ds_read_b64_tr_b16 a[2:3], v6 offset:33280
 v_mfma_f32_16x16x32_bf16 v[60:63], a[4:7], a[20:23], v[60:63]
 v_mfma_f32_16x16x32_bf16 v[56:59], a[4:7], a[16:19], v[56:59]
 buffer_load_dwordx4 v1, s[12:15], s33 offen offset:1024 sc1 lds
 s_add_u32 s33, s33, 2048
 s_waitcnt lgkmcnt(4)
 v_mfma_f32_16x16x32_bf16 v[72:75], a[8:11], a[16:19], v[72:75]
 ds_read_b64_tr_b16 a[4:5], v7 offset:32768
 v_mfma_f32_16x16x32_bf16 v[76:79], a[8:11], a[20:23], v[76:79]
 ds_read_b64_tr_b16 a[6:7], v7 offset:33280
 v_mfma_f32_16x16x32_bf16 v[80:83], a[8:11], a[24:27], v[80:83]
 s_add_u32 m0, s40, 12288
 v_mfma_f32_16x16x32_bf16 v[84:87], a[8:11], a[28:31], v[84:87]
 buffer_load_dwordx4 v2, s[16:19], s34 offen nt lds
 s_add_u32 s34, s34, s37
 s_waitcnt lgkmcnt(4)
 v_mfma_f32_16x16x32_bf16 v[100:103], a[12:15], a[28:31], v[100:103]
 ds_read_b64_tr_b16 a[8:9], v6 offset:49152
 v_mfma_f32_16x16x32_bf16 v[96:99], a[12:15], a[24:27], v[96:99]
 ds_read_b64_tr_b16 a[10:11], v6 offset:49664
 v_mfma_f32_16x16x32_bf16 v[92:95], a[12:15], a[20:23], v[92:95]
 ds_read_b128 a[32:35], v4 offset:17408
 s_add_u32 m0, s40, 14336
 v_mfma_f32_16x16x32_bf16 v[88:91], a[12:15], a[16:19], v[88:91]
 buffer_load_dwordx4 v2, s[16:19], s35 offen nt lds
 s_add_u32 s35, s35, s37
 s_waitcnt lgkmcnt(5)
 v_mfma_f32_16x16x32_bf16 v[104:107], a[16:19], a[0:3], v[104:107]
 ds_read_b64_tr_b16 a[12:13], v7 offset:49152
 v_mfma_f32_16x16x32_bf16 v[108:111], a[20:23], a[0:3], v[108:111]
 ds_read_b64_tr_b16 a[14:15], v7 offset:49664
 v_mfma_f32_16x16x32_bf16 v[112:115], a[24:27], a[0:3], v[112:115]
 ds_read_b128 a[36:39], v4 offset:18432
 v_mfma_f32_16x16x32_bf16 v[116:119], a[28:31], a[0:3], v[116:119]
 s_waitcnt lgkmcnt(6)
 v_mfma_f32_16x16x32_bf16 v[132:135], a[28:31], a[4:7], v[132:135]
 ds_read_b64_tr_b16 a[0:1], v8 offset:0
 v_mfma_f32_16x16x32_bf16 v[128:131], a[24:27], a[4:7], v[128:131]
 ds_read_b64_tr_b16 a[2:3], v8 offset:512
 v_mfma_f32_16x16x32_bf16 v[124:127], a[20:23], a[4:7], v[124:127]
 ds_read_b128 a[40:43], v4 offset:19456
 v_mfma_f32_16x16x32_bf16 v[120:123], a[16:19], a[4:7], v[120:123]
 s_waitcnt lgkmcnt(7)
 v_mfma_f32_16x16x32_bf16 v[136:139], a[8:11], a[16:19], v[136:139]
 ds_read_b64_tr_b16 a[4:5], v9 offset:0
 v_mfma_f32_16x16x32_bf16 v[140:143], a[8:11], a[20:23], v[140:143]
 ds_read_b64_tr_b16 a[6:7], v9 offset:512
 v_mfma_f32_16x16x32_bf16 v[144:147], a[8:11], a[24:27], v[144:147]
 ds_read_b128 a[44:47], v4 offset:20480
 v_mfma_f32_16x16x32_bf16 v[148:151], a[8:11], a[28:31], v[148:151]
 s_waitcnt lgkmcnt(7)
 v_mfma_f32_16x16x32_bf16 v[164:167], a[12:15], a[28:31], v[164:167]
 ds_read_b64_tr_b16 a[8:9], v6 offset:4096
 v_mfma_f32_16x16x32_bf16 v[160:163], a[12:15], a[24:27], v[160:163]
 ds_read_b64_tr_b16 a[10:11], v6 offset:4608
 v_mfma_f32_16x16x32_bf16 v[156:159], a[12:15], a[20:23], v[156:159]
 v_mfma_f32_16x16x32_bf16 v[152:155], a[12:15], a[16:19], v[152:155]
 s_waitcnt lgkmcnt(6)
 v_mfma_f32_16x16x32_bf16 v[168:171], a[0:3], a[16:19], v[168:171]
 ds_read_b64_tr_b16 a[12:13], v7 offset:4096
 v_mfma_f32_16x16x32_bf16 v[172:175], a[0:3], a[20:23], v[172:175]
 ds_read_b64_tr_b16 a[14:15], v7 offset:4608
 v_mfma_f32_16x16x32_bf16 v[176:179], a[0:3], a[24:27], v[176:179]
 v_mfma_f32_16x16x32_bf16 v[180:183], a[0:3], a[28:31], v[180:183]
 s_waitcnt lgkmcnt(5)
 v_mfma_f32_16x16x32_bf16 v[196:199], a[4:7], a[28:31], v[196:199]
 ds_read_b64_tr_b16 a[0:1], v6 offset:20480
 v_mfma_f32_16x16x32_bf16 v[192:195], a[4:7], a[24:27], v[192:195]
 ds_read_b64_tr_b16 a[2:3], v6 offset:20992
 v_mfma_f32_16x16x32_bf16 v[188:191], a[4:7], a[20:23], v[188:191]
 v_mfma_f32_16x16x32_bf16 v[184:187], a[4:7], a[16:19], v[184:187]
 s_waitcnt vmcnt(5)
 s_barrier
 s_waitcnt lgkmcnt(4)
 v_mfma_f32_16x16x32_bf16 v[40:43], a[8:11], a[32:35], v[40:43]
 ds_read_b64_tr_b16 a[4:5], v7 offset:20480
 v_mfma_f32_16x16x32_bf16 v[44:47], a[8:11], a[36:39], v[44:47]
 ds_read_b64_tr_b16 a[6:7], v7 offset:20992
 v_mfma_f32_16x16x32_bf16 v[48:51], a[8:11], a[40:43], v[48:51]
 s_add_u32 m0, s39, 0
 v_mfma_f32_16x16x32_bf16 v[52:55], a[8:11], a[44:47], v[52:55]
 buffer_load_dwordx4 v1, s[12:15], s33 offen sc1 lds
 s_waitcnt lgkmcnt(4)
 v_mfma_f32_16x16x32_bf16 v[68:71], a[12:15], a[44:47], v[68:71]
 ds_read_b64_tr_b16 a[8:9], v6 offset:36864
 v_mfma_f32_16x16x32_bf16 v[64:67], a[12:15], a[40:43], v[64:67]
 ds_read_b64_tr_b16 a[10:11], v6 offset:37376
 v_mfma_f32_16x16x32_bf16 v[60:63], a[12:15], a[36:39], v[60:63]
 v_mfma_f32_16x16x32_bf16 v[56:59], a[12:15], a[32:35], v[56:59]
 buffer_load_dwordx4 v1, s[12:15], s33 offen offset:1024 sc1 lds
 s_add_u32 s33, s33, 2048
 s_waitcnt lgkmcnt(4)
 v_mfma_f32_16x16x32_bf16 v[72:75], a[0:3], a[32:35], v[72:75]
 ds_read_b64_tr_b16 a[12:13], v7 offset:36864
 v_mfma_f32_16x16x32_bf16 v[76:79], a[0:3], a[36:39], v[76:79]
 ds_read_b64_tr_b16 a[14:15], v7 offset:37376
 v_mfma_f32_16x16x32_bf16 v[80:83], a[0:3], a[40:43], v[80:83]
 s_add_u32 m0, s40, 0
 v_mfma_f32_16x16x32_bf16 v[84:87], a[0:3], a[44:47], v[84:87]
 buffer_load_dwordx4 v2, s[16:19], s34 offen nt lds
 s_add_u32 s34, s34, s37
 s_waitcnt lgkmcnt(4)
 v_mfma_f32_16x16x32_bf16 v[100:103], a[4:7], a[44:47], v[100:103]
 ds_read_b64_tr_b16 a[0:1], v6 offset:53248
 v_mfma_f32_16x16x32_bf16 v[96:99], a[4:7], a[40:43], v[96:99]
 ds_read_b64_tr_b16 a[2:3], v6 offset:53760
 v_mfma_f32_16x16x32_bf16 v[92:95], a[4:7], a[36:39], v[92:95]
 ds_read_b128 a[16:19], v4 offset:34816
 s_add_u32 m0, s40, 2048
 v_mfma_f32_16x16x32_bf16 v[88:91], a[4:7], a[32:35], v[88:91]
 buffer_load_dwordx4 v2, s[16:19], s35 offen nt lds
 s_add_u32 s35, s35, s37
 s_waitcnt lgkmcnt(5)
 v_mfma_f32_16x16x32_bf16 v[104:107], a[32:35], a[8:11], v[104:107]
 ds_read_b64_tr_b16 a[4:5], v7 offset:53248
 v_mfma_f32_16x16x32_bf16 v[108:111], a[36:39], a[8:11], v[108:111]
 ds_read_b64_tr_b16 a[6:7], v7 offset:53760
 v_mfma_f32_16x16x32_bf16 v[112:115], a[40:43], a[8:11], v[112:115]
 ds_read_b128 a[20:23], v4 offset:35840
 v_mfma_f32_16x16x32_bf16 v[116:119], a[44:47], a[8:11], v[116:119]
 s_waitcnt lgkmcnt(6)
 v_mfma_f32_16x16x32_bf16 v[132:135], a[44:47], a[12:15], v[132:135]
 ds_read_b64_tr_b16 a[8:9], v8 offset:4096
 v_mfma_f32_16x16x32_bf16 v[128:131], a[40:43], a[12:15], v[128:131]
 ds_read_b64_tr_b16 a[10:11], v8 offset:4608
 v_mfma_f32_16x16x32_bf16 v[124:127], a[36:39], a[12:15], v[124:127]
 ds_read_b128 a[24:27], v4 offset:36864
 v_mfma_f32_16x16x32_bf16 v[120:123], a[32:35], a[12:15], v[120:123]
 s_waitcnt lgkmcnt(7)
 v_mfma_f32_16x16x32_bf16 v[136:139], a[0:3], a[32:35], v[136:139]
 ds_read_b64_tr_b16 a[12:13], v9 offset:4096
 v_mfma_f32_16x16x32_bf16 v[140:143], a[0:3], a[36:39], v[140:143]
 ds_read_b64_tr_b16 a[14:15], v9 offset:4608
 v_mfma_f32_16x16x32_bf16 v[144:147], a[0:3], a[40:43], v[144:147]
 ds_read_b128 a[28:31], v4 offset:37888
 v_mfma_f32_16x16x32_bf16 v[148:151], a[0:3], a[44:47], v[148:151]
 s_waitcnt lgkmcnt(7)
 v_mfma_f32_16x16x32_bf16 v[164:167], a[4:7], a[44:47], v[164:167]
 ds_read_b64_tr_b16 a[0:1], v6 offset:8192
 v_mfma_f32_16x16x32_bf16 v[160:163], a[4:7], a[40:43], v[160:163]
 ds_read_b64_tr_b16 a[2:3], v6 offset:8704
 v_mfma_f32_16x16x32_bf16 v[156:159], a[4:7], a[36:39], v[156:159]
 v_mfma_f32_16x16x32_bf16 v[152:155], a[4:7], a[32:35], v[152:155]
 s_waitcnt lgkmcnt(6)
 v_mfma_f32_16x16x32_bf16 v[168:171], a[8:11], a[32:35], v[168:171]
 ds_read_b64_tr_b16 a[4:5], v7 offset:8192
 v_mfma_f32_16x16x32_bf16 v[172:175], a[8:11], a[36:39], v[172:175]
 ds_read_b64_tr_b16 a[6:7], v7 offset:8704
 v_mfma_f32_16x16x32_bf16 v[176:179], a[8:11], a[40:43], v[176:179]
 v_mfma_f32_16x16x32_bf16 v[180:183], a[8:11], a[44:47], v[180:183]
 s_waitcnt lgkmcnt(5)
 v_mfma_f32_16x16x32_bf16 v[196:199], a[12:15], a[44:47], v[196:199]
 ds_read_b64_tr_b16 a[8:9], v6 offset:24576
 v_mfma_f32_16x16x32_bf16 v[192:195], a[12:15], a[40:43], v[192:195]
 ds_read_b64_tr_b16 a[10:11], v6 offset:25088
 v_mfma_f32_16x16x32_bf16 v[188:191], a[12:15], a[36:39], v[188:191]
 v_mfma_f32_16x16x32_bf16 v[184:187], a[12:15], a[32:35], v[184:187]
 s_waitcnt vmcnt(4)
 s_barrier
 s_waitcnt lgkmcnt(4)
 v_mfma_f32_16x16x32_bf16 v[40:43], a[0:3], a[16:19], v[40:43]
 ds_read_b64_tr_b16 a[12:13], v7 offset:24576
 v_mfma_f32_16x16x32_bf16 v[44:47], a[0:3], a[20:23], v[44:47]
 ds_read_b64_tr_b16 a[14:15], v7 offset:25088
 v_mfma_f32_16x16x32_bf16 v[48:51], a[0:3], a[24:27], v[48:51]
 s_add_u32 m0, s39, 17408
 v_mfma_f32_16x16x32_bf16 v[52:55], a[0:3], a[28:31], v[52:55]
 buffer_load_dwordx4 v1, s[12:15], s33 offen sc1 lds
 s_waitcnt lgkmcnt(4)
 v_mfma_f32_16x16x32_bf16 v[68:71], a[4:7], a[28:31], v[68:71]
 ds_read_b64_tr_b16 a[0:1], v6 offset:40960
 v_mfma_f32_16x16x32_bf16 v[64:67], a[4:7], a[24:27], v[64:67]
 ds_read_b64_tr_b16 a[2:3], v6 offset:41472
 v_mfma_f32_16x16x32_bf16 v[60:63], a[4:7], a[20:23], v[60:63]
 v_mfma_f32_16x16x32_bf16 v[56:59], a[4:7], a[16:19], v[56:59]
 buffer_load_dwordx4 v1, s[12:15], s33 offen offset:1024 sc1 lds
 s_add_u32 s33, s33, 2048
 s_waitcnt lgkmcnt(4)
 v_mfma_f32_16x16x32_bf16 v[72:75], a[8:11], a[16:19], v[72:75]
 ds_read_b64_tr_b16 a[4:5], v7 offset:40960
 v_mfma_f32_16x16x32_bf16 v[76:79], a[8:11], a[20:23], v[76:79]
 ds_read_b64_tr_b16 a[6:7], v7 offset:41472
 v_mfma_f32_16x16x32_bf16 v[80:83], a[8:11], a[24:27], v[80:83]
 s_add_u32 m0, s40, 4096
 v_mfma_f32_16x16x32_bf16 v[84:87], a[8:11], a[28:31], v[84:87]
 buffer_load_dwordx4 v2, s[16:19], s34 offen nt lds
 s_add_u32 s34, s34, s37
 s_waitcnt lgkmcnt(4)
 v_mfma_f32_16x16x32_bf16 v[100:103], a[12:15], a[28:31], v[100:103]
 ds_read_b64_tr_b16 a[8:9], v6 offset:57344
 v_mfma_f32_16x16x32_bf16 v[96:99], a[12:15], a[24:27], v[96:99]
 ds_read_b64_tr_b16 a[10:11], v6 offset:57856
 v_mfma_f32_16x16x32_bf16 v[92:95], a[12:15], a[20:23], v[92:95]
 ds_read_b128 a[32:35], v4 offset:52224
 s_add_u32 m0, s40, 6144
 v_mfma_f32_16x16x32_bf16 v[88:91], a[12:15], a[16:19], v[88:91]
 buffer_load_dwordx4 v2, s[16:19], s35 offen nt lds
 s_add_u32 s35, s35, s37
 s_waitcnt lgkmcnt(5)
 v_mfma_f32_16x16x32_bf16 v[104:107], a[16:19], a[0:3], v[104:107]
 ds_read_b64_tr_b16 a[12:13], v7 offset:57344
 v_mfma_f32_16x16x32_bf16 v[108:111], a[20:23], a[0:3], v[108:111]
 ds_read_b64_tr_b16 a[14:15], v7 offset:57856
 v_mfma_f32_16x16x32_bf16 v[112:115], a[24:27], a[0:3], v[112:115]
 ds_read_b128 a[36:39], v4 offset:53248
 v_mfma_f32_16x16x32_bf16 v[116:119], a[28:31], a[0:3], v[116:119]
 s_waitcnt lgkmcnt(6)
 v_mfma_f32_16x16x32_bf16 v[132:135], a[28:31], a[4:7], v[132:135]
 ds_read_b64_tr_b16 a[0:1], v8 offset:8192
 v_mfma_f32_16x16x32_bf16 v[128:131], a[24:27], a[4:7], v[128:131]
 ds_read_b64_tr_b16 a[2:3], v8 offset:8704
 v_mfma_f32_16x16x32_bf16 v[124:127], a[20:23], a[4:7], v[124:127]
 ds_read_b128 a[40:43], v4 offset:54272
 v_mfma_f32_16x16x32_bf16 v[120:123], a[16:19], a[4:7], v[120:123]
 s_waitcnt lgkmcnt(7)
 v_mfma_f32_16x16x32_bf16 v[136:139], a[8:11], a[16:19], v[136:139]
 ds_read_b64_tr_b16 a[4:5], v9 offset:8192
 v_mfma_f32_16x16x32_bf16 v[140:143], a[8:11], a[20:23], v[140:143]
 ds_read_b64_tr_b16 a[6:7], v9 offset:8704
 v_mfma_f32_16x16x32_bf16 v[144:147], a[8:11], a[24:27], v[144:147]
 ds_read_b128 a[44:47], v4 offset:55296
 v_mfma_f32_16x16x32_bf16 v[148:151], a[8:11], a[28:31], v[148:151]
 s_waitcnt lgkmcnt(7)
 v_mfma_f32_16x16x32_bf16 v[164:167], a[12:15], a[28:31], v[164:167]
 ds_read_b64_tr_b16 a[8:9], v6 offset:12288
 v_mfma_f32_16x16x32_bf16 v[160:163], a[12:15], a[24:27], v[160:163]
 ds_read_b64_tr_b16 a[10:11], v6 offset:12800
 v_mfma_f32_16x16x32_bf16 v[156:159], a[12:15], a[20:23], v[156:159]
 v_mfma_f32_16x16x32_bf16 v[152:155], a[12:15], a[16:19], v[152:155]
 s_waitcnt lgkmcnt(6)
 v_mfma_f32_16x16x32_bf16 v[168:171], a[0:3], a[16:19], v[168:171]
 ds_read_b64_tr_b16 a[12:13], v7 offset:12288
 v_mfma_f32_16x16x32_bf16 v[172:175], a[0:3], a[20:23], v[172:175]
 ds_read_b64_tr_b16 a[14:15], v7 offset:12800
 v_mfma_f32_16x16x32_bf16 v[176:179], a[0:3], a[24:27], v[176:179]
 v_mfma_f32_16x16x32_bf16 v[180:183], a[0:3], a[28:31], v[180:183]
 s_waitcnt lgkmcnt(5)
 v_mfma_f32_16x16x32_bf16 v[196:199], a[4:7], a[28:31], v[196:199]
 ds_read_b64_tr_b16 a[0:1], v6 offset:28672
 v_mfma_f32_16x16x32_bf16 v[192:195], a[4:7], a[24:27], v[192:195]
 ds_read_b64_tr_b16 a[2:3], v6 offset:29184
 v_mfma_f32_16x16x32_bf16 v[188:191], a[4:7], a[20:23], v[188:191]
 v_mfma_f32_16x16x32_bf16 v[184:187], a[4:7], a[16:19], v[184:187]
 s_waitcnt vmcnt(4)
 s_barrier
 s_waitcnt lgkmcnt(4)
 v_mfma_f32_16x16x32_bf16 v[40:43], a[8:11], a[32:35], v[40:43]
 ds_read_b64_tr_b16 a[4:5], v7 offset:28672
 v_mfma_f32_16x16x32_bf16 v[44:47], a[8:11], a[36:39], v[44:47]
 ds_read_b64_tr_b16 a[6:7], v7 offset:29184
 v_mfma_f32_16x16x32_bf16 v[48:51], a[8:11], a[40:43], v[48:51]
 s_add_u32 m0, s39, 34816
 v_mfma_f32_16x16x32_bf16 v[52:55], a[8:11], a[44:47], v[52:55]
 buffer_load_dwordx4 v1, s[12:15], s33 offen sc1 lds
 s_waitcnt lgkmcnt(4)
 v_mfma_f32_16x16x32_bf16 v[68:71], a[12:15], a[44:47], v[68:71]
 ds_read_b64_tr_b16 a[8:9], v6 offset:45056
 v_mfma_f32_16x16x32_bf16 v[64:67], a[12:15], a[40:43], v[64:67]
 ds_read_b64_tr_b16 a[10:11], v6 offset:45568
 v_mfma_f32_16x16x32_bf16 v[60:63], a[12:15], a[36:39], v[60:63]
 v_mfma_f32_16x16x32_bf16 v[56:59], a[12:15], a[32:35], v[56:59]
 buffer_load_dwordx4 v1, s[12:15], s33 offen offset:1024 sc1 lds
 s_add_u32 s33, s33, 2048
 s_waitcnt lgkmcnt(4)
 v_mfma_f32_16x16x32_bf16 v[72:75], a[0:3], a[32:35], v[72:75]
 ds_read_b64_tr_b16 a[12:13], v7 offset:45056
 v_mfma_f32_16x16x32_bf16 v[76:79], a[0:3], a[36:39], v[76:79]
 ds_read_b64_tr_b16 a[14:15], v7 offset:45568
 v_mfma_f32_16x16x32_bf16 v[80:83], a[0:3], a[40:43], v[80:83]
 s_add_u32 m0, s40, 8192
 v_mfma_f32_16x16x32_bf16 v[84:87], a[0:3], a[44:47], v[84:87]
 buffer_load_dwordx4 v2, s[16:19], s34 offen nt lds
 s_add_u32 s34, s34, s37
 s_waitcnt lgkmcnt(4)
 v_mfma_f32_16x16x32_bf16 v[100:103], a[4:7], a[44:47], v[100:103]
 ds_read_b64_tr_b16 a[0:1], v6 offset:61440
 v_mfma_f32_16x16x32_bf16 v[96:99], a[4:7], a[40:43], v[96:99]
 ds_read_b64_tr_b16 a[2:3], v6 offset:61952
 v_mfma_f32_16x16x32_bf16 v[92:95], a[4:7], a[36:39], v[92:95]
 ds_read_b128 a[16:19], v4 offset:0
 s_add_u32 m0, s40, 10240
 v_mfma_f32_16x16x32_bf16 v[88:91], a[4:7], a[32:35], v[88:91]
 buffer_load_dwordx4 v2, s[16:19], s35 offen nt lds
 s_add_u32 s35, s35, s37
 s_waitcnt lgkmcnt(5)
 v_mfma_f32_16x16x32_bf16 v[104:107], a[32:35], a[8:11], v[104:107]
 ds_read_b64_tr_b16 a[4:5], v7 offset:61440
 v_mfma_f32_16x16x32_bf16 v[108:111], a[36:39], a[8:11], v[108:111]
 ds_read_b64_tr_b16 a[6:7], v7 offset:61952
 v_mfma_f32_16x16x32_bf16 v[112:115], a[40:43], a[8:11], v[112:115]
 ds_read_b128 a[20:23], v4 offset:1024
 v_mfma_f32_16x16x32_bf16 v[116:119], a[44:47], a[8:11], v[116:119]
 s_waitcnt lgkmcnt(6)
 v_mfma_f32_16x16x32_bf16 v[132:135], a[44:47], a[12:15], v[132:135]
 ds_read_b64_tr_b16 a[8:9], v8 offset:12288
 v_mfma_f32_16x16x32_bf16 v[128:131], a[40:43], a[12:15], v[128:131]
 ds_read_b64_tr_b16 a[10:11], v8 offset:12800
 v_mfma_f32_16x16x32_bf16 v[124:127], a[36:39], a[12:15], v[124:127]
 ds_read_b128 a[24:27], v4 offset:2048
 v_mfma_f32_16x16x32_bf16 v[120:123], a[32:35], a[12:15], v[120:123]
 s_waitcnt lgkmcnt(7)
 v_mfma_f32_16x16x32_bf16 v[136:139], a[0:3], a[32:35], v[136:139]
 ds_read_b64_tr_b16 a[12:13], v9 offset:12288
 v_mfma_f32_16x16x32_bf16 v[140:143], a[0:3], a[36:39], v[140:143]
 ds_read_b64_tr_b16 a[14:15], v9 offset:12800
 v_mfma_f32_16x16x32_bf16 v[144:147], a[0:3], a[40:43], v[144:147]
 ds_read_b128 a[28:31], v4 offset:3072
 v_mfma_f32_16x16x32_bf16 v[148:151], a[0:3], a[44:47], v[148:151]
 s_waitcnt lgkmcnt(7)
 v_mfma_f32_16x16x32_bf16 v[164:167], a[4:7], a[44:47], v[164:167]
 ds_read_b64_tr_b16 a[0:1], v6 offset:0
 v_mfma_f32_16x16x32_bf16 v[160:163], a[4:7], a[40:43], v[160:163]
 ds_read_b64_tr_b16 a[2:3], v6 offset:512
 v_mfma_f32_16x16x32_bf16 v[156:159], a[4:7], a[36:39], v[156:159]
 v_mfma_f32_16x16x32_bf16 v[152:155], a[4:7], a[32:35], v[152:155]
 s_waitcnt lgkmcnt(6)
 v_mfma_f32_16x16x32_bf16 v[168:171], a[8:11], a[32:35], v[168:171]
 ds_read_b64_tr_b16 a[4:5], v7 offset:0
 v_mfma_f32_16x16x32_bf16 v[172:175], a[8:11], a[36:39], v[172:175]
 ds_read_b64_tr_b16 a[6:7], v7 offset:512
 v_mfma_f32_16x16x32_bf16 v[176:179], a[8:11], a[40:43], v[176:179]
 v_mfma_f32_16x16x32_bf16 v[180:183], a[8:11], a[44:47], v[180:183]
 s_waitcnt lgkmcnt(5)
 v_mfma_f32_16x16x32_bf16 v[196:199], a[12:15], a[44:47], v[196:199]
 ds_read_b64_tr_b16 a[8:9], v6 offset:16384
 v_mfma_f32_16x16x32_bf16 v[192:195], a[12:15], a[40:43], v[192:195]
 ds_read_b64_tr_b16 a[10:11], v6 offset:16896
 v_mfma_f32_16x16x32_bf16 v[188:191], a[12:15], a[36:39], v[188:191]
 v_mfma_f32_16x16x32_bf16 v[184:187], a[12:15], a[32:35], v[184:187]
 s_waitcnt vmcnt(4)
 s_barrier
 s_waitcnt lgkmcnt(4)
 v_mfma_f32_16x16x32_bf16 v[40:43], a[0:3], a[16:19], v[40:43]
 ds_read_b64_tr_b16 a[12:13], v7 offset:16384
 v_mfma_f32_16x16x32_bf16 v[44:47], a[0:3], a[20:23], v[44:47]
 ds_read_b64_tr_b16 a[14:15], v7 offset:16896
 v_mfma_f32_16x16x32_bf16 v[48:51], a[0:3], a[24:27], v[48:51]
 s_add_u32 m0, s39, 52224
 v_mfma_f32_16x16x32_bf16 v[52:55], a[0:3], a[28:31], v[52:55]
 buffer_load_dwordx4 v1, s[12:15], s33 offen sc1 lds
 s_waitcnt lgkmcnt(4)
 v_mfma_f32_16x16x32_bf16 v[68:71], a[4:7], a[28:31], v[68:71]
 ds_read_b64_tr_b16 a[0:1], v6 offset:32768
 v_mfma_f32_16x16x32_bf16 v[64:67], a[4:7], a[24:27], v[64:67]
 ds_read_b64_tr_b16 a[2:3], v6 offset:33280
 v_mfma_f32_16x16x32_bf16 v[60:63], a[4:7], a[20:23], v[60:63]
 v_mfma_f32_16x16x32_bf16 v[56:59], a[4:7], a[16:19], v[56:59]
 buffer_load_dwordx4 v1, s[12:15], s33 offen offset:1024 sc1 lds
 s_add_u32 s33, s33, 2048
 s_waitcnt lgkmcnt(4)
 v_mfma_f32_16x16x32_bf16 v[72:75], a[8:11], a[16:19], v[72:75]
 ds_read_b64_tr_b16 a[4:5], v7 offset:32768
 v_mfma_f32_16x16x32_bf16 v[76:79], a[8:11], a[20:23], v[76:79]
 ds_read_b64_tr_b16 a[6:7], v7 offset:33280
 v_mfma_f32_16x16x32_bf16 v[80:83], a[8:11], a[24:27], v[80:83]
 s_add_u32 m0, s40, 12288
 v_mfma_f32_16x16x32_bf16 v[84:87], a[8:11], a[28:31], v[84:87]
 buffer_load_dwordx4 v2, s[16:19], s34 offen nt lds
 s_add_u32 s34, s34, s37
 s_waitcnt lgkmcnt(4)
 v_mfma_f32_16x16x32_bf16 v[100:103], a[12:15], a[28:31], v[100:103]
 ds_read_b64_tr_b16 a[8:9], v6 offset:49152
 v_mfma_f32_16x16x32_bf16 v[96:99], a[12:15], a[24:27], v[96:99]
 ds_read_b64_tr_b16 a[10:11], v6 offset:49664
 v_mfma_f32_16x16x32_bf16 v[92:95], a[12:15], a[20:23], v[92:95]
 ds_read_b128 a[32:35], v4 offset:17408
 s_add_u32 m0, s40, 14336
 v_mfma_f32_16x16x32_bf16 v[88:91], a[12:15], a[16:19], v[88:91]
 buffer_load_dwordx4 v2, s[16:19], s35 offen nt lds
 s_add_u32 s35, s35, s37
 s_waitcnt lgkmcnt(5)
 v_mfma_f32_16x16x32_bf16 v[104:107], a[16:19], a[0:3], v[104:107]
 ds_read_b64_tr_b16 a[12:13], v7 offset:49152
 v_mfma_f32_16x16x32_bf16 v[108:111], a[20:23], a[0:3], v[108:111]
 ds_read_b64_tr_b16 a[14:15], v7 offset:49664
 v_mfma_f32_16x16x32_bf16 v[112:115], a[24:27], a[0:3], v[112:115]
 ds_read_b128 a[36:39], v4 offset:18432
 v_mfma_f32_16x16x32_bf16 v[116:119], a[28:31], a[0:3], v[116:119]
 s_waitcnt lgkmcnt(6)
 v_mfma_f32_16x16x32_bf16 v[132:135], a[28:31], a[4:7], v[132:135]
 ds_read_b64_tr_b16 a[0:1], v8 offset:0
 v_mfma_f32_16x16x32_bf16 v[128:131], a[24:27], a[4:7], v[128:131]
 ds_read_b64_tr_b16 a[2:3], v8 offset:512
 v_mfma_f32_16x16x32_bf16 v[124:127], a[20:23], a[4:7], v[124:127]
 ds_read_b128 a[40:43], v4 offset:19456
 v_mfma_f32_16x16x32_bf16 v[120:123], a[16:19], a[4:7], v[120:123]
 s_waitcnt lgkmcnt(7)
 v_mfma_f32_16x16x32_bf16 v[136:139], a[8:11], a[16:19], v[136:139]
 ds_read_b64_tr_b16 a[4:5], v9 offset:0
 v_mfma_f32_16x16x32_bf16 v[140:143], a[8:11], a[20:23], v[140:143]
 ds_read_b64_tr_b16 a[6:7], v9 offset:512
 v_mfma_f32_16x16x32_bf16 v[144:147], a[8:11], a[24:27], v[144:147]
 ds_read_b128 a[44:47], v4 offset:20480
 v_mfma_f32_16x16x32_bf16 v[148:151], a[8:11], a[28:31], v[148:151]
 s_waitcnt lgkmcnt(7)
 v_mfma_f32_16x16x32_bf16 v[164:167], a[12:15], a[28:31], v[164:167]
 ds_read_b64_tr_b16 a[8:9], v6 offset:4096
 v_mfma_f32_16x16x32_bf16 v[160:163], a[12:15], a[24:27], v[160:163]
 ds_read_b64_tr_b16 a[10:11], v6 offset:4608
 v_mfma_f32_16x16x32_bf16 v[156:159], a[12:15], a[20:23], v[156:159]
 v_mfma_f32_16x16x32_bf16 v[152:155], a[12:15], a[16:19], v[152:155]
 s_waitcnt lgkmcnt(6)
 v_mfma_f32_16x16x32_bf16 v[168:171], a[0:3], a[16:19], v[168:171]
 ds_read_b64_tr_b16 a[12:13], v7 offset:4096
 v_mfma_f32_16x16x32_bf16 v[172:175], a[0:3], a[20:23], v[172:175]
 ds_read_b64_tr_b16 a[14:15], v7 offset:4608
 v_mfma_f32_16x16x32_bf16 v[176:179], a[0:3], a[24:27], v[176:179]
 v_mfma_f32_16x16x32_bf16 v[180:183], a[0:3], a[28:31], v[180:183]
 s_waitcnt lgkmcnt(5)
 v_mfma_f32_16x16x32_bf16 v[196:199], a[4:7], a[28:31], v[196:199]
 ds_read_b64_tr_b16 a[0:1], v6 offset:20480
 v_mfma_f32_16x16x32_bf16 v[192:195], a[4:7], a[24:27], v[192:195]
 ds_read_b64_tr_b16 a[2:3], v6 offset:20992
 v_mfma_f32_16x16x32_bf16 v[188:191], a[4:7], a[20:23], v[188:191]
 v_mfma_f32_16x16x32_bf16 v[184:187], a[4:7], a[16:19], v[184:187]
 s_waitcnt vmcnt(4)
 s_barrier
 s_waitcnt lgkmcnt(4)
 v_mfma_f32_16x16x32_bf16 v[40:43], a[8:11], a[32:35], v[40:43]
 ds_read_b64_tr_b16 a[4:5], v7 offset:20480
 v_mfma_f32_16x16x32_bf16 v[44:47], a[8:11], a[36:39], v[44:47]
 ds_read_b64_tr_b16 a[6:7], v7 offset:20992
 v_mfma_f32_16x16x32_bf16 v[48:51], a[8:11], a[40:43], v[48:51]
 v_mfma_f32_16x16x32_bf16 v[52:55], a[8:11], a[44:47], v[52:55]
 s_waitcnt lgkmcnt(4)
 v_mfma_f32_16x16x32_bf16 v[68:71], a[12:15], a[44:47], v[68:71]
 ds_read_b64_tr_b16 a[8:9], v6 offset:36864
 v_mfma_f32_16x16x32_bf16 v[64:67], a[12:15], a[40:43], v[64:67]
 ds_read_b64_tr_b16 a[10:11], v6 offset:37376
 v_mfma_f32_16x16x32_bf16 v[60:63], a[12:15], a[36:39], v[60:63]
 v_mfma_f32_16x16x32_bf16 v[56:59], a[12:15], a[32:35], v[56:59]
 s_waitcnt lgkmcnt(4)
 v_mfma_f32_16x16x32_bf16 v[72:75], a[0:3], a[32:35], v[72:75]
 ds_read_b64_tr_b16 a[12:13], v7 offset:36864
 v_mfma_f32_16x16x32_bf16 v[76:79], a[0:3], a[36:39], v[76:79]
 ds_read_b64_tr_b16 a[14:15], v7 offset:37376
 v_mfma_f32_16x16x32_bf16 v[80:83], a[0:3], a[40:43], v[80:83]
 v_mfma_f32_16x16x32_bf16 v[84:87], a[0:3], a[44:47], v[84:87]
 s_waitcnt lgkmcnt(4)
 v_mfma_f32_16x16x32_bf16 v[100:103], a[4:7], a[44:47], v[100:103]
 ds_read_b64_tr_b16 a[0:1], v6 offset:53248
 v_mfma_f32_16x16x32_bf16 v[96:99], a[4:7], a[40:43], v[96:99]
 ds_read_b64_tr_b16 a[2:3], v6 offset:53760
 v_mfma_f32_16x16x32_bf16 v[92:95], a[4:7], a[36:39], v[92:95]
 ds_read_b128 a[16:19], v4 offset:34816
 v_mfma_f32_16x16x32_bf16 v[88:91], a[4:7], a[32:35], v[88:91]
 s_waitcnt lgkmcnt(5)
 v_mfma_f32_16x16x32_bf16 v[104:107], a[32:35], a[8:11], v[104:107]
 ds_read_b64_tr_b16 a[4:5], v7 offset:53248
 v_mfma_f32_16x16x32_bf16 v[108:111], a[36:39], a[8:11], v[108:111]
 ds_read_b64_tr_b16 a[6:7], v7 offset:53760
 v_mfma_f32_16x16x32_bf16 v[112:115], a[40:43], a[8:11], v[112:115]
 ds_read_b128 a[20:23], v4 offset:35840
 v_mfma_f32_16x16x32_bf16 v[116:119], a[44:47], a[8:11], v[116:119]
 s_waitcnt lgkmcnt(6)
 v_mfma_f32_16x16x32_bf16 v[132:135], a[44:47], a[12:15], v[132:135]
 ds_read_b64_tr_b16 a[8:9], v8 offset:4096
 v_mfma_f32_16x16x32_bf16 v[128:131], a[40:43], a[12:15], v[128:131]
 ds_read_b64_tr_b16 a[10:11], v8 offset:4608
 v_mfma_f32_16x16x32_bf16 v[124:127], a[36:39], a[12:15], v[124:127]
 ds_read_b128 a[24:27], v4 offset:36864
 v_mfma_f32_16x16x32_bf16 v[120:123], a[32:35], a[12:15], v[120:123]
 s_waitcnt lgkmcnt(7)
 v_mfma_f32_16x16x32_bf16 v[136:139], a[0:3], a[32:35], v[136:139]
 ds_read_b64_tr_b16 a[12:13], v9 offset:4096
 v_mfma_f32_16x16x32_bf16 v[140:143], a[0:3], a[36:39], v[140:143]
 ds_read_b64_tr_b16 a[14:15], v9 offset:4608
 v_mfma_f32_16x16x32_bf16 v[144:147], a[0:3], a[40:43], v[144:147]
 ds_read_b128 a[28:31], v4 offset:37888
 v_mfma_f32_16x16x32_bf16 v[148:151], a[0:3], a[44:47], v[148:151]
 s_waitcnt lgkmcnt(7)
 v_mfma_f32_16x16x32_bf16 v[164:167], a[4:7], a[44:47], v[164:167]
 ds_read_b64_tr_b16 a[0:1], v6 offset:8192
 v_mfma_f32_16x16x32_bf16 v[160:163], a[4:7], a[40:43], v[160:163]
 ds_read_b64_tr_b16 a[2:3], v6 offset:8704
 v_mfma_f32_16x16x32_bf16 v[156:159], a[4:7], a[36:39], v[156:159]
 v_mfma_f32_16x16x32_bf16 v[152:155], a[4:7], a[32:35], v[152:155]
 s_waitcnt lgkmcnt(6)
 v_mfma_f32_16x16x32_bf16 v[168:171], a[8:11], a[32:35], v[168:171]
 ds_read_b64_tr_b16 a[4:5], v7 offset:8192
 v_mfma_f32_16x16x32_bf16 v[172:175], a[8:11], a[36:39], v[172:175]
 ds_read_b64_tr_b16 a[6:7], v7 offset:8704
 v_mfma_f32_16x16x32_bf16 v[176:179], a[8:11], a[40:43], v[176:179]
 v_mfma_f32_16x16x32_bf16 v[180:183], a[8:11], a[44:47], v[180:183]
 s_waitcnt lgkmcnt(5)
 v_mfma_f32_16x16x32_bf16 v[196:199], a[12:15], a[44:47], v[196:199]
 ds_read_b64_tr_b16 a[8:9], v6 offset:24576
 v_mfma_f32_16x16x32_bf16 v[192:195], a[12:15], a[40:43], v[192:195]
 ds_read_b64_tr_b16 a[10:11], v6 offset:25088
 v_mfma_f32_16x16x32_bf16 v[188:191], a[12:15], a[36:39], v[188:191]
 v_mfma_f32_16x16x32_bf16 v[184:187], a[12:15], a[32:35], v[184:187]
 s_waitcnt vmcnt(0)
 s_barrier
 s_load_dwordx2 s[12:13], s[0:1], 16
 s_load_dwordx2 s[16:17], s[0:1], 48
 s_load_dwordx2 s[8:9], s[0:1], 0
 s_load_dwordx2 s[40:41], s[0:1], 56
 s_and_b32 s56, s2, 7
 s_lshr_b32 s34, s56, 2
 s_lshr_b32 s57, s2, 3
 s_bfe_u32 s58, s56, 0x10001
 s_lshl_b32 s58, s58, 3
 s_and_b32 s39, s57, 7
 s_add_u32 s39, s39, s58
 s_and_b32 s58, s56, 1
 s_lshl_b32 s58, s58, 2
 s_lshr_b32 s57, s57, 3
 s_add_u32 s33, s57, s58
 s_lshr_b32 s94, s39, 1
 s_waitcnt lgkmcnt(0)
 s_and_b32 s13, s13, 0xffff
 s_mov_b32 s14, 2097152
 s_mov_b32 s15, 0x20000
 s_and_b32 s17, s17, 0xffff
 s_mov_b32 s18, 7340032
 s_mov_b32 s19, 0x20000
 s_and_b32 s9, s9, 0xffff
 s_mov_b32 s10, 4194304
 s_mov_b32 s11, 0x20000
 s_and_b32 s41, s41, 0xffff
 s_mov_b32 s42, 4194304
 s_mov_b32 s43, 0x20000
 s_add_u32 s20, s6, 25165824
 s_addc_u32 s21, s7, 0
 s_and_b32 s21, s21, 0xffff
 s_mov_b32 s22, 4194304
 s_mov_b32 s23, 0x20000
 s_waitcnt lgkmcnt(4)
 v_mfma_f32_16x16x32_bf16 v[40:43], a[0:3], a[16:19], v[40:43]
 ds_read_b64_tr_b16 a[12:13], v7 offset:24576
 v_mfma_f32_16x16x32_bf16 v[44:47], a[0:3], a[20:23], v[44:47]
 ds_read_b64_tr_b16 a[14:15], v7 offset:25088
 v_mfma_f32_16x16x32_bf16 v[48:51], a[0:3], a[24:27], v[48:51]
 v_mfma_f32_16x16x32_bf16 v[52:55], a[0:3], a[28:31], v[52:55]
 s_waitcnt lgkmcnt(4)
 v_mfma_f32_16x16x32_bf16 v[68:71], a[4:7], a[28:31], v[68:71]
 ds_read_b64_tr_b16 a[0:1], v6 offset:40960
 v_mfma_f32_16x16x32_bf16 v[64:67], a[4:7], a[24:27], v[64:67]
 ds_read_b64_tr_b16 a[2:3], v6 offset:41472
 v_mfma_f32_16x16x32_bf16 v[60:63], a[4:7], a[20:23], v[60:63]
 v_mfma_f32_16x16x32_bf16 v[56:59], a[4:7], a[16:19], v[56:59]
 s_waitcnt lgkmcnt(4)
 v_mfma_f32_16x16x32_bf16 v[72:75], a[8:11], a[16:19], v[72:75]
 ds_read_b64_tr_b16 a[4:5], v7 offset:40960
 v_mfma_f32_16x16x32_bf16 v[76:79], a[8:11], a[20:23], v[76:79]
 ds_read_b64_tr_b16 a[6:7], v7 offset:41472
 v_mfma_f32_16x16x32_bf16 v[80:83], a[8:11], a[24:27], v[80:83]
 v_mfma_f32_16x16x32_bf16 v[84:87], a[8:11], a[28:31], v[84:87]
 s_waitcnt lgkmcnt(4)
 v_mfma_f32_16x16x32_bf16 v[100:103], a[12:15], a[28:31], v[100:103]
 ds_read_b64_tr_b16 a[8:9], v6 offset:57344
 v_mfma_f32_16x16x32_bf16 v[96:99], a[12:15], a[24:27], v[96:99]
 ds_read_b64_tr_b16 a[10:11], v6 offset:57856
 v_mfma_f32_16x16x32_bf16 v[92:95], a[12:15], a[20:23], v[92:95]
 ds_read_b128 a[32:35], v4 offset:52224
 v_mfma_f32_16x16x32_bf16 v[88:91], a[12:15], a[16:19], v[88:91]
 s_waitcnt lgkmcnt(5)
 v_mfma_f32_16x16x32_bf16 v[104:107], a[16:19], a[0:3], v[104:107]
 ds_read_b64_tr_b16 a[12:13], v7 offset:57344
 v_mfma_f32_16x16x32_bf16 v[108:111], a[20:23], a[0:3], v[108:111]
 ds_read_b64_tr_b16 a[14:15], v7 offset:57856
 v_mfma_f32_16x16x32_bf16 v[112:115], a[24:27], a[0:3], v[112:115]
 ds_read_b128 a[36:39], v4 offset:53248
 v_mfma_f32_16x16x32_bf16 v[116:119], a[28:31], a[0:3], v[116:119]
 s_waitcnt lgkmcnt(6)
 v_mfma_f32_16x16x32_bf16 v[132:135], a[28:31], a[4:7], v[132:135]
 ds_read_b64_tr_b16 a[0:1], v8 offset:8192
 v_mfma_f32_16x16x32_bf16 v[128:131], a[24:27], a[4:7], v[128:131]
 ds_read_b64_tr_b16 a[2:3], v8 offset:8704
 v_mfma_f32_16x16x32_bf16 v[124:127], a[20:23], a[4:7], v[124:127]
 ds_read_b128 a[40:43], v4 offset:54272
 v_mfma_f32_16x16x32_bf16 v[120:123], a[16:19], a[4:7], v[120:123]
 s_waitcnt lgkmcnt(7)
 v_mfma_f32_16x16x32_bf16 v[136:139], a[8:11], a[16:19], v[136:139]
 ds_read_b64_tr_b16 a[4:5], v9 offset:8192
 v_mfma_f32_16x16x32_bf16 v[140:143], a[8:11], a[20:23], v[140:143]
 ds_read_b64_tr_b16 a[6:7], v9 offset:8704
 v_mfma_f32_16x16x32_bf16 v[144:147], a[8:11], a[24:27], v[144:147]
 ds_read_b128 a[44:47], v4 offset:55296
 v_mfma_f32_16x16x32_bf16 v[148:151], a[8:11], a[28:31], v[148:151]
 s_waitcnt lgkmcnt(7)
 v_mfma_f32_16x16x32_bf16 v[164:167], a[12:15], a[28:31], v[164:167]
 ds_read_b64_tr_b16 a[8:9], v6 offset:12288
 v_mfma_f32_16x16x32_bf16 v[160:163], a[12:15], a[24:27], v[160:163]
 ds_read_b64_tr_b16 a[10:11], v6 offset:12800
 v_mfma_f32_16x16x32_bf16 v[156:159], a[12:15], a[20:23], v[156:159]
 v_mfma_f32_16x16x32_bf16 v[152:155], a[12:15], a[16:19], v[152:155]
 s_waitcnt lgkmcnt(6)
 v_mfma_f32_16x16x32_bf16 v[168:171], a[0:3], a[16:19], v[168:171]
 ds_read_b64_tr_b16 a[12:13], v7 offset:12288
 v_mfma_f32_16x16x32_bf16 v[172:175], a[0:3], a[20:23], v[172:175]
 ds_read_b64_tr_b16 a[14:15], v7 offset:12800
 v_mfma_f32_16x16x32_bf16 v[176:179], a[0:3], a[24:27], v[176:179]
 v_mfma_f32_16x16x32_bf16 v[180:183], a[0:3], a[28:31], v[180:183]
 s_waitcnt lgkmcnt(5)
 v_mfma_f32_16x16x32_bf16 v[196:199], a[4:7], a[28:31], v[196:199]
 ds_read_b64_tr_b16 a[0:1], v6 offset:28672
 v_mfma_f32_16x16x32_bf16 v[192:195], a[4:7], a[24:27], v[192:195]
 ds_read_b64_tr_b16 a[2:3], v6 offset:29184
 v_mfma_f32_16x16x32_bf16 v[188:191], a[4:7], a[20:23], v[188:191]
 v_mfma_f32_16x16x32_bf16 v[184:187], a[4:7], a[16:19], v[184:187]
 s_barrier
 s_waitcnt lgkmcnt(4)
 v_mfma_f32_16x16x32_bf16 v[40:43], a[8:11], a[32:35], v[40:43]
 ds_read_b64_tr_b16 a[4:5], v7 offset:28672
 v_mfma_f32_16x16x32_bf16 v[44:47], a[8:11], a[36:39], v[44:47]
 ds_read_b64_tr_b16 a[6:7], v7 offset:29184
 v_mfma_f32_16x16x32_bf16 v[48:51], a[8:11], a[40:43], v[48:51]
 v_mfma_f32_16x16x32_bf16 v[52:55], a[8:11], a[44:47], v[52:55]
 s_waitcnt lgkmcnt(4)
 v_mfma_f32_16x16x32_bf16 v[68:71], a[12:15], a[44:47], v[68:71]
 ds_read_b64_tr_b16 a[8:9], v6 offset:45056
 v_mfma_f32_16x16x32_bf16 v[64:67], a[12:15], a[40:43], v[64:67]
 ds_read_b64_tr_b16 a[10:11], v6 offset:45568
 v_mfma_f32_16x16x32_bf16 v[60:63], a[12:15], a[36:39], v[60:63]
 v_mfma_f32_16x16x32_bf16 v[56:59], a[12:15], a[32:35], v[56:59]
 s_waitcnt lgkmcnt(4)
 v_mfma_f32_16x16x32_bf16 v[72:75], a[0:3], a[32:35], v[72:75]
 ds_read_b64_tr_b16 a[12:13], v7 offset:45056
 v_mfma_f32_16x16x32_bf16 v[76:79], a[0:3], a[36:39], v[76:79]
 ds_read_b64_tr_b16 a[14:15], v7 offset:45568
 v_mfma_f32_16x16x32_bf16 v[80:83], a[0:3], a[40:43], v[80:83]
 v_mfma_f32_16x16x32_bf16 v[84:87], a[0:3], a[44:47], v[84:87]
 s_waitcnt lgkmcnt(4)
 v_mfma_f32_16x16x32_bf16 v[100:103], a[4:7], a[44:47], v[100:103]
 ds_read_b64_tr_b16 a[0:1], v6 offset:61440
 v_mfma_f32_16x16x32_bf16 v[96:99], a[4:7], a[40:43], v[96:99]
 ds_read_b64_tr_b16 a[2:3], v6 offset:61952
 v_mfma_f32_16x16x32_bf16 v[92:95], a[4:7], a[36:39], v[92:95]
 v_mfma_f32_16x16x32_bf16 v[88:91], a[4:7], a[32:35], v[88:91]
 s_waitcnt lgkmcnt(4)
 v_mfma_f32_16x16x32_bf16 v[104:107], a[32:35], a[8:11], v[104:107]
 ds_read_b64_tr_b16 a[4:5], v7 offset:61440
 v_mfma_f32_16x16x32_bf16 v[108:111], a[36:39], a[8:11], v[108:111]
 ds_read_b64_tr_b16 a[6:7], v7 offset:61952
 v_mfma_f32_16x16x32_bf16 v[112:115], a[40:43], a[8:11], v[112:115]
 v_mfma_f32_16x16x32_bf16 v[116:119], a[44:47], a[8:11], v[116:119]
 s_waitcnt lgkmcnt(4)
 v_mfma_f32_16x16x32_bf16 v[132:135], a[44:47], a[12:15], v[132:135]
 ds_read_b64_tr_b16 a[8:9], v8 offset:12288
 v_mfma_f32_16x16x32_bf16 v[128:131], a[40:43], a[12:15], v[128:131]
 ds_read_b64_tr_b16 a[10:11], v8 offset:12800
 v_mfma_f32_16x16x32_bf16 v[124:127], a[36:39], a[12:15], v[124:127]
 v_mfma_f32_16x16x32_bf16 v[120:123], a[32:35], a[12:15], v[120:123]
 s_waitcnt lgkmcnt(4)
 v_mfma_f32_16x16x32_bf16 v[136:139], a[0:3], a[32:35], v[136:139]
 ds_read_b64_tr_b16 a[12:13], v9 offset:12288
 v_mfma_f32_16x16x32_bf16 v[140:143], a[0:3], a[36:39], v[140:143]
 ds_read_b64_tr_b16 a[14:15], v9 offset:12800
 v_mfma_f32_16x16x32_bf16 v[144:147], a[0:3], a[40:43], v[144:147]
 v_mfma_f32_16x16x32_bf16 v[148:151], a[0:3], a[44:47], v[148:151]
 s_waitcnt lgkmcnt(4)
 v_mfma_f32_16x16x32_bf16 v[164:167], a[4:7], a[44:47], v[164:167]
 v_mfma_f32_16x16x32_bf16 v[160:163], a[4:7], a[40:43], v[160:163]
 v_mfma_f32_16x16x32_bf16 v[156:159], a[4:7], a[36:39], v[156:159]
 v_mfma_f32_16x16x32_bf16 v[152:155], a[4:7], a[32:35], v[152:155]
 s_waitcnt lgkmcnt(2)
 v_mfma_f32_16x16x32_bf16 v[168:171], a[8:11], a[32:35], v[168:171]
 v_mfma_f32_16x16x32_bf16 v[172:175], a[8:11], a[36:39], v[172:175]
 v_mfma_f32_16x16x32_bf16 v[176:179], a[8:11], a[40:43], v[176:179]
 v_mfma_f32_16x16x32_bf16 v[180:183], a[8:11], a[44:47], v[180:183]
 s_waitcnt lgkmcnt(0)
 v_mfma_f32_16x16x32_bf16 v[196:199], a[12:15], a[44:47], v[196:199]
 v_mfma_f32_16x16x32_bf16 v[192:195], a[12:15], a[40:43], v[192:195]
 v_mfma_f32_16x16x32_bf16 v[188:191], a[12:15], a[36:39], v[188:191]
 v_mfma_f32_16x16x32_bf16 v[184:187], a[12:15], a[32:35], v[184:187]
 s_barrier
 s_branch L_k1_epiX
L_k1_epiX:
 s_nop 15
 s_mov_b32 s56, 0xbdd2d3e8
 s_mov_b32 s57, 0xbdd2d3e8
 v_mov_b32 v12, 0xc0135761
 v_mov_b32 v13, 0xc0135761
 v_mov_b32 v14, 1.0
 v_mov_b32 v15, 1.0
 v_lshlrev_b32 v11, 4, v0
 s_lshl_b32 s46, s31, 3
 s_lshl_b32 s47, s29, 1
 s_add_u32 s46, s46, s47
 s_mul_i32 s48, s46, 294912
 s_add_u32 s52, s6, 24117248
 s_addc_u32 s53, s7, 0
 s_and_b32 s53, s53, 0xffff
 s_mov_b32 s54, 524288
 s_mov_b32 s55, 0x20000
 s_lshl_b32 s59, s31, 4
 s_add_u32 s59, s59, s32
 s_lshl_b32 s59, s59, 1
 s_add_u32 s59, s59, s30
 s_lshl_b32 s59, s59, 11
 s_cmp_lg_u32 s29, 3
 s_cbranch_scc1 L_hs_18
 s_cmp_eq_u32 s31, 7
 s_cbranch_scc1 L_hs_18
 v_cvt_pk_bf16_f32 v20, v84, v85
 v_cvt_pk_bf16_f32 v21, v86, v87
 v_cvt_pk_bf16_f32 v22, v100, v101
 v_cvt_pk_bf16_f32 v23, v102, v103
 v_cvt_pk_bf16_f32 v24, v116, v117
 v_cvt_pk_bf16_f32 v25, v118, v119
 v_cvt_pk_bf16_f32 v26, v132, v133
 v_cvt_pk_bf16_f32 v27, v134, v135
 s_add_u32 s49, s59, 65536
 buffer_store_dwordx4 v[20:23], v11, s[52:55], s49 offen sc1
 buffer_store_dwordx4 v[24:27], v11, s[52:55], s49 offen offset:1024 sc1
 s_nop 1
L_hs_18:
 v_pk_mul_f32 v[16:17], v[136:137], v[136:137]
 v_pk_mul_f32 v[18:19], v[138:139], v[138:139]
 v_pk_mul_f32 v[20:21], v[152:153], v[152:153]
 v_pk_mul_f32 v[22:23], v[154:155], v[154:155]
 v_pk_fma_f32 v[16:17], v[16:17], s[56:57], v[12:13]
 v_pk_fma_f32 v[18:19], v[18:19], s[56:57], v[12:13]
 v_pk_fma_f32 v[20:21], v[20:21], s[56:57], v[12:13]
 v_pk_fma_f32 v[22:23], v[22:23], s[56:57], v[12:13]
 v_pk_mul_f32 v[16:17], v[16:17], v[136:137]
 v_pk_mul_f32 v[18:19], v[18:19], v[138:139]
 v_pk_mul_f32 v[20:21], v[20:21], v[152:153]
 v_pk_mul_f32 v[22:23], v[22:23], v[154:155]
 v_exp_f32 v16, v16
 v_exp_f32 v17, v17
 v_exp_f32 v18, v18
 v_exp_f32 v19, v19
 v_exp_f32 v20, v20
 v_exp_f32 v21, v21
 v_exp_f32 v22, v22
 v_exp_f32 v23, v23
 v_pk_mul_f32 v[168:169], v[168:169], v[136:137]
 v_pk_mul_f32 v[170:171], v[170:171], v[138:139]
 v_pk_mul_f32 v[184:185], v[184:185], v[152:153]
 v_pk_mul_f32 v[186:187], v[186:187], v[154:155]
 v_pk_add_f32 v[16:17], v[16:17], v[14:15]
 v_pk_add_f32 v[18:19], v[18:19], v[14:15]
 v_pk_add_f32 v[20:21], v[20:21], v[14:15]
 v_pk_add_f32 v[22:23], v[22:23], v[14:15]
 v_rcp_f32 v16, v16
 v_rcp_f32 v17, v17
 v_rcp_f32 v18, v18
 v_rcp_f32 v19, v19
 v_rcp_f32 v20, v20
 v_rcp_f32 v21, v21
 v_rcp_f32 v22, v22
 v_rcp_f32 v23, v23
 s_nop 0
 v_pk_mul_f32 v[168:169], v[168:169], v[16:17]
 v_pk_mul_f32 v[170:171], v[170:171], v[18:19]
 v_pk_mul_f32 v[184:185], v[184:185], v[20:21]
 v_pk_mul_f32 v[186:187], v[186:187], v[22:23]
 v_cvt_pk_bf16_f32 v136, v168, v169
 v_cvt_pk_bf16_f32 v137, v170, v171
 v_cvt_pk_bf16_f32 v138, v184, v185
 v_cvt_pk_bf16_f32 v139, v186, v187
 s_add_u32 s51, s48, s70
 s_add_u32 s51, s51, 0
 buffer_store_dwordx4 v[136:139], v11, s[24:27], s51 offen sc1
 v_pk_mul_f32 v[16:17], v[140:141], v[140:141]
 v_pk_mul_f32 v[18:19], v[142:143], v[142:143]
 v_pk_mul_f32 v[20:21], v[156:157], v[156:157]
 v_pk_mul_f32 v[22:23], v[158:159], v[158:159]
 v_pk_fma_f32 v[16:17], v[16:17], s[56:57], v[12:13]
 v_pk_fma_f32 v[18:19], v[18:19], s[56:57], v[12:13]
 v_pk_fma_f32 v[20:21], v[20:21], s[56:57], v[12:13]
 v_pk_fma_f32 v[22:23], v[22:23], s[56:57], v[12:13]
 v_pk_mul_f32 v[16:17], v[16:17], v[140:141]
 v_pk_mul_f32 v[18:19], v[18:19], v[142:143]
 v_pk_mul_f32 v[20:21], v[20:21], v[156:157]
 v_pk_mul_f32 v[22:23], v[22:23], v[158:159]
 v_exp_f32 v16, v16
 v_exp_f32 v17, v17
 v_exp_f32 v18, v18
 v_exp_f32 v19, v19
 v_exp_f32 v20, v20
 v_exp_f32 v21, v21
 v_exp_f32 v22, v22
 v_exp_f32 v23, v23
 v_pk_mul_f32 v[172:173], v[172:173], v[140:141]
 v_pk_mul_f32 v[174:175], v[174:175], v[142:143]
 v_pk_mul_f32 v[188:189], v[188:189], v[156:157]
 v_pk_mul_f32 v[190:191], v[190:191], v[158:159]
 v_pk_add_f32 v[16:17], v[16:17], v[14:15]
 v_pk_add_f32 v[18:19], v[18:19], v[14:15]
 v_pk_add_f32 v[20:21], v[20:21], v[14:15]
 v_pk_add_f32 v[22:23], v[22:23], v[14:15]
 v_rcp_f32 v16, v16
 v_rcp_f32 v17, v17
 v_rcp_f32 v18, v18
 v_rcp_f32 v19, v19
 v_rcp_f32 v20, v20
 v_rcp_f32 v21, v21
 v_rcp_f32 v22, v22
 v_rcp_f32 v23, v23
 s_nop 0
 v_pk_mul_f32 v[172:173], v[172:173], v[16:17]
 v_pk_mul_f32 v[174:175], v[174:175], v[18:19]
 v_pk_mul_f32 v[188:189], v[188:189], v[20:21]
 v_pk_mul_f32 v[190:191], v[190:191], v[22:23]
 v_cvt_pk_bf16_f32 v140, v172, v173
 v_cvt_pk_bf16_f32 v141, v174, v175
 v_cvt_pk_bf16_f32 v142, v188, v189
 v_cvt_pk_bf16_f32 v143, v190, v191
 s_add_u32 s51, s48, s70
 s_add_u32 s51, s51, 1024
 buffer_store_dwordx4 v[140:143], v11, s[24:27], s51 offen sc1
 v_pk_mul_f32 v[16:17], v[144:145], v[144:145]
 v_pk_mul_f32 v[18:19], v[146:147], v[146:147]
 v_pk_mul_f32 v[20:21], v[160:161], v[160:161]
 v_pk_mul_f32 v[22:23], v[162:163], v[162:163]
 v_pk_fma_f32 v[16:17], v[16:17], s[56:57], v[12:13]
 v_pk_fma_f32 v[18:19], v[18:19], s[56:57], v[12:13]
 v_pk_fma_f32 v[20:21], v[20:21], s[56:57], v[12:13]
 v_pk_fma_f32 v[22:23], v[22:23], s[56:57], v[12:13]
 v_pk_mul_f32 v[16:17], v[16:17], v[144:145]
 v_pk_mul_f32 v[18:19], v[18:19], v[146:147]
 v_pk_mul_f32 v[20:21], v[20:21], v[160:161]
 v_pk_mul_f32 v[22:23], v[22:23], v[162:163]
 v_exp_f32 v16, v16
 v_exp_f32 v17, v17
 v_exp_f32 v18, v18
 v_exp_f32 v19, v19
 v_exp_f32 v20, v20
 v_exp_f32 v21, v21
 v_exp_f32 v22, v22
 v_exp_f32 v23, v23
 v_pk_mul_f32 v[176:177], v[176:177], v[144:145]
 v_pk_mul_f32 v[178:179], v[178:179], v[146:147]
 v_pk_mul_f32 v[192:193], v[192:193], v[160:161]
 v_pk_mul_f32 v[194:195], v[194:195], v[162:163]
 v_pk_add_f32 v[16:17], v[16:17], v[14:15]
 v_pk_add_f32 v[18:19], v[18:19], v[14:15]
 v_pk_add_f32 v[20:21], v[20:21], v[14:15]
 v_pk_add_f32 v[22:23], v[22:23], v[14:15]
 v_rcp_f32 v16, v16
 v_rcp_f32 v17, v17
 v_rcp_f32 v18, v18
 v_rcp_f32 v19, v19
 v_rcp_f32 v20, v20
 v_rcp_f32 v21, v21
 v_rcp_f32 v22, v22
 v_rcp_f32 v23, v23
 s_nop 0
 v_pk_mul_f32 v[176:177], v[176:177], v[16:17]
 v_pk_mul_f32 v[178:179], v[178:179], v[18:19]
 v_pk_mul_f32 v[192:193], v[192:193], v[20:21]
 v_pk_mul_f32 v[194:195], v[194:195], v[22:23]
 v_cvt_pk_bf16_f32 v144, v176, v177
 v_cvt_pk_bf16_f32 v145, v178, v179
 v_cvt_pk_bf16_f32 v146, v192, v193
 v_cvt_pk_bf16_f32 v147, v194, v195
 s_add_u32 s51, s48, s70
 s_add_u32 s51, s51, 294912
 buffer_store_dwordx4 v[144:147], v11, s[24:27], s51 offen sc1
 v_pk_mul_f32 v[16:17], v[148:149], v[148:149]
 v_pk_mul_f32 v[18:19], v[150:151], v[150:151]
 v_pk_mul_f32 v[20:21], v[164:165], v[164:165]
 v_pk_mul_f32 v[22:23], v[166:167], v[166:167]
 v_pk_fma_f32 v[16:17], v[16:17], s[56:57], v[12:13]
 v_pk_fma_f32 v[18:19], v[18:19], s[56:57], v[12:13]
 v_pk_fma_f32 v[20:21], v[20:21], s[56:57], v[12:13]
 v_pk_fma_f32 v[22:23], v[22:23], s[56:57], v[12:13]
 v_pk_mul_f32 v[16:17], v[16:17], v[148:149]
 v_pk_mul_f32 v[18:19], v[18:19], v[150:151]
 v_pk_mul_f32 v[20:21], v[20:21], v[164:165]
 v_pk_mul_f32 v[22:23], v[22:23], v[166:167]
 v_exp_f32 v16, v16
 v_exp_f32 v17, v17
 v_exp_f32 v18, v18
 v_exp_f32 v19, v19
 v_exp_f32 v20, v20
 v_exp_f32 v21, v21
 v_exp_f32 v22, v22
 v_exp_f32 v23, v23
 v_pk_mul_f32 v[180:181], v[180:181], v[148:149]
 v_pk_mul_f32 v[182:183], v[182:183], v[150:151]
 v_pk_mul_f32 v[196:197], v[196:197], v[164:165]
 v_pk_mul_f32 v[198:199], v[198:199], v[166:167]
 v_pk_add_f32 v[16:17], v[16:17], v[14:15]
 v_pk_add_f32 v[18:19], v[18:19], v[14:15]
 v_pk_add_f32 v[20:21], v[20:21], v[14:15]
 v_pk_add_f32 v[22:23], v[22:23], v[14:15]
 v_rcp_f32 v16, v16
 v_rcp_f32 v17, v17
 v_rcp_f32 v18, v18
 v_rcp_f32 v19, v19
 v_rcp_f32 v20, v20
 v_rcp_f32 v21, v21
 v_rcp_f32 v22, v22
 v_rcp_f32 v23, v23
 s_nop 0
 v_pk_mul_f32 v[180:181], v[180:181], v[16:17]
 v_pk_mul_f32 v[182:183], v[182:183], v[18:19]
 v_pk_mul_f32 v[196:197], v[196:197], v[20:21]
 v_pk_mul_f32 v[198:199], v[198:199], v[22:23]
 v_cvt_pk_bf16_f32 v148, v180, v181
 v_cvt_pk_bf16_f32 v149, v182, v183
 v_cvt_pk_bf16_f32 v150, v196, v197
 v_cvt_pk_bf16_f32 v151, v198, v199
 s_add_u32 s51, s48, s70
 s_add_u32 s51, s51, 295936
 buffer_store_dwordx4 v[148:151], v11, s[24:27], s51 offen sc1
 v_lshlrev_b32 v35, 3, v0
 s_lshl_b32 s49, s30, 13
 v_add_u32 v35, s49, v35
 v_cvt_pk_bf16_f32 v20, v84, v85
 v_cvt_pk_bf16_f32 v21, v86, v87
 v_cvt_pk_bf16_f32 v22, v100, v101
 v_cvt_pk_bf16_f32 v23, v102, v103
 v_cvt_pk_bf16_f32 v24, v116, v117
 v_cvt_pk_bf16_f32 v25, v118, v119
 v_cvt_pk_bf16_f32 v26, v132, v133
 v_cvt_pk_bf16_f32 v27, v134, v135
 s_lshl_b32 s49, s29, 11
 v_add_u32 v35, s49, v35
 s_cmp_eq_u32 s29, 3
 s_cbranch_scc1 L_k1_noxw
 ds_write_b64 v35, v[20:21] offset:2048
 ds_write_b64 v35, v[22:23] offset:2560
 ds_write_b64 v35, v[24:25] offset:3072
 ds_write_b64 v35, v[26:27] offset:3584
L_k1_noxw:
 s_waitcnt lgkmcnt(0)
 s_barrier
 s_cmp_eq_u32 s29, 0
 s_cbranch_scc1 L_h0_19
 ds_read_b64 v[188:189], v35 offset:0
 ds_read_b64 v[190:191], v35 offset:512
 ds_read_b64 v[168:169], v35 offset:1024
 ds_read_b64 v[178:179], v35 offset:1536
 s_branch L_h2_21
L_h0_19:
 s_cmp_eq_u32 s31, 0
 s_cbranch_scc1 L_h1_20
 buffer_load_dwordx4 v[188:191], v11, s[52:55], s59 offen sc1
 buffer_load_dwordx2 v[168:169], v11, s[52:55], s59 offen offset:1024 sc1
 buffer_load_dwordx2 v[178:179], v11, s[52:55], s59 offen offset:1032 sc1
 s_branch L_h2_21
L_h1_20:
 v_mov_b32 v188, 0
 v_mov_b32 v189, 0
 v_mov_b32 v190, 0
 v_mov_b32 v191, 0
 v_mov_b32 v168, 0
 v_mov_b32 v169, 0
 v_mov_b32 v178, 0
 v_mov_b32 v179, 0
L_h2_21:
 v_and_b32 v16, 15, v0
 v_lshrrev_b32 v17, 4, v0
 v_and_b32 v18, 1, v0
 v_cmp_eq_u32 s[80:81], 1, v18
 v_lshl_add_u32 v17, v17, 2, v18
 v_add_u32 v19, 2, v17
 v_cmp_le_u32 s[82:83], v17, v16
 v_cmp_le_u32 s[84:85], v19, v16
 v_add_u32 v16, 2, v16
 v_cmp_ge_u32 s[86:87], v17, v16
 v_cmp_ge_u32 s[88:89], v19, v16
 s_or_b32 s49, s31, s29
 s_cmp_eq_u32 s49, 0
 s_nop 1
 s_cselect_b64 s[90:91], 0, s[86:87]
 s_cselect_b64 s[92:93], 0, s[88:89]
 v_mov_b32 v32, 0x0c0c0100
 v_mov_b32 v16, 0x01000c0c
 v_cndmask_b32 v32, v32, v16, s[80:81]
 v_mov_b32 v33, 0x0c0c0302
 v_mov_b32 v16, 0x03020c0c
 v_cndmask_b32 v33, v33, v16, s[80:81]
 v_mov_b32 v34, 0xff000000
 s_mov_b32 s58, 0x3e8293ee
 v_mov_b32 v192, 0x3f803f80
 v_mov_b32 v193, 0x3f803f80
 v_mov_b32 v194, 0x3f803f80
 v_mov_b32 v195, 0x3f803f80
 v_cvt_pk_bf16_f32 v40, v40, v41
 v_cvt_pk_bf16_f32 v41, v42, v43
 v_cvt_pk_bf16_f32 v42, v56, v57
 v_cvt_pk_bf16_f32 v43, v58, v59
 v_cvt_pk_bf16_f32 v72, v72, v73
 v_cvt_pk_bf16_f32 v73, v74, v75
 v_cvt_pk_bf16_f32 v74, v88, v89
 v_cvt_pk_bf16_f32 v75, v90, v91
 v_cvt_pk_bf16_f32 v170, v104, v105
 v_cvt_pk_bf16_f32 v171, v106, v107
 v_cvt_pk_bf16_f32 v180, v120, v121
 v_cvt_pk_bf16_f32 v181, v122, v123
 v_cvt_pk_bf16_f32 v44, v44, v45
 v_cvt_pk_bf16_f32 v45, v46, v47
 v_cvt_pk_bf16_f32 v46, v60, v61
 v_cvt_pk_bf16_f32 v47, v62, v63
 v_cvt_pk_bf16_f32 v76, v76, v77
 v_cvt_pk_bf16_f32 v77, v78, v79
 v_cvt_pk_bf16_f32 v78, v92, v93
 v_cvt_pk_bf16_f32 v79, v94, v95
 v_cvt_pk_bf16_f32 v172, v108, v109
 v_cvt_pk_bf16_f32 v173, v110, v111
 v_cvt_pk_bf16_f32 v182, v124, v125
 v_cvt_pk_bf16_f32 v183, v126, v127
 v_cvt_pk_bf16_f32 v48, v48, v49
 v_cvt_pk_bf16_f32 v49, v50, v51
 v_cvt_pk_bf16_f32 v50, v64, v65
 v_cvt_pk_bf16_f32 v51, v66, v67
 v_cvt_pk_bf16_f32 v80, v80, v81
 v_cvt_pk_bf16_f32 v81, v82, v83
 v_cvt_pk_bf16_f32 v82, v96, v97
 v_cvt_pk_bf16_f32 v83, v98, v99
 v_cvt_pk_bf16_f32 v174, v112, v113
 v_cvt_pk_bf16_f32 v175, v114, v115
 v_cvt_pk_bf16_f32 v184, v128, v129
 v_cvt_pk_bf16_f32 v185, v130, v131
 v_cvt_pk_bf16_f32 v52, v52, v53
 v_cvt_pk_bf16_f32 v53, v54, v55
 v_cvt_pk_bf16_f32 v54, v68, v69
 v_cvt_pk_bf16_f32 v55, v70, v71
 v_cvt_pk_bf16_f32 v84, v84, v85
 v_cvt_pk_bf16_f32 v85, v86, v87
 v_cvt_pk_bf16_f32 v86, v100, v101
 v_cvt_pk_bf16_f32 v87, v102, v103
 v_cvt_pk_bf16_f32 v176, v116, v117
 v_cvt_pk_bf16_f32 v177, v118, v119
 v_cvt_pk_bf16_f32 v186, v132, v133
 v_cvt_pk_bf16_f32 v187, v134, v135
 s_waitcnt vmcnt(0) lgkmcnt(0)
 s_barrier
 s_cmp_lg_u32 s28, 0
 s_cbranch_scc1 L_arr_22
 s_lshl_b32 s46, s31, 5
 s_add_u32 s46, s46, 16
 v_mov_b32 v27, s46
 v_mov_b32 v28, 1
 v_cmp_eq_u32 vcc, 0, v0
 s_and_saveexec_b64 s[46:47], vcc
 buffer_atomic_add v28, v27, s[96:99], 0 offen sc1
 s_mov_b64 exec, s[46:47]
L_arr_22:
 s_cmp_lg_u32 s29, 0
 s_cbranch_scc1 L_hd_23
 s_cmp_eq_u32 s31, 0
 s_cbranch_scc1 L_hd_23
 s_mov_b32 s49, 0
L_hp_24:
 v_max3_u32 v16, v188, v189, v190
 v_max3_u32 v16, v16, v191, v168
 v_max3_u32 v16, v16, v169, v178
 v_max_u32 v16, v16, v179
 v_cmp_eq_u32 vcc, -1, v16
 s_add_u32 s49, s49, 1
 s_cbranch_vccz L_hd_23
 s_cmp_lt_u32 s49, 0x4000
 s_cbranch_scc0 L_hd_23
 s_sleep 2
 buffer_load_dwordx4 v[188:191], v11, s[52:55], s59 offen sc1
 buffer_load_dwordx2 v[168:169], v11, s[52:55], s59 offen offset:1024 sc1
 buffer_load_dwordx2 v[178:179], v11, s[52:55], s59 offen offset:1032 sc1
 s_waitcnt vmcnt(0)
 s_branch L_hp_24
L_hd_23:
 s_waitcnt lgkmcnt(0)
 s_nop 1
 v_mfma_f32_16x16x32_bf16 v[56:59], v[72:75], v[40:43], 0
 v_mfma_f32_16x16x32_bf16 v[88:91], v[188:191], v[40:43], 0
 v_mfma_f32_16x16x32_bf16 v[60:63], v[76:79], v[44:47], 0
 v_mfma_f32_16x16x32_bf16 v[92:95], v[72:75], v[44:47], 0
 v_mfma_f32_16x16x32_bf16 v[64:67], v[80:83], v[48:51], 0
 v_mfma_f32_16x16x32_bf16 v[96:99], v[76:79], v[48:51], 0
 v_mfma_f32_16x16x32_bf16 v[68:71], v[84:87], v[52:55], 0
 v_mfma_f32_16x16x32_bf16 v[100:103], v[80:83], v[52:55], 0
 s_nop 7
 v_cndmask_b32 v56, v56, v57, s[80:81]
 v_cndmask_b32 v57, v58, v59, s[80:81]
 v_cndmask_b32 v88, v88, v89, s[80:81]
 v_cndmask_b32 v89, v90, v91, s[80:81]
 v_cndmask_b32 v60, v60, v61, s[80:81]
 v_cndmask_b32 v61, v62, v63, s[80:81]
 v_cndmask_b32 v92, v92, v93, s[80:81]
 v_cndmask_b32 v93, v94, v95, s[80:81]
 v_cndmask_b32 v64, v64, v65, s[80:81]
 v_cndmask_b32 v65, v66, v67, s[80:81]
 v_cndmask_b32 v96, v96, v97, s[80:81]
 v_cndmask_b32 v97, v98, v99, s[80:81]
 v_cndmask_b32 v68, v68, v69, s[80:81]
 v_cndmask_b32 v69, v70, v71, s[80:81]
 v_cndmask_b32 v100, v100, v101, s[80:81]
 v_cndmask_b32 v101, v102, v103, s[80:81]
 v_cndmask_b32 v56, v34, v56, s[82:83]
 v_cndmask_b32 v57, v34, v57, s[84:85]
 v_cndmask_b32 v88, v34, v88, s[90:91]
 v_cndmask_b32 v89, v34, v89, s[92:93]
 v_cndmask_b32 v60, v34, v60, s[82:83]
 v_cndmask_b32 v61, v34, v61, s[84:85]
 v_cndmask_b32 v92, v34, v92, s[86:87]
 v_cndmask_b32 v93, v34, v93, s[88:89]
 v_cndmask_b32 v64, v34, v64, s[82:83]
 v_cndmask_b32 v65, v34, v65, s[84:85]
 v_cndmask_b32 v96, v34, v96, s[86:87]
 v_cndmask_b32 v97, v34, v97, s[88:89]
 v_cndmask_b32 v68, v34, v68, s[82:83]
 v_cndmask_b32 v69, v34, v69, s[84:85]
 v_cndmask_b32 v100, v34, v100, s[86:87]
 v_cndmask_b32 v101, v34, v101, s[88:89]
 v_max3_f32 v58, v56, v57, v88
 v_max3_f32 v62, v60, v61, v92
 v_max3_f32 v66, v64, v65, v96
 v_max3_f32 v70, v68, v69, v100
 v_max_f32 v58, v58, v89
 v_max_f32 v62, v62, v93
 v_max_f32 v66, v66, v97
 v_max_f32 v70, v70, v101
 v_mov_b32 v59, v58
 v_mov_b32 v63, v62
 v_mov_b32 v67, v66
 v_mov_b32 v71, v70
 s_nop 0
 v_permlane16_swap_b32 v58, v59
 v_permlane16_swap_b32 v62, v63
 v_permlane16_swap_b32 v66, v67
 v_permlane16_swap_b32 v70, v71
 s_nop 0
 v_max_f32 v58, v58, v59
 v_max_f32 v62, v62, v63
 v_max_f32 v66, v66, v67
 v_max_f32 v70, v70, v71
 v_mov_b32 v59, v58
 v_mov_b32 v63, v62
 v_mov_b32 v67, v66
 v_mov_b32 v71, v70
 s_nop 0
 v_permlane32_swap_b32 v58, v59
 v_permlane32_swap_b32 v62, v63
 v_permlane32_swap_b32 v66, v67
 v_permlane32_swap_b32 v70, v71
 s_nop 0
 v_max_f32 v58, v58, v59
 v_max_f32 v62, v62, v63
 v_max_f32 v66, v66, v67
 v_max_f32 v70, v70, v71
 v_mul_f32 v58, s58, v58
 v_mul_f32 v62, s58, v62
 v_mul_f32 v66, s58, v66
 v_mul_f32 v70, s58, v70
 v_fma_f32 v56, v56, s58, -v58
 v_fma_f32 v57, v57, s58, -v58
 v_fma_f32 v88, v88, s58, -v58
 v_fma_f32 v89, v89, s58, -v58
 v_fma_f32 v60, v60, s58, -v62
 v_fma_f32 v61, v61, s58, -v62
 v_fma_f32 v92, v92, s58, -v62
 v_fma_f32 v93, v93, s58, -v62
 v_fma_f32 v64, v64, s58, -v66
 v_fma_f32 v65, v65, s58, -v66
 v_fma_f32 v96, v96, s58, -v66
 v_fma_f32 v97, v97, s58, -v66
 v_fma_f32 v68, v68, s58, -v70
 v_fma_f32 v69, v69, s58, -v70
 v_fma_f32 v100, v100, s58, -v70
 v_fma_f32 v101, v101, s58, -v70
 v_exp_f32 v56, v56
 v_exp_f32 v57, v57
 v_exp_f32 v88, v88
 v_exp_f32 v89, v89
 v_exp_f32 v60, v60
 v_exp_f32 v61, v61
 v_exp_f32 v92, v92
 v_exp_f32 v93, v93
 v_exp_f32 v64, v64
 v_exp_f32 v65, v65
 v_exp_f32 v96, v96
 v_exp_f32 v97, v97
 v_exp_f32 v68, v68
 v_exp_f32 v69, v69
 v_exp_f32 v100, v100
 v_exp_f32 v101, v101
 s_nop 0
 v_cvt_pk_bf16_f32 v90, v88, v89
 v_cvt_pk_bf16_f32 v91, v56, v57
 v_cvt_pk_bf16_f32 v94, v92, v93
 v_cvt_pk_bf16_f32 v95, v60, v61
 v_cvt_pk_bf16_f32 v98, v96, v97
 v_cvt_pk_bf16_f32 v99, v64, v65
 v_cvt_pk_bf16_f32 v102, v100, v101
 v_cvt_pk_bf16_f32 v103, v68, v69
 v_perm_b32 v40, v90, v90, v32
 v_perm_b32 v41, v90, v90, v33
 v_perm_b32 v42, v91, v91, v32
 v_perm_b32 v43, v91, v91, v33
 v_perm_b32 v44, v94, v94, v32
 v_perm_b32 v45, v94, v94, v33
 v_perm_b32 v46, v95, v95, v32
 v_perm_b32 v47, v95, v95, v33
 v_perm_b32 v48, v98, v98, v32
 v_perm_b32 v49, v98, v98, v33
 v_perm_b32 v50, v99, v99, v32
 v_perm_b32 v51, v99, v99, v33
 v_perm_b32 v52, v102, v102, v32
 v_perm_b32 v53, v102, v102, v33
 v_perm_b32 v54, v103, v103, v32
 v_perm_b32 v55, v103, v103, v33
 s_nop 1
 v_mfma_f32_16x16x32_bf16 v[72:75], v[192:195], v[40:43], 0
 v_mfma_f32_16x16x32_bf16 v[104:107], v[168:171], v[40:43], 0
 v_mfma_f32_16x16x32_bf16 v[120:123], v[178:181], v[40:43], 0
 v_mfma_f32_16x16x32_bf16 v[76:79], v[192:195], v[44:47], 0
 v_mfma_f32_16x16x32_bf16 v[108:111], v[170:173], v[44:47], 0
 v_mfma_f32_16x16x32_bf16 v[124:127], v[180:183], v[44:47], 0
 v_mfma_f32_16x16x32_bf16 v[80:83], v[192:195], v[48:51], 0
 v_mfma_f32_16x16x32_bf16 v[112:115], v[172:175], v[48:51], 0
 v_mfma_f32_16x16x32_bf16 v[128:131], v[182:185], v[48:51], 0
 v_mfma_f32_16x16x32_bf16 v[84:87], v[192:195], v[52:55], 0
 v_mfma_f32_16x16x32_bf16 v[116:119], v[174:177], v[52:55], 0
 v_mfma_f32_16x16x32_bf16 v[132:135], v[184:187], v[52:55], 0
 s_nop 7
 v_rcp_f32 v72, v72
 v_rcp_f32 v76, v76
 v_rcp_f32 v80, v80
 v_rcp_f32 v84, v84
 s_nop 0
 v_mul_f32 v104, v104, v72
 v_mul_f32 v105, v105, v72
 v_mul_f32 v106, v106, v72
 v_mul_f32 v107, v107, v72
 v_mul_f32 v120, v120, v72
 v_mul_f32 v121, v121, v72
 v_mul_f32 v122, v122, v72
 v_mul_f32 v123, v123, v72
 v_mul_f32 v108, v108, v76
 v_mul_f32 v109, v109, v76
 v_mul_f32 v110, v110, v76
 v_mul_f32 v111, v111, v76
 v_mul_f32 v124, v124, v76
 v_mul_f32 v125, v125, v76
 v_mul_f32 v126, v126, v76
 v_mul_f32 v127, v127, v76
 v_mul_f32 v112, v112, v80
 v_mul_f32 v113, v113, v80
 v_mul_f32 v114, v114, v80
 v_mul_f32 v115, v115, v80
 v_mul_f32 v128, v128, v80
 v_mul_f32 v129, v129, v80
 v_mul_f32 v130, v130, v80
 v_mul_f32 v131, v131, v80
 v_mul_f32 v116, v116, v84
 v_mul_f32 v117, v117, v84
 v_mul_f32 v118, v118, v84
 v_mul_f32 v119, v119, v84
 v_mul_f32 v132, v132, v84
 v_mul_f32 v133, v133, v84
 v_mul_f32 v134, v134, v84
 v_mul_f32 v135, v135, v84
 s_lshl_b32 s52, s32, 1
 s_add_u32 s52, s52, s30
 s_lshl_b32 s52, s52, 11
 s_add_u32 s52, s52, s48
 v_cvt_pk_bf16_f32 v56, v104, v105
 v_cvt_pk_bf16_f32 v57, v106, v107
 v_cvt_pk_bf16_f32 v58, v120, v121
 v_cvt_pk_bf16_f32 v59, v122, v123
 s_add_u32 s51, s52, 0
 buffer_store_dwordx4 v[56:59], v11, s[24:27], s51 offen sc1
 v_cvt_pk_bf16_f32 v60, v108, v109
 v_cvt_pk_bf16_f32 v61, v110, v111
 v_cvt_pk_bf16_f32 v62, v124, v125
 v_cvt_pk_bf16_f32 v63, v126, v127
 s_add_u32 s51, s52, 1024
 buffer_store_dwordx4 v[60:63], v11, s[24:27], s51 offen sc1
 v_cvt_pk_bf16_f32 v64, v112, v113
 v_cvt_pk_bf16_f32 v65, v114, v115
 v_cvt_pk_bf16_f32 v66, v128, v129
 v_cvt_pk_bf16_f32 v67, v130, v131
 s_add_u32 s51, s52, 294912
 buffer_store_dwordx4 v[64:67], v11, s[24:27], s51 offen sc1
 v_cvt_pk_bf16_f32 v68, v116, v117
 v_cvt_pk_bf16_f32 v69, v118, v119
 v_cvt_pk_bf16_f32 v70, v132, v133
 v_cvt_pk_bf16_f32 v71, v134, v135
 s_add_u32 s51, s52, 295936
 buffer_store_dwordx4 v[68:71], v11, s[24:27], s51 offen sc1
 v_lshrrev_b32 v12, 3, v0
 v_bfe_u32 v13, v0, 1, 2
 v_bfe_u32 v14, v12, 1, 2
 v_xor_b32 v13, v13, v14
 s_and_b32 s56, s28, 1
 s_lshl_b32 s56, s56, 4
 v_add_u32 v12, s56, v12
 v_lshlrev_b32 v12, 11, v12
 v_lshl_add_u32 v12, v13, 5, v12
 v_and_b32 v13, 1, v0
 v_lshl_add_u32 v12, v13, 4, v12
 s_lshl_b32 s56, s33, 8
 s_lshl_b32 s57, s30, 7
 s_add_u32 s56, s56, s57
 v_add_u32 v2, s56, v12
 s_bfe_u32 s56, s28, 0x10001
 s_lshl_b32 s57, s34, 4
 s_add_u32 s57, s57, s56
 s_lshl_b32 s35, s57, 16
 s_mul_i32 s57, s34, 40
 s_add_u32 s57, s57, s56
 s_add_u32 s58, s57, 36
 s_lshl_b32 s44, s58, 16
 s_add_u32 s57, s57, s56
 s_add_u32 s57, s57, 32
 s_lshl_b32 s36, s57, 16
 s_mul_i32 s56, s30, 40960
 s_lshl_b32 s57, s29, 11
 s_add_u32 s56, s56, s57
 s_add_u32 s38, s56, 81920
 s_add_u32 s92, s35, 0
 s_add_u32 m0, s38, 0
 s_nop 0
 buffer_load_dwordx4 v2, s[16:19], s92 offen lds
 s_add_u32 s92, s35, 16384
 s_add_u32 m0, s38, 1024
 s_nop 0
 buffer_load_dwordx4 v2, s[16:19], s92 offen lds
 s_add_u32 s92, s35, 131072
 s_add_u32 m0, s38, 8192
 s_nop 0
 buffer_load_dwordx4 v2, s[16:19], s92 offen lds
 s_add_u32 s92, s35, 147456
 s_add_u32 m0, s38, 9216
 s_nop 0
 buffer_load_dwordx4 v2, s[16:19], s92 offen lds
 s_add_u32 s92, s35, 262144
 s_add_u32 m0, s38, 16384
 s_nop 0
 buffer_load_dwordx4 v2, s[16:19], s92 offen lds
 s_add_u32 s92, s35, 278528
 s_add_u32 m0, s38, 17408
 s_nop 0
 buffer_load_dwordx4 v2, s[16:19], s92 offen lds
 s_add_u32 s92, s35, 393216
 s_add_u32 m0, s38, 24576
 s_nop 0
 buffer_load_dwordx4 v2, s[16:19], s92 offen lds
 s_add_u32 s92, s35, 409600
 s_add_u32 m0, s38, 25600
 s_nop 0
 buffer_load_dwordx4 v2, s[16:19], s92 offen lds
 s_add_u32 s92, s35, 524288
 s_add_u32 m0, s38, 32768
 s_nop 0
 buffer_load_dwordx4 v2, s[16:19], s92 offen lds
 s_add_u32 s92, s35, 540672
 s_add_u32 m0, s38, 33792
 s_nop 0
 buffer_load_dwordx4 v2, s[16:19], s92 offen lds
 s_branch L_k1_fin
L_k1_setupY:
 s_mul_i32 s49, s32, 320
 s_add_u32 s49, s49, 2048
 s_and_b32 s50, s32, 1
 s_cmp_eq_u32 s50, 0
 s_cselect_b32 s51, 0, 64
 s_cselect_b32 s52, 256, 0
 s_add_u32 s58, s49, s51
 s_add_u32 s59, s49, s52
 s_lshr_b32 s49, s28, 1
 s_and_b32 s50, s28, 1
 s_and_b32 s55, s49, 1
 s_lshr_b32 s51, s49, 1
 s_lshl_b32 s51, s51, 7
 s_add_u32 s51, s51, s58
 s_cmp_eq_u32 s55, 1
 s_cselect_b32 s52, s10, s8
 s_cselect_b32 s53, s11, s9
 s_mov_b32 s16, s52
 s_and_b32 s17, s53, 0xffff
 s_mov_b32 s18, 7340032
 s_mov_b32 s19, 0x20000
 s_mov_b32 s53, 7168
 s_lshl_b32 s54, s50, 3
 v_add_u32 v22, s54, v19
 v_mul_lo_u32 v22, v22, s53
 s_and_b32 s54, s50, 1
 s_lshl_b32 s54, s54, 1
 v_xor_b32 v23, s54, v20
 v_lshl_add_u32 v22, v23, 5, v22
 v_lshl_add_u32 v22, v21, 4, v22
 v_add_u32 v2, s51, v22
 s_mov_b32 s37, 229376
 s_mov_b32 s34, 0
 s_mov_b32 s35, 114688
 s_lshl_b32 s52, s49, 14
 s_lshl_b32 s54, s50, 10
 s_add_u32 s52, s52, s54
 s_add_u32 s40, s52, 69632
 s_and_b32 s55, s28, 1
 s_bfe_u32 s50, s28, 0x10001
 s_cmp_eq_u32 s55, 1
 s_cselect_b32 s52, s10, s8
 s_cselect_b32 s53, s11, s9
 s_mov_b32 s20, s52
 s_and_b32 s21, s53, 0xffff
 s_mov_b32 s22, 7340032
 s_mov_b32 s23, 0x20000
 v_lshrrev_b32 v22, 2, v0
 v_bfe_u32 v14, v22, 3, 1
 s_lshl_b32 s54, s50, 4
 v_add_u32 v22, s54, v22
 s_mov_b32 s53, 7168
 v_mul_lo_u32 v22, v22, s53
 v_bfe_u32 v23, v0, 1, 1
 v_xor_b32 v23, v14, v23
 v_lshl_add_u32 v22, v23, 5, v22
 v_and_b32 v23, 1, v0
 v_lshl_add_u32 v22, v23, 4, v22
 v_add_u32 v3, s59, v22
 s_mov_b32 s38, 229376
 s_mov_b32 s36, 0
 s_lshl_b32 s54, s50, 10
 s_lshl_b32 s52, s55, 11
 s_add_u32 s54, s54, s52
 s_add_u32 s41, s54, 135168
 s_add_u32 s42, s54, 139264
 s_add_u32 s43, s54, 143360
 s_add_u32 s44, s54, 147456
 s_lshl_b32 s49, s30, 15
 v_add_u32 v22, s49, v17
 v_xor_b32 v21, 0, v18
 v_lshl_add_u32 v6, v21, 5, v22
 v_xor_b32 v21, 1, v18
 v_lshl_add_u32 v7, v21, 5, v22
 v_xor_b32 v21, 2, v18
 v_lshl_add_u32 v8, v21, 5, v22
 v_xor_b32 v21, 3, v18
 v_lshl_add_u32 v9, v21, 5, v22
 v_lshlrev_b32 v22, 9, v13
 v_lshl_add_u32 v22, v15, 6, v22
 v_lshl_add_u32 v22, v16, 3, v22
 v_and_b32 v14, 1, v13
 v_xor_b32 v21, s30, v14
 v_lshl_add_u32 v22, v21, 5, v22
 v_add_u32 v10, 135168, v22
 s_lshl_b32 s49, s30, 7
 s_add_u32 s49, s49, s58
 s_lshl_b32 s49, s49, 5
 s_add_u32 s70, s49, 65536
 s_lshl_b32 s49, s59, 5
 s_add_u32 s71, s49, 65536
 s_cmp_lt_u32 s28, 4
 s_cselect_b32 s49, 1, 0
 s_mov_b32 s59, s49
 s_cmp_lg_u32 s28, 0
 s_cbranch_scc1 L_w0_25
 s_add_u32 m0, s40, 0
 s_nop 0
 buffer_load_dwordx4 v2, s[16:19], s34 offen nt lds
 s_add_u32 s34, s34, s37
 s_add_u32 m0, s40, 2048
 s_nop 0
 buffer_load_dwordx4 v2, s[16:19], s35 offen nt lds
 s_add_u32 s35, s35, s37
 s_cmp_lg_u32 s59, 1
 s_cbranch_scc1 L_now_28
 s_mov_b32 m0, s41
 s_nop 0
 buffer_load_dwordx4 v3, s[20:23], s36 offen sc1 nt lds
 s_add_u32 s36, s36, s38
L_now_28:
 s_add_u32 m0, s40, 4096
 s_nop 0
 buffer_load_dwordx4 v2, s[16:19], s34 offen nt lds
 s_add_u32 s34, s34, s37
 s_add_u32 m0, s40, 6144
 s_nop 0
 buffer_load_dwordx4 v2, s[16:19], s35 offen nt lds
 s_add_u32 s35, s35, s37
 s_cmp_lg_u32 s59, 1
 s_cbranch_scc1 L_now_29
 s_mov_b32 m0, s42
 s_nop 0
 buffer_load_dwordx4 v3, s[20:23], s36 offen sc1 nt lds
 s_add_u32 s36, s36, s38
L_now_29:
 s_add_u32 m0, s40, 8192
 s_nop 0
 buffer_load_dwordx4 v2, s[16:19], s34 offen nt lds
 s_add_u32 s34, s34, s37
 s_add_u32 m0, s40, 10240
 s_nop 0
 buffer_load_dwordx4 v2, s[16:19], s35 offen nt lds
 s_add_u32 s35, s35, s37
 s_cmp_lg_u32 s59, 1
 s_cbranch_scc1 L_now_30
 s_mov_b32 m0, s43
 s_nop 0
 buffer_load_dwordx4 v3, s[20:23], s36 offen sc1 nt lds
 s_add_u32 s36, s36, s38
L_now_30:
 s_waitcnt vmcnt(6)
 s_branch L_w1_26
L_w0_25:
 s_waitcnt vmcnt(0)
L_w1_26:
 s_waitcnt vmcnt(9)
 v_lshlrev_b32 v41, 16, v41
 v_lshlrev_b32 v60, 16, v48
 v_and_b32 v61, 0xffff0000, v48
 v_lshlrev_b32 v62, 16, v49
 v_and_b32 v63, 0xffff0000, v49
 v_lshlrev_b32 v64, 16, v50
 v_and_b32 v65, 0xffff0000, v50
 v_lshlrev_b32 v66, 16, v51
 v_and_b32 v67, 0xffff0000, v51
 v_lshlrev_b32 v68, 16, v52
 v_and_b32 v69, 0xffff0000, v52
 v_lshlrev_b32 v70, 16, v53
 v_and_b32 v71, 0xffff0000, v53
 v_lshlrev_b32 v72, 16, v54
 v_and_b32 v73, 0xffff0000, v54
 v_lshlrev_b32 v74, 16, v55
 v_and_b32 v75, 0xffff0000, v55
 v_sub_f32 v42, 0, v41
 v_mov_b32 v43, v42
 v_pk_add_f32 v[80:81], v[60:61], v[42:43]
 v_pk_mul_f32 v[82:83], v[80:81], v[80:81]
 v_pk_add_f32 v[86:87], v[62:63], v[42:43]
 v_pk_add_f32 v[80:81], v[80:81], v[86:87]
 v_pk_fma_f32 v[82:83], v[86:87], v[86:87], v[82:83]
 v_pk_add_f32 v[84:85], v[64:65], v[42:43]
 v_pk_add_f32 v[80:81], v[80:81], v[84:85]
 v_pk_fma_f32 v[82:83], v[84:85], v[84:85], v[82:83]
 v_pk_add_f32 v[86:87], v[66:67], v[42:43]
 v_pk_add_f32 v[80:81], v[80:81], v[86:87]
 v_pk_fma_f32 v[82:83], v[86:87], v[86:87], v[82:83]
 v_pk_add_f32 v[84:85], v[68:69], v[42:43]
 v_pk_add_f32 v[80:81], v[80:81], v[84:85]
 v_pk_fma_f32 v[82:83], v[84:85], v[84:85], v[82:83]
 v_pk_add_f32 v[86:87], v[70:71], v[42:43]
 v_pk_add_f32 v[80:81], v[80:81], v[86:87]
 v_pk_fma_f32 v[82:83], v[86:87], v[86:87], v[82:83]
 v_pk_add_f32 v[84:85], v[72:73], v[42:43]
 v_pk_add_f32 v[80:81], v[80:81], v[84:85]
 v_pk_fma_f32 v[82:83], v[84:85], v[84:85], v[82:83]
 v_pk_add_f32 v[86:87], v[74:75], v[42:43]
 v_pk_add_f32 v[80:81], v[80:81], v[86:87]
 v_pk_fma_f32 v[82:83], v[86:87], v[86:87], v[82:83]
 v_add_f32 v80, v80, v81
 v_add_f32 v81, v82, v83
 s_nop 1
 v_add_f32_dpp v80, v80, v80 row_ror:8 row_mask:0xf bank_mask:0xf
 v_add_f32_dpp v81, v81, v81 row_ror:8 row_mask:0xf bank_mask:0xf
 v_mov_b32 v84, v80
 v_mov_b32 v86, v81
 v_mov_b32 v85, v80
 v_mov_b32 v87, v81
 s_nop 1
 v_permlane16_swap_b32 v84, v85
 v_permlane16_swap_b32 v86, v87
 s_nop 1
 v_add_f32 v80, v84, v85
 v_add_f32 v81, v86, v87
 v_mov_b32 v84, v80
 v_mov_b32 v86, v81
 v_mov_b32 v85, v80
 v_mov_b32 v87, v81
 s_nop 1
 v_permlane32_swap_b32 v84, v85
 v_permlane32_swap_b32 v86, v87
 s_nop 1
 v_add_f32 v80, v84, v85
 v_add_f32 v81, v86, v87
 v_cmp_gt_u32 vcc, 8, v0
 s_and_saveexec_b64 s[84:85], vcc
 ds_write_b32 v59, v80
 ds_write_b32 v59, v81 offset:256
 s_mov_b64 exec, s[84:85]
 s_waitcnt lgkmcnt(0)
 s_barrier
 ds_read_b128 v[84:87], v58
 ds_read_b128 v[88:91], v58 offset:16
 ds_read_b128 v[92:95], v58 offset:256
 ds_read_b128 v[96:99], v58 offset:272
 s_waitcnt lgkmcnt(2)
 v_add_f32 v84, v84, v88
 v_add_f32 v85, v85, v89
 v_add_f32 v86, v86, v90
 v_add_f32 v87, v87, v91
 v_add_f32 v84, v84, v85
 v_add_f32 v86, v86, v87
 v_add_f32 v80, v84, v86
 s_waitcnt lgkmcnt(0)
 v_add_f32 v92, v92, v96
 v_add_f32 v93, v93, v97
 v_add_f32 v94, v94, v98
 v_add_f32 v95, v95, v99
 v_add_f32 v92, v92, v93
 v_add_f32 v94, v94, v95
 v_add_f32 v83, v92, v94
 v_mul_f32 v80, 0x3a800000, v80
 v_mul_f32 v83, 0x3a800000, v83
 v_fma_f32 v83, -v80, v80, v83
 v_max_f32 v83, 0, v83
 v_add_f32 v80, v80, v41
 v_cvt_pk_bf16_f32 v80, v80, v80
 v_lshlrev_b32 v80, 16, v80
 v_cvt_pk_bf16_f32 v83, v83, v83
 v_lshlrev_b32 v83, 16, v83
 v_add_f32 v83, 0x3727c5ac, v83
 v_cvt_pk_bf16_f32 v83, v83, v83
 v_lshlrev_b32 v83, 16, v83
 v_sqrt_f32 v83, v83
 v_sub_f32 v42, 0, v80
 v_mov_b32 v43, v42
 v_pk_add_f32 v[60:61], v[60:61], v[42:43]
 v_pk_add_f32 v[62:63], v[62:63], v[42:43]
 v_pk_add_f32 v[64:65], v[64:65], v[42:43]
 v_pk_add_f32 v[66:67], v[66:67], v[42:43]
 v_pk_add_f32 v[68:69], v[68:69], v[42:43]
 v_pk_add_f32 v[70:71], v[70:71], v[42:43]
 v_pk_add_f32 v[72:73], v[72:73], v[42:43]
 v_pk_add_f32 v[74:75], v[74:75], v[42:43]
 v_cvt_pk_bf16_f32 v83, v83, v83
 v_lshlrev_b32 v83, 16, v83
 v_rcp_f32 v83, v83
 v_cvt_pk_bf16_f32 v48, v60, v61
 v_cvt_pk_bf16_f32 v49, v62, v63
 v_cvt_pk_bf16_f32 v50, v64, v65
 v_cvt_pk_bf16_f32 v51, v66, v67
 v_cvt_pk_bf16_f32 v52, v68, v69
 v_cvt_pk_bf16_f32 v53, v70, v71
 v_cvt_pk_bf16_f32 v54, v72, v73
 v_cvt_pk_bf16_f32 v55, v74, v75
 v_lshlrev_b32 v60, 16, v48
 v_and_b32 v61, 0xffff0000, v48
 v_lshlrev_b32 v62, 16, v49
 v_and_b32 v63, 0xffff0000, v49
 v_lshlrev_b32 v64, 16, v50
 v_and_b32 v65, 0xffff0000, v50
 v_lshlrev_b32 v66, 16, v51
 v_and_b32 v67, 0xffff0000, v51
 v_lshlrev_b32 v68, 16, v52
 v_and_b32 v69, 0xffff0000, v52
 v_lshlrev_b32 v70, 16, v53
 v_and_b32 v71, 0xffff0000, v53
 v_lshlrev_b32 v72, 16, v54
 v_and_b32 v73, 0xffff0000, v54
 v_lshlrev_b32 v74, 16, v55
 v_and_b32 v75, 0xffff0000, v55
 v_mov_b32 v82, v83
 v_pk_mul_f32 v[60:61], v[60:61], v[82:83]
 v_pk_mul_f32 v[62:63], v[62:63], v[82:83]
 v_pk_mul_f32 v[64:65], v[64:65], v[82:83]
 v_pk_mul_f32 v[66:67], v[66:67], v[82:83]
 v_pk_mul_f32 v[68:69], v[68:69], v[82:83]
 v_pk_mul_f32 v[70:71], v[70:71], v[82:83]
 v_pk_mul_f32 v[72:73], v[72:73], v[82:83]
 v_pk_mul_f32 v[74:75], v[74:75], v[82:83]
 v_cvt_pk_bf16_f32 v48, v60, v61
 v_cvt_pk_bf16_f32 v49, v62, v63
 v_cvt_pk_bf16_f32 v50, v64, v65
 v_cvt_pk_bf16_f32 v51, v66, v67
 v_cvt_pk_bf16_f32 v52, v68, v69
 v_cvt_pk_bf16_f32 v53, v70, v71
 v_cvt_pk_bf16_f32 v54, v72, v73
 v_cvt_pk_bf16_f32 v55, v74, v75
 v_add_u32 v57, 0x8000, v56
 buffer_store_dwordx4 v[48:51], v56, s[12:15], 0 offen sc1
 buffer_store_dwordx4 v[52:55], v57, s[12:15], 0 offen sc1
 s_waitcnt vmcnt(0)
 s_barrier
 s_cmp_lg_u32 s28, 0
 s_cbranch_scc1 L_arr_31
 s_lshl_b32 s46, s31, 5
 s_add_u32 s46, s46, 0
 v_mov_b32 v27, s46
 v_mov_b32 v28, 1
 v_cmp_eq_u32 vcc, 0, v0
 s_and_saveexec_b64 s[46:47], vcc
 buffer_atomic_add v28, v27, s[96:99], 0 offen sc1
 s_mov_b64 exec, s[46:47]
L_arr_31:
 s_cmp_eq_u32 s28, 0
 s_cbranch_scc1 L_w2_27
 s_add_u32 m0, s40, 0
 s_nop 0
 buffer_load_dwordx4 v2, s[16:19], s34 offen nt lds
 s_add_u32 s34, s34, s37
 s_add_u32 m0, s40, 2048
 s_nop 0
 buffer_load_dwordx4 v2, s[16:19], s35 offen nt lds
 s_add_u32 s35, s35, s37
 s_cmp_lg_u32 s59, 1
 s_cbranch_scc1 L_now_32
 s_mov_b32 m0, s41
 s_nop 0
 buffer_load_dwordx4 v3, s[20:23], s36 offen sc1 nt lds
 s_add_u32 s36, s36, s38
L_now_32:
 s_add_u32 m0, s40, 4096
 s_nop 0
 buffer_load_dwordx4 v2, s[16:19], s34 offen nt lds
 s_add_u32 s34, s34, s37
 s_add_u32 m0, s40, 6144
 s_nop 0
 buffer_load_dwordx4 v2, s[16:19], s35 offen nt lds
 s_add_u32 s35, s35, s37
 s_cmp_lg_u32 s59, 1
 s_cbranch_scc1 L_now_33
 s_mov_b32 m0, s42
 s_nop 0
 buffer_load_dwordx4 v3, s[20:23], s36 offen sc1 nt lds
 s_add_u32 s36, s36, s38
L_now_33:
 s_add_u32 m0, s40, 8192
 s_nop 0
 buffer_load_dwordx4 v2, s[16:19], s34 offen nt lds
 s_add_u32 s34, s34, s37
 s_add_u32 m0, s40, 10240
 s_nop 0
 buffer_load_dwordx4 v2, s[16:19], s35 offen nt lds
 s_add_u32 s35, s35, s37
 s_cmp_lg_u32 s59, 1
 s_cbranch_scc1 L_now_34
 s_mov_b32 m0, s43
 s_nop 0
 buffer_load_dwordx4 v3, s[20:23], s36 offen sc1 nt lds
 s_add_u32 s36, s36, s38
L_now_34:
L_w2_27:
 s_cmp_lt_u32 s28, 4
 s_cbranch_scc1 L_sb_35
 s_add_u32 s84, s6, 25165824
 s_addc_u32 s85, s7, 0
 s_and_b32 s85, s85, 0xffff
 s_mov_b32 s86, 4194304
 s_mov_b32 s87, 0x20000
 s_lshl_b32 s88, s2, 14
 s_and_b32 s89, s28, 3
 s_lshl_b32 s89, s89, 12
 s_add_u32 s88, s88, s89
 v_lshlrev_b32 v30, 4, v0
 v_mov_b32 v24, -1
 v_mov_b32 v25, -1
 v_mov_b32 v26, -1
 v_mov_b32 v27, -1
 s_add_u32 s89, s88, 0
 buffer_store_dwordx4 v[24:27], v30, s[84:87], s89 offen sc1
 s_add_u32 s89, s88, 1024
 buffer_store_dwordx4 v[24:27], v30, s[84:87], s89 offen sc1
 s_add_u32 s89, s88, 2048
 buffer_store_dwordx4 v[24:27], v30, s[84:87], s89 offen sc1
 s_add_u32 s89, s88, 3072
 buffer_store_dwordx4 v[24:27], v30, s[84:87], s89 offen sc1
L_sb_35:
 s_load_dwordx2 s[80:81], s[0:1], 16
 s_load_dwordx2 s[84:85], s[0:1], 48
 s_and_b32 s88, s2, 7
 s_lshr_b32 s89, s88, 2
 s_lshr_b32 s90, s2, 3
 s_bfe_u32 s91, s88, 0x10001
 s_lshl_b32 s91, s91, 3
 s_and_b32 s92, s90, 7
 s_add_u32 s92, s92, s91
 s_and_b32 s91, s88, 1
 s_lshl_b32 s91, s91, 2
 s_lshr_b32 s90, s90, 3
 s_add_u32 s90, s90, s91
 v_and_b32 v17, 1, v0
 v_lshlrev_b32 v17, 7, v17
 s_lshl_b32 s91, s90, 8
 v_add_u32 v17, s91, v17
 v_mov_b32 v14, 0x7ffffff0
 s_mul_i32 s91, s89, 512
 s_mul_i32 s93, s92, 32
 s_add_u32 s91, s91, s93
 s_mul_i32 s93, s28, 4
 s_add_u32 s91, s91, s93
 v_subrev_u32 v16, 0, v0
 v_lshrrev_b32 v16, 1, v16
 v_add_u32 v12, s91, v16
 v_lshl_add_u32 v12, v12, 11, v17
 s_mul_i32 s91, s89, 1280
 s_mul_i32 s93, s92, 80
 s_add_u32 s91, s91, s93
 s_mul_i32 s93, s28, 10
 s_add_u32 s91, s91, s93
 s_add_u32 s91, s91, 1024
 v_subrev_u32 v16, 8, v0
 v_lshrrev_b32 v16, 1, v16
 v_add_u32 v15, s91, v16
 v_lshl_add_u32 v15, v15, 11, v17
 v_cmp_gt_u32 vcc, 8, v0
 s_nop 1
 v_cndmask_b32 v12, v15, v12, vcc
 v_cmp_gt_u32 vcc, 28, v0
 s_nop 1
 v_cndmask_b32 v12, v14, v12, vcc
 s_mul_i32 s91, s89, 512
 s_mul_i32 s93, s92, 32
 s_add_u32 s91, s91, s93
 s_mul_i32 s93, s28, 4
 s_add_u32 s91, s91, s93
 v_subrev_u32 v16, 0, v0
 v_lshrrev_b32 v16, 1, v16
 v_add_u32 v13, s91, v16
 v_lshl_add_u32 v13, v13, 11, v17
 v_cmp_gt_u32 vcc, 8, v0
 s_nop 1
 v_cndmask_b32 v13, v14, v13, vcc
 s_mul_i32 s88, s28, 43
 s_lshr_b32 s88, s88, 8
 s_mul_i32 s88, s88, 6
 s_sub_u32 s88, s28, s88
 s_add_u32 s89, s88, 3
 s_cmp_ge_u32 s89, 6
 s_cselect_b32 s93, 6, 0
 s_sub_u32 s89, s89, s93
 s_add_u32 s88, s88, 1
 s_add_u32 s89, s89, 1
 s_waitcnt lgkmcnt(0)
 s_and_b32 s81, s81, 0xffff
 s_mov_b32 s82, 2097152
 s_mov_b32 s83, 0x20000
 s_and_b32 s85, s85, 0xffff
 s_mov_b32 s86, 7340032
 s_mov_b32 s87, 0x20000
 v_mov_b32 v36, 0
 v_mov_b32 v37, 0
 v_mov_b32 v38, 0
 v_mov_b32 v39, 0
 v_mov_b32 v40, 0
 v_mov_b32 v41, 0
 v_mov_b32 v42, 0
 v_mov_b32 v43, 0
 v_mov_b32 v44, 0
 v_mov_b32 v45, 0
 v_mov_b32 v46, 0
 v_mov_b32 v47, 0
 v_mov_b32 v48, 0
 v_mov_b32 v49, 0
 v_mov_b32 v50, 0
 v_mov_b32 v51, 0
 v_mov_b32 v52, 0
 v_mov_b32 v53, 0
 v_mov_b32 v54, 0
 v_mov_b32 v55, 0
 v_mov_b32 v56, 0
 v_mov_b32 v57, 0
 v_mov_b32 v58, 0
 v_mov_b32 v59, 0
 v_mov_b32 v60, 0
 v_mov_b32 v61, 0
 v_mov_b32 v62, 0
 v_mov_b32 v63, 0
 v_mov_b32 v64, 0
 v_mov_b32 v65, 0
 v_mov_b32 v66, 0
 v_mov_b32 v67, 0
 v_mov_b32 v68, 0
 v_mov_b32 v69, 0
 v_mov_b32 v70, 0
 v_mov_b32 v71, 0
 v_mov_b32 v72, 0
 v_mov_b32 v73, 0
 v_mov_b32 v74, 0
 v_mov_b32 v75, 0
 v_mov_b32 v76, 0
 v_mov_b32 v77, 0
 v_mov_b32 v78, 0
 v_mov_b32 v79, 0
 v_mov_b32 v80, 0
 v_mov_b32 v81, 0
 v_mov_b32 v82, 0
 v_mov_b32 v83, 0
 v_mov_b32 v84, 0
 v_mov_b32 v85, 0
 v_mov_b32 v86, 0
 v_mov_b32 v87, 0
 v_mov_b32 v88, 0
 v_mov_b32 v89, 0
 v_mov_b32 v90, 0
 v_mov_b32 v91, 0
 v_mov_b32 v92, 0
 v_mov_b32 v93, 0
 v_mov_b32 v94, 0
 v_mov_b32 v95, 0
 v_mov_b32 v96, 0
 v_mov_b32 v97, 0
 v_mov_b32 v98, 0
 v_mov_b32 v99, 0
 v_mov_b32 v100, 0
 v_mov_b32 v101, 0
 v_mov_b32 v102, 0
 v_mov_b32 v103, 0
 v_mov_b32 v104, 0
 v_mov_b32 v105, 0
 v_mov_b32 v106, 0
 v_mov_b32 v107, 0
 v_mov_b32 v108, 0
 v_mov_b32 v109, 0
 v_mov_b32 v110, 0
 v_mov_b32 v111, 0
 v_mov_b32 v112, 0
 v_mov_b32 v113, 0
 v_mov_b32 v114, 0
 v_mov_b32 v115, 0
 v_mov_b32 v116, 0
 v_mov_b32 v117, 0
 v_mov_b32 v118, 0
 v_mov_b32 v119, 0
 v_mov_b32 v120, 0
 v_mov_b32 v121, 0
 v_mov_b32 v122, 0
 v_mov_b32 v123, 0
 v_mov_b32 v124, 0
 v_mov_b32 v125, 0
 v_mov_b32 v126, 0
 v_mov_b32 v127, 0
 v_mov_b32 v128, 0
 v_mov_b32 v129, 0
 v_mov_b32 v130, 0
 v_mov_b32 v131, 0
 v_mov_b32 v132, 0
 v_mov_b32 v133, 0
 v_mov_b32 v134, 0
 v_mov_b32 v135, 0
 v_mov_b32 v136, 0
 v_mov_b32 v137, 0
 v_mov_b32 v138, 0
 v_mov_b32 v139, 0
 v_mov_b32 v140, 0
 v_mov_b32 v141, 0
 v_mov_b32 v142, 0
 v_mov_b32 v143, 0
 v_mov_b32 v144, 0
 v_mov_b32 v145, 0
 v_mov_b32 v146, 0
 v_mov_b32 v147, 0
 v_mov_b32 v148, 0
 v_mov_b32 v149, 0
 v_mov_b32 v150, 0
 v_mov_b32 v151, 0
 v_mov_b32 v152, 0
 v_mov_b32 v153, 0
 v_mov_b32 v154, 0
 v_mov_b32 v155, 0
 v_mov_b32 v156, 0
 v_mov_b32 v157, 0
 v_mov_b32 v158, 0
 v_mov_b32 v159, 0
 v_mov_b32 v160, 0
 v_mov_b32 v161, 0
 v_mov_b32 v162, 0
 v_mov_b32 v163, 0
 v_mov_b32 v164, 0
 v_mov_b32 v165, 0
 v_mov_b32 v166, 0
 v_mov_b32 v167, 0
 v_mov_b32 v168, 0
 v_mov_b32 v169, 0
 v_mov_b32 v170, 0
 v_mov_b32 v171, 0
 v_mov_b32 v172, 0
 v_mov_b32 v173, 0
 v_mov_b32 v174, 0
 v_mov_b32 v175, 0
 v_mov_b32 v176, 0
 v_mov_b32 v177, 0
 v_mov_b32 v178, 0
 v_mov_b32 v179, 0
 v_mov_b32 v180, 0
 v_mov_b32 v181, 0
 v_mov_b32 v182, 0
 v_mov_b32 v183, 0
 v_mov_b32 v184, 0
 v_mov_b32 v185, 0
 v_mov_b32 v186, 0
 v_mov_b32 v187, 0
 v_mov_b32 v188, 0
 v_mov_b32 v189, 0
 v_mov_b32 v190, 0
 v_mov_b32 v191, 0
 v_mov_b32 v192, 0
 v_mov_b32 v193, 0
 v_mov_b32 v194, 0
 v_mov_b32 v195, 0
 v_mov_b32 v196, 0
 v_mov_b32 v197, 0
 v_mov_b32 v198, 0
 v_mov_b32 v199, 0
 s_cmp_lg_u32 s28, 0
 s_cbranch_scc1 L_wd_36
 s_lshl_b32 s46, s31, 5
 s_add_u32 s46, s46, 0
 s_mov_b32 s47, s46
 v_mov_b32 v27, s47
 v_mov_b32 v28, s46
 v_cmp_eq_u32 vcc, 0, v0
 s_nop 1
 v_cndmask_b32 v27, v27, v28, vcc
 s_mov_b32 s48, 0
L_wp_37:
 buffer_load_dword v28, v27, s[96:99], 0 offen sc1
 s_waitcnt vmcnt(0)
 v_cmp_gt_u32 vcc, 32, v28
 s_add_u32 s48, s48, 1
 s_cbranch_vccz L_wd_36
 s_cmp_lt_u32 s48, 0x20000
 s_cbranch_scc0 L_wd_36
 s_sleep 8
 s_branch L_wp_37
L_wd_36:
 s_barrier
 s_add_u32 m0, s39, 0
 s_nop 0
 buffer_load_dwordx4 v1, s[12:15], s33 offen sc1 lds
 buffer_load_dwordx4 v1, s[12:15], s33 offen offset:1024 sc1 lds
 s_add_u32 s33, s33, 2048
 s_cmp_lg_u32 s59, 2
 s_cbranch_scc1 L_noh_38
 s_mov_b32 m0, s41
 s_nop 0
 buffer_load_dwordx4 v3, s[20:23], s36 offen sc1 nt lds
 s_add_u32 s36, s36, s38
L_noh_38:
 s_add_u32 m0, s39, 17408
 s_nop 0
 buffer_load_dwordx4 v1, s[12:15], s33 offen sc1 lds
 buffer_load_dwordx4 v1, s[12:15], s33 offen offset:1024 sc1 lds
 s_add_u32 s33, s33, 2048
 s_cmp_lg_u32 s59, 2
 s_cbranch_scc1 L_noh_39
 s_mov_b32 m0, s42
 s_nop 0
 buffer_load_dwordx4 v3, s[20:23], s36 offen sc1 nt lds
 s_add_u32 s36, s36, s38
L_noh_39:
 s_add_u32 m0, s39, 34816
 s_nop 0
 buffer_load_dwordx4 v1, s[12:15], s33 offen sc1 lds
 buffer_load_dwordx4 v1, s[12:15], s33 offen offset:1024 sc1 lds
 s_add_u32 s33, s33, 2048
 s_cmp_lg_u32 s59, 2
 s_cbranch_scc1 L_noh_40
 s_mov_b32 m0, s43
 s_nop 0
 buffer_load_dwordx4 v3, s[20:23], s36 offen sc1 nt lds
 s_add_u32 s36, s36, s38
L_noh_40:
 s_cmp_lt_u32 s28, 4
 s_cbranch_scc0 L_k1_Y_0
 s_waitcnt vmcnt(4)
 s_barrier
 s_mov_b32 s45, 6
 ds_read_b128 a[16:19], v4 offset:0
 ds_read_b128 a[20:23], v4 offset:1024
 ds_read_b128 a[24:27], v4 offset:2048
 ds_read_b128 a[28:31], v4 offset:3072
 ds_read_b64_tr_b16 a[0:1], v6 offset:0
 ds_read_b64_tr_b16 a[2:3], v6 offset:512
 ds_read_b64_tr_b16 a[4:5], v7 offset:0
 ds_read_b64_tr_b16 a[6:7], v7 offset:512
 ds_read_b64_tr_b16 a[8:9], v8 offset:0
 ds_read_b64_tr_b16 a[10:11], v8 offset:512
 s_waitcnt vmcnt(2)
 s_barrier
 s_waitcnt lgkmcnt(4)
 v_mfma_f32_16x16x32_bf16 v[40:43], a[0:3], a[16:19], v[40:43]
 ds_read_b64_tr_b16 a[12:13], v9 offset:0
 v_mfma_f32_16x16x32_bf16 v[44:47], a[0:3], a[20:23], v[44:47]
 ds_read_b64_tr_b16 a[14:15], v9 offset:512
 v_mfma_f32_16x16x32_bf16 v[48:51], a[0:3], a[24:27], v[48:51]
 s_add_u32 m0, s39, 52224
 v_mfma_f32_16x16x32_bf16 v[52:55], a[0:3], a[28:31], v[52:55]
 buffer_load_dwordx4 v1, s[12:15], s33 offen sc1 lds
 s_waitcnt lgkmcnt(4)
 v_mfma_f32_16x16x32_bf16 v[68:71], a[4:7], a[28:31], v[68:71]
 ds_read_b64_tr_b16 a[0:1], v6 offset:16384
 v_mfma_f32_16x16x32_bf16 v[64:67], a[4:7], a[24:27], v[64:67]
 ds_read_b64_tr_b16 a[2:3], v6 offset:16896
 v_mfma_f32_16x16x32_bf16 v[60:63], a[4:7], a[20:23], v[60:63]
 v_mfma_f32_16x16x32_bf16 v[56:59], a[4:7], a[16:19], v[56:59]
 buffer_load_dwordx4 v1, s[12:15], s33 offen offset:1024 sc1 lds
 s_add_u32 s33, s33, 2048
 s_waitcnt lgkmcnt(4)
 v_mfma_f32_16x16x32_bf16 v[72:75], a[8:11], a[16:19], v[72:75]
 ds_read_b64_tr_b16 a[4:5], v7 offset:16384
 v_mfma_f32_16x16x32_bf16 v[76:79], a[8:11], a[20:23], v[76:79]
 ds_read_b64_tr_b16 a[6:7], v7 offset:16896
 v_mfma_f32_16x16x32_bf16 v[80:83], a[8:11], a[24:27], v[80:83]
 s_add_u32 m0, s40, 12288
 v_mfma_f32_16x16x32_bf16 v[84:87], a[8:11], a[28:31], v[84:87]
 buffer_load_dwordx4 v2, s[16:19], s34 offen nt lds
 s_add_u32 s34, s34, s37
 s_waitcnt lgkmcnt(4)
 v_mfma_f32_16x16x32_bf16 v[100:103], a[12:15], a[28:31], v[100:103]
 ds_read_b64_tr_b16 a[8:9], v8 offset:16384
 v_mfma_f32_16x16x32_bf16 v[96:99], a[12:15], a[24:27], v[96:99]
 ds_read_b64_tr_b16 a[10:11], v8 offset:16896
 v_mfma_f32_16x16x32_bf16 v[92:95], a[12:15], a[20:23], v[92:95]
 ds_read_b128 a[32:35], v4 offset:17408
 s_add_u32 m0, s40, 14336
 v_mfma_f32_16x16x32_bf16 v[88:91], a[12:15], a[16:19], v[88:91]
 buffer_load_dwordx4 v2, s[16:19], s35 offen nt lds
 s_add_u32 s35, s35, s37
 s_waitcnt lgkmcnt(5)
 v_mfma_f32_16x16x32_bf16 v[104:107], a[0:3], a[16:19], v[104:107]
 ds_read_b64_tr_b16 a[12:13], v9 offset:16384
 v_mfma_f32_16x16x32_bf16 v[108:111], a[0:3], a[20:23], v[108:111]
 ds_read_b64_tr_b16 a[14:15], v9 offset:16896
 v_mfma_f32_16x16x32_bf16 v[112:115], a[0:3], a[24:27], v[112:115]
 ds_read_b128 a[36:39], v4 offset:18432
 s_mov_b32 m0, s44
 v_mfma_f32_16x16x32_bf16 v[116:119], a[0:3], a[28:31], v[116:119]
 buffer_load_dwordx4 v3, s[20:23], s36 offen sc1 nt lds
 s_add_u32 s36, s36, s38
 s_waitcnt lgkmcnt(6)
 v_mfma_f32_16x16x32_bf16 v[132:135], a[4:7], a[28:31], v[132:135]
 ds_read_b64_tr_b16 a[0:1], v10 offset:0
 v_mfma_f32_16x16x32_bf16 v[128:131], a[4:7], a[24:27], v[128:131]
 ds_read_b64_tr_b16 a[2:3], v10 offset:256
 v_mfma_f32_16x16x32_bf16 v[124:127], a[4:7], a[20:23], v[124:127]
 ds_read_b128 a[40:43], v4 offset:19456
 v_mfma_f32_16x16x32_bf16 v[120:123], a[4:7], a[16:19], v[120:123]
 s_waitcnt lgkmcnt(7)
 v_mfma_f32_16x16x32_bf16 v[136:139], a[8:11], a[16:19], v[136:139]
 ds_read_b64_tr_b16 a[4:5], v10 offset:2048
 v_mfma_f32_16x16x32_bf16 v[140:143], a[8:11], a[20:23], v[140:143]
 ds_read_b64_tr_b16 a[6:7], v10 offset:2304
 v_mfma_f32_16x16x32_bf16 v[144:147], a[8:11], a[24:27], v[144:147]
 ds_read_b128 a[44:47], v4 offset:20480
 v_mfma_f32_16x16x32_bf16 v[148:151], a[8:11], a[28:31], v[148:151]
 s_waitcnt lgkmcnt(7)
 v_mfma_f32_16x16x32_bf16 v[164:167], a[12:15], a[28:31], v[164:167]
 ds_read_b64_tr_b16 a[8:9], v6 offset:4096
 v_mfma_f32_16x16x32_bf16 v[160:163], a[12:15], a[24:27], v[160:163]
 ds_read_b64_tr_b16 a[10:11], v6 offset:4608
 v_mfma_f32_16x16x32_bf16 v[156:159], a[12:15], a[20:23], v[156:159]
 v_mfma_f32_16x16x32_bf16 v[152:155], a[12:15], a[16:19], v[152:155]
 s_waitcnt lgkmcnt(6)
 v_mfma_f32_16x16x32_bf16 v[168:171], a[0:3], a[16:19], v[168:171]
 ds_read_b64_tr_b16 a[12:13], v7 offset:4096
 v_mfma_f32_16x16x32_bf16 v[172:175], a[0:3], a[20:23], v[172:175]
 ds_read_b64_tr_b16 a[14:15], v7 offset:4608
 v_mfma_f32_16x16x32_bf16 v[176:179], a[0:3], a[24:27], v[176:179]
 v_mfma_f32_16x16x32_bf16 v[180:183], a[0:3], a[28:31], v[180:183]
 s_waitcnt lgkmcnt(5)
 v_mfma_f32_16x16x32_bf16 v[196:199], a[4:7], a[28:31], v[196:199]
 ds_read_b64_tr_b16 a[0:1], v8 offset:4096
 v_mfma_f32_16x16x32_bf16 v[192:195], a[4:7], a[24:27], v[192:195]
 ds_read_b64_tr_b16 a[2:3], v8 offset:4608
 v_mfma_f32_16x16x32_bf16 v[188:191], a[4:7], a[20:23], v[188:191]
 v_mfma_f32_16x16x32_bf16 v[184:187], a[4:7], a[16:19], v[184:187]
 s_waitcnt vmcnt(5)
 s_barrier
 s_waitcnt lgkmcnt(4)
 v_mfma_f32_16x16x32_bf16 v[40:43], a[8:11], a[32:35], v[40:43]
 ds_read_b64_tr_b16 a[4:5], v9 offset:4096
 v_mfma_f32_16x16x32_bf16 v[44:47], a[8:11], a[36:39], v[44:47]
 ds_read_b64_tr_b16 a[6:7], v9 offset:4608
 v_mfma_f32_16x16x32_bf16 v[48:51], a[8:11], a[40:43], v[48:51]
 s_add_u32 m0, s39, 0
 v_mfma_f32_16x16x32_bf16 v[52:55], a[8:11], a[44:47], v[52:55]
 buffer_load_dwordx4 v1, s[12:15], s33 offen sc1 lds
 s_waitcnt lgkmcnt(4)
 v_mfma_f32_16x16x32_bf16 v[68:71], a[12:15], a[44:47], v[68:71]
 ds_read_b64_tr_b16 a[8:9], v6 offset:20480
 v_mfma_f32_16x16x32_bf16 v[64:67], a[12:15], a[40:43], v[64:67]
 ds_read_b64_tr_b16 a[10:11], v6 offset:20992
 v_mfma_f32_16x16x32_bf16 v[60:63], a[12:15], a[36:39], v[60:63]
 v_mfma_f32_16x16x32_bf16 v[56:59], a[12:15], a[32:35], v[56:59]
 buffer_load_dwordx4 v1, s[12:15], s33 offen offset:1024 sc1 lds
 s_add_u32 s33, s33, 2048
 s_waitcnt lgkmcnt(4)
 v_mfma_f32_16x16x32_bf16 v[72:75], a[0:3], a[32:35], v[72:75]
 ds_read_b64_tr_b16 a[12:13], v7 offset:20480
 v_mfma_f32_16x16x32_bf16 v[76:79], a[0:3], a[36:39], v[76:79]
 ds_read_b64_tr_b16 a[14:15], v7 offset:20992
 v_mfma_f32_16x16x32_bf16 v[80:83], a[0:3], a[40:43], v[80:83]
 s_add_u32 m0, s40, 0
 v_mfma_f32_16x16x32_bf16 v[84:87], a[0:3], a[44:47], v[84:87]
 buffer_load_dwordx4 v2, s[16:19], s34 offen nt lds
 s_add_u32 s34, s34, s37
 s_waitcnt lgkmcnt(4)
 v_mfma_f32_16x16x32_bf16 v[100:103], a[4:7], a[44:47], v[100:103]
 ds_read_b64_tr_b16 a[0:1], v8 offset:20480
 v_mfma_f32_16x16x32_bf16 v[96:99], a[4:7], a[40:43], v[96:99]
 ds_read_b64_tr_b16 a[2:3], v8 offset:20992
 v_mfma_f32_16x16x32_bf16 v[92:95], a[4:7], a[36:39], v[92:95]
 ds_read_b128 a[16:19], v4 offset:34816
 s_add_u32 m0, s40, 2048
 v_mfma_f32_16x16x32_bf16 v[88:91], a[4:7], a[32:35], v[88:91]
 buffer_load_dwordx4 v2, s[16:19], s35 offen nt lds
 s_add_u32 s35, s35, s37
 s_waitcnt lgkmcnt(5)
 v_mfma_f32_16x16x32_bf16 v[104:107], a[8:11], a[32:35], v[104:107]
 ds_read_b64_tr_b16 a[4:5], v9 offset:20480
 v_mfma_f32_16x16x32_bf16 v[108:111], a[8:11], a[36:39], v[108:111]
 ds_read_b64_tr_b16 a[6:7], v9 offset:20992
 v_mfma_f32_16x16x32_bf16 v[112:115], a[8:11], a[40:43], v[112:115]
 ds_read_b128 a[20:23], v4 offset:35840
 s_mov_b32 m0, s41
 v_mfma_f32_16x16x32_bf16 v[116:119], a[8:11], a[44:47], v[116:119]
 buffer_load_dwordx4 v3, s[20:23], s36 offen sc1 nt lds
 s_add_u32 s36, s36, s38
 s_waitcnt lgkmcnt(6)
 v_mfma_f32_16x16x32_bf16 v[132:135], a[12:15], a[44:47], v[132:135]
 ds_read_b64_tr_b16 a[8:9], v10 offset:4096
 v_mfma_f32_16x16x32_bf16 v[128:131], a[12:15], a[40:43], v[128:131]
 ds_read_b64_tr_b16 a[10:11], v10 offset:4352
 v_mfma_f32_16x16x32_bf16 v[124:127], a[12:15], a[36:39], v[124:127]
 ds_read_b128 a[24:27], v4 offset:36864
 v_mfma_f32_16x16x32_bf16 v[120:123], a[12:15], a[32:35], v[120:123]
 s_cmp_eq_u32 s45, s88
 s_cselect_b64 vcc, -1, 0
 v_cndmask_b32 v15, v14, v12, vcc
 buffer_load_dword v31, v15, s[84:87], 0 offen
 s_waitcnt lgkmcnt(7)
 v_mfma_f32_16x16x32_bf16 v[136:139], a[0:3], a[32:35], v[136:139]
 ds_read_b64_tr_b16 a[12:13], v10 offset:6144
 v_mfma_f32_16x16x32_bf16 v[140:143], a[0:3], a[36:39], v[140:143]
 ds_read_b64_tr_b16 a[14:15], v10 offset:6400
 v_mfma_f32_16x16x32_bf16 v[144:147], a[0:3], a[40:43], v[144:147]
 ds_read_b128 a[28:31], v4 offset:37888
 v_mfma_f32_16x16x32_bf16 v[148:151], a[0:3], a[44:47], v[148:151]
 s_waitcnt lgkmcnt(7)
 v_mfma_f32_16x16x32_bf16 v[164:167], a[4:7], a[44:47], v[164:167]
 ds_read_b64_tr_b16 a[0:1], v6 offset:8192
 v_mfma_f32_16x16x32_bf16 v[160:163], a[4:7], a[40:43], v[160:163]
 ds_read_b64_tr_b16 a[2:3], v6 offset:8704
 v_mfma_f32_16x16x32_bf16 v[156:159], a[4:7], a[36:39], v[156:159]
 v_mfma_f32_16x16x32_bf16 v[152:155], a[4:7], a[32:35], v[152:155]
 s_waitcnt lgkmcnt(6)
 v_mfma_f32_16x16x32_bf16 v[168:171], a[8:11], a[32:35], v[168:171]
 ds_read_b64_tr_b16 a[4:5], v7 offset:8192
 v_mfma_f32_16x16x32_bf16 v[172:175], a[8:11], a[36:39], v[172:175]
 ds_read_b64_tr_b16 a[6:7], v7 offset:8704
 v_mfma_f32_16x16x32_bf16 v[176:179], a[8:11], a[40:43], v[176:179]
 v_mfma_f32_16x16x32_bf16 v[180:183], a[8:11], a[44:47], v[180:183]
 s_waitcnt lgkmcnt(5)
 v_mfma_f32_16x16x32_bf16 v[196:199], a[12:15], a[44:47], v[196:199]
 ds_read_b64_tr_b16 a[8:9], v8 offset:8192
 v_mfma_f32_16x16x32_bf16 v[192:195], a[12:15], a[40:43], v[192:195]
 ds_read_b64_tr_b16 a[10:11], v8 offset:8704
 v_mfma_f32_16x16x32_bf16 v[188:191], a[12:15], a[36:39], v[188:191]
 v_mfma_f32_16x16x32_bf16 v[184:187], a[12:15], a[32:35], v[184:187]
 s_waitcnt vmcnt(6)
 s_barrier
 s_waitcnt lgkmcnt(4)
 v_mfma_f32_16x16x32_bf16 v[40:43], a[0:3], a[16:19], v[40:43]
 ds_read_b64_tr_b16 a[12:13], v9 offset:8192
 v_mfma_f32_16x16x32_bf16 v[44:47], a[0:3], a[20:23], v[44:47]
 ds_read_b64_tr_b16 a[14:15], v9 offset:8704
 v_mfma_f32_16x16x32_bf16 v[48:51], a[0:3], a[24:27], v[48:51]
 s_add_u32 m0, s39, 17408
 v_mfma_f32_16x16x32_bf16 v[52:55], a[0:3], a[28:31], v[52:55]
 buffer_load_dwordx4 v1, s[12:15], s33 offen sc1 lds
 s_waitcnt lgkmcnt(4)
 v_mfma_f32_16x16x32_bf16 v[68:71], a[4:7], a[28:31], v[68:71]
 ds_read_b64_tr_b16 a[0:1], v6 offset:24576
 v_mfma_f32_16x16x32_bf16 v[64:67], a[4:7], a[24:27], v[64:67]
 ds_read_b64_tr_b16 a[2:3], v6 offset:25088
 v_mfma_f32_16x16x32_bf16 v[60:63], a[4:7], a[20:23], v[60:63]
 v_mfma_f32_16x16x32_bf16 v[56:59], a[4:7], a[16:19], v[56:59]
 buffer_load_dwordx4 v1, s[12:15], s33 offen offset:1024 sc1 lds
 s_add_u32 s33, s33, 2048
 s_waitcnt lgkmcnt(4)
 v_mfma_f32_16x16x32_bf16 v[72:75], a[8:11], a[16:19], v[72:75]
 ds_read_b64_tr_b16 a[4:5], v7 offset:24576
 v_mfma_f32_16x16x32_bf16 v[76:79], a[8:11], a[20:23], v[76:79]
 ds_read_b64_tr_b16 a[6:7], v7 offset:25088
 v_mfma_f32_16x16x32_bf16 v[80:83], a[8:11], a[24:27], v[80:83]
 s_add_u32 m0, s40, 4096
 v_mfma_f32_16x16x32_bf16 v[84:87], a[8:11], a[28:31], v[84:87]
 buffer_load_dwordx4 v2, s[16:19], s34 offen nt lds
 s_add_u32 s34, s34, s37
 s_waitcnt lgkmcnt(4)
 v_mfma_f32_16x16x32_bf16 v[100:103], a[12:15], a[28:31], v[100:103]
 ds_read_b64_tr_b16 a[8:9], v8 offset:24576
 v_mfma_f32_16x16x32_bf16 v[96:99], a[12:15], a[24:27], v[96:99]
 ds_read_b64_tr_b16 a[10:11], v8 offset:25088
 v_mfma_f32_16x16x32_bf16 v[92:95], a[12:15], a[20:23], v[92:95]
 ds_read_b128 a[32:35], v4 offset:52224
 s_add_u32 m0, s40, 6144
 v_mfma_f32_16x16x32_bf16 v[88:91], a[12:15], a[16:19], v[88:91]
 buffer_load_dwordx4 v2, s[16:19], s35 offen nt lds
 s_add_u32 s35, s35, s37
 s_waitcnt lgkmcnt(5)
 v_mfma_f32_16x16x32_bf16 v[104:107], a[0:3], a[16:19], v[104:107]
 ds_read_b64_tr_b16 a[12:13], v9 offset:24576
 v_mfma_f32_16x16x32_bf16 v[108:111], a[0:3], a[20:23], v[108:111]
 ds_read_b64_tr_b16 a[14:15], v9 offset:25088
 v_mfma_f32_16x16x32_bf16 v[112:115], a[0:3], a[24:27], v[112:115]
 ds_read_b128 a[36:39], v4 offset:53248
 s_mov_b32 m0, s42
 v_mfma_f32_16x16x32_bf16 v[116:119], a[0:3], a[28:31], v[116:119]
 buffer_load_dwordx4 v3, s[20:23], s36 offen sc1 nt lds
 s_add_u32 s36, s36, s38
 s_waitcnt lgkmcnt(6)
 v_mfma_f32_16x16x32_bf16 v[132:135], a[4:7], a[28:31], v[132:135]
 ds_read_b64_tr_b16 a[0:1], v10 offset:8192
 v_mfma_f32_16x16x32_bf16 v[128:131], a[4:7], a[24:27], v[128:131]
 ds_read_b64_tr_b16 a[2:3], v10 offset:8448
 v_mfma_f32_16x16x32_bf16 v[124:127], a[4:7], a[20:23], v[124:127]
 ds_read_b128 a[40:43], v4 offset:54272
 v_mfma_f32_16x16x32_bf16 v[120:123], a[4:7], a[16:19], v[120:123]
 s_waitcnt lgkmcnt(7)
 v_mfma_f32_16x16x32_bf16 v[136:139], a[8:11], a[16:19], v[136:139]
 ds_read_b64_tr_b16 a[4:5], v10 offset:10240
 v_mfma_f32_16x16x32_bf16 v[140:143], a[8:11], a[20:23], v[140:143]
 ds_read_b64_tr_b16 a[6:7], v10 offset:10496
 v_mfma_f32_16x16x32_bf16 v[144:147], a[8:11], a[24:27], v[144:147]
 ds_read_b128 a[44:47], v4 offset:55296
 v_mfma_f32_16x16x32_bf16 v[148:151], a[8:11], a[28:31], v[148:151]
 s_waitcnt lgkmcnt(7)
 v_mfma_f32_16x16x32_bf16 v[164:167], a[12:15], a[28:31], v[164:167]
 ds_read_b64_tr_b16 a[8:9], v6 offset:12288
 v_mfma_f32_16x16x32_bf16 v[160:163], a[12:15], a[24:27], v[160:163]
 ds_read_b64_tr_b16 a[10:11], v6 offset:12800
 v_mfma_f32_16x16x32_bf16 v[156:159], a[12:15], a[20:23], v[156:159]
 v_mfma_f32_16x16x32_bf16 v[152:155], a[12:15], a[16:19], v[152:155]
 s_waitcnt lgkmcnt(6)
 v_mfma_f32_16x16x32_bf16 v[168:171], a[0:3], a[16:19], v[168:171]
 ds_read_b64_tr_b16 a[12:13], v7 offset:12288
 v_mfma_f32_16x16x32_bf16 v[172:175], a[0:3], a[20:23], v[172:175]
 ds_read_b64_tr_b16 a[14:15], v7 offset:12800
 v_mfma_f32_16x16x32_bf16 v[176:179], a[0:3], a[24:27], v[176:179]
 v_mfma_f32_16x16x32_bf16 v[180:183], a[0:3], a[28:31], v[180:183]
 s_waitcnt lgkmcnt(5)
 v_mfma_f32_16x16x32_bf16 v[196:199], a[4:7], a[28:31], v[196:199]
 ds_read_b64_tr_b16 a[0:1], v8 offset:12288
 v_mfma_f32_16x16x32_bf16 v[192:195], a[4:7], a[24:27], v[192:195]
 ds_read_b64_tr_b16 a[2:3], v8 offset:12800
 v_mfma_f32_16x16x32_bf16 v[188:191], a[4:7], a[20:23], v[188:191]
 v_mfma_f32_16x16x32_bf16 v[184:187], a[4:7], a[16:19], v[184:187]
 s_waitcnt vmcnt(6)
 s_barrier
 s_waitcnt lgkmcnt(4)
 v_mfma_f32_16x16x32_bf16 v[40:43], a[8:11], a[32:35], v[40:43]
 ds_read_b64_tr_b16 a[4:5], v9 offset:12288
 v_mfma_f32_16x16x32_bf16 v[44:47], a[8:11], a[36:39], v[44:47]
 ds_read_b64_tr_b16 a[6:7], v9 offset:12800
 v_mfma_f32_16x16x32_bf16 v[48:51], a[8:11], a[40:43], v[48:51]
 s_add_u32 m0, s39, 34816
 v_mfma_f32_16x16x32_bf16 v[52:55], a[8:11], a[44:47], v[52:55]
 buffer_load_dwordx4 v1, s[12:15], s33 offen sc1 lds
 s_waitcnt lgkmcnt(4)
 v_mfma_f32_16x16x32_bf16 v[68:71], a[12:15], a[44:47], v[68:71]
 ds_read_b64_tr_b16 a[8:9], v6 offset:28672
 v_mfma_f32_16x16x32_bf16 v[64:67], a[12:15], a[40:43], v[64:67]
 ds_read_b64_tr_b16 a[10:11], v6 offset:29184
 v_mfma_f32_16x16x32_bf16 v[60:63], a[12:15], a[36:39], v[60:63]
 v_mfma_f32_16x16x32_bf16 v[56:59], a[12:15], a[32:35], v[56:59]
 buffer_load_dwordx4 v1, s[12:15], s33 offen offset:1024 sc1 lds
 s_add_u32 s33, s33, 2048
 s_waitcnt lgkmcnt(4)
 v_mfma_f32_16x16x32_bf16 v[72:75], a[0:3], a[32:35], v[72:75]
 ds_read_b64_tr_b16 a[12:13], v7 offset:28672
 v_mfma_f32_16x16x32_bf16 v[76:79], a[0:3], a[36:39], v[76:79]
 ds_read_b64_tr_b16 a[14:15], v7 offset:29184
 v_mfma_f32_16x16x32_bf16 v[80:83], a[0:3], a[40:43], v[80:83]
 s_add_u32 m0, s40, 8192
 v_mfma_f32_16x16x32_bf16 v[84:87], a[0:3], a[44:47], v[84:87]
 buffer_load_dwordx4 v2, s[16:19], s34 offen nt lds
 s_add_u32 s34, s34, s37
 s_waitcnt lgkmcnt(4)
 v_mfma_f32_16x16x32_bf16 v[100:103], a[4:7], a[44:47], v[100:103]
 ds_read_b64_tr_b16 a[0:1], v8 offset:28672
 v_mfma_f32_16x16x32_bf16 v[96:99], a[4:7], a[40:43], v[96:99]
 ds_read_b64_tr_b16 a[2:3], v8 offset:29184
 v_mfma_f32_16x16x32_bf16 v[92:95], a[4:7], a[36:39], v[92:95]
 ds_read_b128 a[16:19], v4 offset:0
 s_add_u32 m0, s40, 10240
 v_mfma_f32_16x16x32_bf16 v[88:91], a[4:7], a[32:35], v[88:91]
 buffer_load_dwordx4 v2, s[16:19], s35 offen nt lds
 s_add_u32 s35, s35, s37
 s_waitcnt lgkmcnt(5)
 v_mfma_f32_16x16x32_bf16 v[104:107], a[8:11], a[32:35], v[104:107]
 ds_read_b64_tr_b16 a[4:5], v9 offset:28672
 v_mfma_f32_16x16x32_bf16 v[108:111], a[8:11], a[36:39], v[108:111]
 ds_read_b64_tr_b16 a[6:7], v9 offset:29184
 v_mfma_f32_16x16x32_bf16 v[112:115], a[8:11], a[40:43], v[112:115]
 ds_read_b128 a[20:23], v4 offset:1024
 s_mov_b32 m0, s43
 v_mfma_f32_16x16x32_bf16 v[116:119], a[8:11], a[44:47], v[116:119]
 buffer_load_dwordx4 v3, s[20:23], s36 offen sc1 nt lds
 s_add_u32 s36, s36, s38
 s_waitcnt lgkmcnt(6)
 v_mfma_f32_16x16x32_bf16 v[132:135], a[12:15], a[44:47], v[132:135]
 ds_read_b64_tr_b16 a[8:9], v10 offset:12288
 v_mfma_f32_16x16x32_bf16 v[128:131], a[12:15], a[40:43], v[128:131]
 ds_read_b64_tr_b16 a[10:11], v10 offset:12544
 v_mfma_f32_16x16x32_bf16 v[124:127], a[12:15], a[36:39], v[124:127]
 ds_read_b128 a[24:27], v4 offset:2048
 v_mfma_f32_16x16x32_bf16 v[120:123], a[12:15], a[32:35], v[120:123]
 s_cmp_eq_u32 s45, s89
 s_cselect_b64 vcc, -1, 0
 v_cndmask_b32 v15, v14, v13, vcc
 buffer_load_dword v31, v15, s[80:83], 0 offen
 s_waitcnt lgkmcnt(7)
 v_mfma_f32_16x16x32_bf16 v[136:139], a[0:3], a[32:35], v[136:139]
 ds_read_b64_tr_b16 a[12:13], v10 offset:14336
 v_mfma_f32_16x16x32_bf16 v[140:143], a[0:3], a[36:39], v[140:143]
 ds_read_b64_tr_b16 a[14:15], v10 offset:14592
 v_mfma_f32_16x16x32_bf16 v[144:147], a[0:3], a[40:43], v[144:147]
 ds_read_b128 a[28:31], v4 offset:3072
 v_mfma_f32_16x16x32_bf16 v[148:151], a[0:3], a[44:47], v[148:151]
 s_waitcnt lgkmcnt(7)
 v_mfma_f32_16x16x32_bf16 v[164:167], a[4:7], a[44:47], v[164:167]
 ds_read_b64_tr_b16 a[0:1], v6 offset:0
 v_mfma_f32_16x16x32_bf16 v[160:163], a[4:7], a[40:43], v[160:163]
 ds_read_b64_tr_b16 a[2:3], v6 offset:512
 v_mfma_f32_16x16x32_bf16 v[156:159], a[4:7], a[36:39], v[156:159]
 v_mfma_f32_16x16x32_bf16 v[152:155], a[4:7], a[32:35], v[152:155]
 s_waitcnt lgkmcnt(6)
 v_mfma_f32_16x16x32_bf16 v[168:171], a[8:11], a[32:35], v[168:171]
 ds_read_b64_tr_b16 a[4:5], v7 offset:0
 v_mfma_f32_16x16x32_bf16 v[172:175], a[8:11], a[36:39], v[172:175]
 ds_read_b64_tr_b16 a[6:7], v7 offset:512
 v_mfma_f32_16x16x32_bf16 v[176:179], a[8:11], a[40:43], v[176:179]
 v_mfma_f32_16x16x32_bf16 v[180:183], a[8:11], a[44:47], v[180:183]
 s_waitcnt lgkmcnt(5)
 v_mfma_f32_16x16x32_bf16 v[196:199], a[12:15], a[44:47], v[196:199]
 ds_read_b64_tr_b16 a[8:9], v8 offset:0
 v_mfma_f32_16x16x32_bf16 v[192:195], a[12:15], a[40:43], v[192:195]
 ds_read_b64_tr_b16 a[10:11], v8 offset:512
 v_mfma_f32_16x16x32_bf16 v[188:191], a[12:15], a[36:39], v[188:191]
 v_mfma_f32_16x16x32_bf16 v[184:187], a[12:15], a[32:35], v[184:187]
 s_waitcnt vmcnt(6)
 s_barrier
 s_mov_b32 s45, 5
.p2align 3
L_loop_Y_n_1:
 s_waitcnt lgkmcnt(4)
 v_mfma_f32_16x16x32_bf16 v[40:43], a[0:3], a[16:19], v[40:43]
 ds_read_b64_tr_b16 a[12:13], v9 offset:0
 v_mfma_f32_16x16x32_bf16 v[44:47], a[0:3], a[20:23], v[44:47]
 ds_read_b64_tr_b16 a[14:15], v9 offset:512
 v_mfma_f32_16x16x32_bf16 v[48:51], a[0:3], a[24:27], v[48:51]
 s_add_u32 m0, s39, 52224
 v_mfma_f32_16x16x32_bf16 v[52:55], a[0:3], a[28:31], v[52:55]
 buffer_load_dwordx4 v1, s[12:15], s33 offen sc1 lds
 s_waitcnt lgkmcnt(4)
 v_mfma_f32_16x16x32_bf16 v[68:71], a[4:7], a[28:31], v[68:71]
 ds_read_b64_tr_b16 a[0:1], v6 offset:16384
 v_mfma_f32_16x16x32_bf16 v[64:67], a[4:7], a[24:27], v[64:67]
 ds_read_b64_tr_b16 a[2:3], v6 offset:16896
 v_mfma_f32_16x16x32_bf16 v[60:63], a[4:7], a[20:23], v[60:63]
 v_mfma_f32_16x16x32_bf16 v[56:59], a[4:7], a[16:19], v[56:59]
 buffer_load_dwordx4 v1, s[12:15], s33 offen offset:1024 sc1 lds
 s_add_u32 s33, s33, 2048
 s_waitcnt lgkmcnt(4)
 v_mfma_f32_16x16x32_bf16 v[72:75], a[8:11], a[16:19], v[72:75]
 ds_read_b64_tr_b16 a[4:5], v7 offset:16384
 v_mfma_f32_16x16x32_bf16 v[76:79], a[8:11], a[20:23], v[76:79]
 ds_read_b64_tr_b16 a[6:7], v7 offset:16896
 v_mfma_f32_16x16x32_bf16 v[80:83], a[8:11], a[24:27], v[80:83]
 s_add_u32 m0, s40, 12288
 v_mfma_f32_16x16x32_bf16 v[84:87], a[8:11], a[28:31], v[84:87]
 buffer_load_dwordx4 v2, s[16:19], s34 offen nt lds
 s_add_u32 s34, s34, s37
 s_waitcnt lgkmcnt(4)
 v_mfma_f32_16x16x32_bf16 v[100:103], a[12:15], a[28:31], v[100:103]
 ds_read_b64_tr_b16 a[8:9], v8 offset:16384
 v_mfma_f32_16x16x32_bf16 v[96:99], a[12:15], a[24:27], v[96:99]
 ds_read_b64_tr_b16 a[10:11], v8 offset:16896
 v_mfma_f32_16x16x32_bf16 v[92:95], a[12:15], a[20:23], v[92:95]
 ds_read_b128 a[32:35], v4 offset:17408
 s_add_u32 m0, s40, 14336
 v_mfma_f32_16x16x32_bf16 v[88:91], a[12:15], a[16:19], v[88:91]
 buffer_load_dwordx4 v2, s[16:19], s35 offen nt lds
 s_add_u32 s35, s35, s37
 s_waitcnt lgkmcnt(5)
 v_mfma_f32_16x16x32_bf16 v[104:107], a[0:3], a[16:19], v[104:107]
 ds_read_b64_tr_b16 a[12:13], v9 offset:16384
 v_mfma_f32_16x16x32_bf16 v[108:111], a[0:3], a[20:23], v[108:111]
 ds_read_b64_tr_b16 a[14:15], v9 offset:16896
 v_mfma_f32_16x16x32_bf16 v[112:115], a[0:3], a[24:27], v[112:115]
 ds_read_b128 a[36:39], v4 offset:18432
 s_mov_b32 m0, s44
 v_mfma_f32_16x16x32_bf16 v[116:119], a[0:3], a[28:31], v[116:119]
 buffer_load_dwordx4 v3, s[20:23], s36 offen sc1 nt lds
 s_add_u32 s36, s36, s38
 s_waitcnt lgkmcnt(6)
 v_mfma_f32_16x16x32_bf16 v[132:135], a[4:7], a[28:31], v[132:135]
 ds_read_b64_tr_b16 a[0:1], v10 offset:0
 v_mfma_f32_16x16x32_bf16 v[128:131], a[4:7], a[24:27], v[128:131]
 ds_read_b64_tr_b16 a[2:3], v10 offset:256
 v_mfma_f32_16x16x32_bf16 v[124:127], a[4:7], a[20:23], v[124:127]
 ds_read_b128 a[40:43], v4 offset:19456
 v_mfma_f32_16x16x32_bf16 v[120:123], a[4:7], a[16:19], v[120:123]
 s_waitcnt lgkmcnt(7)
 v_mfma_f32_16x16x32_bf16 v[136:139], a[8:11], a[16:19], v[136:139]
 ds_read_b64_tr_b16 a[4:5], v10 offset:2048
 v_mfma_f32_16x16x32_bf16 v[140:143], a[8:11], a[20:23], v[140:143]
 ds_read_b64_tr_b16 a[6:7], v10 offset:2304
 v_mfma_f32_16x16x32_bf16 v[144:147], a[8:11], a[24:27], v[144:147]
 ds_read_b128 a[44:47], v4 offset:20480
 v_mfma_f32_16x16x32_bf16 v[148:151], a[8:11], a[28:31], v[148:151]
 s_waitcnt lgkmcnt(7)
 v_mfma_f32_16x16x32_bf16 v[164:167], a[12:15], a[28:31], v[164:167]
 ds_read_b64_tr_b16 a[8:9], v6 offset:4096
 v_mfma_f32_16x16x32_bf16 v[160:163], a[12:15], a[24:27], v[160:163]
 ds_read_b64_tr_b16 a[10:11], v6 offset:4608
 v_mfma_f32_16x16x32_bf16 v[156:159], a[12:15], a[20:23], v[156:159]
 v_mfma_f32_16x16x32_bf16 v[152:155], a[12:15], a[16:19], v[152:155]
 s_waitcnt lgkmcnt(6)
 v_mfma_f32_16x16x32_bf16 v[168:171], a[0:3], a[16:19], v[168:171]
 ds_read_b64_tr_b16 a[12:13], v7 offset:4096
 v_mfma_f32_16x16x32_bf16 v[172:175], a[0:3], a[20:23], v[172:175]
 ds_read_b64_tr_b16 a[14:15], v7 offset:4608
 v_mfma_f32_16x16x32_bf16 v[176:179], a[0:3], a[24:27], v[176:179]
 v_mfma_f32_16x16x32_bf16 v[180:183], a[0:3], a[28:31], v[180:183]
 s_waitcnt lgkmcnt(5)
 v_mfma_f32_16x16x32_bf16 v[196:199], a[4:7], a[28:31], v[196:199]
 ds_read_b64_tr_b16 a[0:1], v8 offset:4096
 v_mfma_f32_16x16x32_bf16 v[192:195], a[4:7], a[24:27], v[192:195]
 ds_read_b64_tr_b16 a[2:3], v8 offset:4608
 v_mfma_f32_16x16x32_bf16 v[188:191], a[4:7], a[20:23], v[188:191]
 v_mfma_f32_16x16x32_bf16 v[184:187], a[4:7], a[16:19], v[184:187]
 s_waitcnt vmcnt(6)
 s_barrier
 s_waitcnt lgkmcnt(4)
 v_mfma_f32_16x16x32_bf16 v[40:43], a[8:11], a[32:35], v[40:43]
 ds_read_b64_tr_b16 a[4:5], v9 offset:4096
 v_mfma_f32_16x16x32_bf16 v[44:47], a[8:11], a[36:39], v[44:47]
 ds_read_b64_tr_b16 a[6:7], v9 offset:4608
 v_mfma_f32_16x16x32_bf16 v[48:51], a[8:11], a[40:43], v[48:51]
 s_add_u32 m0, s39, 0
 v_mfma_f32_16x16x32_bf16 v[52:55], a[8:11], a[44:47], v[52:55]
 buffer_load_dwordx4 v1, s[12:15], s33 offen sc1 lds
 s_waitcnt lgkmcnt(4)
 v_mfma_f32_16x16x32_bf16 v[68:71], a[12:15], a[44:47], v[68:71]
 ds_read_b64_tr_b16 a[8:9], v6 offset:20480
 v_mfma_f32_16x16x32_bf16 v[64:67], a[12:15], a[40:43], v[64:67]
 ds_read_b64_tr_b16 a[10:11], v6 offset:20992
 v_mfma_f32_16x16x32_bf16 v[60:63], a[12:15], a[36:39], v[60:63]
 v_mfma_f32_16x16x32_bf16 v[56:59], a[12:15], a[32:35], v[56:59]
 buffer_load_dwordx4 v1, s[12:15], s33 offen offset:1024 sc1 lds
 s_add_u32 s33, s33, 2048
 s_waitcnt lgkmcnt(4)
 v_mfma_f32_16x16x32_bf16 v[72:75], a[0:3], a[32:35], v[72:75]
 ds_read_b64_tr_b16 a[12:13], v7 offset:20480
 v_mfma_f32_16x16x32_bf16 v[76:79], a[0:3], a[36:39], v[76:79]
 ds_read_b64_tr_b16 a[14:15], v7 offset:20992
 v_mfma_f32_16x16x32_bf16 v[80:83], a[0:3], a[40:43], v[80:83]
 s_add_u32 m0, s40, 0
 v_mfma_f32_16x16x32_bf16 v[84:87], a[0:3], a[44:47], v[84:87]
 buffer_load_dwordx4 v2, s[16:19], s34 offen nt lds
 s_add_u32 s34, s34, s37
 s_waitcnt lgkmcnt(4)
 v_mfma_f32_16x16x32_bf16 v[100:103], a[4:7], a[44:47], v[100:103]
 ds_read_b64_tr_b16 a[0:1], v8 offset:20480
 v_mfma_f32_16x16x32_bf16 v[96:99], a[4:7], a[40:43], v[96:99]
 ds_read_b64_tr_b16 a[2:3], v8 offset:20992
 v_mfma_f32_16x16x32_bf16 v[92:95], a[4:7], a[36:39], v[92:95]
 ds_read_b128 a[16:19], v4 offset:34816
 s_add_u32 m0, s40, 2048
 v_mfma_f32_16x16x32_bf16 v[88:91], a[4:7], a[32:35], v[88:91]
 buffer_load_dwordx4 v2, s[16:19], s35 offen nt lds
 s_add_u32 s35, s35, s37
 s_waitcnt lgkmcnt(5)
 v_mfma_f32_16x16x32_bf16 v[104:107], a[8:11], a[32:35], v[104:107]
 ds_read_b64_tr_b16 a[4:5], v9 offset:20480
 v_mfma_f32_16x16x32_bf16 v[108:111], a[8:11], a[36:39], v[108:111]
 ds_read_b64_tr_b16 a[6:7], v9 offset:20992
 v_mfma_f32_16x16x32_bf16 v[112:115], a[8:11], a[40:43], v[112:115]
 ds_read_b128 a[20:23], v4 offset:35840
 s_mov_b32 m0, s41
 v_mfma_f32_16x16x32_bf16 v[116:119], a[8:11], a[44:47], v[116:119]
 buffer_load_dwordx4 v3, s[20:23], s36 offen sc1 nt lds
 s_add_u32 s36, s36, s38
 s_waitcnt lgkmcnt(6)
 v_mfma_f32_16x16x32_bf16 v[132:135], a[12:15], a[44:47], v[132:135]
 ds_read_b64_tr_b16 a[8:9], v10 offset:4096
 v_mfma_f32_16x16x32_bf16 v[128:131], a[12:15], a[40:43], v[128:131]
 ds_read_b64_tr_b16 a[10:11], v10 offset:4352
 v_mfma_f32_16x16x32_bf16 v[124:127], a[12:15], a[36:39], v[124:127]
 ds_read_b128 a[24:27], v4 offset:36864
 v_mfma_f32_16x16x32_bf16 v[120:123], a[12:15], a[32:35], v[120:123]
 s_cmp_eq_u32 s45, s88
 s_cselect_b64 vcc, -1, 0
 v_cndmask_b32 v15, v14, v12, vcc
 buffer_load_dword v31, v15, s[84:87], 0 offen
 s_waitcnt lgkmcnt(7)
 v_mfma_f32_16x16x32_bf16 v[136:139], a[0:3], a[32:35], v[136:139]
 ds_read_b64_tr_b16 a[12:13], v10 offset:6144
 v_mfma_f32_16x16x32_bf16 v[140:143], a[0:3], a[36:39], v[140:143]
 ds_read_b64_tr_b16 a[14:15], v10 offset:6400
 v_mfma_f32_16x16x32_bf16 v[144:147], a[0:3], a[40:43], v[144:147]
 ds_read_b128 a[28:31], v4 offset:37888
 v_mfma_f32_16x16x32_bf16 v[148:151], a[0:3], a[44:47], v[148:151]
 s_waitcnt lgkmcnt(7)
 v_mfma_f32_16x16x32_bf16 v[164:167], a[4:7], a[44:47], v[164:167]
 ds_read_b64_tr_b16 a[0:1], v6 offset:8192
 v_mfma_f32_16x16x32_bf16 v[160:163], a[4:7], a[40:43], v[160:163]
 ds_read_b64_tr_b16 a[2:3], v6 offset:8704
 v_mfma_f32_16x16x32_bf16 v[156:159], a[4:7], a[36:39], v[156:159]
 v_mfma_f32_16x16x32_bf16 v[152:155], a[4:7], a[32:35], v[152:155]
 s_waitcnt lgkmcnt(6)
 v_mfma_f32_16x16x32_bf16 v[168:171], a[8:11], a[32:35], v[168:171]
 ds_read_b64_tr_b16 a[4:5], v7 offset:8192
 v_mfma_f32_16x16x32_bf16 v[172:175], a[8:11], a[36:39], v[172:175]
 ds_read_b64_tr_b16 a[6:7], v7 offset:8704
 v_mfma_f32_16x16x32_bf16 v[176:179], a[8:11], a[40:43], v[176:179]
 v_mfma_f32_16x16x32_bf16 v[180:183], a[8:11], a[44:47], v[180:183]
 s_waitcnt lgkmcnt(5)
 v_mfma_f32_16x16x32_bf16 v[196:199], a[12:15], a[44:47], v[196:199]
 ds_read_b64_tr_b16 a[8:9], v8 offset:8192
 v_mfma_f32_16x16x32_bf16 v[192:195], a[12:15], a[40:43], v[192:195]
 ds_read_b64_tr_b16 a[10:11], v8 offset:8704
 v_mfma_f32_16x16x32_bf16 v[188:191], a[12:15], a[36:39], v[188:191]
 v_mfma_f32_16x16x32_bf16 v[184:187], a[12:15], a[32:35], v[184:187]
 s_waitcnt vmcnt(6)
 s_barrier
 s_waitcnt lgkmcnt(4)
 v_mfma_f32_16x16x32_bf16 v[40:43], a[0:3], a[16:19], v[40:43]
 ds_read_b64_tr_b16 a[12:13], v9 offset:8192
 v_mfma_f32_16x16x32_bf16 v[44:47], a[0:3], a[20:23], v[44:47]
 ds_read_b64_tr_b16 a[14:15], v9 offset:8704
 v_mfma_f32_16x16x32_bf16 v[48:51], a[0:3], a[24:27], v[48:51]
 s_add_u32 m0, s39, 17408
 v_mfma_f32_16x16x32_bf16 v[52:55], a[0:3], a[28:31], v[52:55]
 buffer_load_dwordx4 v1, s[12:15], s33 offen sc1 lds
 s_waitcnt lgkmcnt(4)
 v_mfma_f32_16x16x32_bf16 v[68:71], a[4:7], a[28:31], v[68:71]
 ds_read_b64_tr_b16 a[0:1], v6 offset:24576
 v_mfma_f32_16x16x32_bf16 v[64:67], a[4:7], a[24:27], v[64:67]
 ds_read_b64_tr_b16 a[2:3], v6 offset:25088
 v_mfma_f32_16x16x32_bf16 v[60:63], a[4:7], a[20:23], v[60:63]
 v_mfma_f32_16x16x32_bf16 v[56:59], a[4:7], a[16:19], v[56:59]
 buffer_load_dwordx4 v1, s[12:15], s33 offen offset:1024 sc1 lds
 s_add_u32 s33, s33, 2048
 s_waitcnt lgkmcnt(4)
 v_mfma_f32_16x16x32_bf16 v[72:75], a[8:11], a[16:19], v[72:75]
 ds_read_b64_tr_b16 a[4:5], v7 offset:24576
 v_mfma_f32_16x16x32_bf16 v[76:79], a[8:11], a[20:23], v[76:79]
 ds_read_b64_tr_b16 a[6:7], v7 offset:25088
 v_mfma_f32_16x16x32_bf16 v[80:83], a[8:11], a[24:27], v[80:83]
 s_add_u32 m0, s40, 4096
 v_mfma_f32_16x16x32_bf16 v[84:87], a[8:11], a[28:31], v[84:87]
 buffer_load_dwordx4 v2, s[16:19], s34 offen nt lds
 s_add_u32 s34, s34, s37
 s_waitcnt lgkmcnt(4)
 v_mfma_f32_16x16x32_bf16 v[100:103], a[12:15], a[28:31], v[100:103]
 ds_read_b64_tr_b16 a[8:9], v8 offset:24576
 v_mfma_f32_16x16x32_bf16 v[96:99], a[12:15], a[24:27], v[96:99]
 ds_read_b64_tr_b16 a[10:11], v8 offset:25088
 v_mfma_f32_16x16x32_bf16 v[92:95], a[12:15], a[20:23], v[92:95]
 ds_read_b128 a[32:35], v4 offset:52224
 s_add_u32 m0, s40, 6144
 v_mfma_f32_16x16x32_bf16 v[88:91], a[12:15], a[16:19], v[88:91]
 buffer_load_dwordx4 v2, s[16:19], s35 offen nt lds
 s_add_u32 s35, s35, s37
 s_waitcnt lgkmcnt(5)
 v_mfma_f32_16x16x32_bf16 v[104:107], a[0:3], a[16:19], v[104:107]
 ds_read_b64_tr_b16 a[12:13], v9 offset:24576
 v_mfma_f32_16x16x32_bf16 v[108:111], a[0:3], a[20:23], v[108:111]
 ds_read_b64_tr_b16 a[14:15], v9 offset:25088
 v_mfma_f32_16x16x32_bf16 v[112:115], a[0:3], a[24:27], v[112:115]
 ds_read_b128 a[36:39], v4 offset:53248
 s_mov_b32 m0, s42
 v_mfma_f32_16x16x32_bf16 v[116:119], a[0:3], a[28:31], v[116:119]
 buffer_load_dwordx4 v3, s[20:23], s36 offen sc1 nt lds
 s_add_u32 s36, s36, s38
 s_waitcnt lgkmcnt(6)
 v_mfma_f32_16x16x32_bf16 v[132:135], a[4:7], a[28:31], v[132:135]
 ds_read_b64_tr_b16 a[0:1], v10 offset:8192
 v_mfma_f32_16x16x32_bf16 v[128:131], a[4:7], a[24:27], v[128:131]
 ds_read_b64_tr_b16 a[2:3], v10 offset:8448
 v_mfma_f32_16x16x32_bf16 v[124:127], a[4:7], a[20:23], v[124:127]
 ds_read_b128 a[40:43], v4 offset:54272
 v_mfma_f32_16x16x32_bf16 v[120:123], a[4:7], a[16:19], v[120:123]
 s_waitcnt lgkmcnt(7)
 v_mfma_f32_16x16x32_bf16 v[136:139], a[8:11], a[16:19], v[136:139]
 ds_read_b64_tr_b16 a[4:5], v10 offset:10240
 v_mfma_f32_16x16x32_bf16 v[140:143], a[8:11], a[20:23], v[140:143]
 ds_read_b64_tr_b16 a[6:7], v10 offset:10496
 v_mfma_f32_16x16x32_bf16 v[144:147], a[8:11], a[24:27], v[144:147]
 ds_read_b128 a[44:47], v4 offset:55296
 v_mfma_f32_16x16x32_bf16 v[148:151], a[8:11], a[28:31], v[148:151]
 s_waitcnt lgkmcnt(7)
 v_mfma_f32_16x16x32_bf16 v[164:167], a[12:15], a[28:31], v[164:167]
 ds_read_b64_tr_b16 a[8:9], v6 offset:12288
 v_mfma_f32_16x16x32_bf16 v[160:163], a[12:15], a[24:27], v[160:163]
 ds_read_b64_tr_b16 a[10:11], v6 offset:12800
 v_mfma_f32_16x16x32_bf16 v[156:159], a[12:15], a[20:23], v[156:159]
 v_mfma_f32_16x16x32_bf16 v[152:155], a[12:15], a[16:19], v[152:155]
 s_waitcnt lgkmcnt(6)
 v_mfma_f32_16x16x32_bf16 v[168:171], a[0:3], a[16:19], v[168:171]
 ds_read_b64_tr_b16 a[12:13], v7 offset:12288
 v_mfma_f32_16x16x32_bf16 v[172:175], a[0:3], a[20:23], v[172:175]
 ds_read_b64_tr_b16 a[14:15], v7 offset:12800
 v_mfma_f32_16x16x32_bf16 v[176:179], a[0:3], a[24:27], v[176:179]
 v_mfma_f32_16x16x32_bf16 v[180:183], a[0:3], a[28:31], v[180:183]
 s_waitcnt lgkmcnt(5)
 v_mfma_f32_16x16x32_bf16 v[196:199], a[4:7], a[28:31], v[196:199]
 ds_read_b64_tr_b16 a[0:1], v8 offset:12288
 v_mfma_f32_16x16x32_bf16 v[192:195], a[4:7], a[24:27], v[192:195]
 ds_read_b64_tr_b16 a[2:3], v8 offset:12800
 v_mfma_f32_16x16x32_bf16 v[188:191], a[4:7], a[20:23], v[188:191]
 v_mfma_f32_16x16x32_bf16 v[184:187], a[4:7], a[16:19], v[184:187]
 s_waitcnt vmcnt(6)
 s_barrier
 s_waitcnt lgkmcnt(4)
 v_mfma_f32_16x16x32_bf16 v[40:43], a[8:11], a[32:35], v[40:43]
 ds_read_b64_tr_b16 a[4:5], v9 offset:12288
 v_mfma_f32_16x16x32_bf16 v[44:47], a[8:11], a[36:39], v[44:47]
 ds_read_b64_tr_b16 a[6:7], v9 offset:12800
 v_mfma_f32_16x16x32_bf16 v[48:51], a[8:11], a[40:43], v[48:51]
 s_add_u32 m0, s39, 34816
 v_mfma_f32_16x16x32_bf16 v[52:55], a[8:11], a[44:47], v[52:55]
 buffer_load_dwordx4 v1, s[12:15], s33 offen sc1 lds
 s_waitcnt lgkmcnt(4)
 v_mfma_f32_16x16x32_bf16 v[68:71], a[12:15], a[44:47], v[68:71]
 ds_read_b64_tr_b16 a[8:9], v6 offset:28672
 v_mfma_f32_16x16x32_bf16 v[64:67], a[12:15], a[40:43], v[64:67]
 ds_read_b64_tr_b16 a[10:11], v6 offset:29184
 v_mfma_f32_16x16x32_bf16 v[60:63], a[12:15], a[36:39], v[60:63]
 v_mfma_f32_16x16x32_bf16 v[56:59], a[12:15], a[32:35], v[56:59]
 buffer_load_dwordx4 v1, s[12:15], s33 offen offset:1024 sc1 lds
 s_add_u32 s33, s33, 2048
 s_waitcnt lgkmcnt(4)
 v_mfma_f32_16x16x32_bf16 v[72:75], a[0:3], a[32:35], v[72:75]
 ds_read_b64_tr_b16 a[12:13], v7 offset:28672
 v_mfma_f32_16x16x32_bf16 v[76:79], a[0:3], a[36:39], v[76:79]
 ds_read_b64_tr_b16 a[14:15], v7 offset:29184
 v_mfma_f32_16x16x32_bf16 v[80:83], a[0:3], a[40:43], v[80:83]
 s_add_u32 m0, s40, 8192
 v_mfma_f32_16x16x32_bf16 v[84:87], a[0:3], a[44:47], v[84:87]
 buffer_load_dwordx4 v2, s[16:19], s34 offen nt lds
 s_add_u32 s34, s34, s37
 s_waitcnt lgkmcnt(4)
 v_mfma_f32_16x16x32_bf16 v[100:103], a[4:7], a[44:47], v[100:103]
 ds_read_b64_tr_b16 a[0:1], v8 offset:28672
 v_mfma_f32_16x16x32_bf16 v[96:99], a[4:7], a[40:43], v[96:99]
 ds_read_b64_tr_b16 a[2:3], v8 offset:29184
 v_mfma_f32_16x16x32_bf16 v[92:95], a[4:7], a[36:39], v[92:95]
 ds_read_b128 a[16:19], v4 offset:0
 s_add_u32 m0, s40, 10240
 v_mfma_f32_16x16x32_bf16 v[88:91], a[4:7], a[32:35], v[88:91]
 buffer_load_dwordx4 v2, s[16:19], s35 offen nt lds
 s_add_u32 s35, s35, s37
 s_waitcnt lgkmcnt(5)
 v_mfma_f32_16x16x32_bf16 v[104:107], a[8:11], a[32:35], v[104:107]
 ds_read_b64_tr_b16 a[4:5], v9 offset:28672
 v_mfma_f32_16x16x32_bf16 v[108:111], a[8:11], a[36:39], v[108:111]
 ds_read_b64_tr_b16 a[6:7], v9 offset:29184
 v_mfma_f32_16x16x32_bf16 v[112:115], a[8:11], a[40:43], v[112:115]
 ds_read_b128 a[20:23], v4 offset:1024
 s_mov_b32 m0, s43
 v_mfma_f32_16x16x32_bf16 v[116:119], a[8:11], a[44:47], v[116:119]
 buffer_load_dwordx4 v3, s[20:23], s36 offen sc1 nt lds
 s_add_u32 s36, s36, s38
 s_waitcnt lgkmcnt(6)
 v_mfma_f32_16x16x32_bf16 v[132:135], a[12:15], a[44:47], v[132:135]
 ds_read_b64_tr_b16 a[8:9], v10 offset:12288
 v_mfma_f32_16x16x32_bf16 v[128:131], a[12:15], a[40:43], v[128:131]
 ds_read_b64_tr_b16 a[10:11], v10 offset:12544
 v_mfma_f32_16x16x32_bf16 v[124:127], a[12:15], a[36:39], v[124:127]
 ds_read_b128 a[24:27], v4 offset:2048
 v_mfma_f32_16x16x32_bf16 v[120:123], a[12:15], a[32:35], v[120:123]
 s_cmp_eq_u32 s45, s89
 s_cselect_b64 vcc, -1, 0
 v_cndmask_b32 v15, v14, v13, vcc
 buffer_load_dword v31, v15, s[80:83], 0 offen
 s_waitcnt lgkmcnt(7)
 v_mfma_f32_16x16x32_bf16 v[136:139], a[0:3], a[32:35], v[136:139]
 ds_read_b64_tr_b16 a[12:13], v10 offset:14336
 v_mfma_f32_16x16x32_bf16 v[140:143], a[0:3], a[36:39], v[140:143]
 ds_read_b64_tr_b16 a[14:15], v10 offset:14592
 v_mfma_f32_16x16x32_bf16 v[144:147], a[0:3], a[40:43], v[144:147]
 ds_read_b128 a[28:31], v4 offset:3072
 v_mfma_f32_16x16x32_bf16 v[148:151], a[0:3], a[44:47], v[148:151]
 s_waitcnt lgkmcnt(7)
 v_mfma_f32_16x16x32_bf16 v[164:167], a[4:7], a[44:47], v[164:167]
 ds_read_b64_tr_b16 a[0:1], v6 offset:0
 v_mfma_f32_16x16x32_bf16 v[160:163], a[4:7], a[40:43], v[160:163]
 ds_read_b64_tr_b16 a[2:3], v6 offset:512
 v_mfma_f32_16x16x32_bf16 v[156:159], a[4:7], a[36:39], v[156:159]
 v_mfma_f32_16x16x32_bf16 v[152:155], a[4:7], a[32:35], v[152:155]
 s_waitcnt lgkmcnt(6)
 v_mfma_f32_16x16x32_bf16 v[168:171], a[8:11], a[32:35], v[168:171]
 ds_read_b64_tr_b16 a[4:5], v7 offset:0
 v_mfma_f32_16x16x32_bf16 v[172:175], a[8:11], a[36:39], v[172:175]
 ds_read_b64_tr_b16 a[6:7], v7 offset:512
 v_mfma_f32_16x16x32_bf16 v[176:179], a[8:11], a[40:43], v[176:179]
 v_mfma_f32_16x16x32_bf16 v[180:183], a[8:11], a[44:47], v[180:183]
 s_waitcnt lgkmcnt(5)
 v_mfma_f32_16x16x32_bf16 v[196:199], a[12:15], a[44:47], v[196:199]
 ds_read_b64_tr_b16 a[8:9], v8 offset:0
 v_mfma_f32_16x16x32_bf16 v[192:195], a[12:15], a[40:43], v[192:195]
 ds_read_b64_tr_b16 a[10:11], v8 offset:512
 v_mfma_f32_16x16x32_bf16 v[188:191], a[12:15], a[36:39], v[188:191]
 v_mfma_f32_16x16x32_bf16 v[184:187], a[12:15], a[32:35], v[184:187]
 s_waitcnt vmcnt(6)
 s_barrier
 s_sub_u32 s45, s45, 1
 s_cmp_lg_u32 s45, 0
 s_cbranch_scc1 L_loop_Y_n_1
 s_waitcnt lgkmcnt(4)
 v_mfma_f32_16x16x32_bf16 v[40:43], a[0:3], a[16:19], v[40:43]
 ds_read_b64_tr_b16 a[12:13], v9 offset:0
 v_mfma_f32_16x16x32_bf16 v[44:47], a[0:3], a[20:23], v[44:47]
 ds_read_b64_tr_b16 a[14:15], v9 offset:512
 v_mfma_f32_16x16x32_bf16 v[48:51], a[0:3], a[24:27], v[48:51]
 s_add_u32 m0, s39, 52224
 v_mfma_f32_16x16x32_bf16 v[52:55], a[0:3], a[28:31], v[52:55]
 buffer_load_dwordx4 v1, s[12:15], s33 offen sc1 lds
 s_waitcnt lgkmcnt(4)
 v_mfma_f32_16x16x32_bf16 v[68:71], a[4:7], a[28:31], v[68:71]
 ds_read_b64_tr_b16 a[0:1], v6 offset:16384
 v_mfma_f32_16x16x32_bf16 v[64:67], a[4:7], a[24:27], v[64:67]
 ds_read_b64_tr_b16 a[2:3], v6 offset:16896
 v_mfma_f32_16x16x32_bf16 v[60:63], a[4:7], a[20:23], v[60:63]
 v_mfma_f32_16x16x32_bf16 v[56:59], a[4:7], a[16:19], v[56:59]
 buffer_load_dwordx4 v1, s[12:15], s33 offen offset:1024 sc1 lds
 s_add_u32 s33, s33, 2048
 s_waitcnt lgkmcnt(4)
 v_mfma_f32_16x16x32_bf16 v[72:75], a[8:11], a[16:19], v[72:75]
 ds_read_b64_tr_b16 a[4:5], v7 offset:16384
 v_mfma_f32_16x16x32_bf16 v[76:79], a[8:11], a[20:23], v[76:79]
 ds_read_b64_tr_b16 a[6:7], v7 offset:16896
 v_mfma_f32_16x16x32_bf16 v[80:83], a[8:11], a[24:27], v[80:83]
 s_add_u32 m0, s40, 12288
 v_mfma_f32_16x16x32_bf16 v[84:87], a[8:11], a[28:31], v[84:87]
 buffer_load_dwordx4 v2, s[16:19], s34 offen nt lds
 s_add_u32 s34, s34, s37
 s_waitcnt lgkmcnt(4)
 v_mfma_f32_16x16x32_bf16 v[100:103], a[12:15], a[28:31], v[100:103]
 ds_read_b64_tr_b16 a[8:9], v8 offset:16384
 v_mfma_f32_16x16x32_bf16 v[96:99], a[12:15], a[24:27], v[96:99]
 ds_read_b64_tr_b16 a[10:11], v8 offset:16896
 v_mfma_f32_16x16x32_bf16 v[92:95], a[12:15], a[20:23], v[92:95]
 ds_read_b128 a[32:35], v4 offset:17408
 s_add_u32 m0, s40, 14336
 v_mfma_f32_16x16x32_bf16 v[88:91], a[12:15], a[16:19], v[88:91]
 buffer_load_dwordx4 v2, s[16:19], s35 offen nt lds
 s_add_u32 s35, s35, s37
 s_waitcnt lgkmcnt(5)
 v_mfma_f32_16x16x32_bf16 v[104:107], a[0:3], a[16:19], v[104:107]
 ds_read_b64_tr_b16 a[12:13], v9 offset:16384
 v_mfma_f32_16x16x32_bf16 v[108:111], a[0:3], a[20:23], v[108:111]
 ds_read_b64_tr_b16 a[14:15], v9 offset:16896
 v_mfma_f32_16x16x32_bf16 v[112:115], a[0:3], a[24:27], v[112:115]
 ds_read_b128 a[36:39], v4 offset:18432
 s_mov_b32 m0, s44
 v_mfma_f32_16x16x32_bf16 v[116:119], a[0:3], a[28:31], v[116:119]
 buffer_load_dwordx4 v3, s[20:23], s36 offen sc1 nt lds
 s_add_u32 s36, s36, s38
 s_waitcnt lgkmcnt(6)
 v_mfma_f32_16x16x32_bf16 v[132:135], a[4:7], a[28:31], v[132:135]
 ds_read_b64_tr_b16 a[0:1], v10 offset:0
 v_mfma_f32_16x16x32_bf16 v[128:131], a[4:7], a[24:27], v[128:131]
 ds_read_b64_tr_b16 a[2:3], v10 offset:256
 v_mfma_f32_16x16x32_bf16 v[124:127], a[4:7], a[20:23], v[124:127]
 ds_read_b128 a[40:43], v4 offset:19456
 v_mfma_f32_16x16x32_bf16 v[120:123], a[4:7], a[16:19], v[120:123]
 s_waitcnt lgkmcnt(7)
 v_mfma_f32_16x16x32_bf16 v[136:139], a[8:11], a[16:19], v[136:139]
 ds_read_b64_tr_b16 a[4:5], v10 offset:2048
 v_mfma_f32_16x16x32_bf16 v[140:143], a[8:11], a[20:23], v[140:143]
 ds_read_b64_tr_b16 a[6:7], v10 offset:2304
 v_mfma_f32_16x16x32_bf16 v[144:147], a[8:11], a[24:27], v[144:147]
 ds_read_b128 a[44:47], v4 offset:20480
 v_mfma_f32_16x16x32_bf16 v[148:151], a[8:11], a[28:31], v[148:151]
 s_waitcnt lgkmcnt(7)
 v_mfma_f32_16x16x32_bf16 v[164:167], a[12:15], a[28:31], v[164:167]
 ds_read_b64_tr_b16 a[8:9], v6 offset:4096
 v_mfma_f32_16x16x32_bf16 v[160:163], a[12:15], a[24:27], v[160:163]
 ds_read_b64_tr_b16 a[10:11], v6 offset:4608
 v_mfma_f32_16x16x32_bf16 v[156:159], a[12:15], a[20:23], v[156:159]
 v_mfma_f32_16x16x32_bf16 v[152:155], a[12:15], a[16:19], v[152:155]
 s_waitcnt lgkmcnt(6)
 v_mfma_f32_16x16x32_bf16 v[168:171], a[0:3], a[16:19], v[168:171]
 ds_read_b64_tr_b16 a[12:13], v7 offset:4096
 v_mfma_f32_16x16x32_bf16 v[172:175], a[0:3], a[20:23], v[172:175]
 ds_read_b64_tr_b16 a[14:15], v7 offset:4608
 v_mfma_f32_16x16x32_bf16 v[176:179], a[0:3], a[24:27], v[176:179]
 v_mfma_f32_16x16x32_bf16 v[180:183], a[0:3], a[28:31], v[180:183]
 s_waitcnt lgkmcnt(5)
 v_mfma_f32_16x16x32_bf16 v[196:199], a[4:7], a[28:31], v[196:199]
 ds_read_b64_tr_b16 a[0:1], v8 offset:4096
 v_mfma_f32_16x16x32_bf16 v[192:195], a[4:7], a[24:27], v[192:195]
 ds_read_b64_tr_b16 a[2:3], v8 offset:4608
 v_mfma_f32_16x16x32_bf16 v[188:191], a[4:7], a[20:23], v[188:191]
 v_mfma_f32_16x16x32_bf16 v[184:187], a[4:7], a[16:19], v[184:187]
 s_waitcnt vmcnt(6)
 s_barrier
 s_waitcnt lgkmcnt(4)
 v_mfma_f32_16x16x32_bf16 v[40:43], a[8:11], a[32:35], v[40:43]
 ds_read_b64_tr_b16 a[4:5], v9 offset:4096
 v_mfma_f32_16x16x32_bf16 v[44:47], a[8:11], a[36:39], v[44:47]
 ds_read_b64_tr_b16 a[6:7], v9 offset:4608
 v_mfma_f32_16x16x32_bf16 v[48:51], a[8:11], a[40:43], v[48:51]
 s_add_u32 m0, s39, 0
 v_mfma_f32_16x16x32_bf16 v[52:55], a[8:11], a[44:47], v[52:55]
 buffer_load_dwordx4 v1, s[12:15], s33 offen sc1 lds
 s_waitcnt lgkmcnt(4)
 v_mfma_f32_16x16x32_bf16 v[68:71], a[12:15], a[44:47], v[68:71]
 ds_read_b64_tr_b16 a[8:9], v6 offset:20480
 v_mfma_f32_16x16x32_bf16 v[64:67], a[12:15], a[40:43], v[64:67]
 ds_read_b64_tr_b16 a[10:11], v6 offset:20992
 v_mfma_f32_16x16x32_bf16 v[60:63], a[12:15], a[36:39], v[60:63]
 v_mfma_f32_16x16x32_bf16 v[56:59], a[12:15], a[32:35], v[56:59]
 buffer_load_dwordx4 v1, s[12:15], s33 offen offset:1024 sc1 lds
 s_add_u32 s33, s33, 2048
 s_waitcnt lgkmcnt(4)
 v_mfma_f32_16x16x32_bf16 v[72:75], a[0:3], a[32:35], v[72:75]
 ds_read_b64_tr_b16 a[12:13], v7 offset:20480
 v_mfma_f32_16x16x32_bf16 v[76:79], a[0:3], a[36:39], v[76:79]
 ds_read_b64_tr_b16 a[14:15], v7 offset:20992
 v_mfma_f32_16x16x32_bf16 v[80:83], a[0:3], a[40:43], v[80:83]
 s_add_u32 m0, s40, 0
 v_mfma_f32_16x16x32_bf16 v[84:87], a[0:3], a[44:47], v[84:87]
 buffer_load_dwordx4 v2, s[16:19], s34 offen nt lds
 s_add_u32 s34, s34, s37
 s_waitcnt lgkmcnt(4)
 v_mfma_f32_16x16x32_bf16 v[100:103], a[4:7], a[44:47], v[100:103]
 ds_read_b64_tr_b16 a[0:1], v8 offset:20480
 v_mfma_f32_16x16x32_bf16 v[96:99], a[4:7], a[40:43], v[96:99]
 ds_read_b64_tr_b16 a[2:3], v8 offset:20992
 v_mfma_f32_16x16x32_bf16 v[92:95], a[4:7], a[36:39], v[92:95]
 ds_read_b128 a[16:19], v4 offset:34816
 s_add_u32 m0, s40, 2048
 v_mfma_f32_16x16x32_bf16 v[88:91], a[4:7], a[32:35], v[88:91]
 buffer_load_dwordx4 v2, s[16:19], s35 offen nt lds
 s_add_u32 s35, s35, s37
 s_waitcnt lgkmcnt(5)
 v_mfma_f32_16x16x32_bf16 v[104:107], a[8:11], a[32:35], v[104:107]
 ds_read_b64_tr_b16 a[4:5], v9 offset:20480
 v_mfma_f32_16x16x32_bf16 v[108:111], a[8:11], a[36:39], v[108:111]
 ds_read_b64_tr_b16 a[6:7], v9 offset:20992
 v_mfma_f32_16x16x32_bf16 v[112:115], a[8:11], a[40:43], v[112:115]
 ds_read_b128 a[20:23], v4 offset:35840
 s_mov_b32 m0, s41
 v_mfma_f32_16x16x32_bf16 v[116:119], a[8:11], a[44:47], v[116:119]
 buffer_load_dwordx4 v3, s[20:23], s36 offen sc1 nt lds
 s_add_u32 s36, s36, s38
 s_waitcnt lgkmcnt(6)
 v_mfma_f32_16x16x32_bf16 v[132:135], a[12:15], a[44:47], v[132:135]
 ds_read_b64_tr_b16 a[8:9], v10 offset:4096
 v_mfma_f32_16x16x32_bf16 v[128:131], a[12:15], a[40:43], v[128:131]
 ds_read_b64_tr_b16 a[10:11], v10 offset:4352
 v_mfma_f32_16x16x32_bf16 v[124:127], a[12:15], a[36:39], v[124:127]
 ds_read_b128 a[24:27], v4 offset:36864
 v_mfma_f32_16x16x32_bf16 v[120:123], a[12:15], a[32:35], v[120:123]
 s_waitcnt lgkmcnt(7)
 v_mfma_f32_16x16x32_bf16 v[136:139], a[0:3], a[32:35], v[136:139]
 ds_read_b64_tr_b16 a[12:13], v10 offset:6144
 v_mfma_f32_16x16x32_bf16 v[140:143], a[0:3], a[36:39], v[140:143]
 ds_read_b64_tr_b16 a[14:15], v10 offset:6400
 v_mfma_f32_16x16x32_bf16 v[144:147], a[0:3], a[40:43], v[144:147]
 ds_read_b128 a[28:31], v4 offset:37888
 v_mfma_f32_16x16x32_bf16 v[148:151], a[0:3], a[44:47], v[148:151]
 s_waitcnt lgkmcnt(7)
 v_mfma_f32_16x16x32_bf16 v[164:167], a[4:7], a[44:47], v[164:167]
 ds_read_b64_tr_b16 a[0:1], v6 offset:8192
 v_mfma_f32_16x16x32_bf16 v[160:163], a[4:7], a[40:43], v[160:163]
 ds_read_b64_tr_b16 a[2:3], v6 offset:8704
 v_mfma_f32_16x16x32_bf16 v[156:159], a[4:7], a[36:39], v[156:159]
 v_mfma_f32_16x16x32_bf16 v[152:155], a[4:7], a[32:35], v[152:155]
 s_waitcnt lgkmcnt(6)
 v_mfma_f32_16x16x32_bf16 v[168:171], a[8:11], a[32:35], v[168:171]
 ds_read_b64_tr_b16 a[4:5], v7 offset:8192
 v_mfma_f32_16x16x32_bf16 v[172:175], a[8:11], a[36:39], v[172:175]
 ds_read_b64_tr_b16 a[6:7], v7 offset:8704
 v_mfma_f32_16x16x32_bf16 v[176:179], a[8:11], a[40:43], v[176:179]
 v_mfma_f32_16x16x32_bf16 v[180:183], a[8:11], a[44:47], v[180:183]
 s_waitcnt lgkmcnt(5)
 v_mfma_f32_16x16x32_bf16 v[196:199], a[12:15], a[44:47], v[196:199]
 ds_read_b64_tr_b16 a[8:9], v8 offset:8192
 v_mfma_f32_16x16x32_bf16 v[192:195], a[12:15], a[40:43], v[192:195]
 ds_read_b64_tr_b16 a[10:11], v8 offset:8704
 v_mfma_f32_16x16x32_bf16 v[188:191], a[12:15], a[36:39], v[188:191]
 v_mfma_f32_16x16x32_bf16 v[184:187], a[12:15], a[32:35], v[184:187]
 s_waitcnt vmcnt(5)
 s_barrier
 s_waitcnt lgkmcnt(4)
 v_mfma_f32_16x16x32_bf16 v[40:43], a[0:3], a[16:19], v[40:43]
 ds_read_b64_tr_b16 a[12:13], v9 offset:8192
 v_mfma_f32_16x16x32_bf16 v[44:47], a[0:3], a[20:23], v[44:47]
 ds_read_b64_tr_b16 a[14:15], v9 offset:8704
 v_mfma_f32_16x16x32_bf16 v[48:51], a[0:3], a[24:27], v[48:51]
 s_add_u32 m0, s39, 17408
 v_mfma_f32_16x16x32_bf16 v[52:55], a[0:3], a[28:31], v[52:55]
 buffer_load_dwordx4 v1, s[12:15], s33 offen sc1 lds
 s_waitcnt lgkmcnt(4)
 v_mfma_f32_16x16x32_bf16 v[68:71], a[4:7], a[28:31], v[68:71]
 ds_read_b64_tr_b16 a[0:1], v6 offset:24576
 v_mfma_f32_16x16x32_bf16 v[64:67], a[4:7], a[24:27], v[64:67]
 ds_read_b64_tr_b16 a[2:3], v6 offset:25088
 v_mfma_f32_16x16x32_bf16 v[60:63], a[4:7], a[20:23], v[60:63]
 v_mfma_f32_16x16x32_bf16 v[56:59], a[4:7], a[16:19], v[56:59]
 buffer_load_dwordx4 v1, s[12:15], s33 offen offset:1024 sc1 lds
 s_add_u32 s33, s33, 2048
 s_waitcnt lgkmcnt(4)
 v_mfma_f32_16x16x32_bf16 v[72:75], a[8:11], a[16:19], v[72:75]
 ds_read_b64_tr_b16 a[4:5], v7 offset:24576
 v_mfma_f32_16x16x32_bf16 v[76:79], a[8:11], a[20:23], v[76:79]
 ds_read_b64_tr_b16 a[6:7], v7 offset:25088
 v_mfma_f32_16x16x32_bf16 v[80:83], a[8:11], a[24:27], v[80:83]
 s_add_u32 m0, s40, 4096
 v_mfma_f32_16x16x32_bf16 v[84:87], a[8:11], a[28:31], v[84:87]
 buffer_load_dwordx4 v2, s[16:19], s34 offen nt lds
 s_add_u32 s34, s34, s37
 s_waitcnt lgkmcnt(4)
 v_mfma_f32_16x16x32_bf16 v[100:103], a[12:15], a[28:31], v[100:103]
 ds_read_b64_tr_b16 a[8:9], v8 offset:24576
 v_mfma_f32_16x16x32_bf16 v[96:99], a[12:15], a[24:27], v[96:99]
 ds_read_b64_tr_b16 a[10:11], v8 offset:25088
 v_mfma_f32_16x16x32_bf16 v[92:95], a[12:15], a[20:23], v[92:95]
 ds_read_b128 a[32:35], v4 offset:52224
 s_add_u32 m0, s40, 6144
 v_mfma_f32_16x16x32_bf16 v[88:91], a[12:15], a[16:19], v[88:91]
 buffer_load_dwordx4 v2, s[16:19], s35 offen nt lds
 s_add_u32 s35, s35, s37
 s_waitcnt lgkmcnt(5)
 v_mfma_f32_16x16x32_bf16 v[104:107], a[0:3], a[16:19], v[104:107]
 ds_read_b64_tr_b16 a[12:13], v9 offset:24576
 v_mfma_f32_16x16x32_bf16 v[108:111], a[0:3], a[20:23], v[108:111]
 ds_read_b64_tr_b16 a[14:15], v9 offset:25088
 v_mfma_f32_16x16x32_bf16 v[112:115], a[0:3], a[24:27], v[112:115]
 ds_read_b128 a[36:39], v4 offset:53248
 s_mov_b32 m0, s42
 v_mfma_f32_16x16x32_bf16 v[116:119], a[0:3], a[28:31], v[116:119]
 buffer_load_dwordx4 v3, s[20:23], s36 offen sc1 nt lds
 s_add_u32 s36, s36, s38
 s_waitcnt lgkmcnt(6)
 v_mfma_f32_16x16x32_bf16 v[132:135], a[4:7], a[28:31], v[132:135]
 ds_read_b64_tr_b16 a[0:1], v10 offset:8192
 v_mfma_f32_16x16x32_bf16 v[128:131], a[4:7], a[24:27], v[128:131]
 ds_read_b64_tr_b16 a[2:3], v10 offset:8448
 v_mfma_f32_16x16x32_bf16 v[124:127], a[4:7], a[20:23], v[124:127]
 ds_read_b128 a[40:43], v4 offset:54272
 v_mfma_f32_16x16x32_bf16 v[120:123], a[4:7], a[16:19], v[120:123]
 s_waitcnt lgkmcnt(7)
 v_mfma_f32_16x16x32_bf16 v[136:139], a[8:11], a[16:19], v[136:139]
 ds_read_b64_tr_b16 a[4:5], v10 offset:10240
 v_mfma_f32_16x16x32_bf16 v[140:143], a[8:11], a[20:23], v[140:143]
 ds_read_b64_tr_b16 a[6:7], v10 offset:10496
 v_mfma_f32_16x16x32_bf16 v[144:147], a[8:11], a[24:27], v[144:147]
 ds_read_b128 a[44:47], v4 offset:55296
 v_mfma_f32_16x16x32_bf16 v[148:151], a[8:11], a[28:31], v[148:151]
 s_waitcnt lgkmcnt(7)
 v_mfma_f32_16x16x32_bf16 v[164:167], a[12:15], a[28:31], v[164:167]
 ds_read_b64_tr_b16 a[8:9], v6 offset:12288
 v_mfma_f32_16x16x32_bf16 v[160:163], a[12:15], a[24:27], v[160:163]
 ds_read_b64_tr_b16 a[10:11], v6 offset:12800
 v_mfma_f32_16x16x32_bf16 v[156:159], a[12:15], a[20:23], v[156:159]
 v_mfma_f32_16x16x32_bf16 v[152:155], a[12:15], a[16:19], v[152:155]
 s_waitcnt lgkmcnt(6)
 v_mfma_f32_16x16x32_bf16 v[168:171], a[0:3], a[16:19], v[168:171]
 ds_read_b64_tr_b16 a[12:13], v7 offset:12288
 v_mfma_f32_16x16x32_bf16 v[172:175], a[0:3], a[20:23], v[172:175]
 ds_read_b64_tr_b16 a[14:15], v7 offset:12800
 v_mfma_f32_16x16x32_bf16 v[176:179], a[0:3], a[24:27], v[176:179]
 v_mfma_f32_16x16x32_bf16 v[180:183], a[0:3], a[28:31], v[180:183]
 s_waitcnt lgkmcnt(5)
 v_mfma_f32_16x16x32_bf16 v[196:199], a[4:7], a[28:31], v[196:199]
 ds_read_b64_tr_b16 a[0:1], v8 offset:12288
 v_mfma_f32_16x16x32_bf16 v[192:195], a[4:7], a[24:27], v[192:195]
 ds_read_b64_tr_b16 a[2:3], v8 offset:12800
 v_mfma_f32_16x16x32_bf16 v[188:191], a[4:7], a[20:23], v[188:191]
 v_mfma_f32_16x16x32_bf16 v[184:187], a[4:7], a[16:19], v[184:187]
 s_waitcnt vmcnt(5)
 s_barrier
 s_waitcnt lgkmcnt(4)
 v_mfma_f32_16x16x32_bf16 v[40:43], a[8:11], a[32:35], v[40:43]
 ds_read_b64_tr_b16 a[4:5], v9 offset:12288
 v_mfma_f32_16x16x32_bf16 v[44:47], a[8:11], a[36:39], v[44:47]
 ds_read_b64_tr_b16 a[6:7], v9 offset:12800
 v_mfma_f32_16x16x32_bf16 v[48:51], a[8:11], a[40:43], v[48:51]
 s_add_u32 m0, s39, 34816
 v_mfma_f32_16x16x32_bf16 v[52:55], a[8:11], a[44:47], v[52:55]
 buffer_load_dwordx4 v1, s[12:15], s33 offen sc1 lds
 s_waitcnt lgkmcnt(4)
 v_mfma_f32_16x16x32_bf16 v[68:71], a[12:15], a[44:47], v[68:71]
 ds_read_b64_tr_b16 a[8:9], v6 offset:28672
 v_mfma_f32_16x16x32_bf16 v[64:67], a[12:15], a[40:43], v[64:67]
 ds_read_b64_tr_b16 a[10:11], v6 offset:29184
 v_mfma_f32_16x16x32_bf16 v[60:63], a[12:15], a[36:39], v[60:63]
 v_mfma_f32_16x16x32_bf16 v[56:59], a[12:15], a[32:35], v[56:59]
 buffer_load_dwordx4 v1, s[12:15], s33 offen offset:1024 sc1 lds
 s_add_u32 s33, s33, 2048
 s_waitcnt lgkmcnt(4)
 v_mfma_f32_16x16x32_bf16 v[72:75], a[0:3], a[32:35], v[72:75]
 ds_read_b64_tr_b16 a[12:13], v7 offset:28672
 v_mfma_f32_16x16x32_bf16 v[76:79], a[0:3], a[36:39], v[76:79]
 ds_read_b64_tr_b16 a[14:15], v7 offset:29184
 v_mfma_f32_16x16x32_bf16 v[80:83], a[0:3], a[40:43], v[80:83]
 s_add_u32 m0, s40, 8192
 v_mfma_f32_16x16x32_bf16 v[84:87], a[0:3], a[44:47], v[84:87]
 buffer_load_dwordx4 v2, s[16:19], s34 offen nt lds
 s_add_u32 s34, s34, s37
 s_waitcnt lgkmcnt(4)
 v_mfma_f32_16x16x32_bf16 v[100:103], a[4:7], a[44:47], v[100:103]
 ds_read_b64_tr_b16 a[0:1], v8 offset:28672
 v_mfma_f32_16x16x32_bf16 v[96:99], a[4:7], a[40:43], v[96:99]
 ds_read_b64_tr_b16 a[2:3], v8 offset:29184
 v_mfma_f32_16x16x32_bf16 v[92:95], a[4:7], a[36:39], v[92:95]
 ds_read_b128 a[16:19], v4 offset:0
 s_add_u32 m0, s40, 10240
 v_mfma_f32_16x16x32_bf16 v[88:91], a[4:7], a[32:35], v[88:91]
 buffer_load_dwordx4 v2, s[16:19], s35 offen nt lds
 s_add_u32 s35, s35, s37
 s_waitcnt lgkmcnt(5)
 v_mfma_f32_16x16x32_bf16 v[104:107], a[8:11], a[32:35], v[104:107]
 ds_read_b64_tr_b16 a[4:5], v9 offset:28672
 v_mfma_f32_16x16x32_bf16 v[108:111], a[8:11], a[36:39], v[108:111]
 ds_read_b64_tr_b16 a[6:7], v9 offset:29184
 v_mfma_f32_16x16x32_bf16 v[112:115], a[8:11], a[40:43], v[112:115]
 ds_read_b128 a[20:23], v4 offset:1024
 s_mov_b32 m0, s43
 v_mfma_f32_16x16x32_bf16 v[116:119], a[8:11], a[44:47], v[116:119]
 buffer_load_dwordx4 v3, s[20:23], s36 offen sc1 nt lds
 s_add_u32 s36, s36, s38
 s_waitcnt lgkmcnt(6)
 v_mfma_f32_16x16x32_bf16 v[132:135], a[12:15], a[44:47], v[132:135]
 ds_read_b64_tr_b16 a[8:9], v10 offset:12288
 v_mfma_f32_16x16x32_bf16 v[128:131], a[12:15], a[40:43], v[128:131]
 ds_read_b64_tr_b16 a[10:11], v10 offset:12544
 v_mfma_f32_16x16x32_bf16 v[124:127], a[12:15], a[36:39], v[124:127]
 ds_read_b128 a[24:27], v4 offset:2048
 v_mfma_f32_16x16x32_bf16 v[120:123], a[12:15], a[32:35], v[120:123]
 s_waitcnt lgkmcnt(7)
 v_mfma_f32_16x16x32_bf16 v[136:139], a[0:3], a[32:35], v[136:139]
 ds_read_b64_tr_b16 a[12:13], v10 offset:14336
 v_mfma_f32_16x16x32_bf16 v[140:143], a[0:3], a[36:39], v[140:143]
 ds_read_b64_tr_b16 a[14:15], v10 offset:14592
 v_mfma_f32_16x16x32_bf16 v[144:147], a[0:3], a[40:43], v[144:147]
 ds_read_b128 a[28:31], v4 offset:3072
 v_mfma_f32_16x16x32_bf16 v[148:151], a[0:3], a[44:47], v[148:151]
 s_waitcnt lgkmcnt(7)
 v_mfma_f32_16x16x32_bf16 v[164:167], a[4:7], a[44:47], v[164:167]
 ds_read_b64_tr_b16 a[0:1], v6 offset:0
 v_mfma_f32_16x16x32_bf16 v[160:163], a[4:7], a[40:43], v[160:163]
 ds_read_b64_tr_b16 a[2:3], v6 offset:512
 v_mfma_f32_16x16x32_bf16 v[156:159], a[4:7], a[36:39], v[156:159]
 v_mfma_f32_16x16x32_bf16 v[152:155], a[4:7], a[32:35], v[152:155]
 s_waitcnt lgkmcnt(6)
 v_mfma_f32_16x16x32_bf16 v[168:171], a[8:11], a[32:35], v[168:171]
 ds_read_b64_tr_b16 a[4:5], v7 offset:0
 v_mfma_f32_16x16x32_bf16 v[172:175], a[8:11], a[36:39], v[172:175]
 ds_read_b64_tr_b16 a[6:7], v7 offset:512
 v_mfma_f32_16x16x32_bf16 v[176:179], a[8:11], a[40:43], v[176:179]
 v_mfma_f32_16x16x32_bf16 v[180:183], a[8:11], a[44:47], v[180:183]
 s_waitcnt lgkmcnt(5)
 v_mfma_f32_16x16x32_bf16 v[196:199], a[12:15], a[44:47], v[196:199]
 ds_read_b64_tr_b16 a[8:9], v8 offset:0
 v_mfma_f32_16x16x32_bf16 v[192:195], a[12:15], a[40:43], v[192:195]
 ds_read_b64_tr_b16 a[10:11], v8 offset:512
 v_mfma_f32_16x16x32_bf16 v[188:191], a[12:15], a[36:39], v[188:191]
 v_mfma_f32_16x16x32_bf16 v[184:187], a[12:15], a[32:35], v[184:187]
 s_waitcnt vmcnt(5)
 s_barrier
 s_waitcnt lgkmcnt(4)
 v_mfma_f32_16x16x32_bf16 v[40:43], a[0:3], a[16:19], v[40:43]
 ds_read_b64_tr_b16 a[12:13], v9 offset:0
 v_mfma_f32_16x16x32_bf16 v[44:47], a[0:3], a[20:23], v[44:47]
 ds_read_b64_tr_b16 a[14:15], v9 offset:512
 v_mfma_f32_16x16x32_bf16 v[48:51], a[0:3], a[24:27], v[48:51]
 s_add_u32 m0, s39, 52224
 v_mfma_f32_16x16x32_bf16 v[52:55], a[0:3], a[28:31], v[52:55]
 buffer_load_dwordx4 v1, s[12:15], s33 offen sc1 lds
 s_waitcnt lgkmcnt(4)
 v_mfma_f32_16x16x32_bf16 v[68:71], a[4:7], a[28:31], v[68:71]
 ds_read_b64_tr_b16 a[0:1], v6 offset:16384
 v_mfma_f32_16x16x32_bf16 v[64:67], a[4:7], a[24:27], v[64:67]
 ds_read_b64_tr_b16 a[2:3], v6 offset:16896
 v_mfma_f32_16x16x32_bf16 v[60:63], a[4:7], a[20:23], v[60:63]
 v_mfma_f32_16x16x32_bf16 v[56:59], a[4:7], a[16:19], v[56:59]
 buffer_load_dwordx4 v1, s[12:15], s33 offen offset:1024 sc1 lds
 s_add_u32 s33, s33, 2048
 s_waitcnt lgkmcnt(4)
 v_mfma_f32_16x16x32_bf16 v[72:75], a[8:11], a[16:19], v[72:75]
 ds_read_b64_tr_b16 a[4:5], v7 offset:16384
 v_mfma_f32_16x16x32_bf16 v[76:79], a[8:11], a[20:23], v[76:79]
 ds_read_b64_tr_b16 a[6:7], v7 offset:16896
 v_mfma_f32_16x16x32_bf16 v[80:83], a[8:11], a[24:27], v[80:83]
 s_add_u32 m0, s40, 12288
 v_mfma_f32_16x16x32_bf16 v[84:87], a[8:11], a[28:31], v[84:87]
 buffer_load_dwordx4 v2, s[16:19], s34 offen nt lds
 s_add_u32 s34, s34, s37
 s_waitcnt lgkmcnt(4)
 v_mfma_f32_16x16x32_bf16 v[100:103], a[12:15], a[28:31], v[100:103]
 ds_read_b64_tr_b16 a[8:9], v8 offset:16384
 v_mfma_f32_16x16x32_bf16 v[96:99], a[12:15], a[24:27], v[96:99]
 ds_read_b64_tr_b16 a[10:11], v8 offset:16896
 v_mfma_f32_16x16x32_bf16 v[92:95], a[12:15], a[20:23], v[92:95]
 ds_read_b128 a[32:35], v4 offset:17408
 s_add_u32 m0, s40, 14336
 v_mfma_f32_16x16x32_bf16 v[88:91], a[12:15], a[16:19], v[88:91]
 buffer_load_dwordx4 v2, s[16:19], s35 offen nt lds
 s_add_u32 s35, s35, s37
 s_waitcnt lgkmcnt(5)
 v_mfma_f32_16x16x32_bf16 v[104:107], a[0:3], a[16:19], v[104:107]
 ds_read_b64_tr_b16 a[12:13], v9 offset:16384
 v_mfma_f32_16x16x32_bf16 v[108:111], a[0:3], a[20:23], v[108:111]
 ds_read_b64_tr_b16 a[14:15], v9 offset:16896
 v_mfma_f32_16x16x32_bf16 v[112:115], a[0:3], a[24:27], v[112:115]
 ds_read_b128 a[36:39], v4 offset:18432
 s_mov_b32 m0, s44
 v_mfma_f32_16x16x32_bf16 v[116:119], a[0:3], a[28:31], v[116:119]
 buffer_load_dwordx4 v3, s[20:23], s36 offen sc1 nt lds
 s_add_u32 s36, s36, s38
 s_waitcnt lgkmcnt(6)
 v_mfma_f32_16x16x32_bf16 v[132:135], a[4:7], a[28:31], v[132:135]
 ds_read_b64_tr_b16 a[0:1], v10 offset:0
 v_mfma_f32_16x16x32_bf16 v[128:131], a[4:7], a[24:27], v[128:131]
 ds_read_b64_tr_b16 a[2:3], v10 offset:256
 v_mfma_f32_16x16x32_bf16 v[124:127], a[4:7], a[20:23], v[124:127]
 ds_read_b128 a[40:43], v4 offset:19456
 v_mfma_f32_16x16x32_bf16 v[120:123], a[4:7], a[16:19], v[120:123]
 s_waitcnt lgkmcnt(7)
 v_mfma_f32_16x16x32_bf16 v[136:139], a[8:11], a[16:19], v[136:139]
 ds_read_b64_tr_b16 a[4:5], v10 offset:2048
 v_mfma_f32_16x16x32_bf16 v[140:143], a[8:11], a[20:23], v[140:143]
 ds_read_b64_tr_b16 a[6:7], v10 offset:2304
 v_mfma_f32_16x16x32_bf16 v[144:147], a[8:11], a[24:27], v[144:147]
 ds_read_b128 a[44:47], v4 offset:20480
 v_mfma_f32_16x16x32_bf16 v[148:151], a[8:11], a[28:31], v[148:151]
 s_waitcnt lgkmcnt(7)
 v_mfma_f32_16x16x32_bf16 v[164:167], a[12:15], a[28:31], v[164:167]
 ds_read_b64_tr_b16 a[8:9], v6 offset:4096
 v_mfma_f32_16x16x32_bf16 v[160:163], a[12:15], a[24:27], v[160:163]
 ds_read_b64_tr_b16 a[10:11], v6 offset:4608
 v_mfma_f32_16x16x32_bf16 v[156:159], a[12:15], a[20:23], v[156:159]
 v_mfma_f32_16x16x32_bf16 v[152:155], a[12:15], a[16:19], v[152:155]
 s_waitcnt lgkmcnt(6)
 v_mfma_f32_16x16x32_bf16 v[168:171], a[0:3], a[16:19], v[168:171]
 ds_read_b64_tr_b16 a[12:13], v7 offset:4096
 v_mfma_f32_16x16x32_bf16 v[172:175], a[0:3], a[20:23], v[172:175]
 ds_read_b64_tr_b16 a[14:15], v7 offset:4608
 v_mfma_f32_16x16x32_bf16 v[176:179], a[0:3], a[24:27], v[176:179]
 v_mfma_f32_16x16x32_bf16 v[180:183], a[0:3], a[28:31], v[180:183]
 s_waitcnt lgkmcnt(5)
 v_mfma_f32_16x16x32_bf16 v[196:199], a[4:7], a[28:31], v[196:199]
 ds_read_b64_tr_b16 a[0:1], v8 offset:4096
 v_mfma_f32_16x16x32_bf16 v[192:195], a[4:7], a[24:27], v[192:195]
 ds_read_b64_tr_b16 a[2:3], v8 offset:4608
 v_mfma_f32_16x16x32_bf16 v[188:191], a[4:7], a[20:23], v[188:191]
 v_mfma_f32_16x16x32_bf16 v[184:187], a[4:7], a[16:19], v[184:187]
 s_waitcnt vmcnt(5)
 s_barrier
 s_waitcnt lgkmcnt(4)
 v_mfma_f32_16x16x32_bf16 v[40:43], a[8:11], a[32:35], v[40:43]
 ds_read_b64_tr_b16 a[4:5], v9 offset:4096
 v_mfma_f32_16x16x32_bf16 v[44:47], a[8:11], a[36:39], v[44:47]
 ds_read_b64_tr_b16 a[6:7], v9 offset:4608
 v_mfma_f32_16x16x32_bf16 v[48:51], a[8:11], a[40:43], v[48:51]
 v_mfma_f32_16x16x32_bf16 v[52:55], a[8:11], a[44:47], v[52:55]
 s_waitcnt lgkmcnt(4)
 v_mfma_f32_16x16x32_bf16 v[68:71], a[12:15], a[44:47], v[68:71]
 ds_read_b64_tr_b16 a[8:9], v6 offset:20480
 v_mfma_f32_16x16x32_bf16 v[64:67], a[12:15], a[40:43], v[64:67]
 ds_read_b64_tr_b16 a[10:11], v6 offset:20992
 v_mfma_f32_16x16x32_bf16 v[60:63], a[12:15], a[36:39], v[60:63]
 v_mfma_f32_16x16x32_bf16 v[56:59], a[12:15], a[32:35], v[56:59]
 s_waitcnt lgkmcnt(4)
 v_mfma_f32_16x16x32_bf16 v[72:75], a[0:3], a[32:35], v[72:75]
 ds_read_b64_tr_b16 a[12:13], v7 offset:20480
 v_mfma_f32_16x16x32_bf16 v[76:79], a[0:3], a[36:39], v[76:79]
 ds_read_b64_tr_b16 a[14:15], v7 offset:20992
 v_mfma_f32_16x16x32_bf16 v[80:83], a[0:3], a[40:43], v[80:83]
 v_mfma_f32_16x16x32_bf16 v[84:87], a[0:3], a[44:47], v[84:87]
 s_waitcnt lgkmcnt(4)
 v_mfma_f32_16x16x32_bf16 v[100:103], a[4:7], a[44:47], v[100:103]
 ds_read_b64_tr_b16 a[0:1], v8 offset:20480
 v_mfma_f32_16x16x32_bf16 v[96:99], a[4:7], a[40:43], v[96:99]
 ds_read_b64_tr_b16 a[2:3], v8 offset:20992
 v_mfma_f32_16x16x32_bf16 v[92:95], a[4:7], a[36:39], v[92:95]
 ds_read_b128 a[16:19], v4 offset:34816
 v_mfma_f32_16x16x32_bf16 v[88:91], a[4:7], a[32:35], v[88:91]
 s_waitcnt lgkmcnt(5)
 v_mfma_f32_16x16x32_bf16 v[104:107], a[8:11], a[32:35], v[104:107]
 ds_read_b64_tr_b16 a[4:5], v9 offset:20480
 v_mfma_f32_16x16x32_bf16 v[108:111], a[8:11], a[36:39], v[108:111]
 ds_read_b64_tr_b16 a[6:7], v9 offset:20992
 v_mfma_f32_16x16x32_bf16 v[112:115], a[8:11], a[40:43], v[112:115]
 ds_read_b128 a[20:23], v4 offset:35840
 v_mfma_f32_16x16x32_bf16 v[116:119], a[8:11], a[44:47], v[116:119]
 s_waitcnt lgkmcnt(6)
 v_mfma_f32_16x16x32_bf16 v[132:135], a[12:15], a[44:47], v[132:135]
 ds_read_b64_tr_b16 a[8:9], v10 offset:4096
 v_mfma_f32_16x16x32_bf16 v[128:131], a[12:15], a[40:43], v[128:131]
 ds_read_b64_tr_b16 a[10:11], v10 offset:4352
 v_mfma_f32_16x16x32_bf16 v[124:127], a[12:15], a[36:39], v[124:127]
 ds_read_b128 a[24:27], v4 offset:36864
 v_mfma_f32_16x16x32_bf16 v[120:123], a[12:15], a[32:35], v[120:123]
 s_waitcnt lgkmcnt(7)
 v_mfma_f32_16x16x32_bf16 v[136:139], a[0:3], a[32:35], v[136:139]
 ds_read_b64_tr_b16 a[12:13], v10 offset:6144
 v_mfma_f32_16x16x32_bf16 v[140:143], a[0:3], a[36:39], v[140:143]
 ds_read_b64_tr_b16 a[14:15], v10 offset:6400
 v_mfma_f32_16x16x32_bf16 v[144:147], a[0:3], a[40:43], v[144:147]
 ds_read_b128 a[28:31], v4 offset:37888
 v_mfma_f32_16x16x32_bf16 v[148:151], a[0:3], a[44:47], v[148:151]
 s_waitcnt lgkmcnt(7)
 v_mfma_f32_16x16x32_bf16 v[164:167], a[4:7], a[44:47], v[164:167]
 ds_read_b64_tr_b16 a[0:1], v6 offset:8192
 v_mfma_f32_16x16x32_bf16 v[160:163], a[4:7], a[40:43], v[160:163]
 ds_read_b64_tr_b16 a[2:3], v6 offset:8704
 v_mfma_f32_16x16x32_bf16 v[156:159], a[4:7], a[36:39], v[156:159]
 v_mfma_f32_16x16x32_bf16 v[152:155], a[4:7], a[32:35], v[152:155]
 s_waitcnt lgkmcnt(6)
 v_mfma_f32_16x16x32_bf16 v[168:171], a[8:11], a[32:35], v[168:171]
 ds_read_b64_tr_b16 a[4:5], v7 offset:8192
 v_mfma_f32_16x16x32_bf16 v[172:175], a[8:11], a[36:39], v[172:175]
 ds_read_b64_tr_b16 a[6:7], v7 offset:8704
 v_mfma_f32_16x16x32_bf16 v[176:179], a[8:11], a[40:43], v[176:179]
 v_mfma_f32_16x16x32_bf16 v[180:183], a[8:11], a[44:47], v[180:183]
 s_waitcnt lgkmcnt(5)
 v_mfma_f32_16x16x32_bf16 v[196:199], a[12:15], a[44:47], v[196:199]
 ds_read_b64_tr_b16 a[8:9], v8 offset:8192
 v_mfma_f32_16x16x32_bf16 v[192:195], a[12:15], a[40:43], v[192:195]
 ds_read_b64_tr_b16 a[10:11], v8 offset:8704
 v_mfma_f32_16x16x32_bf16 v[188:191], a[12:15], a[36:39], v[188:191]
 v_mfma_f32_16x16x32_bf16 v[184:187], a[12:15], a[32:35], v[184:187]
 s_waitcnt vmcnt(0)
 s_barrier
 s_load_dwordx2 s[12:13], s[0:1], 16
 s_load_dwordx2 s[16:17], s[0:1], 48
 s_load_dwordx2 s[8:9], s[0:1], 0
 s_load_dwordx2 s[40:41], s[0:1], 56
 s_and_b32 s56, s2, 7
 s_lshr_b32 s34, s56, 2
 s_lshr_b32 s57, s2, 3
 s_bfe_u32 s58, s56, 0x10001
 s_lshl_b32 s58, s58, 3
 s_and_b32 s39, s57, 7
 s_add_u32 s39, s39, s58
 s_and_b32 s58, s56, 1
 s_lshl_b32 s58, s58, 2
 s_lshr_b32 s57, s57, 3
 s_add_u32 s33, s57, s58
 s_lshr_b32 s94, s39, 1
 s_waitcnt lgkmcnt(0)
 s_and_b32 s13, s13, 0xffff
 s_mov_b32 s14, 2097152
 s_mov_b32 s15, 0x20000
 s_and_b32 s17, s17, 0xffff
 s_mov_b32 s18, 7340032
 s_mov_b32 s19, 0x20000
 s_and_b32 s9, s9, 0xffff
 s_mov_b32 s10, 4194304
 s_mov_b32 s11, 0x20000
 s_and_b32 s41, s41, 0xffff
 s_mov_b32 s42, 4194304
 s_mov_b32 s43, 0x20000
 s_add_u32 s20, s6, 25165824
 s_addc_u32 s21, s7, 0
 s_and_b32 s21, s21, 0xffff
 s_mov_b32 s22, 4194304
 s_mov_b32 s23, 0x20000
 s_waitcnt lgkmcnt(4)
 v_mfma_f32_16x16x32_bf16 v[40:43], a[0:3], a[16:19], v[40:43]
 ds_read_b64_tr_b16 a[12:13], v9 offset:8192
 v_mfma_f32_16x16x32_bf16 v[44:47], a[0:3], a[20:23], v[44:47]
 ds_read_b64_tr_b16 a[14:15], v9 offset:8704
 v_mfma_f32_16x16x32_bf16 v[48:51], a[0:3], a[24:27], v[48:51]
 v_mfma_f32_16x16x32_bf16 v[52:55], a[0:3], a[28:31], v[52:55]
 s_waitcnt lgkmcnt(4)
 v_mfma_f32_16x16x32_bf16 v[68:71], a[4:7], a[28:31], v[68:71]
 ds_read_b64_tr_b16 a[0:1], v6 offset:24576
 v_mfma_f32_16x16x32_bf16 v[64:67], a[4:7], a[24:27], v[64:67]
 ds_read_b64_tr_b16 a[2:3], v6 offset:25088
 v_mfma_f32_16x16x32_bf16 v[60:63], a[4:7], a[20:23], v[60:63]
 v_mfma_f32_16x16x32_bf16 v[56:59], a[4:7], a[16:19], v[56:59]
 s_waitcnt lgkmcnt(4)
 v_mfma_f32_16x16x32_bf16 v[72:75], a[8:11], a[16:19], v[72:75]
 ds_read_b64_tr_b16 a[4:5], v7 offset:24576
 v_mfma_f32_16x16x32_bf16 v[76:79], a[8:11], a[20:23], v[76:79]
 ds_read_b64_tr_b16 a[6:7], v7 offset:25088
 v_mfma_f32_16x16x32_bf16 v[80:83], a[8:11], a[24:27], v[80:83]
 v_mfma_f32_16x16x32_bf16 v[84:87], a[8:11], a[28:31], v[84:87]
 s_waitcnt lgkmcnt(4)
 v_mfma_f32_16x16x32_bf16 v[100:103], a[12:15], a[28:31], v[100:103]
 ds_read_b64_tr_b16 a[8:9], v8 offset:24576
 v_mfma_f32_16x16x32_bf16 v[96:99], a[12:15], a[24:27], v[96:99]
 ds_read_b64_tr_b16 a[10:11], v8 offset:25088
 v_mfma_f32_16x16x32_bf16 v[92:95], a[12:15], a[20:23], v[92:95]
 ds_read_b128 a[32:35], v4 offset:52224
 v_mfma_f32_16x16x32_bf16 v[88:91], a[12:15], a[16:19], v[88:91]
 s_waitcnt lgkmcnt(5)
 v_mfma_f32_16x16x32_bf16 v[104:107], a[0:3], a[16:19], v[104:107]
 ds_read_b64_tr_b16 a[12:13], v9 offset:24576
 v_mfma_f32_16x16x32_bf16 v[108:111], a[0:3], a[20:23], v[108:111]
 ds_read_b64_tr_b16 a[14:15], v9 offset:25088
 v_mfma_f32_16x16x32_bf16 v[112:115], a[0:3], a[24:27], v[112:115]
 ds_read_b128 a[36:39], v4 offset:53248
 v_mfma_f32_16x16x32_bf16 v[116:119], a[0:3], a[28:31], v[116:119]
 s_waitcnt lgkmcnt(6)
 v_mfma_f32_16x16x32_bf16 v[132:135], a[4:7], a[28:31], v[132:135]
 ds_read_b64_tr_b16 a[0:1], v10 offset:8192
 v_mfma_f32_16x16x32_bf16 v[128:131], a[4:7], a[24:27], v[128:131]
 ds_read_b64_tr_b16 a[2:3], v10 offset:8448
 v_mfma_f32_16x16x32_bf16 v[124:127], a[4:7], a[20:23], v[124:127]
 ds_read_b128 a[40:43], v4 offset:54272
 v_mfma_f32_16x16x32_bf16 v[120:123], a[4:7], a[16:19], v[120:123]
 s_waitcnt lgkmcnt(7)
 v_mfma_f32_16x16x32_bf16 v[136:139], a[8:11], a[16:19], v[136:139]
 ds_read_b64_tr_b16 a[4:5], v10 offset:10240
 v_mfma_f32_16x16x32_bf16 v[140:143], a[8:11], a[20:23], v[140:143]
 ds_read_b64_tr_b16 a[6:7], v10 offset:10496
 v_mfma_f32_16x16x32_bf16 v[144:147], a[8:11], a[24:27], v[144:147]
 ds_read_b128 a[44:47], v4 offset:55296
 v_mfma_f32_16x16x32_bf16 v[148:151], a[8:11], a[28:31], v[148:151]
 s_waitcnt lgkmcnt(7)
 v_mfma_f32_16x16x32_bf16 v[164:167], a[12:15], a[28:31], v[164:167]
 ds_read_b64_tr_b16 a[8:9], v6 offset:12288
 v_mfma_f32_16x16x32_bf16 v[160:163], a[12:15], a[24:27], v[160:163]
 ds_read_b64_tr_b16 a[10:11], v6 offset:12800
 v_mfma_f32_16x16x32_bf16 v[156:159], a[12:15], a[20:23], v[156:159]
 v_mfma_f32_16x16x32_bf16 v[152:155], a[12:15], a[16:19], v[152:155]
 s_waitcnt lgkmcnt(6)
 v_mfma_f32_16x16x32_bf16 v[168:171], a[0:3], a[16:19], v[168:171]
 ds_read_b64_tr_b16 a[12:13], v7 offset:12288
 v_mfma_f32_16x16x32_bf16 v[172:175], a[0:3], a[20:23], v[172:175]
 ds_read_b64_tr_b16 a[14:15], v7 offset:12800
 v_mfma_f32_16x16x32_bf16 v[176:179], a[0:3], a[24:27], v[176:179]
 v_mfma_f32_16x16x32_bf16 v[180:183], a[0:3], a[28:31], v[180:183]
 s_waitcnt lgkmcnt(5)
 v_mfma_f32_16x16x32_bf16 v[196:199], a[4:7], a[28:31], v[196:199]
 ds_read_b64_tr_b16 a[0:1], v8 offset:12288
 v_mfma_f32_16x16x32_bf16 v[192:195], a[4:7], a[24:27], v[192:195]
 ds_read_b64_tr_b16 a[2:3], v8 offset:12800
 v_mfma_f32_16x16x32_bf16 v[188:191], a[4:7], a[20:23], v[188:191]
 v_mfma_f32_16x16x32_bf16 v[184:187], a[4:7], a[16:19], v[184:187]
 s_barrier
 s_waitcnt lgkmcnt(4)
 v_mfma_f32_16x16x32_bf16 v[40:43], a[8:11], a[32:35], v[40:43]
 ds_read_b64_tr_b16 a[4:5], v9 offset:12288
 v_mfma_f32_16x16x32_bf16 v[44:47], a[8:11], a[36:39], v[44:47]
 ds_read_b64_tr_b16 a[6:7], v9 offset:12800
 v_mfma_f32_16x16x32_bf16 v[48:51], a[8:11], a[40:43], v[48:51]
 v_mfma_f32_16x16x32_bf16 v[52:55], a[8:11], a[44:47], v[52:55]
 s_waitcnt lgkmcnt(4)
 v_mfma_f32_16x16x32_bf16 v[68:71], a[12:15], a[44:47], v[68:71]
 ds_read_b64_tr_b16 a[8:9], v6 offset:28672
 v_mfma_f32_16x16x32_bf16 v[64:67], a[12:15], a[40:43], v[64:67]
 ds_read_b64_tr_b16 a[10:11], v6 offset:29184
 v_mfma_f32_16x16x32_bf16 v[60:63], a[12:15], a[36:39], v[60:63]
 v_mfma_f32_16x16x32_bf16 v[56:59], a[12:15], a[32:35], v[56:59]
 s_waitcnt lgkmcnt(4)
 v_mfma_f32_16x16x32_bf16 v[72:75], a[0:3], a[32:35], v[72:75]
 ds_read_b64_tr_b16 a[12:13], v7 offset:28672
 v_mfma_f32_16x16x32_bf16 v[76:79], a[0:3], a[36:39], v[76:79]
 ds_read_b64_tr_b16 a[14:15], v7 offset:29184
 v_mfma_f32_16x16x32_bf16 v[80:83], a[0:3], a[40:43], v[80:83]
 v_mfma_f32_16x16x32_bf16 v[84:87], a[0:3], a[44:47], v[84:87]
 s_waitcnt lgkmcnt(4)
 v_mfma_f32_16x16x32_bf16 v[100:103], a[4:7], a[44:47], v[100:103]
 ds_read_b64_tr_b16 a[0:1], v8 offset:28672
 v_mfma_f32_16x16x32_bf16 v[96:99], a[4:7], a[40:43], v[96:99]
 ds_read_b64_tr_b16 a[2:3], v8 offset:29184
 v_mfma_f32_16x16x32_bf16 v[92:95], a[4:7], a[36:39], v[92:95]
 v_mfma_f32_16x16x32_bf16 v[88:91], a[4:7], a[32:35], v[88:91]
 s_waitcnt lgkmcnt(4)
 v_mfma_f32_16x16x32_bf16 v[104:107], a[8:11], a[32:35], v[104:107]
 ds_read_b64_tr_b16 a[4:5], v9 offset:28672
 v_mfma_f32_16x16x32_bf16 v[108:111], a[8:11], a[36:39], v[108:111]
 ds_read_b64_tr_b16 a[6:7], v9 offset:29184
 v_mfma_f32_16x16x32_bf16 v[112:115], a[8:11], a[40:43], v[112:115]
 v_mfma_f32_16x16x32_bf16 v[116:119], a[8:11], a[44:47], v[116:119]
 s_waitcnt lgkmcnt(4)
 v_mfma_f32_16x16x32_bf16 v[132:135], a[12:15], a[44:47], v[132:135]
 ds_read_b64_tr_b16 a[8:9], v10 offset:12288
 v_mfma_f32_16x16x32_bf16 v[128:131], a[12:15], a[40:43], v[128:131]
 ds_read_b64_tr_b16 a[10:11], v10 offset:12544
 v_mfma_f32_16x16x32_bf16 v[124:127], a[12:15], a[36:39], v[124:127]
 v_mfma_f32_16x16x32_bf16 v[120:123], a[12:15], a[32:35], v[120:123]
 s_waitcnt lgkmcnt(4)
 v_mfma_f32_16x16x32_bf16 v[136:139], a[0:3], a[32:35], v[136:139]
 ds_read_b64_tr_b16 a[12:13], v10 offset:14336
 v_mfma_f32_16x16x32_bf16 v[140:143], a[0:3], a[36:39], v[140:143]
 ds_read_b64_tr_b16 a[14:15], v10 offset:14592
 v_mfma_f32_16x16x32_bf16 v[144:147], a[0:3], a[40:43], v[144:147]
 v_mfma_f32_16x16x32_bf16 v[148:151], a[0:3], a[44:47], v[148:151]
 s_waitcnt lgkmcnt(4)
 v_mfma_f32_16x16x32_bf16 v[164:167], a[4:7], a[44:47], v[164:167]
 v_mfma_f32_16x16x32_bf16 v[160:163], a[4:7], a[40:43], v[160:163]
 v_mfma_f32_16x16x32_bf16 v[156:159], a[4:7], a[36:39], v[156:159]
 v_mfma_f32_16x16x32_bf16 v[152:155], a[4:7], a[32:35], v[152:155]
 s_waitcnt lgkmcnt(2)
 v_mfma_f32_16x16x32_bf16 v[168:171], a[8:11], a[32:35], v[168:171]
 v_mfma_f32_16x16x32_bf16 v[172:175], a[8:11], a[36:39], v[172:175]
 v_mfma_f32_16x16x32_bf16 v[176:179], a[8:11], a[40:43], v[176:179]
 v_mfma_f32_16x16x32_bf16 v[180:183], a[8:11], a[44:47], v[180:183]
 s_waitcnt lgkmcnt(0)
 v_mfma_f32_16x16x32_bf16 v[196:199], a[12:15], a[44:47], v[196:199]
 v_mfma_f32_16x16x32_bf16 v[192:195], a[12:15], a[40:43], v[192:195]
 v_mfma_f32_16x16x32_bf16 v[188:191], a[12:15], a[36:39], v[188:191]
 v_mfma_f32_16x16x32_bf16 v[184:187], a[12:15], a[32:35], v[184:187]
 s_barrier
 s_branch L_k1_epiY
L_k1_Y_0:
 s_waitcnt vmcnt(4)
 s_barrier
 s_mov_b32 s45, 6
 ds_read_b128 a[16:19], v4 offset:0
 ds_read_b128 a[20:23], v4 offset:1024
 ds_read_b128 a[24:27], v4 offset:2048
 ds_read_b128 a[28:31], v4 offset:3072
 ds_read_b64_tr_b16 a[0:1], v6 offset:0
 ds_read_b64_tr_b16 a[2:3], v6 offset:512
 ds_read_b64_tr_b16 a[4:5], v7 offset:0
 ds_read_b64_tr_b16 a[6:7], v7 offset:512
 ds_read_b64_tr_b16 a[8:9], v8 offset:0
 ds_read_b64_tr_b16 a[10:11], v8 offset:512
 s_waitcnt vmcnt(2)
 s_barrier
 s_waitcnt lgkmcnt(4)
 v_mfma_f32_16x16x32_bf16 v[40:43], a[0:3], a[16:19], v[40:43]
 ds_read_b64_tr_b16 a[12:13], v9 offset:0
 v_mfma_f32_16x16x32_bf16 v[44:47], a[0:3], a[20:23], v[44:47]
 ds_read_b64_tr_b16 a[14:15], v9 offset:512
 v_mfma_f32_16x16x32_bf16 v[48:51], a[0:3], a[24:27], v[48:51]
 s_add_u32 m0, s39, 52224
 v_mfma_f32_16x16x32_bf16 v[52:55], a[0:3], a[28:31], v[52:55]
 buffer_load_dwordx4 v1, s[12:15], s33 offen sc1 lds
 s_waitcnt lgkmcnt(4)
 v_mfma_f32_16x16x32_bf16 v[68:71], a[4:7], a[28:31], v[68:71]
 ds_read_b64_tr_b16 a[0:1], v6 offset:16384
 v_mfma_f32_16x16x32_bf16 v[64:67], a[4:7], a[24:27], v[64:67]
 ds_read_b64_tr_b16 a[2:3], v6 offset:16896
 v_mfma_f32_16x16x32_bf16 v[60:63], a[4:7], a[20:23], v[60:63]
 v_mfma_f32_16x16x32_bf16 v[56:59], a[4:7], a[16:19], v[56:59]
 buffer_load_dwordx4 v1, s[12:15], s33 offen offset:1024 sc1 lds
 s_add_u32 s33, s33, 2048
 s_waitcnt lgkmcnt(4)
 v_mfma_f32_16x16x32_bf16 v[72:75], a[8:11], a[16:19], v[72:75]
 ds_read_b64_tr_b16 a[4:5], v7 offset:16384
 v_mfma_f32_16x16x32_bf16 v[76:79], a[8:11], a[20:23], v[76:79]
 ds_read_b64_tr_b16 a[6:7], v7 offset:16896
 v_mfma_f32_16x16x32_bf16 v[80:83], a[8:11], a[24:27], v[80:83]
 s_add_u32 m0, s40, 12288
 v_mfma_f32_16x16x32_bf16 v[84:87], a[8:11], a[28:31], v[84:87]
 buffer_load_dwordx4 v2, s[16:19], s34 offen nt lds
 s_add_u32 s34, s34, s37
 s_waitcnt lgkmcnt(4)
 v_mfma_f32_16x16x32_bf16 v[100:103], a[12:15], a[28:31], v[100:103]
 ds_read_b64_tr_b16 a[8:9], v8 offset:16384
 v_mfma_f32_16x16x32_bf16 v[96:99], a[12:15], a[24:27], v[96:99]
 ds_read_b64_tr_b16 a[10:11], v8 offset:16896
 v_mfma_f32_16x16x32_bf16 v[92:95], a[12:15], a[20:23], v[92:95]
 ds_read_b128 a[32:35], v4 offset:17408
 s_add_u32 m0, s40, 14336
 v_mfma_f32_16x16x32_bf16 v[88:91], a[12:15], a[16:19], v[88:91]
 buffer_load_dwordx4 v2, s[16:19], s35 offen nt lds
 s_add_u32 s35, s35, s37
 s_waitcnt lgkmcnt(5)
 v_mfma_f32_16x16x32_bf16 v[104:107], a[0:3], a[16:19], v[104:107]
 ds_read_b64_tr_b16 a[12:13], v9 offset:16384
 v_mfma_f32_16x16x32_bf16 v[108:111], a[0:3], a[20:23], v[108:111]
 ds_read_b64_tr_b16 a[14:15], v9 offset:16896
 v_mfma_f32_16x16x32_bf16 v[112:115], a[0:3], a[24:27], v[112:115]
 ds_read_b128 a[36:39], v4 offset:18432
 v_mfma_f32_16x16x32_bf16 v[116:119], a[0:3], a[28:31], v[116:119]
 s_waitcnt lgkmcnt(6)
 v_mfma_f32_16x16x32_bf16 v[132:135], a[4:7], a[28:31], v[132:135]
 ds_read_b64_tr_b16 a[0:1], v10 offset:0
 v_mfma_f32_16x16x32_bf16 v[128:131], a[4:7], a[24:27], v[128:131]
 ds_read_b64_tr_b16 a[2:3], v10 offset:256
 v_mfma_f32_16x16x32_bf16 v[124:127], a[4:7], a[20:23], v[124:127]
 ds_read_b128 a[40:43], v4 offset:19456
 v_mfma_f32_16x16x32_bf16 v[120:123], a[4:7], a[16:19], v[120:123]
 s_waitcnt lgkmcnt(7)
 v_mfma_f32_16x16x32_bf16 v[136:139], a[8:11], a[16:19], v[136:139]
 ds_read_b64_tr_b16 a[4:5], v10 offset:2048
 v_mfma_f32_16x16x32_bf16 v[140:143], a[8:11], a[20:23], v[140:143]
 ds_read_b64_tr_b16 a[6:7], v10 offset:2304
 v_mfma_f32_16x16x32_bf16 v[144:147], a[8:11], a[24:27], v[144:147]
 ds_read_b128 a[44:47], v4 offset:20480
 v_mfma_f32_16x16x32_bf16 v[148:151], a[8:11], a[28:31], v[148:151]
 s_waitcnt lgkmcnt(7)
 v_mfma_f32_16x16x32_bf16 v[164:167], a[12:15], a[28:31], v[164:167]
 ds_read_b64_tr_b16 a[8:9], v6 offset:4096
 v_mfma_f32_16x16x32_bf16 v[160:163], a[12:15], a[24:27], v[160:163]
 ds_read_b64_tr_b16 a[10:11], v6 offset:4608
 v_mfma_f32_16x16x32_bf16 v[156:159], a[12:15], a[20:23], v[156:159]
 v_mfma_f32_16x16x32_bf16 v[152:155], a[12:15], a[16:19], v[152:155]
 s_waitcnt lgkmcnt(6)
 v_mfma_f32_16x16x32_bf16 v[168:171], a[0:3], a[16:19], v[168:171]
 ds_read_b64_tr_b16 a[12:13], v7 offset:4096
 v_mfma_f32_16x16x32_bf16 v[172:175], a[0:3], a[20:23], v[172:175]
 ds_read_b64_tr_b16 a[14:15], v7 offset:4608
 v_mfma_f32_16x16x32_bf16 v[176:179], a[0:3], a[24:27], v[176:179]
 v_mfma_f32_16x16x32_bf16 v[180:183], a[0:3], a[28:31], v[180:183]
 s_waitcnt lgkmcnt(5)
 v_mfma_f32_16x16x32_bf16 v[196:199], a[4:7], a[28:31], v[196:199]
 ds_read_b64_tr_b16 a[0:1], v8 offset:4096
 v_mfma_f32_16x16x32_bf16 v[192:195], a[4:7], a[24:27], v[192:195]
 ds_read_b64_tr_b16 a[2:3], v8 offset:4608
 v_mfma_f32_16x16x32_bf16 v[188:191], a[4:7], a[20:23], v[188:191]
 v_mfma_f32_16x16x32_bf16 v[184:187], a[4:7], a[16:19], v[184:187]
 s_waitcnt vmcnt(4)
 s_barrier
 s_waitcnt lgkmcnt(4)
 v_mfma_f32_16x16x32_bf16 v[40:43], a[8:11], a[32:35], v[40:43]
 ds_read_b64_tr_b16 a[4:5], v9 offset:4096
 v_mfma_f32_16x16x32_bf16 v[44:47], a[8:11], a[36:39], v[44:47]
 ds_read_b64_tr_b16 a[6:7], v9 offset:4608
 v_mfma_f32_16x16x32_bf16 v[48:51], a[8:11], a[40:43], v[48:51]
 s_add_u32 m0, s39, 0
 v_mfma_f32_16x16x32_bf16 v[52:55], a[8:11], a[44:47], v[52:55]
 buffer_load_dwordx4 v1, s[12:15], s33 offen sc1 lds
 s_waitcnt lgkmcnt(4)
 v_mfma_f32_16x16x32_bf16 v[68:71], a[12:15], a[44:47], v[68:71]
 ds_read_b64_tr_b16 a[8:9], v6 offset:20480
 v_mfma_f32_16x16x32_bf16 v[64:67], a[12:15], a[40:43], v[64:67]
 ds_read_b64_tr_b16 a[10:11], v6 offset:20992
 v_mfma_f32_16x16x32_bf16 v[60:63], a[12:15], a[36:39], v[60:63]
 v_mfma_f32_16x16x32_bf16 v[56:59], a[12:15], a[32:35], v[56:59]
 buffer_load_dwordx4 v1, s[12:15], s33 offen offset:1024 sc1 lds
 s_add_u32 s33, s33, 2048
 s_waitcnt lgkmcnt(4)
 v_mfma_f32_16x16x32_bf16 v[72:75], a[0:3], a[32:35], v[72:75]
 ds_read_b64_tr_b16 a[12:13], v7 offset:20480
 v_mfma_f32_16x16x32_bf16 v[76:79], a[0:3], a[36:39], v[76:79]
 ds_read_b64_tr_b16 a[14:15], v7 offset:20992
 v_mfma_f32_16x16x32_bf16 v[80:83], a[0:3], a[40:43], v[80:83]
 s_add_u32 m0, s40, 0
 v_mfma_f32_16x16x32_bf16 v[84:87], a[0:3], a[44:47], v[84:87]
 buffer_load_dwordx4 v2, s[16:19], s34 offen nt lds
 s_add_u32 s34, s34, s37
 s_waitcnt lgkmcnt(4)
 v_mfma_f32_16x16x32_bf16 v[100:103], a[4:7], a[44:47], v[100:103]
 ds_read_b64_tr_b16 a[0:1], v8 offset:20480
 v_mfma_f32_16x16x32_bf16 v[96:99], a[4:7], a[40:43], v[96:99]
 ds_read_b64_tr_b16 a[2:3], v8 offset:20992
 v_mfma_f32_16x16x32_bf16 v[92:95], a[4:7], a[36:39], v[92:95]
 ds_read_b128 a[16:19], v4 offset:34816
 s_add_u32 m0, s40, 2048
 v_mfma_f32_16x16x32_bf16 v[88:91], a[4:7], a[32:35], v[88:91]
 buffer_load_dwordx4 v2, s[16:19], s35 offen nt lds
 s_add_u32 s35, s35, s37
 s_waitcnt lgkmcnt(5)
 v_mfma_f32_16x16x32_bf16 v[104:107], a[8:11], a[32:35], v[104:107]
 ds_read_b64_tr_b16 a[4:5], v9 offset:20480
 v_mfma_f32_16x16x32_bf16 v[108:111], a[8:11], a[36:39], v[108:111]
 ds_read_b64_tr_b16 a[6:7], v9 offset:20992
 v_mfma_f32_16x16x32_bf16 v[112:115], a[8:11], a[40:43], v[112:115]
 ds_read_b128 a[20:23], v4 offset:35840
 v_mfma_f32_16x16x32_bf16 v[116:119], a[8:11], a[44:47], v[116:119]
 s_waitcnt lgkmcnt(6)
 v_mfma_f32_16x16x32_bf16 v[132:135], a[12:15], a[44:47], v[132:135]
 ds_read_b64_tr_b16 a[8:9], v10 offset:4096
 v_mfma_f32_16x16x32_bf16 v[128:131], a[12:15], a[40:43], v[128:131]
 ds_read_b64_tr_b16 a[10:11], v10 offset:4352
 v_mfma_f32_16x16x32_bf16 v[124:127], a[12:15], a[36:39], v[124:127]
 ds_read_b128 a[24:27], v4 offset:36864
 v_mfma_f32_16x16x32_bf16 v[120:123], a[12:15], a[32:35], v[120:123]
 s_cmp_eq_u32 s45, s88
 s_cselect_b64 vcc, -1, 0
 v_cndmask_b32 v15, v14, v12, vcc
 buffer_load_dword v31, v15, s[84:87], 0 offen
 s_waitcnt lgkmcnt(7)
 v_mfma_f32_16x16x32_bf16 v[136:139], a[0:3], a[32:35], v[136:139]
 ds_read_b64_tr_b16 a[12:13], v10 offset:6144
 v_mfma_f32_16x16x32_bf16 v[140:143], a[0:3], a[36:39], v[140:143]
 ds_read_b64_tr_b16 a[14:15], v10 offset:6400
 v_mfma_f32_16x16x32_bf16 v[144:147], a[0:3], a[40:43], v[144:147]
 ds_read_b128 a[28:31], v4 offset:37888
 v_mfma_f32_16x16x32_bf16 v[148:151], a[0:3], a[44:47], v[148:151]
 s_waitcnt lgkmcnt(7)
 v_mfma_f32_16x16x32_bf16 v[164:167], a[4:7], a[44:47], v[164:167]
 ds_read_b64_tr_b16 a[0:1], v6 offset:8192
 v_mfma_f32_16x16x32_bf16 v[160:163], a[4:7], a[40:43], v[160:163]
 ds_read_b64_tr_b16 a[2:3], v6 offset:8704
 v_mfma_f32_16x16x32_bf16 v[156:159], a[4:7], a[36:39], v[156:159]
 v_mfma_f32_16x16x32_bf16 v[152:155], a[4:7], a[32:35], v[152:155]
 s_waitcnt lgkmcnt(6)
 v_mfma_f32_16x16x32_bf16 v[168:171], a[8:11], a[32:35], v[168:171]
 ds_read_b64_tr_b16 a[4:5], v7 offset:8192
 v_mfma_f32_16x16x32_bf16 v[172:175], a[8:11], a[36:39], v[172:175]
 ds_read_b64_tr_b16 a[6:7], v7 offset:8704
 v_mfma_f32_16x16x32_bf16 v[176:179], a[8:11], a[40:43], v[176:179]
 v_mfma_f32_16x16x32_bf16 v[180:183], a[8:11], a[44:47], v[180:183]
 s_waitcnt lgkmcnt(5)
 v_mfma_f32_16x16x32_bf16 v[196:199], a[12:15], a[44:47], v[196:199]
 ds_read_b64_tr_b16 a[8:9], v8 offset:8192
 v_mfma_f32_16x16x32_bf16 v[192:195], a[12:15], a[40:43], v[192:195]
 ds_read_b64_tr_b16 a[10:11], v8 offset:8704
 v_mfma_f32_16x16x32_bf16 v[188:191], a[12:15], a[36:39], v[188:191]
 v_mfma_f32_16x16x32_bf16 v[184:187], a[12:15], a[32:35], v[184:187]
 s_waitcnt vmcnt(5)
 s_barrier
 s_waitcnt lgkmcnt(4)
 v_mfma_f32_16x16x32_bf16 v[40:43], a[0:3], a[16:19], v[40:43]
 ds_read_b64_tr_b16 a[12:13], v9 offset:8192
 v_mfma_f32_16x16x32_bf16 v[44:47], a[0:3], a[20:23], v[44:47]
 ds_read_b64_tr_b16 a[14:15], v9 offset:8704
 v_mfma_f32_16x16x32_bf16 v[48:51], a[0:3], a[24:27], v[48:51]
 s_add_u32 m0, s39, 17408
 v_mfma_f32_16x16x32_bf16 v[52:55], a[0:3], a[28:31], v[52:55]
 buffer_load_dwordx4 v1, s[12:15], s33 offen sc1 lds
 s_waitcnt lgkmcnt(4)
 v_mfma_f32_16x16x32_bf16 v[68:71], a[4:7], a[28:31], v[68:71]
 ds_read_b64_tr_b16 a[0:1], v6 offset:24576
 v_mfma_f32_16x16x32_bf16 v[64:67], a[4:7], a[24:27], v[64:67]
 ds_read_b64_tr_b16 a[2:3], v6 offset:25088
 v_mfma_f32_16x16x32_bf16 v[60:63], a[4:7], a[20:23], v[60:63]
 v_mfma_f32_16x16x32_bf16 v[56:59], a[4:7], a[16:19], v[56:59]
 buffer_load_dwordx4 v1, s[12:15], s33 offen offset:1024 sc1 lds
 s_add_u32 s33, s33, 2048
 s_waitcnt lgkmcnt(4)
 v_mfma_f32_16x16x32_bf16 v[72:75], a[8:11], a[16:19], v[72:75]
 ds_read_b64_tr_b16 a[4:5], v7 offset:24576
 v_mfma_f32_16x16x32_bf16 v[76:79], a[8:11], a[20:23], v[76:79]
 ds_read_b64_tr_b16 a[6:7], v7 offset:25088
 v_mfma_f32_16x16x32_bf16 v[80:83], a[8:11], a[24:27], v[80:83]
 s_add_u32 m0, s40, 4096
 v_mfma_f32_16x16x32_bf16 v[84:87], a[8:11], a[28:31], v[84:87]
 buffer_load_dwordx4 v2, s[16:19], s34 offen nt lds
 s_add_u32 s34, s34, s37
 s_waitcnt lgkmcnt(4)
 v_mfma_f32_16x16x32_bf16 v[100:103], a[12:15], a[28:31], v[100:103]
 ds_read_b64_tr_b16 a[8:9], v8 offset:24576
 v_mfma_f32_16x16x32_bf16 v[96:99], a[12:15], a[24:27], v[96:99]
 ds_read_b64_tr_b16 a[10:11], v8 offset:25088
 v_mfma_f32_16x16x32_bf16 v[92:95], a[12:15], a[20:23], v[92:95]
 ds_read_b128 a[32:35], v4 offset:52224
 s_add_u32 m0, s40, 6144
 v_mfma_f32_16x16x32_bf16 v[88:91], a[12:15], a[16:19], v[88:91]
 buffer_load_dwordx4 v2, s[16:19], s35 offen nt lds
 s_add_u32 s35, s35, s37
 s_waitcnt lgkmcnt(5)
 v_mfma_f32_16x16x32_bf16 v[104:107], a[0:3], a[16:19], v[104:107]
 ds_read_b64_tr_b16 a[12:13], v9 offset:24576
 v_mfma_f32_16x16x32_bf16 v[108:111], a[0:3], a[20:23], v[108:111]
 ds_read_b64_tr_b16 a[14:15], v9 offset:25088
 v_mfma_f32_16x16x32_bf16 v[112:115], a[0:3], a[24:27], v[112:115]
 ds_read_b128 a[36:39], v4 offset:53248
 v_mfma_f32_16x16x32_bf16 v[116:119], a[0:3], a[28:31], v[116:119]
 s_waitcnt lgkmcnt(6)
 v_mfma_f32_16x16x32_bf16 v[132:135], a[4:7], a[28:31], v[132:135]
 ds_read_b64_tr_b16 a[0:1], v10 offset:8192
 v_mfma_f32_16x16x32_bf16 v[128:131], a[4:7], a[24:27], v[128:131]
 ds_read_b64_tr_b16 a[2:3], v10 offset:8448
 v_mfma_f32_16x16x32_bf16 v[124:127], a[4:7], a[20:23], v[124:127]
 ds_read_b128 a[40:43], v4 offset:54272
 v_mfma_f32_16x16x32_bf16 v[120:123], a[4:7], a[16:19], v[120:123]
 s_waitcnt lgkmcnt(7)
 v_mfma_f32_16x16x32_bf16 v[136:139], a[8:11], a[16:19], v[136:139]
 ds_read_b64_tr_b16 a[4:5], v10 offset:10240
 v_mfma_f32_16x16x32_bf16 v[140:143], a[8:11], a[20:23], v[140:143]
 ds_read_b64_tr_b16 a[6:7], v10 offset:10496
 v_mfma_f32_16x16x32_bf16 v[144:147], a[8:11], a[24:27], v[144:147]
 ds_read_b128 a[44:47], v4 offset:55296
 v_mfma_f32_16x16x32_bf16 v[148:151], a[8:11], a[28:31], v[148:151]
 s_waitcnt lgkmcnt(7)
 v_mfma_f32_16x16x32_bf16 v[164:167], a[12:15], a[28:31], v[164:167]
 ds_read_b64_tr_b16 a[8:9], v6 offset:12288
 v_mfma_f32_16x16x32_bf16 v[160:163], a[12:15], a[24:27], v[160:163]
 ds_read_b64_tr_b16 a[10:11], v6 offset:12800
 v_mfma_f32_16x16x32_bf16 v[156:159], a[12:15], a[20:23], v[156:159]
 v_mfma_f32_16x16x32_bf16 v[152:155], a[12:15], a[16:19], v[152:155]
 s_waitcnt lgkmcnt(6)
 v_mfma_f32_16x16x32_bf16 v[168:171], a[0:3], a[16:19], v[168:171]
 ds_read_b64_tr_b16 a[12:13], v7 offset:12288
 v_mfma_f32_16x16x32_bf16 v[172:175], a[0:3], a[20:23], v[172:175]
 ds_read_b64_tr_b16 a[14:15], v7 offset:12800
 v_mfma_f32_16x16x32_bf16 v[176:179], a[0:3], a[24:27], v[176:179]
 v_mfma_f32_16x16x32_bf16 v[180:183], a[0:3], a[28:31], v[180:183]
 s_waitcnt lgkmcnt(5)
 v_mfma_f32_16x16x32_bf16 v[196:199], a[4:7], a[28:31], v[196:199]
 ds_read_b64_tr_b16 a[0:1], v8 offset:12288
 v_mfma_f32_16x16x32_bf16 v[192:195], a[4:7], a[24:27], v[192:195]
 ds_read_b64_tr_b16 a[2:3], v8 offset:12800
 v_mfma_f32_16x16x32_bf16 v[188:191], a[4:7], a[20:23], v[188:191]
 v_mfma_f32_16x16x32_bf16 v[184:187], a[4:7], a[16:19], v[184:187]
 s_waitcnt vmcnt(5)
 s_barrier
 s_waitcnt lgkmcnt(4)
 v_mfma_f32_16x16x32_bf16 v[40:43], a[8:11], a[32:35], v[40:43]
 ds_read_b64_tr_b16 a[4:5], v9 offset:12288
 v_mfma_f32_16x16x32_bf16 v[44:47], a[8:11], a[36:39], v[44:47]
 ds_read_b64_tr_b16 a[6:7], v9 offset:12800
 v_mfma_f32_16x16x32_bf16 v[48:51], a[8:11], a[40:43], v[48:51]
 s_add_u32 m0, s39, 34816
 v_mfma_f32_16x16x32_bf16 v[52:55], a[8:11], a[44:47], v[52:55]
 buffer_load_dwordx4 v1, s[12:15], s33 offen sc1 lds
 s_waitcnt lgkmcnt(4)
 v_mfma_f32_16x16x32_bf16 v[68:71], a[12:15], a[44:47], v[68:71]
 ds_read_b64_tr_b16 a[8:9], v6 offset:28672
 v_mfma_f32_16x16x32_bf16 v[64:67], a[12:15], a[40:43], v[64:67]
 ds_read_b64_tr_b16 a[10:11], v6 offset:29184
 v_mfma_f32_16x16x32_bf16 v[60:63], a[12:15], a[36:39], v[60:63]
 v_mfma_f32_16x16x32_bf16 v[56:59], a[12:15], a[32:35], v[56:59]
 buffer_load_dwordx4 v1, s[12:15], s33 offen offset:1024 sc1 lds
 s_add_u32 s33, s33, 2048
 s_waitcnt lgkmcnt(4)
 v_mfma_f32_16x16x32_bf16 v[72:75], a[0:3], a[32:35], v[72:75]
 ds_read_b64_tr_b16 a[12:13], v7 offset:28672
 v_mfma_f32_16x16x32_bf16 v[76:79], a[0:3], a[36:39], v[76:79]
 ds_read_b64_tr_b16 a[14:15], v7 offset:29184
 v_mfma_f32_16x16x32_bf16 v[80:83], a[0:3], a[40:43], v[80:83]
 s_add_u32 m0, s40, 8192
 v_mfma_f32_16x16x32_bf16 v[84:87], a[0:3], a[44:47], v[84:87]
 buffer_load_dwordx4 v2, s[16:19], s34 offen nt lds
 s_add_u32 s34, s34, s37
 s_waitcnt lgkmcnt(4)
 v_mfma_f32_16x16x32_bf16 v[100:103], a[4:7], a[44:47], v[100:103]
 ds_read_b64_tr_b16 a[0:1], v8 offset:28672
 v_mfma_f32_16x16x32_bf16 v[96:99], a[4:7], a[40:43], v[96:99]
 ds_read_b64_tr_b16 a[2:3], v8 offset:29184
 v_mfma_f32_16x16x32_bf16 v[92:95], a[4:7], a[36:39], v[92:95]
 ds_read_b128 a[16:19], v4 offset:0
 s_add_u32 m0, s40, 10240
 v_mfma_f32_16x16x32_bf16 v[88:91], a[4:7], a[32:35], v[88:91]
 buffer_load_dwordx4 v2, s[16:19], s35 offen nt lds
 s_add_u32 s35, s35, s37
 s_waitcnt lgkmcnt(5)
 v_mfma_f32_16x16x32_bf16 v[104:107], a[8:11], a[32:35], v[104:107]
 ds_read_b64_tr_b16 a[4:5], v9 offset:28672
 v_mfma_f32_16x16x32_bf16 v[108:111], a[8:11], a[36:39], v[108:111]
 ds_read_b64_tr_b16 a[6:7], v9 offset:29184
 v_mfma_f32_16x16x32_bf16 v[112:115], a[8:11], a[40:43], v[112:115]
 ds_read_b128 a[20:23], v4 offset:1024
 v_mfma_f32_16x16x32_bf16 v[116:119], a[8:11], a[44:47], v[116:119]
 s_waitcnt lgkmcnt(6)
 v_mfma_f32_16x16x32_bf16 v[132:135], a[12:15], a[44:47], v[132:135]
 ds_read_b64_tr_b16 a[8:9], v10 offset:12288
 v_mfma_f32_16x16x32_bf16 v[128:131], a[12:15], a[40:43], v[128:131]
 ds_read_b64_tr_b16 a[10:11], v10 offset:12544
 v_mfma_f32_16x16x32_bf16 v[124:127], a[12:15], a[36:39], v[124:127]
 ds_read_b128 a[24:27], v4 offset:2048
 v_mfma_f32_16x16x32_bf16 v[120:123], a[12:15], a[32:35], v[120:123]
 s_cmp_eq_u32 s45, s89
 s_cselect_b64 vcc, -1, 0
 v_cndmask_b32 v15, v14, v13, vcc
 buffer_load_dword v31, v15, s[80:83], 0 offen
 s_waitcnt lgkmcnt(7)
 v_mfma_f32_16x16x32_bf16 v[136:139], a[0:3], a[32:35], v[136:139]
 ds_read_b64_tr_b16 a[12:13], v10 offset:14336
 v_mfma_f32_16x16x32_bf16 v[140:143], a[0:3], a[36:39], v[140:143]
 ds_read_b64_tr_b16 a[14:15], v10 offset:14592
 v_mfma_f32_16x16x32_bf16 v[144:147], a[0:3], a[40:43], v[144:147]
 ds_read_b128 a[28:31], v4 offset:3072
 v_mfma_f32_16x16x32_bf16 v[148:151], a[0:3], a[44:47], v[148:151]
 s_waitcnt lgkmcnt(7)
 v_mfma_f32_16x16x32_bf16 v[164:167], a[4:7], a[44:47], v[164:167]
 ds_read_b64_tr_b16 a[0:1], v6 offset:0
 v_mfma_f32_16x16x32_bf16 v[160:163], a[4:7], a[40:43], v[160:163]
 ds_read_b64_tr_b16 a[2:3], v6 offset:512
 v_mfma_f32_16x16x32_bf16 v[156:159], a[4:7], a[36:39], v[156:159]
 v_mfma_f32_16x16x32_bf16 v[152:155], a[4:7], a[32:35], v[152:155]
 s_waitcnt lgkmcnt(6)
 v_mfma_f32_16x16x32_bf16 v[168:171], a[8:11], a[32:35], v[168:171]
 ds_read_b64_tr_b16 a[4:5], v7 offset:0
 v_mfma_f32_16x16x32_bf16 v[172:175], a[8:11], a[36:39], v[172:175]
 ds_read_b64_tr_b16 a[6:7], v7 offset:512
 v_mfma_f32_16x16x32_bf16 v[176:179], a[8:11], a[40:43], v[176:179]
 v_mfma_f32_16x16x32_bf16 v[180:183], a[8:11], a[44:47], v[180:183]
 s_waitcnt lgkmcnt(5)
 v_mfma_f32_16x16x32_bf16 v[196:199], a[12:15], a[44:47], v[196:199]
 ds_read_b64_tr_b16 a[8:9], v8 offset:0
 v_mfma_f32_16x16x32_bf16 v[192:195], a[12:15], a[40:43], v[192:195]
 ds_read_b64_tr_b16 a[10:11], v8 offset:512
 v_mfma_f32_16x16x32_bf16 v[188:191], a[12:15], a[36:39], v[188:191]
 v_mfma_f32_16x16x32_bf16 v[184:187], a[12:15], a[32:35], v[184:187]
 s_waitcnt vmcnt(5)
 s_barrier
 s_mov_b32 s45, 5
.p2align 3
L_loop_Y_n_0:
 s_waitcnt lgkmcnt(4)
 v_mfma_f32_16x16x32_bf16 v[40:43], a[0:3], a[16:19], v[40:43]
 ds_read_b64_tr_b16 a[12:13], v9 offset:0
 v_mfma_f32_16x16x32_bf16 v[44:47], a[0:3], a[20:23], v[44:47]
 ds_read_b64_tr_b16 a[14:15], v9 offset:512
 v_mfma_f32_16x16x32_bf16 v[48:51], a[0:3], a[24:27], v[48:51]
 s_add_u32 m0, s39, 52224
 v_mfma_f32_16x16x32_bf16 v[52:55], a[0:3], a[28:31], v[52:55]
 buffer_load_dwordx4 v1, s[12:15], s33 offen sc1 lds
 s_waitcnt lgkmcnt(4)
 v_mfma_f32_16x16x32_bf16 v[68:71], a[4:7], a[28:31], v[68:71]
 ds_read_b64_tr_b16 a[0:1], v6 offset:16384
 v_mfma_f32_16x16x32_bf16 v[64:67], a[4:7], a[24:27], v[64:67]
 ds_read_b64_tr_b16 a[2:3], v6 offset:16896
 v_mfma_f32_16x16x32_bf16 v[60:63], a[4:7], a[20:23], v[60:63]
 v_mfma_f32_16x16x32_bf16 v[56:59], a[4:7], a[16:19], v[56:59]
 buffer_load_dwordx4 v1, s[12:15], s33 offen offset:1024 sc1 lds
 s_add_u32 s33, s33, 2048
 s_waitcnt lgkmcnt(4)
 v_mfma_f32_16x16x32_bf16 v[72:75], a[8:11], a[16:19], v[72:75]
 ds_read_b64_tr_b16 a[4:5], v7 offset:16384
 v_mfma_f32_16x16x32_bf16 v[76:79], a[8:11], a[20:23], v[76:79]
 ds_read_b64_tr_b16 a[6:7], v7 offset:16896
 v_mfma_f32_16x16x32_bf16 v[80:83], a[8:11], a[24:27], v[80:83]
 s_add_u32 m0, s40, 12288
 v_mfma_f32_16x16x32_bf16 v[84:87], a[8:11], a[28:31], v[84:87]
 buffer_load_dwordx4 v2, s[16:19], s34 offen nt lds
 s_add_u32 s34, s34, s37
 s_waitcnt lgkmcnt(4)
 v_mfma_f32_16x16x32_bf16 v[100:103], a[12:15], a[28:31], v[100:103]
 ds_read_b64_tr_b16 a[8:9], v8 offset:16384
 v_mfma_f32_16x16x32_bf16 v[96:99], a[12:15], a[24:27], v[96:99]
 ds_read_b64_tr_b16 a[10:11], v8 offset:16896
 v_mfma_f32_16x16x32_bf16 v[92:95], a[12:15], a[20:23], v[92:95]
 ds_read_b128 a[32:35], v4 offset:17408
 s_add_u32 m0, s40, 14336
 v_mfma_f32_16x16x32_bf16 v[88:91], a[12:15], a[16:19], v[88:91]
 buffer_load_dwordx4 v2, s[16:19], s35 offen nt lds
 s_add_u32 s35, s35, s37
 s_waitcnt lgkmcnt(5)
 v_mfma_f32_16x16x32_bf16 v[104:107], a[0:3], a[16:19], v[104:107]
 ds_read_b64_tr_b16 a[12:13], v9 offset:16384
 v_mfma_f32_16x16x32_bf16 v[108:111], a[0:3], a[20:23], v[108:111]
 ds_read_b64_tr_b16 a[14:15], v9 offset:16896
 v_mfma_f32_16x16x32_bf16 v[112:115], a[0:3], a[24:27], v[112:115]
 ds_read_b128 a[36:39], v4 offset:18432
 v_mfma_f32_16x16x32_bf16 v[116:119], a[0:3], a[28:31], v[116:119]
 s_waitcnt lgkmcnt(6)
 v_mfma_f32_16x16x32_bf16 v[132:135], a[4:7], a[28:31], v[132:135]
 ds_read_b64_tr_b16 a[0:1], v10 offset:0
 v_mfma_f32_16x16x32_bf16 v[128:131], a[4:7], a[24:27], v[128:131]
 ds_read_b64_tr_b16 a[2:3], v10 offset:256
 v_mfma_f32_16x16x32_bf16 v[124:127], a[4:7], a[20:23], v[124:127]
 ds_read_b128 a[40:43], v4 offset:19456
 v_mfma_f32_16x16x32_bf16 v[120:123], a[4:7], a[16:19], v[120:123]
 s_waitcnt lgkmcnt(7)
 v_mfma_f32_16x16x32_bf16 v[136:139], a[8:11], a[16:19], v[136:139]
 ds_read_b64_tr_b16 a[4:5], v10 offset:2048
 v_mfma_f32_16x16x32_bf16 v[140:143], a[8:11], a[20:23], v[140:143]
 ds_read_b64_tr_b16 a[6:7], v10 offset:2304
 v_mfma_f32_16x16x32_bf16 v[144:147], a[8:11], a[24:27], v[144:147]
 ds_read_b128 a[44:47], v4 offset:20480
 v_mfma_f32_16x16x32_bf16 v[148:151], a[8:11], a[28:31], v[148:151]
 s_waitcnt lgkmcnt(7)
 v_mfma_f32_16x16x32_bf16 v[164:167], a[12:15], a[28:31], v[164:167]
 ds_read_b64_tr_b16 a[8:9], v6 offset:4096
 v_mfma_f32_16x16x32_bf16 v[160:163], a[12:15], a[24:27], v[160:163]
 ds_read_b64_tr_b16 a[10:11], v6 offset:4608
 v_mfma_f32_16x16x32_bf16 v[156:159], a[12:15], a[20:23], v[156:159]
 v_mfma_f32_16x16x32_bf16 v[152:155], a[12:15], a[16:19], v[152:155]
 s_waitcnt lgkmcnt(6)
 v_mfma_f32_16x16x32_bf16 v[168:171], a[0:3], a[16:19], v[168:171]
 ds_read_b64_tr_b16 a[12:13], v7 offset:4096
 v_mfma_f32_16x16x32_bf16 v[172:175], a[0:3], a[20:23], v[172:175]
 ds_read_b64_tr_b16 a[14:15], v7 offset:4608
 v_mfma_f32_16x16x32_bf16 v[176:179], a[0:3], a[24:27], v[176:179]
 v_mfma_f32_16x16x32_bf16 v[180:183], a[0:3], a[28:31], v[180:183]
 s_waitcnt lgkmcnt(5)
 v_mfma_f32_16x16x32_bf16 v[196:199], a[4:7], a[28:31], v[196:199]
 ds_read_b64_tr_b16 a[0:1], v8 offset:4096
 v_mfma_f32_16x16x32_bf16 v[192:195], a[4:7], a[24:27], v[192:195]
 ds_read_b64_tr_b16 a[2:3], v8 offset:4608
 v_mfma_f32_16x16x32_bf16 v[188:191], a[4:7], a[20:23], v[188:191]
 v_mfma_f32_16x16x32_bf16 v[184:187], a[4:7], a[16:19], v[184:187]
 s_waitcnt vmcnt(5)
 s_barrier
 s_waitcnt lgkmcnt(4)
 v_mfma_f32_16x16x32_bf16 v[40:43], a[8:11], a[32:35], v[40:43]
 ds_read_b64_tr_b16 a[4:5], v9 offset:4096
 v_mfma_f32_16x16x32_bf16 v[44:47], a[8:11], a[36:39], v[44:47]
 ds_read_b64_tr_b16 a[6:7], v9 offset:4608
 v_mfma_f32_16x16x32_bf16 v[48:51], a[8:11], a[40:43], v[48:51]
 s_add_u32 m0, s39, 0
 v_mfma_f32_16x16x32_bf16 v[52:55], a[8:11], a[44:47], v[52:55]
 buffer_load_dwordx4 v1, s[12:15], s33 offen sc1 lds
 s_waitcnt lgkmcnt(4)
 v_mfma_f32_16x16x32_bf16 v[68:71], a[12:15], a[44:47], v[68:71]
 ds_read_b64_tr_b16 a[8:9], v6 offset:20480
 v_mfma_f32_16x16x32_bf16 v[64:67], a[12:15], a[40:43], v[64:67]
 ds_read_b64_tr_b16 a[10:11], v6 offset:20992
 v_mfma_f32_16x16x32_bf16 v[60:63], a[12:15], a[36:39], v[60:63]
 v_mfma_f32_16x16x32_bf16 v[56:59], a[12:15], a[32:35], v[56:59]
 buffer_load_dwordx4 v1, s[12:15], s33 offen offset:1024 sc1 lds
 s_add_u32 s33, s33, 2048
 s_waitcnt lgkmcnt(4)
 v_mfma_f32_16x16x32_bf16 v[72:75], a[0:3], a[32:35], v[72:75]
 ds_read_b64_tr_b16 a[12:13], v7 offset:20480
 v_mfma_f32_16x16x32_bf16 v[76:79], a[0:3], a[36:39], v[76:79]
 ds_read_b64_tr_b16 a[14:15], v7 offset:20992
 v_mfma_f32_16x16x32_bf16 v[80:83], a[0:3], a[40:43], v[80:83]
 s_add_u32 m0, s40, 0
 v_mfma_f32_16x16x32_bf16 v[84:87], a[0:3], a[44:47], v[84:87]
 buffer_load_dwordx4 v2, s[16:19], s34 offen nt lds
 s_add_u32 s34, s34, s37
 s_waitcnt lgkmcnt(4)
 v_mfma_f32_16x16x32_bf16 v[100:103], a[4:7], a[44:47], v[100:103]
 ds_read_b64_tr_b16 a[0:1], v8 offset:20480
 v_mfma_f32_16x16x32_bf16 v[96:99], a[4:7], a[40:43], v[96:99]
 ds_read_b64_tr_b16 a[2:3], v8 offset:20992
 v_mfma_f32_16x16x32_bf16 v[92:95], a[4:7], a[36:39], v[92:95]
 ds_read_b128 a[16:19], v4 offset:34816
 s_add_u32 m0, s40, 2048
 v_mfma_f32_16x16x32_bf16 v[88:91], a[4:7], a[32:35], v[88:91]
 buffer_load_dwordx4 v2, s[16:19], s35 offen nt lds
 s_add_u32 s35, s35, s37
 s_waitcnt lgkmcnt(5)
 v_mfma_f32_16x16x32_bf16 v[104:107], a[8:11], a[32:35], v[104:107]
 ds_read_b64_tr_b16 a[4:5], v9 offset:20480
 v_mfma_f32_16x16x32_bf16 v[108:111], a[8:11], a[36:39], v[108:111]
 ds_read_b64_tr_b16 a[6:7], v9 offset:20992
 v_mfma_f32_16x16x32_bf16 v[112:115], a[8:11], a[40:43], v[112:115]
 ds_read_b128 a[20:23], v4 offset:35840
 v_mfma_f32_16x16x32_bf16 v[116:119], a[8:11], a[44:47], v[116:119]
 s_waitcnt lgkmcnt(6)
 v_mfma_f32_16x16x32_bf16 v[132:135], a[12:15], a[44:47], v[132:135]
 ds_read_b64_tr_b16 a[8:9], v10 offset:4096
 v_mfma_f32_16x16x32_bf16 v[128:131], a[12:15], a[40:43], v[128:131]
 ds_read_b64_tr_b16 a[10:11], v10 offset:4352
 v_mfma_f32_16x16x32_bf16 v[124:127], a[12:15], a[36:39], v[124:127]
 ds_read_b128 a[24:27], v4 offset:36864
 v_mfma_f32_16x16x32_bf16 v[120:123], a[12:15], a[32:35], v[120:123]
 s_cmp_eq_u32 s45, s88
 s_cselect_b64 vcc, -1, 0
 v_cndmask_b32 v15, v14, v12, vcc
 buffer_load_dword v31, v15, s[84:87], 0 offen
 s_waitcnt lgkmcnt(7)
 v_mfma_f32_16x16x32_bf16 v[136:139], a[0:3], a[32:35], v[136:139]
 ds_read_b64_tr_b16 a[12:13], v10 offset:6144
 v_mfma_f32_16x16x32_bf16 v[140:143], a[0:3], a[36:39], v[140:143]
 ds_read_b64_tr_b16 a[14:15], v10 offset:6400
 v_mfma_f32_16x16x32_bf16 v[144:147], a[0:3], a[40:43], v[144:147]
 ds_read_b128 a[28:31], v4 offset:37888
 v_mfma_f32_16x16x32_bf16 v[148:151], a[0:3], a[44:47], v[148:151]
 s_waitcnt lgkmcnt(7)
 v_mfma_f32_16x16x32_bf16 v[164:167], a[4:7], a[44:47], v[164:167]
 ds_read_b64_tr_b16 a[0:1], v6 offset:8192
 v_mfma_f32_16x16x32_bf16 v[160:163], a[4:7], a[40:43], v[160:163]
 ds_read_b64_tr_b16 a[2:3], v6 offset:8704
 v_mfma_f32_16x16x32_bf16 v[156:159], a[4:7], a[36:39], v[156:159]
 v_mfma_f32_16x16x32_bf16 v[152:155], a[4:7], a[32:35], v[152:155]
 s_waitcnt lgkmcnt(6)
 v_mfma_f32_16x16x32_bf16 v[168:171], a[8:11], a[32:35], v[168:171]
 ds_read_b64_tr_b16 a[4:5], v7 offset:8192
 v_mfma_f32_16x16x32_bf16 v[172:175], a[8:11], a[36:39], v[172:175]
 ds_read_b64_tr_b16 a[6:7], v7 offset:8704
 v_mfma_f32_16x16x32_bf16 v[176:179], a[8:11], a[40:43], v[176:179]
 v_mfma_f32_16x16x32_bf16 v[180:183], a[8:11], a[44:47], v[180:183]
 s_waitcnt lgkmcnt(5)
 v_mfma_f32_16x16x32_bf16 v[196:199], a[12:15], a[44:47], v[196:199]
 ds_read_b64_tr_b16 a[8:9], v8 offset:8192
 v_mfma_f32_16x16x32_bf16 v[192:195], a[12:15], a[40:43], v[192:195]
 ds_read_b64_tr_b16 a[10:11], v8 offset:8704
 v_mfma_f32_16x16x32_bf16 v[188:191], a[12:15], a[36:39], v[188:191]
 v_mfma_f32_16x16x32_bf16 v[184:187], a[12:15], a[32:35], v[184:187]
 s_waitcnt vmcnt(5)
 s_barrier
 s_waitcnt lgkmcnt(4)
 v_mfma_f32_16x16x32_bf16 v[40:43], a[0:3], a[16:19], v[40:43]
 ds_read_b64_tr_b16 a[12:13], v9 offset:8192
 v_mfma_f32_16x16x32_bf16 v[44:47], a[0:3], a[20:23], v[44:47]
 ds_read_b64_tr_b16 a[14:15], v9 offset:8704
 v_mfma_f32_16x16x32_bf16 v[48:51], a[0:3], a[24:27], v[48:51]
 s_add_u32 m0, s39, 17408
 v_mfma_f32_16x16x32_bf16 v[52:55], a[0:3], a[28:31], v[52:55]
 buffer_load_dwordx4 v1, s[12:15], s33 offen sc1 lds
 s_waitcnt lgkmcnt(4)
 v_mfma_f32_16x16x32_bf16 v[68:71], a[4:7], a[28:31], v[68:71]
 ds_read_b64_tr_b16 a[0:1], v6 offset:24576
 v_mfma_f32_16x16x32_bf16 v[64:67], a[4:7], a[24:27], v[64:67]
 ds_read_b64_tr_b16 a[2:3], v6 offset:25088
 v_mfma_f32_16x16x32_bf16 v[60:63], a[4:7], a[20:23], v[60:63]
 v_mfma_f32_16x16x32_bf16 v[56:59], a[4:7], a[16:19], v[56:59]
 buffer_load_dwordx4 v1, s[12:15], s33 offen offset:1024 sc1 lds
 s_add_u32 s33, s33, 2048
 s_waitcnt lgkmcnt(4)
 v_mfma_f32_16x16x32_bf16 v[72:75], a[8:11], a[16:19], v[72:75]
 ds_read_b64_tr_b16 a[4:5], v7 offset:24576
 v_mfma_f32_16x16x32_bf16 v[76:79], a[8:11], a[20:23], v[76:79]
 ds_read_b64_tr_b16 a[6:7], v7 offset:25088
 v_mfma_f32_16x16x32_bf16 v[80:83], a[8:11], a[24:27], v[80:83]
 s_add_u32 m0, s40, 4096
 v_mfma_f32_16x16x32_bf16 v[84:87], a[8:11], a[28:31], v[84:87]
 buffer_load_dwordx4 v2, s[16:19], s34 offen nt lds
 s_add_u32 s34, s34, s37
 s_waitcnt lgkmcnt(4)
 v_mfma_f32_16x16x32_bf16 v[100:103], a[12:15], a[28:31], v[100:103]
 ds_read_b64_tr_b16 a[8:9], v8 offset:24576
 v_mfma_f32_16x16x32_bf16 v[96:99], a[12:15], a[24:27], v[96:99]
 ds_read_b64_tr_b16 a[10:11], v8 offset:25088
 v_mfma_f32_16x16x32_bf16 v[92:95], a[12:15], a[20:23], v[92:95]
 ds_read_b128 a[32:35], v4 offset:52224
 s_add_u32 m0, s40, 6144
 v_mfma_f32_16x16x32_bf16 v[88:91], a[12:15], a[16:19], v[88:91]
 buffer_load_dwordx4 v2, s[16:19], s35 offen nt lds
 s_add_u32 s35, s35, s37
 s_waitcnt lgkmcnt(5)
 v_mfma_f32_16x16x32_bf16 v[104:107], a[0:3], a[16:19], v[104:107]
 ds_read_b64_tr_b16 a[12:13], v9 offset:24576
 v_mfma_f32_16x16x32_bf16 v[108:111], a[0:3], a[20:23], v[108:111]
 ds_read_b64_tr_b16 a[14:15], v9 offset:25088
 v_mfma_f32_16x16x32_bf16 v[112:115], a[0:3], a[24:27], v[112:115]
 ds_read_b128 a[36:39], v4 offset:53248
 v_mfma_f32_16x16x32_bf16 v[116:119], a[0:3], a[28:31], v[116:119]
 s_waitcnt lgkmcnt(6)
 v_mfma_f32_16x16x32_bf16 v[132:135], a[4:7], a[28:31], v[132:135]
 ds_read_b64_tr_b16 a[0:1], v10 offset:8192
 v_mfma_f32_16x16x32_bf16 v[128:131], a[4:7], a[24:27], v[128:131]
 ds_read_b64_tr_b16 a[2:3], v10 offset:8448
 v_mfma_f32_16x16x32_bf16 v[124:127], a[4:7], a[20:23], v[124:127]
 ds_read_b128 a[40:43], v4 offset:54272
 v_mfma_f32_16x16x32_bf16 v[120:123], a[4:7], a[16:19], v[120:123]
 s_waitcnt lgkmcnt(7)
 v_mfma_f32_16x16x32_bf16 v[136:139], a[8:11], a[16:19], v[136:139]
 ds_read_b64_tr_b16 a[4:5], v10 offset:10240
 v_mfma_f32_16x16x32_bf16 v[140:143], a[8:11], a[20:23], v[140:143]
 ds_read_b64_tr_b16 a[6:7], v10 offset:10496
 v_mfma_f32_16x16x32_bf16 v[144:147], a[8:11], a[24:27], v[144:147]
 ds_read_b128 a[44:47], v4 offset:55296
 v_mfma_f32_16x16x32_bf16 v[148:151], a[8:11], a[28:31], v[148:151]
 s_waitcnt lgkmcnt(7)
 v_mfma_f32_16x16x32_bf16 v[164:167], a[12:15], a[28:31], v[164:167]
 ds_read_b64_tr_b16 a[8:9], v6 offset:12288
 v_mfma_f32_16x16x32_bf16 v[160:163], a[12:15], a[24:27], v[160:163]
 ds_read_b64_tr_b16 a[10:11], v6 offset:12800
 v_mfma_f32_16x16x32_bf16 v[156:159], a[12:15], a[20:23], v[156:159]
 v_mfma_f32_16x16x32_bf16 v[152:155], a[12:15], a[16:19], v[152:155]
 s_waitcnt lgkmcnt(6)
 v_mfma_f32_16x16x32_bf16 v[168:171], a[0:3], a[16:19], v[168:171]
 ds_read_b64_tr_b16 a[12:13], v7 offset:12288
 v_mfma_f32_16x16x32_bf16 v[172:175], a[0:3], a[20:23], v[172:175]
 ds_read_b64_tr_b16 a[14:15], v7 offset:12800
 v_mfma_f32_16x16x32_bf16 v[176:179], a[0:3], a[24:27], v[176:179]
 v_mfma_f32_16x16x32_bf16 v[180:183], a[0:3], a[28:31], v[180:183]
 s_waitcnt lgkmcnt(5)
 v_mfma_f32_16x16x32_bf16 v[196:199], a[4:7], a[28:31], v[196:199]
 ds_read_b64_tr_b16 a[0:1], v8 offset:12288
 v_mfma_f32_16x16x32_bf16 v[192:195], a[4:7], a[24:27], v[192:195]
 ds_read_b64_tr_b16 a[2:3], v8 offset:12800
 v_mfma_f32_16x16x32_bf16 v[188:191], a[4:7], a[20:23], v[188:191]
 v_mfma_f32_16x16x32_bf16 v[184:187], a[4:7], a[16:19], v[184:187]
 s_waitcnt vmcnt(5)
 s_barrier
 s_waitcnt lgkmcnt(4)
 v_mfma_f32_16x16x32_bf16 v[40:43], a[8:11], a[32:35], v[40:43]
 ds_read_b64_tr_b16 a[4:5], v9 offset:12288
 v_mfma_f32_16x16x32_bf16 v[44:47], a[8:11], a[36:39], v[44:47]
 ds_read_b64_tr_b16 a[6:7], v9 offset:12800
 v_mfma_f32_16x16x32_bf16 v[48:51], a[8:11], a[40:43], v[48:51]
 s_add_u32 m0, s39, 34816
 v_mfma_f32_16x16x32_bf16 v[52:55], a[8:11], a[44:47], v[52:55]
 buffer_load_dwordx4 v1, s[12:15], s33 offen sc1 lds
 s_waitcnt lgkmcnt(4)
 v_mfma_f32_16x16x32_bf16 v[68:71], a[12:15], a[44:47], v[68:71]
 ds_read_b64_tr_b16 a[8:9], v6 offset:28672
 v_mfma_f32_16x16x32_bf16 v[64:67], a[12:15], a[40:43], v[64:67]
 ds_read_b64_tr_b16 a[10:11], v6 offset:29184
 v_mfma_f32_16x16x32_bf16 v[60:63], a[12:15], a[36:39], v[60:63]
 v_mfma_f32_16x16x32_bf16 v[56:59], a[12:15], a[32:35], v[56:59]
 buffer_load_dwordx4 v1, s[12:15], s33 offen offset:1024 sc1 lds
 s_add_u32 s33, s33, 2048
 s_waitcnt lgkmcnt(4)
 v_mfma_f32_16x16x32_bf16 v[72:75], a[0:3], a[32:35], v[72:75]
 ds_read_b64_tr_b16 a[12:13], v7 offset:28672
 v_mfma_f32_16x16x32_bf16 v[76:79], a[0:3], a[36:39], v[76:79]
 ds_read_b64_tr_b16 a[14:15], v7 offset:29184
 v_mfma_f32_16x16x32_bf16 v[80:83], a[0:3], a[40:43], v[80:83]
 s_add_u32 m0, s40, 8192
 v_mfma_f32_16x16x32_bf16 v[84:87], a[0:3], a[44:47], v[84:87]
 buffer_load_dwordx4 v2, s[16:19], s34 offen nt lds
 s_add_u32 s34, s34, s37
 s_waitcnt lgkmcnt(4)
 v_mfma_f32_16x16x32_bf16 v[100:103], a[4:7], a[44:47], v[100:103]
 ds_read_b64_tr_b16 a[0:1], v8 offset:28672
 v_mfma_f32_16x16x32_bf16 v[96:99], a[4:7], a[40:43], v[96:99]
 ds_read_b64_tr_b16 a[2:3], v8 offset:29184
 v_mfma_f32_16x16x32_bf16 v[92:95], a[4:7], a[36:39], v[92:95]
 ds_read_b128 a[16:19], v4 offset:0
 s_add_u32 m0, s40, 10240
 v_mfma_f32_16x16x32_bf16 v[88:91], a[4:7], a[32:35], v[88:91]
 buffer_load_dwordx4 v2, s[16:19], s35 offen nt lds
 s_add_u32 s35, s35, s37
 s_waitcnt lgkmcnt(5)
 v_mfma_f32_16x16x32_bf16 v[104:107], a[8:11], a[32:35], v[104:107]
 ds_read_b64_tr_b16 a[4:5], v9 offset:28672
 v_mfma_f32_16x16x32_bf16 v[108:111], a[8:11], a[36:39], v[108:111]
 ds_read_b64_tr_b16 a[6:7], v9 offset:29184
 v_mfma_f32_16x16x32_bf16 v[112:115], a[8:11], a[40:43], v[112:115]
 ds_read_b128 a[20:23], v4 offset:1024
 v_mfma_f32_16x16x32_bf16 v[116:119], a[8:11], a[44:47], v[116:119]
 s_waitcnt lgkmcnt(6)
 v_mfma_f32_16x16x32_bf16 v[132:135], a[12:15], a[44:47], v[132:135]
 ds_read_b64_tr_b16 a[8:9], v10 offset:12288
 v_mfma_f32_16x16x32_bf16 v[128:131], a[12:15], a[40:43], v[128:131]
 ds_read_b64_tr_b16 a[10:11], v10 offset:12544
 v_mfma_f32_16x16x32_bf16 v[124:127], a[12:15], a[36:39], v[124:127]
 ds_read_b128 a[24:27], v4 offset:2048
 v_mfma_f32_16x16x32_bf16 v[120:123], a[12:15], a[32:35], v[120:123]
 s_cmp_eq_u32 s45, s89
 s_cselect_b64 vcc, -1, 0
 v_cndmask_b32 v15, v14, v13, vcc
 buffer_load_dword v31, v15, s[80:83], 0 offen
 s_waitcnt lgkmcnt(7)
 v_mfma_f32_16x16x32_bf16 v[136:139], a[0:3], a[32:35], v[136:139]
 ds_read_b64_tr_b16 a[12:13], v10 offset:14336
 v_mfma_f32_16x16x32_bf16 v[140:143], a[0:3], a[36:39], v[140:143]
 ds_read_b64_tr_b16 a[14:15], v10 offset:14592
 v_mfma_f32_16x16x32_bf16 v[144:147], a[0:3], a[40:43], v[144:147]
 ds_read_b128 a[28:31], v4 offset:3072
 v_mfma_f32_16x16x32_bf16 v[148:151], a[0:3], a[44:47], v[148:151]
 s_waitcnt lgkmcnt(7)
 v_mfma_f32_16x16x32_bf16 v[164:167], a[4:7], a[44:47], v[164:167]
 ds_read_b64_tr_b16 a[0:1], v6 offset:0
 v_mfma_f32_16x16x32_bf16 v[160:163], a[4:7], a[40:43], v[160:163]
 ds_read_b64_tr_b16 a[2:3], v6 offset:512
 v_mfma_f32_16x16x32_bf16 v[156:159], a[4:7], a[36:39], v[156:159]
 v_mfma_f32_16x16x32_bf16 v[152:155], a[4:7], a[32:35], v[152:155]
 s_waitcnt lgkmcnt(6)
 v_mfma_f32_16x16x32_bf16 v[168:171], a[8:11], a[32:35], v[168:171]
 ds_read_b64_tr_b16 a[4:5], v7 offset:0
 v_mfma_f32_16x16x32_bf16 v[172:175], a[8:11], a[36:39], v[172:175]
 ds_read_b64_tr_b16 a[6:7], v7 offset:512
 v_mfma_f32_16x16x32_bf16 v[176:179], a[8:11], a[40:43], v[176:179]
 v_mfma_f32_16x16x32_bf16 v[180:183], a[8:11], a[44:47], v[180:183]
 s_waitcnt lgkmcnt(5)
 v_mfma_f32_16x16x32_bf16 v[196:199], a[12:15], a[44:47], v[196:199]
 ds_read_b64_tr_b16 a[8:9], v8 offset:0
 v_mfma_f32_16x16x32_bf16 v[192:195], a[12:15], a[40:43], v[192:195]
 ds_read_b64_tr_b16 a[10:11], v8 offset:512
 v_mfma_f32_16x16x32_bf16 v[188:191], a[12:15], a[36:39], v[188:191]
 v_mfma_f32_16x16x32_bf16 v[184:187], a[12:15], a[32:35], v[184:187]
 s_waitcnt vmcnt(5)
 s_barrier
 s_sub_u32 s45, s45, 1
 s_cmp_lg_u32 s45, 0
 s_cbranch_scc1 L_loop_Y_n_0
 s_waitcnt lgkmcnt(4)
 v_mfma_f32_16x16x32_bf16 v[40:43], a[0:3], a[16:19], v[40:43]
 ds_read_b64_tr_b16 a[12:13], v9 offset:0
 v_mfma_f32_16x16x32_bf16 v[44:47], a[0:3], a[20:23], v[44:47]
 ds_read_b64_tr_b16 a[14:15], v9 offset:512
 v_mfma_f32_16x16x32_bf16 v[48:51], a[0:3], a[24:27], v[48:51]
 s_add_u32 m0, s39, 52224
 v_mfma_f32_16x16x32_bf16 v[52:55], a[0:3], a[28:31], v[52:55]
 buffer_load_dwordx4 v1, s[12:15], s33 offen sc1 lds
 s_waitcnt lgkmcnt(4)
 v_mfma_f32_16x16x32_bf16 v[68:71], a[4:7], a[28:31], v[68:71]
 ds_read_b64_tr_b16 a[0:1], v6 offset:16384
 v_mfma_f32_16x16x32_bf16 v[64:67], a[4:7], a[24:27], v[64:67]
 ds_read_b64_tr_b16 a[2:3], v6 offset:16896
 v_mfma_f32_16x16x32_bf16 v[60:63], a[4:7], a[20:23], v[60:63]
 v_mfma_f32_16x16x32_bf16 v[56:59], a[4:7], a[16:19], v[56:59]
 buffer_load_dwordx4 v1, s[12:15], s33 offen offset:1024 sc1 lds
 s_add_u32 s33, s33, 2048
 s_waitcnt lgkmcnt(4)
 v_mfma_f32_16x16x32_bf16 v[72:75], a[8:11], a[16:19], v[72:75]
 ds_read_b64_tr_b16 a[4:5], v7 offset:16384
 v_mfma_f32_16x16x32_bf16 v[76:79], a[8:11], a[20:23], v[76:79]
 ds_read_b64_tr_b16 a[6:7], v7 offset:16896
 v_mfma_f32_16x16x32_bf16 v[80:83], a[8:11], a[24:27], v[80:83]
 s_add_u32 m0, s40, 12288
 v_mfma_f32_16x16x32_bf16 v[84:87], a[8:11], a[28:31], v[84:87]
 buffer_load_dwordx4 v2, s[16:19], s34 offen nt lds
 s_add_u32 s34, s34, s37
 s_waitcnt lgkmcnt(4)
 v_mfma_f32_16x16x32_bf16 v[100:103], a[12:15], a[28:31], v[100:103]
 ds_read_b64_tr_b16 a[8:9], v8 offset:16384
 v_mfma_f32_16x16x32_bf16 v[96:99], a[12:15], a[24:27], v[96:99]
 ds_read_b64_tr_b16 a[10:11], v8 offset:16896
 v_mfma_f32_16x16x32_bf16 v[92:95], a[12:15], a[20:23], v[92:95]
 ds_read_b128 a[32:35], v4 offset:17408
 s_add_u32 m0, s40, 14336
 v_mfma_f32_16x16x32_bf16 v[88:91], a[12:15], a[16:19], v[88:91]
 buffer_load_dwordx4 v2, s[16:19], s35 offen nt lds
 s_add_u32 s35, s35, s37
 s_waitcnt lgkmcnt(5)
 v_mfma_f32_16x16x32_bf16 v[104:107], a[0:3], a[16:19], v[104:107]
 ds_read_b64_tr_b16 a[12:13], v9 offset:16384
 v_mfma_f32_16x16x32_bf16 v[108:111], a[0:3], a[20:23], v[108:111]
 ds_read_b64_tr_b16 a[14:15], v9 offset:16896
 v_mfma_f32_16x16x32_bf16 v[112:115], a[0:3], a[24:27], v[112:115]
 ds_read_b128 a[36:39], v4 offset:18432
 v_mfma_f32_16x16x32_bf16 v[116:119], a[0:3], a[28:31], v[116:119]
 s_waitcnt lgkmcnt(6)
 v_mfma_f32_16x16x32_bf16 v[132:135], a[4:7], a[28:31], v[132:135]
 ds_read_b64_tr_b16 a[0:1], v10 offset:0
 v_mfma_f32_16x16x32_bf16 v[128:131], a[4:7], a[24:27], v[128:131]
 ds_read_b64_tr_b16 a[2:3], v10 offset:256
 v_mfma_f32_16x16x32_bf16 v[124:127], a[4:7], a[20:23], v[124:127]
 ds_read_b128 a[40:43], v4 offset:19456
 v_mfma_f32_16x16x32_bf16 v[120:123], a[4:7], a[16:19], v[120:123]
 s_waitcnt lgkmcnt(7)
 v_mfma_f32_16x16x32_bf16 v[136:139], a[8:11], a[16:19], v[136:139]
 ds_read_b64_tr_b16 a[4:5], v10 offset:2048
 v_mfma_f32_16x16x32_bf16 v[140:143], a[8:11], a[20:23], v[140:143]
 ds_read_b64_tr_b16 a[6:7], v10 offset:2304
 v_mfma_f32_16x16x32_bf16 v[144:147], a[8:11], a[24:27], v[144:147]
 ds_read_b128 a[44:47], v4 offset:20480
 v_mfma_f32_16x16x32_bf16 v[148:151], a[8:11], a[28:31], v[148:151]
 s_waitcnt lgkmcnt(7)
 v_mfma_f32_16x16x32_bf16 v[164:167], a[12:15], a[28:31], v[164:167]
 ds_read_b64_tr_b16 a[8:9], v6 offset:4096
 v_mfma_f32_16x16x32_bf16 v[160:163], a[12:15], a[24:27], v[160:163]
 ds_read_b64_tr_b16 a[10:11], v6 offset:4608
 v_mfma_f32_16x16x32_bf16 v[156:159], a[12:15], a[20:23], v[156:159]
 v_mfma_f32_16x16x32_bf16 v[152:155], a[12:15], a[16:19], v[152:155]
 s_waitcnt lgkmcnt(6)
 v_mfma_f32_16x16x32_bf16 v[168:171], a[0:3], a[16:19], v[168:171]
 ds_read_b64_tr_b16 a[12:13], v7 offset:4096
 v_mfma_f32_16x16x32_bf16 v[172:175], a[0:3], a[20:23], v[172:175]
 ds_read_b64_tr_b16 a[14:15], v7 offset:4608
 v_mfma_f32_16x16x32_bf16 v[176:179], a[0:3], a[24:27], v[176:179]
 v_mfma_f32_16x16x32_bf16 v[180:183], a[0:3], a[28:31], v[180:183]
 s_waitcnt lgkmcnt(5)
 v_mfma_f32_16x16x32_bf16 v[196:199], a[4:7], a[28:31], v[196:199]
 ds_read_b64_tr_b16 a[0:1], v8 offset:4096
 v_mfma_f32_16x16x32_bf16 v[192:195], a[4:7], a[24:27], v[192:195]
 ds_read_b64_tr_b16 a[2:3], v8 offset:4608
 v_mfma_f32_16x16x32_bf16 v[188:191], a[4:7], a[20:23], v[188:191]
 v_mfma_f32_16x16x32_bf16 v[184:187], a[4:7], a[16:19], v[184:187]
 s_waitcnt vmcnt(5)
 s_barrier
 s_waitcnt lgkmcnt(4)
 v_mfma_f32_16x16x32_bf16 v[40:43], a[8:11], a[32:35], v[40:43]
 ds_read_b64_tr_b16 a[4:5], v9 offset:4096
 v_mfma_f32_16x16x32_bf16 v[44:47], a[8:11], a[36:39], v[44:47]
 ds_read_b64_tr_b16 a[6:7], v9 offset:4608
 v_mfma_f32_16x16x32_bf16 v[48:51], a[8:11], a[40:43], v[48:51]
 s_add_u32 m0, s39, 0
 v_mfma_f32_16x16x32_bf16 v[52:55], a[8:11], a[44:47], v[52:55]
 buffer_load_dwordx4 v1, s[12:15], s33 offen sc1 lds
 s_waitcnt lgkmcnt(4)
 v_mfma_f32_16x16x32_bf16 v[68:71], a[12:15], a[44:47], v[68:71]
 ds_read_b64_tr_b16 a[8:9], v6 offset:20480
 v_mfma_f32_16x16x32_bf16 v[64:67], a[12:15], a[40:43], v[64:67]
 ds_read_b64_tr_b16 a[10:11], v6 offset:20992
 v_mfma_f32_16x16x32_bf16 v[60:63], a[12:15], a[36:39], v[60:63]
 v_mfma_f32_16x16x32_bf16 v[56:59], a[12:15], a[32:35], v[56:59]
 buffer_load_dwordx4 v1, s[12:15], s33 offen offset:1024 sc1 lds
 s_add_u32 s33, s33, 2048
 s_waitcnt lgkmcnt(4)
 v_mfma_f32_16x16x32_bf16 v[72:75], a[0:3], a[32:35], v[72:75]
 ds_read_b64_tr_b16 a[12:13], v7 offset:20480
 v_mfma_f32_16x16x32_bf16 v[76:79], a[0:3], a[36:39], v[76:79]
 ds_read_b64_tr_b16 a[14:15], v7 offset:20992
 v_mfma_f32_16x16x32_bf16 v[80:83], a[0:3], a[40:43], v[80:83]
 s_add_u32 m0, s40, 0
 v_mfma_f32_16x16x32_bf16 v[84:87], a[0:3], a[44:47], v[84:87]
 buffer_load_dwordx4 v2, s[16:19], s34 offen nt lds
 s_add_u32 s34, s34, s37
 s_waitcnt lgkmcnt(4)
 v_mfma_f32_16x16x32_bf16 v[100:103], a[4:7], a[44:47], v[100:103]
 ds_read_b64_tr_b16 a[0:1], v8 offset:20480
 v_mfma_f32_16x16x32_bf16 v[96:99], a[4:7], a[40:43], v[96:99]
 ds_read_b64_tr_b16 a[2:3], v8 offset:20992
 v_mfma_f32_16x16x32_bf16 v[92:95], a[4:7], a[36:39], v[92:95]
 ds_read_b128 a[16:19], v4 offset:34816
 s_add_u32 m0, s40, 2048
 v_mfma_f32_16x16x32_bf16 v[88:91], a[4:7], a[32:35], v[88:91]
 buffer_load_dwordx4 v2, s[16:19], s35 offen nt lds
 s_add_u32 s35, s35, s37
 s_waitcnt lgkmcnt(5)
 v_mfma_f32_16x16x32_bf16 v[104:107], a[8:11], a[32:35], v[104:107]
 ds_read_b64_tr_b16 a[4:5], v9 offset:20480
 v_mfma_f32_16x16x32_bf16 v[108:111], a[8:11], a[36:39], v[108:111]
 ds_read_b64_tr_b16 a[6:7], v9 offset:20992
 v_mfma_f32_16x16x32_bf16 v[112:115], a[8:11], a[40:43], v[112:115]
 ds_read_b128 a[20:23], v4 offset:35840
 v_mfma_f32_16x16x32_bf16 v[116:119], a[8:11], a[44:47], v[116:119]
 s_waitcnt lgkmcnt(6)
 v_mfma_f32_16x16x32_bf16 v[132:135], a[12:15], a[44:47], v[132:135]
 ds_read_b64_tr_b16 a[8:9], v10 offset:4096
 v_mfma_f32_16x16x32_bf16 v[128:131], a[12:15], a[40:43], v[128:131]
 ds_read_b64_tr_b16 a[10:11], v10 offset:4352
 v_mfma_f32_16x16x32_bf16 v[124:127], a[12:15], a[36:39], v[124:127]
 ds_read_b128 a[24:27], v4 offset:36864
 v_mfma_f32_16x16x32_bf16 v[120:123], a[12:15], a[32:35], v[120:123]
 s_waitcnt lgkmcnt(7)
 v_mfma_f32_16x16x32_bf16 v[136:139], a[0:3], a[32:35], v[136:139]
 ds_read_b64_tr_b16 a[12:13], v10 offset:6144
 v_mfma_f32_16x16x32_bf16 v[140:143], a[0:3], a[36:39], v[140:143]
 ds_read_b64_tr_b16 a[14:15], v10 offset:6400
 v_mfma_f32_16x16x32_bf16 v[144:147], a[0:3], a[40:43], v[144:147]
 ds_read_b128 a[28:31], v4 offset:37888
 v_mfma_f32_16x16x32_bf16 v[148:151], a[0:3], a[44:47], v[148:151]
 s_waitcnt lgkmcnt(7)
 v_mfma_f32_16x16x32_bf16 v[164:167], a[4:7], a[44:47], v[164:167]
 ds_read_b64_tr_b16 a[0:1], v6 offset:8192
 v_mfma_f32_16x16x32_bf16 v[160:163], a[4:7], a[40:43], v[160:163]
 ds_read_b64_tr_b16 a[2:3], v6 offset:8704
 v_mfma_f32_16x16x32_bf16 v[156:159], a[4:7], a[36:39], v[156:159]
 v_mfma_f32_16x16x32_bf16 v[152:155], a[4:7], a[32:35], v[152:155]
 s_waitcnt lgkmcnt(6)
 v_mfma_f32_16x16x32_bf16 v[168:171], a[8:11], a[32:35], v[168:171]
 ds_read_b64_tr_b16 a[4:5], v7 offset:8192
 v_mfma_f32_16x16x32_bf16 v[172:175], a[8:11], a[36:39], v[172:175]
 ds_read_b64_tr_b16 a[6:7], v7 offset:8704
 v_mfma_f32_16x16x32_bf16 v[176:179], a[8:11], a[40:43], v[176:179]
 v_mfma_f32_16x16x32_bf16 v[180:183], a[8:11], a[44:47], v[180:183]
 s_waitcnt lgkmcnt(5)
 v_mfma_f32_16x16x32_bf16 v[196:199], a[12:15], a[44:47], v[196:199]
 ds_read_b64_tr_b16 a[8:9], v8 offset:8192
 v_mfma_f32_16x16x32_bf16 v[192:195], a[12:15], a[40:43], v[192:195]
 ds_read_b64_tr_b16 a[10:11], v8 offset:8704
 v_mfma_f32_16x16x32_bf16 v[188:191], a[12:15], a[36:39], v[188:191]
 v_mfma_f32_16x16x32_bf16 v[184:187], a[12:15], a[32:35], v[184:187]
 s_waitcnt vmcnt(4)
 s_barrier
 s_waitcnt lgkmcnt(4)
 v_mfma_f32_16x16x32_bf16 v[40:43], a[0:3], a[16:19], v[40:43]
 ds_read_b64_tr_b16 a[12:13], v9 offset:8192
 v_mfma_f32_16x16x32_bf16 v[44:47], a[0:3], a[20:23], v[44:47]
 ds_read_b64_tr_b16 a[14:15], v9 offset:8704
 v_mfma_f32_16x16x32_bf16 v[48:51], a[0:3], a[24:27], v[48:51]
 s_add_u32 m0, s39, 17408
 v_mfma_f32_16x16x32_bf16 v[52:55], a[0:3], a[28:31], v[52:55]
 buffer_load_dwordx4 v1, s[12:15], s33 offen sc1 lds
 s_waitcnt lgkmcnt(4)
 v_mfma_f32_16x16x32_bf16 v[68:71], a[4:7], a[28:31], v[68:71]
 ds_read_b64_tr_b16 a[0:1], v6 offset:24576
 v_mfma_f32_16x16x32_bf16 v[64:67], a[4:7], a[24:27], v[64:67]
 ds_read_b64_tr_b16 a[2:3], v6 offset:25088
 v_mfma_f32_16x16x32_bf16 v[60:63], a[4:7], a[20:23], v[60:63]
 v_mfma_f32_16x16x32_bf16 v[56:59], a[4:7], a[16:19], v[56:59]
 buffer_load_dwordx4 v1, s[12:15], s33 offen offset:1024 sc1 lds
 s_add_u32 s33, s33, 2048
 s_waitcnt lgkmcnt(4)
 v_mfma_f32_16x16x32_bf16 v[72:75], a[8:11], a[16:19], v[72:75]
 ds_read_b64_tr_b16 a[4:5], v7 offset:24576
 v_mfma_f32_16x16x32_bf16 v[76:79], a[8:11], a[20:23], v[76:79]
 ds_read_b64_tr_b16 a[6:7], v7 offset:25088
 v_mfma_f32_16x16x32_bf16 v[80:83], a[8:11], a[24:27], v[80:83]
 s_add_u32 m0, s40, 4096
 v_mfma_f32_16x16x32_bf16 v[84:87], a[8:11], a[28:31], v[84:87]
 buffer_load_dwordx4 v2, s[16:19], s34 offen nt lds
 s_add_u32 s34, s34, s37
 s_waitcnt lgkmcnt(4)
 v_mfma_f32_16x16x32_bf16 v[100:103], a[12:15], a[28:31], v[100:103]
 ds_read_b64_tr_b16 a[8:9], v8 offset:24576
 v_mfma_f32_16x16x32_bf16 v[96:99], a[12:15], a[24:27], v[96:99]
 ds_read_b64_tr_b16 a[10:11], v8 offset:25088
 v_mfma_f32_16x16x32_bf16 v[92:95], a[12:15], a[20:23], v[92:95]
 ds_read_b128 a[32:35], v4 offset:52224
 s_add_u32 m0, s40, 6144
 v_mfma_f32_16x16x32_bf16 v[88:91], a[12:15], a[16:19], v[88:91]
 buffer_load_dwordx4 v2, s[16:19], s35 offen nt lds
 s_add_u32 s35, s35, s37
 s_waitcnt lgkmcnt(5)
 v_mfma_f32_16x16x32_bf16 v[104:107], a[0:3], a[16:19], v[104:107]
 ds_read_b64_tr_b16 a[12:13], v9 offset:24576
 v_mfma_f32_16x16x32_bf16 v[108:111], a[0:3], a[20:23], v[108:111]
 ds_read_b64_tr_b16 a[14:15], v9 offset:25088
 v_mfma_f32_16x16x32_bf16 v[112:115], a[0:3], a[24:27], v[112:115]
 ds_read_b128 a[36:39], v4 offset:53248
 v_mfma_f32_16x16x32_bf16 v[116:119], a[0:3], a[28:31], v[116:119]
 s_waitcnt lgkmcnt(6)
 v_mfma_f32_16x16x32_bf16 v[132:135], a[4:7], a[28:31], v[132:135]
 ds_read_b64_tr_b16 a[0:1], v10 offset:8192
 v_mfma_f32_16x16x32_bf16 v[128:131], a[4:7], a[24:27], v[128:131]
 ds_read_b64_tr_b16 a[2:3], v10 offset:8448
 v_mfma_f32_16x16x32_bf16 v[124:127], a[4:7], a[20:23], v[124:127]
 ds_read_b128 a[40:43], v4 offset:54272
 v_mfma_f32_16x16x32_bf16 v[120:123], a[4:7], a[16:19], v[120:123]
 s_waitcnt lgkmcnt(7)
 v_mfma_f32_16x16x32_bf16 v[136:139], a[8:11], a[16:19], v[136:139]
 ds_read_b64_tr_b16 a[4:5], v10 offset:10240
 v_mfma_f32_16x16x32_bf16 v[140:143], a[8:11], a[20:23], v[140:143]
 ds_read_b64_tr_b16 a[6:7], v10 offset:10496
 v_mfma_f32_16x16x32_bf16 v[144:147], a[8:11], a[24:27], v[144:147]
 ds_read_b128 a[44:47], v4 offset:55296
 v_mfma_f32_16x16x32_bf16 v[148:151], a[8:11], a[28:31], v[148:151]
 s_waitcnt lgkmcnt(7)
 v_mfma_f32_16x16x32_bf16 v[164:167], a[12:15], a[28:31], v[164:167]
 ds_read_b64_tr_b16 a[8:9], v6 offset:12288
 v_mfma_f32_16x16x32_bf16 v[160:163], a[12:15], a[24:27], v[160:163]
 ds_read_b64_tr_b16 a[10:11], v6 offset:12800
 v_mfma_f32_16x16x32_bf16 v[156:159], a[12:15], a[20:23], v[156:159]
 v_mfma_f32_16x16x32_bf16 v[152:155], a[12:15], a[16:19], v[152:155]
 s_waitcnt lgkmcnt(6)
 v_mfma_f32_16x16x32_bf16 v[168:171], a[0:3], a[16:19], v[168:171]
 ds_read_b64_tr_b16 a[12:13], v7 offset:12288
 v_mfma_f32_16x16x32_bf16 v[172:175], a[0:3], a[20:23], v[172:175]
 ds_read_b64_tr_b16 a[14:15], v7 offset:12800
 v_mfma_f32_16x16x32_bf16 v[176:179], a[0:3], a[24:27], v[176:179]
 v_mfma_f32_16x16x32_bf16 v[180:183], a[0:3], a[28:31], v[180:183]
 s_waitcnt lgkmcnt(5)
 v_mfma_f32_16x16x32_bf16 v[196:199], a[4:7], a[28:31], v[196:199]
 ds_read_b64_tr_b16 a[0:1], v8 offset:12288
 v_mfma_f32_16x16x32_bf16 v[192:195], a[4:7], a[24:27], v[192:195]
 ds_read_b64_tr_b16 a[2:3], v8 offset:12800
 v_mfma_f32_16x16x32_bf16 v[188:191], a[4:7], a[20:23], v[188:191]
 v_mfma_f32_16x16x32_bf16 v[184:187], a[4:7], a[16:19], v[184:187]
 s_waitcnt vmcnt(4)
 s_barrier
 s_waitcnt lgkmcnt(4)
 v_mfma_f32_16x16x32_bf16 v[40:43], a[8:11], a[32:35], v[40:43]
 ds_read_b64_tr_b16 a[4:5], v9 offset:12288
 v_mfma_f32_16x16x32_bf16 v[44:47], a[8:11], a[36:39], v[44:47]
 ds_read_b64_tr_b16 a[6:7], v9 offset:12800
 v_mfma_f32_16x16x32_bf16 v[48:51], a[8:11], a[40:43], v[48:51]
 s_add_u32 m0, s39, 34816
 v_mfma_f32_16x16x32_bf16 v[52:55], a[8:11], a[44:47], v[52:55]
 buffer_load_dwordx4 v1, s[12:15], s33 offen sc1 lds
 s_waitcnt lgkmcnt(4)
 v_mfma_f32_16x16x32_bf16 v[68:71], a[12:15], a[44:47], v[68:71]
 ds_read_b64_tr_b16 a[8:9], v6 offset:28672
 v_mfma_f32_16x16x32_bf16 v[64:67], a[12:15], a[40:43], v[64:67]
 ds_read_b64_tr_b16 a[10:11], v6 offset:29184
 v_mfma_f32_16x16x32_bf16 v[60:63], a[12:15], a[36:39], v[60:63]
 v_mfma_f32_16x16x32_bf16 v[56:59], a[12:15], a[32:35], v[56:59]
 buffer_load_dwordx4 v1, s[12:15], s33 offen offset:1024 sc1 lds
 s_add_u32 s33, s33, 2048
 s_waitcnt lgkmcnt(4)
 v_mfma_f32_16x16x32_bf16 v[72:75], a[0:3], a[32:35], v[72:75]
 ds_read_b64_tr_b16 a[12:13], v7 offset:28672
 v_mfma_f32_16x16x32_bf16 v[76:79], a[0:3], a[36:39], v[76:79]
 ds_read_b64_tr_b16 a[14:15], v7 offset:29184
 v_mfma_f32_16x16x32_bf16 v[80:83], a[0:3], a[40:43], v[80:83]
 s_add_u32 m0, s40, 8192
 v_mfma_f32_16x16x32_bf16 v[84:87], a[0:3], a[44:47], v[84:87]
 buffer_load_dwordx4 v2, s[16:19], s34 offen nt lds
 s_add_u32 s34, s34, s37
 s_waitcnt lgkmcnt(4)
 v_mfma_f32_16x16x32_bf16 v[100:103], a[4:7], a[44:47], v[100:103]
 ds_read_b64_tr_b16 a[0:1], v8 offset:28672
 v_mfma_f32_16x16x32_bf16 v[96:99], a[4:7], a[40:43], v[96:99]
 ds_read_b64_tr_b16 a[2:3], v8 offset:29184
 v_mfma_f32_16x16x32_bf16 v[92:95], a[4:7], a[36:39], v[92:95]
 ds_read_b128 a[16:19], v4 offset:0
 s_add_u32 m0, s40, 10240
 v_mfma_f32_16x16x32_bf16 v[88:91], a[4:7], a[32:35], v[88:91]
 buffer_load_dwordx4 v2, s[16:19], s35 offen nt lds
 s_add_u32 s35, s35, s37
 s_waitcnt lgkmcnt(5)
 v_mfma_f32_16x16x32_bf16 v[104:107], a[8:11], a[32:35], v[104:107]
 ds_read_b64_tr_b16 a[4:5], v9 offset:28672
 v_mfma_f32_16x16x32_bf16 v[108:111], a[8:11], a[36:39], v[108:111]
 ds_read_b64_tr_b16 a[6:7], v9 offset:29184
 v_mfma_f32_16x16x32_bf16 v[112:115], a[8:11], a[40:43], v[112:115]
 ds_read_b128 a[20:23], v4 offset:1024
 v_mfma_f32_16x16x32_bf16 v[116:119], a[8:11], a[44:47], v[116:119]
 s_waitcnt lgkmcnt(6)
 v_mfma_f32_16x16x32_bf16 v[132:135], a[12:15], a[44:47], v[132:135]
 ds_read_b64_tr_b16 a[8:9], v10 offset:12288
 v_mfma_f32_16x16x32_bf16 v[128:131], a[12:15], a[40:43], v[128:131]
 ds_read_b64_tr_b16 a[10:11], v10 offset:12544
 v_mfma_f32_16x16x32_bf16 v[124:127], a[12:15], a[36:39], v[124:127]
 ds_read_b128 a[24:27], v4 offset:2048
 v_mfma_f32_16x16x32_bf16 v[120:123], a[12:15], a[32:35], v[120:123]
 s_waitcnt lgkmcnt(7)
 v_mfma_f32_16x16x32_bf16 v[136:139], a[0:3], a[32:35], v[136:139]
 ds_read_b64_tr_b16 a[12:13], v10 offset:14336
 v_mfma_f32_16x16x32_bf16 v[140:143], a[0:3], a[36:39], v[140:143]
 ds_read_b64_tr_b16 a[14:15], v10 offset:14592
 v_mfma_f32_16x16x32_bf16 v[144:147], a[0:3], a[40:43], v[144:147]
 ds_read_b128 a[28:31], v4 offset:3072
 v_mfma_f32_16x16x32_bf16 v[148:151], a[0:3], a[44:47], v[148:151]
 s_waitcnt lgkmcnt(7)
 v_mfma_f32_16x16x32_bf16 v[164:167], a[4:7], a[44:47], v[164:167]
 ds_read_b64_tr_b16 a[0:1], v6 offset:0
 v_mfma_f32_16x16x32_bf16 v[160:163], a[4:7], a[40:43], v[160:163]
 ds_read_b64_tr_b16 a[2:3], v6 offset:512
 v_mfma_f32_16x16x32_bf16 v[156:159], a[4:7], a[36:39], v[156:159]
 v_mfma_f32_16x16x32_bf16 v[152:155], a[4:7], a[32:35], v[152:155]
 s_waitcnt lgkmcnt(6)
 v_mfma_f32_16x16x32_bf16 v[168:171], a[8:11], a[32:35], v[168:171]
 ds_read_b64_tr_b16 a[4:5], v7 offset:0
 v_mfma_f32_16x16x32_bf16 v[172:175], a[8:11], a[36:39], v[172:175]
 ds_read_b64_tr_b16 a[6:7], v7 offset:512
 v_mfma_f32_16x16x32_bf16 v[176:179], a[8:11], a[40:43], v[176:179]
 v_mfma_f32_16x16x32_bf16 v[180:183], a[8:11], a[44:47], v[180:183]
 s_waitcnt lgkmcnt(5)
 v_mfma_f32_16x16x32_bf16 v[196:199], a[12:15], a[44:47], v[196:199]
 ds_read_b64_tr_b16 a[8:9], v8 offset:0
 v_mfma_f32_16x16x32_bf16 v[192:195], a[12:15], a[40:43], v[192:195]
 ds_read_b64_tr_b16 a[10:11], v8 offset:512
 v_mfma_f32_16x16x32_bf16 v[188:191], a[12:15], a[36:39], v[188:191]
 v_mfma_f32_16x16x32_bf16 v[184:187], a[12:15], a[32:35], v[184:187]
 s_waitcnt vmcnt(4)
 s_barrier
 s_waitcnt lgkmcnt(4)
 v_mfma_f32_16x16x32_bf16 v[40:43], a[0:3], a[16:19], v[40:43]
 ds_read_b64_tr_b16 a[12:13], v9 offset:0
 v_mfma_f32_16x16x32_bf16 v[44:47], a[0:3], a[20:23], v[44:47]
 ds_read_b64_tr_b16 a[14:15], v9 offset:512
 v_mfma_f32_16x16x32_bf16 v[48:51], a[0:3], a[24:27], v[48:51]
 s_add_u32 m0, s39, 52224
 v_mfma_f32_16x16x32_bf16 v[52:55], a[0:3], a[28:31], v[52:55]
 buffer_load_dwordx4 v1, s[12:15], s33 offen sc1 lds
 s_waitcnt lgkmcnt(4)
 v_mfma_f32_16x16x32_bf16 v[68:71], a[4:7], a[28:31], v[68:71]
 ds_read_b64_tr_b16 a[0:1], v6 offset:16384
 v_mfma_f32_16x16x32_bf16 v[64:67], a[4:7], a[24:27], v[64:67]
 ds_read_b64_tr_b16 a[2:3], v6 offset:16896
 v_mfma_f32_16x16x32_bf16 v[60:63], a[4:7], a[20:23], v[60:63]
 v_mfma_f32_16x16x32_bf16 v[56:59], a[4:7], a[16:19], v[56:59]
 buffer_load_dwordx4 v1, s[12:15], s33 offen offset:1024 sc1 lds
 s_add_u32 s33, s33, 2048
 s_waitcnt lgkmcnt(4)
 v_mfma_f32_16x16x32_bf16 v[72:75], a[8:11], a[16:19], v[72:75]
 ds_read_b64_tr_b16 a[4:5], v7 offset:16384
 v_mfma_f32_16x16x32_bf16 v[76:79], a[8:11], a[20:23], v[76:79]
 ds_read_b64_tr_b16 a[6:7], v7 offset:16896
 v_mfma_f32_16x16x32_bf16 v[80:83], a[8:11], a[24:27], v[80:83]
 s_add_u32 m0, s40, 12288
 v_mfma_f32_16x16x32_bf16 v[84:87], a[8:11], a[28:31], v[84:87]
 buffer_load_dwordx4 v2, s[16:19], s34 offen nt lds
 s_add_u32 s34, s34, s37
 s_waitcnt lgkmcnt(4)
 v_mfma_f32_16x16x32_bf16 v[100:103], a[12:15], a[28:31], v[100:103]
 ds_read_b64_tr_b16 a[8:9], v8 offset:16384
 v_mfma_f32_16x16x32_bf16 v[96:99], a[12:15], a[24:27], v[96:99]
 ds_read_b64_tr_b16 a[10:11], v8 offset:16896
 v_mfma_f32_16x16x32_bf16 v[92:95], a[12:15], a[20:23], v[92:95]
 ds_read_b128 a[32:35], v4 offset:17408
 s_add_u32 m0, s40, 14336
 v_mfma_f32_16x16x32_bf16 v[88:91], a[12:15], a[16:19], v[88:91]
 buffer_load_dwordx4 v2, s[16:19], s35 offen nt lds
 s_add_u32 s35, s35, s37
 s_waitcnt lgkmcnt(5)
 v_mfma_f32_16x16x32_bf16 v[104:107], a[0:3], a[16:19], v[104:107]
 ds_read_b64_tr_b16 a[12:13], v9 offset:16384
 v_mfma_f32_16x16x32_bf16 v[108:111], a[0:3], a[20:23], v[108:111]
 ds_read_b64_tr_b16 a[14:15], v9 offset:16896
 v_mfma_f32_16x16x32_bf16 v[112:115], a[0:3], a[24:27], v[112:115]
 ds_read_b128 a[36:39], v4 offset:18432
 v_mfma_f32_16x16x32_bf16 v[116:119], a[0:3], a[28:31], v[116:119]
 s_waitcnt lgkmcnt(6)
 v_mfma_f32_16x16x32_bf16 v[132:135], a[4:7], a[28:31], v[132:135]
 ds_read_b64_tr_b16 a[0:1], v10 offset:0
 v_mfma_f32_16x16x32_bf16 v[128:131], a[4:7], a[24:27], v[128:131]
 ds_read_b64_tr_b16 a[2:3], v10 offset:256
 v_mfma_f32_16x16x32_bf16 v[124:127], a[4:7], a[20:23], v[124:127]
 ds_read_b128 a[40:43], v4 offset:19456
 v_mfma_f32_16x16x32_bf16 v[120:123], a[4:7], a[16:19], v[120:123]
 s_waitcnt lgkmcnt(7)
 v_mfma_f32_16x16x32_bf16 v[136:139], a[8:11], a[16:19], v[136:139]
 ds_read_b64_tr_b16 a[4:5], v10 offset:2048
 v_mfma_f32_16x16x32_bf16 v[140:143], a[8:11], a[20:23], v[140:143]
 ds_read_b64_tr_b16 a[6:7], v10 offset:2304
 v_mfma_f32_16x16x32_bf16 v[144:147], a[8:11], a[24:27], v[144:147]
 ds_read_b128 a[44:47], v4 offset:20480
 v_mfma_f32_16x16x32_bf16 v[148:151], a[8:11], a[28:31], v[148:151]
 s_waitcnt lgkmcnt(7)
 v_mfma_f32_16x16x32_bf16 v[164:167], a[12:15], a[28:31], v[164:167]
 ds_read_b64_tr_b16 a[8:9], v6 offset:4096
 v_mfma_f32_16x16x32_bf16 v[160:163], a[12:15], a[24:27], v[160:163]
 ds_read_b64_tr_b16 a[10:11], v6 offset:4608
 v_mfma_f32_16x16x32_bf16 v[156:159], a[12:15], a[20:23], v[156:159]
 v_mfma_f32_16x16x32_bf16 v[152:155], a[12:15], a[16:19], v[152:155]
 s_waitcnt lgkmcnt(6)
 v_mfma_f32_16x16x32_bf16 v[168:171], a[0:3], a[16:19], v[168:171]
 ds_read_b64_tr_b16 a[12:13], v7 offset:4096
 v_mfma_f32_16x16x32_bf16 v[172:175], a[0:3], a[20:23], v[172:175]
 ds_read_b64_tr_b16 a[14:15], v7 offset:4608
 v_mfma_f32_16x16x32_bf16 v[176:179], a[0:3], a[24:27], v[176:179]
 v_mfma_f32_16x16x32_bf16 v[180:183], a[0:3], a[28:31], v[180:183]
 s_waitcnt lgkmcnt(5)
 v_mfma_f32_16x16x32_bf16 v[196:199], a[4:7], a[28:31], v[196:199]
 ds_read_b64_tr_b16 a[0:1], v8 offset:4096
 v_mfma_f32_16x16x32_bf16 v[192:195], a[4:7], a[24:27], v[192:195]
 ds_read_b64_tr_b16 a[2:3], v8 offset:4608
 v_mfma_f32_16x16x32_bf16 v[188:191], a[4:7], a[20:23], v[188:191]
 v_mfma_f32_16x16x32_bf16 v[184:187], a[4:7], a[16:19], v[184:187]
 s_waitcnt vmcnt(4)
 s_barrier
 s_waitcnt lgkmcnt(4)
 v_mfma_f32_16x16x32_bf16 v[40:43], a[8:11], a[32:35], v[40:43]
 ds_read_b64_tr_b16 a[4:5], v9 offset:4096
 v_mfma_f32_16x16x32_bf16 v[44:47], a[8:11], a[36:39], v[44:47]
 ds_read_b64_tr_b16 a[6:7], v9 offset:4608
 v_mfma_f32_16x16x32_bf16 v[48:51], a[8:11], a[40:43], v[48:51]
 v_mfma_f32_16x16x32_bf16 v[52:55], a[8:11], a[44:47], v[52:55]
 s_waitcnt lgkmcnt(4)
 v_mfma_f32_16x16x32_bf16 v[68:71], a[12:15], a[44:47], v[68:71]
 ds_read_b64_tr_b16 a[8:9], v6 offset:20480
 v_mfma_f32_16x16x32_bf16 v[64:67], a[12:15], a[40:43], v[64:67]
 ds_read_b64_tr_b16 a[10:11], v6 offset:20992
 v_mfma_f32_16x16x32_bf16 v[60:63], a[12:15], a[36:39], v[60:63]
 v_mfma_f32_16x16x32_bf16 v[56:59], a[12:15], a[32:35], v[56:59]
 s_waitcnt lgkmcnt(4)
 v_mfma_f32_16x16x32_bf16 v[72:75], a[0:3], a[32:35], v[72:75]
 ds_read_b64_tr_b16 a[12:13], v7 offset:20480
 v_mfma_f32_16x16x32_bf16 v[76:79], a[0:3], a[36:39], v[76:79]
 ds_read_b64_tr_b16 a[14:15], v7 offset:20992
 v_mfma_f32_16x16x32_bf16 v[80:83], a[0:3], a[40:43], v[80:83]
 v_mfma_f32_16x16x32_bf16 v[84:87], a[0:3], a[44:47], v[84:87]
 s_waitcnt lgkmcnt(4)
 v_mfma_f32_16x16x32_bf16 v[100:103], a[4:7], a[44:47], v[100:103]
 ds_read_b64_tr_b16 a[0:1], v8 offset:20480
 v_mfma_f32_16x16x32_bf16 v[96:99], a[4:7], a[40:43], v[96:99]
 ds_read_b64_tr_b16 a[2:3], v8 offset:20992
 v_mfma_f32_16x16x32_bf16 v[92:95], a[4:7], a[36:39], v[92:95]
 ds_read_b128 a[16:19], v4 offset:34816
 v_mfma_f32_16x16x32_bf16 v[88:91], a[4:7], a[32:35], v[88:91]
 s_waitcnt lgkmcnt(5)
 v_mfma_f32_16x16x32_bf16 v[104:107], a[8:11], a[32:35], v[104:107]
 ds_read_b64_tr_b16 a[4:5], v9 offset:20480
 v_mfma_f32_16x16x32_bf16 v[108:111], a[8:11], a[36:39], v[108:111]
 ds_read_b64_tr_b16 a[6:7], v9 offset:20992
 v_mfma_f32_16x16x32_bf16 v[112:115], a[8:11], a[40:43], v[112:115]
 ds_read_b128 a[20:23], v4 offset:35840
 v_mfma_f32_16x16x32_bf16 v[116:119], a[8:11], a[44:47], v[116:119]
 s_waitcnt lgkmcnt(6)
 v_mfma_f32_16x16x32_bf16 v[132:135], a[12:15], a[44:47], v[132:135]
 ds_read_b64_tr_b16 a[8:9], v10 offset:4096
 v_mfma_f32_16x16x32_bf16 v[128:131], a[12:15], a[40:43], v[128:131]
 ds_read_b64_tr_b16 a[10:11], v10 offset:4352
 v_mfma_f32_16x16x32_bf16 v[124:127], a[12:15], a[36:39], v[124:127]
 ds_read_b128 a[24:27], v4 offset:36864
 v_mfma_f32_16x16x32_bf16 v[120:123], a[12:15], a[32:35], v[120:123]
 s_waitcnt lgkmcnt(7)
 v_mfma_f32_16x16x32_bf16 v[136:139], a[0:3], a[32:35], v[136:139]
 ds_read_b64_tr_b16 a[12:13], v10 offset:6144
 v_mfma_f32_16x16x32_bf16 v[140:143], a[0:3], a[36:39], v[140:143]
 ds_read_b64_tr_b16 a[14:15], v10 offset:6400
 v_mfma_f32_16x16x32_bf16 v[144:147], a[0:3], a[40:43], v[144:147]
 ds_read_b128 a[28:31], v4 offset:37888
 v_mfma_f32_16x16x32_bf16 v[148:151], a[0:3], a[44:47], v[148:151]
 s_waitcnt lgkmcnt(7)
 v_mfma_f32_16x16x32_bf16 v[164:167], a[4:7], a[44:47], v[164:167]
 ds_read_b64_tr_b16 a[0:1], v6 offset:8192
 v_mfma_f32_16x16x32_bf16 v[160:163], a[4:7], a[40:43], v[160:163]
 ds_read_b64_tr_b16 a[2:3], v6 offset:8704
 v_mfma_f32_16x16x32_bf16 v[156:159], a[4:7], a[36:39], v[156:159]
 v_mfma_f32_16x16x32_bf16 v[152:155], a[4:7], a[32:35], v[152:155]
 s_waitcnt lgkmcnt(6)
 v_mfma_f32_16x16x32_bf16 v[168:171], a[8:11], a[32:35], v[168:171]
 ds_read_b64_tr_b16 a[4:5], v7 offset:8192
 v_mfma_f32_16x16x32_bf16 v[172:175], a[8:11], a[36:39], v[172:175]
 ds_read_b64_tr_b16 a[6:7], v7 offset:8704
 v_mfma_f32_16x16x32_bf16 v[176:179], a[8:11], a[40:43], v[176:179]
 v_mfma_f32_16x16x32_bf16 v[180:183], a[8:11], a[44:47], v[180:183]
 s_waitcnt lgkmcnt(5)
 v_mfma_f32_16x16x32_bf16 v[196:199], a[12:15], a[44:47], v[196:199]
 ds_read_b64_tr_b16 a[8:9], v8 offset:8192
 v_mfma_f32_16x16x32_bf16 v[192:195], a[12:15], a[40:43], v[192:195]
 ds_read_b64_tr_b16 a[10:11], v8 offset:8704
 v_mfma_f32_16x16x32_bf16 v[188:191], a[12:15], a[36:39], v[188:191]
 v_mfma_f32_16x16x32_bf16 v[184:187], a[12:15], a[32:35], v[184:187]
 s_waitcnt vmcnt(0)
 s_barrier
 s_load_dwordx2 s[12:13], s[0:1], 16
 s_load_dwordx2 s[16:17], s[0:1], 48
 s_load_dwordx2 s[8:9], s[0:1], 0
 s_load_dwordx2 s[40:41], s[0:1], 56
 s_and_b32 s56, s2, 7
 s_lshr_b32 s34, s56, 2
 s_lshr_b32 s57, s2, 3
 s_bfe_u32 s58, s56, 0x10001
 s_lshl_b32 s58, s58, 3
 s_and_b32 s39, s57, 7
 s_add_u32 s39, s39, s58
 s_and_b32 s58, s56, 1
 s_lshl_b32 s58, s58, 2
 s_lshr_b32 s57, s57, 3
 s_add_u32 s33, s57, s58
 s_lshr_b32 s94, s39, 1
 s_waitcnt lgkmcnt(0)
 s_and_b32 s13, s13, 0xffff
 s_mov_b32 s14, 2097152
 s_mov_b32 s15, 0x20000
 s_and_b32 s17, s17, 0xffff
 s_mov_b32 s18, 7340032
 s_mov_b32 s19, 0x20000
 s_and_b32 s9, s9, 0xffff
 s_mov_b32 s10, 4194304
 s_mov_b32 s11, 0x20000
 s_and_b32 s41, s41, 0xffff
 s_mov_b32 s42, 4194304
 s_mov_b32 s43, 0x20000
 s_add_u32 s20, s6, 25165824
 s_addc_u32 s21, s7, 0
 s_and_b32 s21, s21, 0xffff
 s_mov_b32 s22, 4194304
 s_mov_b32 s23, 0x20000
 s_waitcnt lgkmcnt(4)
 v_mfma_f32_16x16x32_bf16 v[40:43], a[0:3], a[16:19], v[40:43]
 ds_read_b64_tr_b16 a[12:13], v9 offset:8192
 v_mfma_f32_16x16x32_bf16 v[44:47], a[0:3], a[20:23], v[44:47]
 ds_read_b64_tr_b16 a[14:15], v9 offset:8704
 v_mfma_f32_16x16x32_bf16 v[48:51], a[0:3], a[24:27], v[48:51]
 v_mfma_f32_16x16x32_bf16 v[52:55], a[0:3], a[28:31], v[52:55]
 s_waitcnt lgkmcnt(4)
 v_mfma_f32_16x16x32_bf16 v[68:71], a[4:7], a[28:31], v[68:71]
 ds_read_b64_tr_b16 a[0:1], v6 offset:24576
 v_mfma_f32_16x16x32_bf16 v[64:67], a[4:7], a[24:27], v[64:67]
 ds_read_b64_tr_b16 a[2:3], v6 offset:25088
 v_mfma_f32_16x16x32_bf16 v[60:63], a[4:7], a[20:23], v[60:63]
 v_mfma_f32_16x16x32_bf16 v[56:59], a[4:7], a[16:19], v[56:59]
 s_waitcnt lgkmcnt(4)
 v_mfma_f32_16x16x32_bf16 v[72:75], a[8:11], a[16:19], v[72:75]
 ds_read_b64_tr_b16 a[4:5], v7 offset:24576
 v_mfma_f32_16x16x32_bf16 v[76:79], a[8:11], a[20:23], v[76:79]
 ds_read_b64_tr_b16 a[6:7], v7 offset:25088
 v_mfma_f32_16x16x32_bf16 v[80:83], a[8:11], a[24:27], v[80:83]
 v_mfma_f32_16x16x32_bf16 v[84:87], a[8:11], a[28:31], v[84:87]
 s_waitcnt lgkmcnt(4)
 v_mfma_f32_16x16x32_bf16 v[100:103], a[12:15], a[28:31], v[100:103]
 ds_read_b64_tr_b16 a[8:9], v8 offset:24576
 v_mfma_f32_16x16x32_bf16 v[96:99], a[12:15], a[24:27], v[96:99]
 ds_read_b64_tr_b16 a[10:11], v8 offset:25088
 v_mfma_f32_16x16x32_bf16 v[92:95], a[12:15], a[20:23], v[92:95]
 ds_read_b128 a[32:35], v4 offset:52224
 v_mfma_f32_16x16x32_bf16 v[88:91], a[12:15], a[16:19], v[88:91]
 s_waitcnt lgkmcnt(5)
 v_mfma_f32_16x16x32_bf16 v[104:107], a[0:3], a[16:19], v[104:107]
 ds_read_b64_tr_b16 a[12:13], v9 offset:24576
 v_mfma_f32_16x16x32_bf16 v[108:111], a[0:3], a[20:23], v[108:111]
 ds_read_b64_tr_b16 a[14:15], v9 offset:25088
 v_mfma_f32_16x16x32_bf16 v[112:115], a[0:3], a[24:27], v[112:115]
 ds_read_b128 a[36:39], v4 offset:53248
 v_mfma_f32_16x16x32_bf16 v[116:119], a[0:3], a[28:31], v[116:119]
 s_waitcnt lgkmcnt(6)
 v_mfma_f32_16x16x32_bf16 v[132:135], a[4:7], a[28:31], v[132:135]
 ds_read_b64_tr_b16 a[0:1], v10 offset:8192
 v_mfma_f32_16x16x32_bf16 v[128:131], a[4:7], a[24:27], v[128:131]
 ds_read_b64_tr_b16 a[2:3], v10 offset:8448
 v_mfma_f32_16x16x32_bf16 v[124:127], a[4:7], a[20:23], v[124:127]
 ds_read_b128 a[40:43], v4 offset:54272
 v_mfma_f32_16x16x32_bf16 v[120:123], a[4:7], a[16:19], v[120:123]
 s_waitcnt lgkmcnt(7)
 v_mfma_f32_16x16x32_bf16 v[136:139], a[8:11], a[16:19], v[136:139]
 ds_read_b64_tr_b16 a[4:5], v10 offset:10240
 v_mfma_f32_16x16x32_bf16 v[140:143], a[8:11], a[20:23], v[140:143]
 ds_read_b64_tr_b16 a[6:7], v10 offset:10496
 v_mfma_f32_16x16x32_bf16 v[144:147], a[8:11], a[24:27], v[144:147]
 ds_read_b128 a[44:47], v4 offset:55296
 v_mfma_f32_16x16x32_bf16 v[148:151], a[8:11], a[28:31], v[148:151]
 s_waitcnt lgkmcnt(7)
 v_mfma_f32_16x16x32_bf16 v[164:167], a[12:15], a[28:31], v[164:167]
 ds_read_b64_tr_b16 a[8:9], v6 offset:12288
 v_mfma_f32_16x16x32_bf16 v[160:163], a[12:15], a[24:27], v[160:163]
 ds_read_b64_tr_b16 a[10:11], v6 offset:12800
 v_mfma_f32_16x16x32_bf16 v[156:159], a[12:15], a[20:23], v[156:159]
 v_mfma_f32_16x16x32_bf16 v[152:155], a[12:15], a[16:19], v[152:155]
 s_waitcnt lgkmcnt(6)
 v_mfma_f32_16x16x32_bf16 v[168:171], a[0:3], a[16:19], v[168:171]
 ds_read_b64_tr_b16 a[12:13], v7 offset:12288
 v_mfma_f32_16x16x32_bf16 v[172:175], a[0:3], a[20:23], v[172:175]
 ds_read_b64_tr_b16 a[14:15], v7 offset:12800
 v_mfma_f32_16x16x32_bf16 v[176:179], a[0:3], a[24:27], v[176:179]
 v_mfma_f32_16x16x32_bf16 v[180:183], a[0:3], a[28:31], v[180:183]
 s_waitcnt lgkmcnt(5)
 v_mfma_f32_16x16x32_bf16 v[196:199], a[4:7], a[28:31], v[196:199]
 ds_read_b64_tr_b16 a[0:1], v8 offset:12288
 v_mfma_f32_16x16x32_bf16 v[192:195], a[4:7], a[24:27], v[192:195]
 ds_read_b64_tr_b16 a[2:3], v8 offset:12800
 v_mfma_f32_16x16x32_bf16 v[188:191], a[4:7], a[20:23], v[188:191]
 v_mfma_f32_16x16x32_bf16 v[184:187], a[4:7], a[16:19], v[184:187]
 s_barrier
 s_waitcnt lgkmcnt(4)
 v_mfma_f32_16x16x32_bf16 v[40:43], a[8:11], a[32:35], v[40:43]
 ds_read_b64_tr_b16 a[4:5], v9 offset:12288
 v_mfma_f32_16x16x32_bf16 v[44:47], a[8:11], a[36:39], v[44:47]
 ds_read_b64_tr_b16 a[6:7], v9 offset:12800
 v_mfma_f32_16x16x32_bf16 v[48:51], a[8:11], a[40:43], v[48:51]
 v_mfma_f32_16x16x32_bf16 v[52:55], a[8:11], a[44:47], v[52:55]
 s_waitcnt lgkmcnt(4)
 v_mfma_f32_16x16x32_bf16 v[68:71], a[12:15], a[44:47], v[68:71]
 ds_read_b64_tr_b16 a[8:9], v6 offset:28672
 v_mfma_f32_16x16x32_bf16 v[64:67], a[12:15], a[40:43], v[64:67]
 ds_read_b64_tr_b16 a[10:11], v6 offset:29184
 v_mfma_f32_16x16x32_bf16 v[60:63], a[12:15], a[36:39], v[60:63]
 v_mfma_f32_16x16x32_bf16 v[56:59], a[12:15], a[32:35], v[56:59]
 s_waitcnt lgkmcnt(4)
 v_mfma_f32_16x16x32_bf16 v[72:75], a[0:3], a[32:35], v[72:75]
 ds_read_b64_tr_b16 a[12:13], v7 offset:28672
 v_mfma_f32_16x16x32_bf16 v[76:79], a[0:3], a[36:39], v[76:79]
 ds_read_b64_tr_b16 a[14:15], v7 offset:29184
 v_mfma_f32_16x16x32_bf16 v[80:83], a[0:3], a[40:43], v[80:83]
 v_mfma_f32_16x16x32_bf16 v[84:87], a[0:3], a[44:47], v[84:87]
 s_waitcnt lgkmcnt(4)
 v_mfma_f32_16x16x32_bf16 v[100:103], a[4:7], a[44:47], v[100:103]
 ds_read_b64_tr_b16 a[0:1], v8 offset:28672
 v_mfma_f32_16x16x32_bf16 v[96:99], a[4:7], a[40:43], v[96:99]
 ds_read_b64_tr_b16 a[2:3], v8 offset:29184
 v_mfma_f32_16x16x32_bf16 v[92:95], a[4:7], a[36:39], v[92:95]
 v_mfma_f32_16x16x32_bf16 v[88:91], a[4:7], a[32:35], v[88:91]
 s_waitcnt lgkmcnt(4)
 v_mfma_f32_16x16x32_bf16 v[104:107], a[8:11], a[32:35], v[104:107]
 ds_read_b64_tr_b16 a[4:5], v9 offset:28672
 v_mfma_f32_16x16x32_bf16 v[108:111], a[8:11], a[36:39], v[108:111]
 ds_read_b64_tr_b16 a[6:7], v9 offset:29184
 v_mfma_f32_16x16x32_bf16 v[112:115], a[8:11], a[40:43], v[112:115]
 v_mfma_f32_16x16x32_bf16 v[116:119], a[8:11], a[44:47], v[116:119]
 s_waitcnt lgkmcnt(4)
 v_mfma_f32_16x16x32_bf16 v[132:135], a[12:15], a[44:47], v[132:135]
 ds_read_b64_tr_b16 a[8:9], v10 offset:12288
 v_mfma_f32_16x16x32_bf16 v[128:131], a[12:15], a[40:43], v[128:131]
 ds_read_b64_tr_b16 a[10:11], v10 offset:12544
 v_mfma_f32_16x16x32_bf16 v[124:127], a[12:15], a[36:39], v[124:127]
 v_mfma_f32_16x16x32_bf16 v[120:123], a[12:15], a[32:35], v[120:123]
 s_waitcnt lgkmcnt(4)
 v_mfma_f32_16x16x32_bf16 v[136:139], a[0:3], a[32:35], v[136:139]
 ds_read_b64_tr_b16 a[12:13], v10 offset:14336
 v_mfma_f32_16x16x32_bf16 v[140:143], a[0:3], a[36:39], v[140:143]
 ds_read_b64_tr_b16 a[14:15], v10 offset:14592
 v_mfma_f32_16x16x32_bf16 v[144:147], a[0:3], a[40:43], v[144:147]
 v_mfma_f32_16x16x32_bf16 v[148:151], a[0:3], a[44:47], v[148:151]
 s_waitcnt lgkmcnt(4)
 v_mfma_f32_16x16x32_bf16 v[164:167], a[4:7], a[44:47], v[164:167]
 v_mfma_f32_16x16x32_bf16 v[160:163], a[4:7], a[40:43], v[160:163]
 v_mfma_f32_16x16x32_bf16 v[156:159], a[4:7], a[36:39], v[156:159]
 v_mfma_f32_16x16x32_bf16 v[152:155], a[4:7], a[32:35], v[152:155]
 s_waitcnt lgkmcnt(2)
 v_mfma_f32_16x16x32_bf16 v[168:171], a[8:11], a[32:35], v[168:171]
 v_mfma_f32_16x16x32_bf16 v[172:175], a[8:11], a[36:39], v[172:175]
 v_mfma_f32_16x16x32_bf16 v[176:179], a[8:11], a[40:43], v[176:179]
 v_mfma_f32_16x16x32_bf16 v[180:183], a[8:11], a[44:47], v[180:183]
 s_waitcnt lgkmcnt(0)
 v_mfma_f32_16x16x32_bf16 v[196:199], a[12:15], a[44:47], v[196:199]
 v_mfma_f32_16x16x32_bf16 v[192:195], a[12:15], a[40:43], v[192:195]
 v_mfma_f32_16x16x32_bf16 v[188:191], a[12:15], a[36:39], v[188:191]
 v_mfma_f32_16x16x32_bf16 v[184:187], a[12:15], a[32:35], v[184:187]
 s_barrier
L_k1_epiY:
 s_nop 15
 s_mov_b32 s56, 0xbdd2d3e8
 s_mov_b32 s57, 0xbdd2d3e8
 v_mov_b32 v12, 0xc0135761
 v_mov_b32 v13, 0xc0135761
 v_mov_b32 v14, 1.0
 v_mov_b32 v15, 1.0
 v_lshlrev_b32 v11, 4, v0
 s_lshl_b32 s46, s31, 3
 s_lshl_b32 s47, s29, 1
 s_add_u32 s46, s46, s47
 s_mul_i32 s48, s46, 294912
 v_pk_mul_f32 v[16:17], v[40:41], v[40:41]
 v_pk_mul_f32 v[18:19], v[42:43], v[42:43]
 v_pk_mul_f32 v[20:21], v[56:57], v[56:57]
 v_pk_mul_f32 v[22:23], v[58:59], v[58:59]
 v_pk_fma_f32 v[16:17], v[16:17], s[56:57], v[12:13]
 v_pk_fma_f32 v[18:19], v[18:19], s[56:57], v[12:13]
 v_pk_fma_f32 v[20:21], v[20:21], s[56:57], v[12:13]
 v_pk_fma_f32 v[22:23], v[22:23], s[56:57], v[12:13]
 v_pk_mul_f32 v[16:17], v[16:17], v[40:41]
 v_pk_mul_f32 v[18:19], v[18:19], v[42:43]
 v_pk_mul_f32 v[20:21], v[20:21], v[56:57]
 v_pk_mul_f32 v[22:23], v[22:23], v[58:59]
 v_exp_f32 v16, v16
 v_exp_f32 v17, v17
 v_exp_f32 v18, v18
 v_exp_f32 v19, v19
 v_exp_f32 v20, v20
 v_exp_f32 v21, v21
 v_exp_f32 v22, v22
 v_exp_f32 v23, v23
 v_pk_mul_f32 v[104:105], v[104:105], v[40:41]
 v_pk_mul_f32 v[106:107], v[106:107], v[42:43]
 v_pk_mul_f32 v[120:121], v[120:121], v[56:57]
 v_pk_mul_f32 v[122:123], v[122:123], v[58:59]
 v_pk_add_f32 v[16:17], v[16:17], v[14:15]
 v_pk_add_f32 v[18:19], v[18:19], v[14:15]
 v_pk_add_f32 v[20:21], v[20:21], v[14:15]
 v_pk_add_f32 v[22:23], v[22:23], v[14:15]
 v_rcp_f32 v16, v16
 v_rcp_f32 v17, v17
 v_rcp_f32 v18, v18
 v_rcp_f32 v19, v19
 v_rcp_f32 v20, v20
 v_rcp_f32 v21, v21
 v_rcp_f32 v22, v22
 v_rcp_f32 v23, v23
 s_nop 0
 v_pk_mul_f32 v[104:105], v[104:105], v[16:17]
 v_pk_mul_f32 v[106:107], v[106:107], v[18:19]
 v_pk_mul_f32 v[120:121], v[120:121], v[20:21]
 v_pk_mul_f32 v[122:123], v[122:123], v[22:23]
 v_cvt_pk_bf16_f32 v40, v104, v105
 v_cvt_pk_bf16_f32 v41, v106, v107
 v_cvt_pk_bf16_f32 v42, v120, v121
 v_cvt_pk_bf16_f32 v43, v122, v123
 s_add_u32 s51, s48, s70
 s_add_u32 s51, s51, 0
 buffer_store_dwordx4 v[40:43], v11, s[24:27], s51 offen sc1
 v_pk_mul_f32 v[16:17], v[44:45], v[44:45]
 v_pk_mul_f32 v[18:19], v[46:47], v[46:47]
 v_pk_mul_f32 v[20:21], v[60:61], v[60:61]
 v_pk_mul_f32 v[22:23], v[62:63], v[62:63]
 v_pk_fma_f32 v[16:17], v[16:17], s[56:57], v[12:13]
 v_pk_fma_f32 v[18:19], v[18:19], s[56:57], v[12:13]
 v_pk_fma_f32 v[20:21], v[20:21], s[56:57], v[12:13]
 v_pk_fma_f32 v[22:23], v[22:23], s[56:57], v[12:13]
 v_pk_mul_f32 v[16:17], v[16:17], v[44:45]
 v_pk_mul_f32 v[18:19], v[18:19], v[46:47]
 v_pk_mul_f32 v[20:21], v[20:21], v[60:61]
 v_pk_mul_f32 v[22:23], v[22:23], v[62:63]
 v_exp_f32 v16, v16
 v_exp_f32 v17, v17
 v_exp_f32 v18, v18
 v_exp_f32 v19, v19
 v_exp_f32 v20, v20
 v_exp_f32 v21, v21
 v_exp_f32 v22, v22
 v_exp_f32 v23, v23
 v_pk_mul_f32 v[108:109], v[108:109], v[44:45]
 v_pk_mul_f32 v[110:111], v[110:111], v[46:47]
 v_pk_mul_f32 v[124:125], v[124:125], v[60:61]
 v_pk_mul_f32 v[126:127], v[126:127], v[62:63]
 v_pk_add_f32 v[16:17], v[16:17], v[14:15]
 v_pk_add_f32 v[18:19], v[18:19], v[14:15]
 v_pk_add_f32 v[20:21], v[20:21], v[14:15]
 v_pk_add_f32 v[22:23], v[22:23], v[14:15]
 v_rcp_f32 v16, v16
 v_rcp_f32 v17, v17
 v_rcp_f32 v18, v18
 v_rcp_f32 v19, v19
 v_rcp_f32 v20, v20
 v_rcp_f32 v21, v21
 v_rcp_f32 v22, v22
 v_rcp_f32 v23, v23
 s_nop 0
 v_pk_mul_f32 v[108:109], v[108:109], v[16:17]
 v_pk_mul_f32 v[110:111], v[110:111], v[18:19]
 v_pk_mul_f32 v[124:125], v[124:125], v[20:21]
 v_pk_mul_f32 v[126:127], v[126:127], v[22:23]
 v_cvt_pk_bf16_f32 v44, v108, v109
 v_cvt_pk_bf16_f32 v45, v110, v111
 v_cvt_pk_bf16_f32 v46, v124, v125
 v_cvt_pk_bf16_f32 v47, v126, v127
 s_add_u32 s51, s48, s70
 s_add_u32 s51, s51, 1024
 buffer_store_dwordx4 v[44:47], v11, s[24:27], s51 offen sc1
 v_pk_mul_f32 v[16:17], v[48:49], v[48:49]
 v_pk_mul_f32 v[18:19], v[50:51], v[50:51]
 v_pk_mul_f32 v[20:21], v[64:65], v[64:65]
 v_pk_mul_f32 v[22:23], v[66:67], v[66:67]
 v_pk_fma_f32 v[16:17], v[16:17], s[56:57], v[12:13]
 v_pk_fma_f32 v[18:19], v[18:19], s[56:57], v[12:13]
 v_pk_fma_f32 v[20:21], v[20:21], s[56:57], v[12:13]
 v_pk_fma_f32 v[22:23], v[22:23], s[56:57], v[12:13]
 v_pk_mul_f32 v[16:17], v[16:17], v[48:49]
 v_pk_mul_f32 v[18:19], v[18:19], v[50:51]
 v_pk_mul_f32 v[20:21], v[20:21], v[64:65]
 v_pk_mul_f32 v[22:23], v[22:23], v[66:67]
 v_exp_f32 v16, v16
 v_exp_f32 v17, v17
 v_exp_f32 v18, v18
 v_exp_f32 v19, v19
 v_exp_f32 v20, v20
 v_exp_f32 v21, v21
 v_exp_f32 v22, v22
 v_exp_f32 v23, v23
 v_pk_mul_f32 v[112:113], v[112:113], v[48:49]
 v_pk_mul_f32 v[114:115], v[114:115], v[50:51]
 v_pk_mul_f32 v[128:129], v[128:129], v[64:65]
 v_pk_mul_f32 v[130:131], v[130:131], v[66:67]
 v_pk_add_f32 v[16:17], v[16:17], v[14:15]
 v_pk_add_f32 v[18:19], v[18:19], v[14:15]
 v_pk_add_f32 v[20:21], v[20:21], v[14:15]
 v_pk_add_f32 v[22:23], v[22:23], v[14:15]
 v_rcp_f32 v16, v16
 v_rcp_f32 v17, v17
 v_rcp_f32 v18, v18
 v_rcp_f32 v19, v19
 v_rcp_f32 v20, v20
 v_rcp_f32 v21, v21
 v_rcp_f32 v22, v22
 v_rcp_f32 v23, v23
 s_nop 0
 v_pk_mul_f32 v[112:113], v[112:113], v[16:17]
 v_pk_mul_f32 v[114:115], v[114:115], v[18:19]
 v_pk_mul_f32 v[128:129], v[128:129], v[20:21]
 v_pk_mul_f32 v[130:131], v[130:131], v[22:23]
 v_cvt_pk_bf16_f32 v48, v112, v113
 v_cvt_pk_bf16_f32 v49, v114, v115
 v_cvt_pk_bf16_f32 v50, v128, v129
 v_cvt_pk_bf16_f32 v51, v130, v131
 s_add_u32 s51, s48, s70
 s_add_u32 s51, s51, 294912
 buffer_store_dwordx4 v[48:51], v11, s[24:27], s51 offen sc1
 v_pk_mul_f32 v[16:17], v[52:53], v[52:53]
 v_pk_mul_f32 v[18:19], v[54:55], v[54:55]
 v_pk_mul_f32 v[20:21], v[68:69], v[68:69]
 v_pk_mul_f32 v[22:23], v[70:71], v[70:71]
 v_pk_fma_f32 v[16:17], v[16:17], s[56:57], v[12:13]
 v_pk_fma_f32 v[18:19], v[18:19], s[56:57], v[12:13]
 v_pk_fma_f32 v[20:21], v[20:21], s[56:57], v[12:13]
 v_pk_fma_f32 v[22:23], v[22:23], s[56:57], v[12:13]
 v_pk_mul_f32 v[16:17], v[16:17], v[52:53]
 v_pk_mul_f32 v[18:19], v[18:19], v[54:55]
 v_pk_mul_f32 v[20:21], v[20:21], v[68:69]
 v_pk_mul_f32 v[22:23], v[22:23], v[70:71]
 v_exp_f32 v16, v16
 v_exp_f32 v17, v17
 v_exp_f32 v18, v18
 v_exp_f32 v19, v19
 v_exp_f32 v20, v20
 v_exp_f32 v21, v21
 v_exp_f32 v22, v22
 v_exp_f32 v23, v23
 v_pk_mul_f32 v[116:117], v[116:117], v[52:53]
 v_pk_mul_f32 v[118:119], v[118:119], v[54:55]
 v_pk_mul_f32 v[132:133], v[132:133], v[68:69]
 v_pk_mul_f32 v[134:135], v[134:135], v[70:71]
 v_pk_add_f32 v[16:17], v[16:17], v[14:15]
 v_pk_add_f32 v[18:19], v[18:19], v[14:15]
 v_pk_add_f32 v[20:21], v[20:21], v[14:15]
 v_pk_add_f32 v[22:23], v[22:23], v[14:15]
 v_rcp_f32 v16, v16
 v_rcp_f32 v17, v17
 v_rcp_f32 v18, v18
 v_rcp_f32 v19, v19
 v_rcp_f32 v20, v20
 v_rcp_f32 v21, v21
 v_rcp_f32 v22, v22
 v_rcp_f32 v23, v23
 s_nop 0
 v_pk_mul_f32 v[116:117], v[116:117], v[16:17]
 v_pk_mul_f32 v[118:119], v[118:119], v[18:19]
 v_pk_mul_f32 v[132:133], v[132:133], v[20:21]
 v_pk_mul_f32 v[134:135], v[134:135], v[22:23]
 v_cvt_pk_bf16_f32 v52, v116, v117
 v_cvt_pk_bf16_f32 v53, v118, v119
 v_cvt_pk_bf16_f32 v54, v132, v133
 v_cvt_pk_bf16_f32 v55, v134, v135
 s_add_u32 s51, s48, s70
 s_add_u32 s51, s51, 295936
 buffer_store_dwordx4 v[52:55], v11, s[24:27], s51 offen sc1
 v_pk_mul_f32 v[16:17], v[72:73], v[72:73]
 v_pk_mul_f32 v[18:19], v[74:75], v[74:75]
 v_pk_mul_f32 v[20:21], v[88:89], v[88:89]
 v_pk_mul_f32 v[22:23], v[90:91], v[90:91]
 v_pk_fma_f32 v[16:17], v[16:17], s[56:57], v[12:13]
 v_pk_fma_f32 v[18:19], v[18:19], s[56:57], v[12:13]
 v_pk_fma_f32 v[20:21], v[20:21], s[56:57], v[12:13]
 v_pk_fma_f32 v[22:23], v[22:23], s[56:57], v[12:13]
 v_pk_mul_f32 v[16:17], v[16:17], v[72:73]
 v_pk_mul_f32 v[18:19], v[18:19], v[74:75]
 v_pk_mul_f32 v[20:21], v[20:21], v[88:89]
 v_pk_mul_f32 v[22:23], v[22:23], v[90:91]
 v_exp_f32 v16, v16
 v_exp_f32 v17, v17
 v_exp_f32 v18, v18
 v_exp_f32 v19, v19
 v_exp_f32 v20, v20
 v_exp_f32 v21, v21
 v_exp_f32 v22, v22
 v_exp_f32 v23, v23
 v_pk_mul_f32 v[136:137], v[136:137], v[72:73]
 v_pk_mul_f32 v[138:139], v[138:139], v[74:75]
 v_pk_mul_f32 v[152:153], v[152:153], v[88:89]
 v_pk_mul_f32 v[154:155], v[154:155], v[90:91]
 v_pk_add_f32 v[16:17], v[16:17], v[14:15]
 v_pk_add_f32 v[18:19], v[18:19], v[14:15]
 v_pk_add_f32 v[20:21], v[20:21], v[14:15]
 v_pk_add_f32 v[22:23], v[22:23], v[14:15]
 v_rcp_f32 v16, v16
 v_rcp_f32 v17, v17
 v_rcp_f32 v18, v18
 v_rcp_f32 v19, v19
 v_rcp_f32 v20, v20
 v_rcp_f32 v21, v21
 v_rcp_f32 v22, v22
 v_rcp_f32 v23, v23
 s_nop 0
 v_pk_mul_f32 v[136:137], v[136:137], v[16:17]
 v_pk_mul_f32 v[138:139], v[138:139], v[18:19]
 v_pk_mul_f32 v[152:153], v[152:153], v[20:21]
 v_pk_mul_f32 v[154:155], v[154:155], v[22:23]
 v_cvt_pk_bf16_f32 v72, v136, v137
 v_cvt_pk_bf16_f32 v73, v138, v139
 v_cvt_pk_bf16_f32 v74, v152, v153
 v_cvt_pk_bf16_f32 v75, v154, v155
 s_add_u32 s51, s48, s70
 s_add_u32 s51, s51, 2048
 buffer_store_dwordx4 v[72:75], v11, s[24:27], s51 offen sc1
 v_pk_mul_f32 v[16:17], v[76:77], v[76:77]
 v_pk_mul_f32 v[18:19], v[78:79], v[78:79]
 v_pk_mul_f32 v[20:21], v[92:93], v[92:93]
 v_pk_mul_f32 v[22:23], v[94:95], v[94:95]
 v_pk_fma_f32 v[16:17], v[16:17], s[56:57], v[12:13]
 v_pk_fma_f32 v[18:19], v[18:19], s[56:57], v[12:13]
 v_pk_fma_f32 v[20:21], v[20:21], s[56:57], v[12:13]
 v_pk_fma_f32 v[22:23], v[22:23], s[56:57], v[12:13]
 v_pk_mul_f32 v[16:17], v[16:17], v[76:77]
 v_pk_mul_f32 v[18:19], v[18:19], v[78:79]
 v_pk_mul_f32 v[20:21], v[20:21], v[92:93]
 v_pk_mul_f32 v[22:23], v[22:23], v[94:95]
 v_exp_f32 v16, v16
 v_exp_f32 v17, v17
 v_exp_f32 v18, v18
 v_exp_f32 v19, v19
 v_exp_f32 v20, v20
 v_exp_f32 v21, v21
 v_exp_f32 v22, v22
 v_exp_f32 v23, v23
 v_pk_mul_f32 v[140:141], v[140:141], v[76:77]
 v_pk_mul_f32 v[142:143], v[142:143], v[78:79]
 v_pk_mul_f32 v[156:157], v[156:157], v[92:93]
 v_pk_mul_f32 v[158:159], v[158:159], v[94:95]
 v_pk_add_f32 v[16:17], v[16:17], v[14:15]
 v_pk_add_f32 v[18:19], v[18:19], v[14:15]
 v_pk_add_f32 v[20:21], v[20:21], v[14:15]
 v_pk_add_f32 v[22:23], v[22:23], v[14:15]
 v_rcp_f32 v16, v16
 v_rcp_f32 v17, v17
 v_rcp_f32 v18, v18
 v_rcp_f32 v19, v19
 v_rcp_f32 v20, v20
 v_rcp_f32 v21, v21
 v_rcp_f32 v22, v22
 v_rcp_f32 v23, v23
 s_nop 0
 v_pk_mul_f32 v[140:141], v[140:141], v[16:17]
 v_pk_mul_f32 v[142:143], v[142:143], v[18:19]
 v_pk_mul_f32 v[156:157], v[156:157], v[20:21]
 v_pk_mul_f32 v[158:159], v[158:159], v[22:23]
 v_cvt_pk_bf16_f32 v76, v140, v141
 v_cvt_pk_bf16_f32 v77, v142, v143
 v_cvt_pk_bf16_f32 v78, v156, v157
 v_cvt_pk_bf16_f32 v79, v158, v159
 s_add_u32 s51, s48, s70
 s_add_u32 s51, s51, 3072
 buffer_store_dwordx4 v[76:79], v11, s[24:27], s51 offen sc1
 s_waitcnt vmcnt(2)
 s_barrier
 s_cmp_lg_u32 s28, 0
 s_cbranch_scc1 L_arr_41
 s_lshl_b32 s46, s31, 5
 s_add_u32 s46, s46, 16
 v_mov_b32 v27, s46
 v_mov_b32 v28, 1
 v_cmp_eq_u32 vcc, 0, v0
 s_and_saveexec_b64 s[46:47], vcc
 buffer_atomic_add v28, v27, s[96:99], 0 offen sc1
 s_mov_b64 exec, s[46:47]
L_arr_41:
 v_pk_mul_f32 v[16:17], v[80:81], v[80:81]
 v_pk_mul_f32 v[18:19], v[82:83], v[82:83]
 v_pk_mul_f32 v[20:21], v[96:97], v[96:97]
 v_pk_mul_f32 v[22:23], v[98:99], v[98:99]
 v_pk_fma_f32 v[16:17], v[16:17], s[56:57], v[12:13]
 v_pk_fma_f32 v[18:19], v[18:19], s[56:57], v[12:13]
 v_pk_fma_f32 v[20:21], v[20:21], s[56:57], v[12:13]
 v_pk_fma_f32 v[22:23], v[22:23], s[56:57], v[12:13]
 v_pk_mul_f32 v[16:17], v[16:17], v[80:81]
 v_pk_mul_f32 v[18:19], v[18:19], v[82:83]
 v_pk_mul_f32 v[20:21], v[20:21], v[96:97]
 v_pk_mul_f32 v[22:23], v[22:23], v[98:99]
 v_exp_f32 v16, v16
 v_exp_f32 v17, v17
 v_exp_f32 v18, v18
 v_exp_f32 v19, v19
 v_exp_f32 v20, v20
 v_exp_f32 v21, v21
 v_exp_f32 v22, v22
 v_exp_f32 v23, v23
 v_pk_mul_f32 v[144:145], v[144:145], v[80:81]
 v_pk_mul_f32 v[146:147], v[146:147], v[82:83]
 v_pk_mul_f32 v[160:161], v[160:161], v[96:97]
 v_pk_mul_f32 v[162:163], v[162:163], v[98:99]
 v_pk_add_f32 v[16:17], v[16:17], v[14:15]
 v_pk_add_f32 v[18:19], v[18:19], v[14:15]
 v_pk_add_f32 v[20:21], v[20:21], v[14:15]
 v_pk_add_f32 v[22:23], v[22:23], v[14:15]
 v_rcp_f32 v16, v16
 v_rcp_f32 v17, v17
 v_rcp_f32 v18, v18
 v_rcp_f32 v19, v19
 v_rcp_f32 v20, v20
 v_rcp_f32 v21, v21
 v_rcp_f32 v22, v22
 v_rcp_f32 v23, v23
 s_nop 0
 v_pk_mul_f32 v[144:145], v[144:145], v[16:17]
 v_pk_mul_f32 v[146:147], v[146:147], v[18:19]
 v_pk_mul_f32 v[160:161], v[160:161], v[20:21]
 v_pk_mul_f32 v[162:163], v[162:163], v[22:23]
 v_cvt_pk_bf16_f32 v80, v144, v145
 v_cvt_pk_bf16_f32 v81, v146, v147
 v_cvt_pk_bf16_f32 v82, v160, v161
 v_cvt_pk_bf16_f32 v83, v162, v163
 s_add_u32 s51, s48, s70
 s_add_u32 s51, s51, 296960
 buffer_store_dwordx4 v[80:83], v11, s[24:27], s51 offen sc1
 v_pk_mul_f32 v[16:17], v[84:85], v[84:85]
 v_pk_mul_f32 v[18:19], v[86:87], v[86:87]
 v_pk_mul_f32 v[20:21], v[100:101], v[100:101]
 v_pk_mul_f32 v[22:23], v[102:103], v[102:103]
 v_pk_fma_f32 v[16:17], v[16:17], s[56:57], v[12:13]
 v_pk_fma_f32 v[18:19], v[18:19], s[56:57], v[12:13]
 v_pk_fma_f32 v[20:21], v[20:21], s[56:57], v[12:13]
 v_pk_fma_f32 v[22:23], v[22:23], s[56:57], v[12:13]
 v_pk_mul_f32 v[16:17], v[16:17], v[84:85]
 v_pk_mul_f32 v[18:19], v[18:19], v[86:87]
 v_pk_mul_f32 v[20:21], v[20:21], v[100:101]
 v_pk_mul_f32 v[22:23], v[22:23], v[102:103]
 v_exp_f32 v16, v16
 v_exp_f32 v17, v17
 v_exp_f32 v18, v18
 v_exp_f32 v19, v19
 v_exp_f32 v20, v20
 v_exp_f32 v21, v21
 v_exp_f32 v22, v22
 v_exp_f32 v23, v23
 v_pk_mul_f32 v[148:149], v[148:149], v[84:85]
 v_pk_mul_f32 v[150:151], v[150:151], v[86:87]
 v_pk_mul_f32 v[164:165], v[164:165], v[100:101]
 v_pk_mul_f32 v[166:167], v[166:167], v[102:103]
 v_pk_add_f32 v[16:17], v[16:17], v[14:15]
 v_pk_add_f32 v[18:19], v[18:19], v[14:15]
 v_pk_add_f32 v[20:21], v[20:21], v[14:15]
 v_pk_add_f32 v[22:23], v[22:23], v[14:15]
 v_rcp_f32 v16, v16
 v_rcp_f32 v17, v17
 v_rcp_f32 v18, v18
 v_rcp_f32 v19, v19
 v_rcp_f32 v20, v20
 v_rcp_f32 v21, v21
 v_rcp_f32 v22, v22
 v_rcp_f32 v23, v23
 s_nop 0
 v_pk_mul_f32 v[148:149], v[148:149], v[16:17]
 v_pk_mul_f32 v[150:151], v[150:151], v[18:19]
 v_pk_mul_f32 v[164:165], v[164:165], v[20:21]
 v_pk_mul_f32 v[166:167], v[166:167], v[22:23]
 v_cvt_pk_bf16_f32 v84, v148, v149
 v_cvt_pk_bf16_f32 v85, v150, v151
 v_cvt_pk_bf16_f32 v86, v164, v165
 v_cvt_pk_bf16_f32 v87, v166, v167
 s_add_u32 s51, s48, s70
 s_add_u32 s51, s51, 297984
 buffer_store_dwordx4 v[84:87], v11, s[24:27], s51 offen sc1
 v_pk_mul_f32 v[16:17], v[168:169], v[168:169]
 v_pk_mul_f32 v[18:19], v[170:171], v[170:171]
 v_pk_mul_f32 v[20:21], v[172:173], v[172:173]
 v_pk_mul_f32 v[22:23], v[174:175], v[174:175]
 v_pk_fma_f32 v[16:17], v[16:17], s[56:57], v[12:13]
 v_pk_fma_f32 v[18:19], v[18:19], s[56:57], v[12:13]
 v_pk_fma_f32 v[20:21], v[20:21], s[56:57], v[12:13]
 v_pk_fma_f32 v[22:23], v[22:23], s[56:57], v[12:13]
 v_pk_mul_f32 v[16:17], v[16:17], v[168:169]
 v_pk_mul_f32 v[18:19], v[18:19], v[170:171]
 v_pk_mul_f32 v[20:21], v[20:21], v[172:173]
 v_pk_mul_f32 v[22:23], v[22:23], v[174:175]
 v_exp_f32 v16, v16
 v_exp_f32 v17, v17
 v_exp_f32 v18, v18
 v_exp_f32 v19, v19
 v_exp_f32 v20, v20
 v_exp_f32 v21, v21
 v_exp_f32 v22, v22
 v_exp_f32 v23, v23
 v_pk_mul_f32 v[184:185], v[184:185], v[168:169]
 v_pk_mul_f32 v[186:187], v[186:187], v[170:171]
 v_pk_mul_f32 v[188:189], v[188:189], v[172:173]
 v_pk_mul_f32 v[190:191], v[190:191], v[174:175]
 v_pk_add_f32 v[16:17], v[16:17], v[14:15]
 v_pk_add_f32 v[18:19], v[18:19], v[14:15]
 v_pk_add_f32 v[20:21], v[20:21], v[14:15]
 v_pk_add_f32 v[22:23], v[22:23], v[14:15]
 v_rcp_f32 v16, v16
 v_rcp_f32 v17, v17
 v_rcp_f32 v18, v18
 v_rcp_f32 v19, v19
 v_rcp_f32 v20, v20
 v_rcp_f32 v21, v21
 v_rcp_f32 v22, v22
 v_rcp_f32 v23, v23
 s_nop 0
 v_pk_mul_f32 v[184:185], v[184:185], v[16:17]
 v_pk_mul_f32 v[186:187], v[186:187], v[18:19]
 v_pk_mul_f32 v[188:189], v[188:189], v[20:21]
 v_pk_mul_f32 v[190:191], v[190:191], v[22:23]
 v_cvt_pk_bf16_f32 v168, v184, v185
 v_cvt_pk_bf16_f32 v169, v186, v187
 v_cvt_pk_bf16_f32 v170, v188, v189
 v_cvt_pk_bf16_f32 v171, v190, v191
 v_pk_mul_f32 v[16:17], v[176:177], v[176:177]
 v_pk_mul_f32 v[18:19], v[178:179], v[178:179]
 v_pk_mul_f32 v[20:21], v[180:181], v[180:181]
 v_pk_mul_f32 v[22:23], v[182:183], v[182:183]
 v_pk_fma_f32 v[16:17], v[16:17], s[56:57], v[12:13]
 v_pk_fma_f32 v[18:19], v[18:19], s[56:57], v[12:13]
 v_pk_fma_f32 v[20:21], v[20:21], s[56:57], v[12:13]
 v_pk_fma_f32 v[22:23], v[22:23], s[56:57], v[12:13]
 v_pk_mul_f32 v[16:17], v[16:17], v[176:177]
 v_pk_mul_f32 v[18:19], v[18:19], v[178:179]
 v_pk_mul_f32 v[20:21], v[20:21], v[180:181]
 v_pk_mul_f32 v[22:23], v[22:23], v[182:183]
 v_exp_f32 v16, v16
 v_exp_f32 v17, v17
 v_exp_f32 v18, v18
 v_exp_f32 v19, v19
 v_exp_f32 v20, v20
 v_exp_f32 v21, v21
 v_exp_f32 v22, v22
 v_exp_f32 v23, v23
 v_pk_mul_f32 v[192:193], v[192:193], v[176:177]
 v_pk_mul_f32 v[194:195], v[194:195], v[178:179]
 v_pk_mul_f32 v[196:197], v[196:197], v[180:181]
 v_pk_mul_f32 v[198:199], v[198:199], v[182:183]
 v_pk_add_f32 v[16:17], v[16:17], v[14:15]
 v_pk_add_f32 v[18:19], v[18:19], v[14:15]
 v_pk_add_f32 v[20:21], v[20:21], v[14:15]
 v_pk_add_f32 v[22:23], v[22:23], v[14:15]
 v_rcp_f32 v16, v16
 v_rcp_f32 v17, v17
 v_rcp_f32 v18, v18
 v_rcp_f32 v19, v19
 v_rcp_f32 v20, v20
 v_rcp_f32 v21, v21
 v_rcp_f32 v22, v22
 v_rcp_f32 v23, v23
 s_nop 0
 v_pk_mul_f32 v[192:193], v[192:193], v[16:17]
 v_pk_mul_f32 v[194:195], v[194:195], v[18:19]
 v_pk_mul_f32 v[196:197], v[196:197], v[20:21]
 v_pk_mul_f32 v[198:199], v[198:199], v[22:23]
 v_cvt_pk_bf16_f32 v176, v192, v193
 v_cvt_pk_bf16_f32 v177, v194, v195
 v_cvt_pk_bf16_f32 v178, v196, v197
 v_cvt_pk_bf16_f32 v179, v198, v199
 s_lshl_b32 s52, s29, 1
 s_add_u32 s52, s52, s30
 s_lshl_b32 s52, s52, 10
 v_add_u32 v16, s52, v11
 s_cmp_eq_u32 s30, 0
 s_cbranch_scc1 L_k1_hx0
 ds_write_b128 v16, v[168:171]
 v_mov_b32 v20, v176
 v_mov_b32 v21, v177
 v_mov_b32 v22, v178
 v_mov_b32 v23, v179
 s_branch L_k1_hx1
L_k1_hx0:
 ds_write_b128 v16, v[176:179]
 v_mov_b32 v20, v168
 v_mov_b32 v21, v169
 v_mov_b32 v22, v170
 v_mov_b32 v23, v171
L_k1_hx1:
 s_waitcnt lgkmcnt(0)
 s_barrier
 v_xor_b32 v16, 1024, v16
 ds_read_b128 v[24:27], v16
 s_mul_i32 s52, s30, 294912
 s_add_u32 s52, s52, s48
 s_add_u32 s52, s52, s71
 s_waitcnt lgkmcnt(0)
 s_cmp_eq_u32 s30, 0
 s_cbranch_scc1 L_k1_hx2
 v_mov_b32 v192, v24
 v_mov_b32 v193, v25
 v_mov_b32 v194, v20
 v_mov_b32 v195, v21
 s_add_u32 s51, s52, 0
 buffer_store_dwordx4 v[192:195], v11, s[24:27], s51 offen sc1
 v_mov_b32 v196, v26
 v_mov_b32 v197, v27
 v_mov_b32 v198, v22
 v_mov_b32 v199, v23
 s_add_u32 s51, s52, 1024
 buffer_store_dwordx4 v[196:199], v11, s[24:27], s51 offen sc1
 s_branch L_k1_hx3
L_k1_hx2:
 v_mov_b32 v192, v20
 v_mov_b32 v193, v21
 v_mov_b32 v194, v24
 v_mov_b32 v195, v25
 s_add_u32 s51, s52, 0
 buffer_store_dwordx4 v[192:195], v11, s[24:27], s51 offen sc1
 v_mov_b32 v196, v22
 v_mov_b32 v197, v23
 v_mov_b32 v198, v26
 v_mov_b32 v199, v27
 s_add_u32 s51, s52, 1024
 buffer_store_dwordx4 v[196:199], v11, s[24:27], s51 offen sc1
L_k1_hx3:
 v_lshrrev_b32 v12, 3, v0
 v_bfe_u32 v13, v0, 1, 2
 v_bfe_u32 v14, v12, 1, 2
 v_xor_b32 v13, v13, v14
 s_and_b32 s56, s28, 1
 s_lshl_b32 s56, s56, 4
 v_add_u32 v12, s56, v12
 v_lshlrev_b32 v12, 11, v12
 v_lshl_add_u32 v12, v13, 5, v12
 v_and_b32 v13, 1, v0
 v_lshl_add_u32 v12, v13, 4, v12
 s_lshl_b32 s56, s33, 8
 s_lshl_b32 s57, s30, 7
 s_add_u32 s56, s56, s57
 v_add_u32 v2, s56, v12
 s_bfe_u32 s56, s28, 0x10001
 s_lshl_b32 s57, s34, 4
 s_add_u32 s57, s57, s56
 s_lshl_b32 s35, s57, 16
 s_mul_i32 s57, s34, 40
 s_add_u32 s57, s57, s56
 s_add_u32 s58, s57, 36
 s_lshl_b32 s44, s58, 16
 s_add_u32 s57, s57, s56
 s_add_u32 s57, s57, 32
 s_lshl_b32 s36, s57, 16
 s_mul_i32 s56, s30, 40960
 s_lshl_b32 s57, s29, 11
 s_add_u32 s56, s56, s57
 s_add_u32 s38, s56, 81920
 s_add_u32 s92, s35, 0
 s_add_u32 m0, s38, 0
 s_nop 0
 buffer_load_dwordx4 v2, s[16:19], s92 offen lds
 s_add_u32 s92, s35, 16384
 s_add_u32 m0, s38, 1024
 s_nop 0
 buffer_load_dwordx4 v2, s[16:19], s92 offen lds
 s_add_u32 s92, s35, 131072
 s_add_u32 m0, s38, 8192
 s_nop 0
 buffer_load_dwordx4 v2, s[16:19], s92 offen lds
 s_add_u32 s92, s35, 147456
 s_add_u32 m0, s38, 9216
 s_nop 0
 buffer_load_dwordx4 v2, s[16:19], s92 offen lds
 s_add_u32 s92, s35, 262144
 s_add_u32 m0, s38, 16384
 s_nop 0
 buffer_load_dwordx4 v2, s[16:19], s92 offen lds
 s_add_u32 s92, s35, 278528
 s_add_u32 m0, s38, 17408
 s_nop 0
 buffer_load_dwordx4 v2, s[16:19], s92 offen lds
 s_add_u32 s92, s35, 393216
 s_add_u32 m0, s38, 24576
 s_nop 0
 buffer_load_dwordx4 v2, s[16:19], s92 offen lds
 s_add_u32 s92, s35, 409600
 s_add_u32 m0, s38, 25600
 s_nop 0
 buffer_load_dwordx4 v2, s[16:19], s92 offen lds
 s_add_u32 s92, s35, 524288
 s_add_u32 m0, s38, 32768
 s_nop 0
 buffer_load_dwordx4 v2, s[16:19], s92 offen lds
 s_add_u32 s92, s35, 540672
 s_add_u32 m0, s38, 33792
 s_nop 0
 buffer_load_dwordx4 v2, s[16:19], s92 offen lds
L_k1_fin:
 s_lshl_b32 s56, s39, 2
 s_lshr_b32 s57, s28, 1
 s_add_u32 s56, s56, s57
 s_mul_i32 s56, s56, 294912
 v_lshlrev_b32 v10, 4, v0
 v_add_u32 v1, s56, v10
 s_and_b32 s56, s28, 1
 s_lshl_b32 s57, s34, 4
 s_add_u32 s57, s57, s56
 s_lshl_b32 s87, s57, 11
 s_add_u32 s57, s57, 32
 s_lshl_b32 s84, s57, 11
 s_mul_i32 s57, s34, 40
 s_add_u32 s57, s57, s56
 s_add_u32 s58, s57, 68
 s_lshl_b32 s86, s58, 11
 s_add_u32 s57, s57, s56
 s_add_u32 s57, s57, 64
 s_lshl_b32 s85, s57, 11
 s_lshr_b32 s56, s28, 1
 s_lshl_b32 s56, s56, 12
 s_and_b32 s57, s28, 1
 s_lshl_b32 s57, s57, 11
 s_add_u32 s37, s56, s57
 s_bfe_u32 s56, s28, 0x10001
 s_lshl_b32 s56, s56, 13
 s_lshl_b32 s57, s30, 11
 s_add_u32 s56, s56, s57
 v_add_u32 v3, s56, v10
 v_add_u32 v4, 49152, v3
 v_lshrrev_b32 v11, 5, v0
 v_lshlrev_b32 v12, 10, v11
 v_bfe_u32 v13, v0, 4, 1
 v_bfe_u32 v14, v0, 2, 2
 v_lshl_add_u32 v15, v13, 2, v14
 v_lshl_add_u32 v12, v15, 7, v12
 v_and_b32 v16, 3, v0
 v_lshl_add_u32 v12, v16, 3, v12
 s_and_b32 s56, s28, 1
 s_mul_i32 s56, s56, 40960
 s_lshl_b32 s57, s30, 12
 s_add_u32 s56, s56, s57
 s_add_u32 s56, s56, 81920
 v_add_u32 v12, s56, v12
 v_lshrrev_b32 v15, 1, v15
 v_xor_b32 v16, 0, v15
 v_lshl_add_u32 v5, v16, 5, v12
 v_xor_b32 v16, 1, v15
 v_lshl_add_u32 v6, v16, 5, v12
 v_xor_b32 v16, 2, v15
 v_lshl_add_u32 v7, v16, 5, v12
 v_xor_b32 v16, 3, v15
 v_lshl_add_u32 v8, v16, 5, v12
 s_lshl_b32 s56, s94, 5
 s_add_u32 s56, s56, 20
 v_mov_b32 v29, s56
 s_cmp_lg_u32 s28, 0
 s_cbranch_scc1 L_wd_42
 s_lshl_b32 s46, s94, 5
 s_add_u32 s46, s46, 16
 s_mov_b32 s47, s46
 v_mov_b32 v27, s47
 v_mov_b32 v28, s46
 v_cmp_eq_u32 vcc, 0, v0
 s_nop 1
 v_cndmask_b32 v27, v27, v28, vcc
 s_mov_b32 s48, 0
L_wp_43:
 buffer_load_dword v28, v27, s[96:99], 0 offen sc1
 s_waitcnt vmcnt(0)
 v_cmp_gt_u32 vcc, 32, v28
 s_add_u32 s48, s48, 1
 s_cbranch_vccz L_wd_42
 s_cmp_lt_u32 s48, 0x20000
 s_cbranch_scc0 L_wd_42
 s_sleep 8
 s_branch L_wp_43
L_wd_42:
 s_barrier
 s_add_u32 s91, s84, 0
 s_add_u32 m0, s37, 0
 s_nop 0
 buffer_load_dwordx4 v1, s[24:27], s91 offen sc1 lds
 buffer_load_dwordx4 v1, s[24:27], s91 offen offset:1024 sc1 lds
 s_add_u32 s91, s84, 4096
 s_add_u32 m0, s37, 16384
 s_nop 0
 buffer_load_dwordx4 v1, s[24:27], s91 offen sc1 lds
 buffer_load_dwordx4 v1, s[24:27], s91 offen offset:1024 sc1 lds
 s_add_u32 s91, s84, 8192
 s_add_u32 m0, s37, 32768
 s_nop 0
 buffer_load_dwordx4 v1, s[24:27], s91 offen sc1 lds
 buffer_load_dwordx4 v1, s[24:27], s91 offen offset:1024 sc1 lds
 s_add_u32 s91, s84, 12288
 s_add_u32 m0, s37, 49152
 s_nop 0
 buffer_load_dwordx4 v1, s[24:27], s91 offen sc1 lds
 buffer_load_dwordx4 v1, s[24:27], s91 offen offset:1024 sc1 lds
 s_add_u32 s91, s84, 16384
 s_add_u32 m0, s37, 65536
 s_nop 0
 buffer_load_dwordx4 v1, s[24:27], s91 offen sc1 lds
 buffer_load_dwordx4 v1, s[24:27], s91 offen offset:1024 sc1 lds
 s_waitcnt vmcnt(8)
 s_barrier
 s_cmp_lg_u32 s28, 0
 s_cbranch_scc1 L_arr_44
 s_lshl_b32 s46, s31, 5
 s_add_u32 s46, s46, 20
 v_mov_b32 v27, s46
 v_mov_b32 v28, 1
 v_cmp_eq_u32 vcc, 0, v0
 s_and_saveexec_b64 s[46:47], vcc
 buffer_atomic_add v28, v27, s[96:99], 0 offen sc1
 s_mov_b64 exec, s[46:47]
L_arr_44:
 ds_read_b128 v[128:131], v3 offset:0
 ds_read_b64_tr_b16 a[0:1], v5 offset:0
 ds_read_b64_tr_b16 a[2:3], v5 offset:2048
 ds_read_b128 v[132:135], v3 offset:1024
 ds_read_b128 v[136:139], v3 offset:4096
 ds_read_b128 v[140:143], v3 offset:5120
 ds_read_b64_tr_b16 a[4:5], v6 offset:0
 ds_read_b64_tr_b16 a[6:7], v6 offset:2048
 ds_read_b64_tr_b16 a[8:9], v7 offset:0
 ds_read_b64_tr_b16 a[10:11], v7 offset:2048
 ds_read_b64_tr_b16 a[12:13], v8 offset:0
 ds_read_b64_tr_b16 a[14:15], v8 offset:2048
 s_waitcnt vmcnt(6)
 s_waitcnt lgkmcnt(0)
 s_barrier
 v_mfma_f32_16x16x32_bf16 v[64:67], a[0:3], v[128:131], 0
 ds_read_b128 v[144:147], v3 offset:16384
 s_add_u32 s91, s84, 20480
 s_add_u32 m0, s37, 0
 v_mfma_f32_16x16x32_bf16 v[68:71], a[0:3], v[132:135], 0
 ds_read_b64_tr_b16 a[16:17], v5 offset:8192
 buffer_load_dwordx4 v1, s[24:27], s91 offen sc1 lds
 v_mfma_f32_16x16x32_bf16 v[72:75], a[0:3], v[136:139], 0
 ds_read_b64_tr_b16 a[18:19], v5 offset:10240
 v_mfma_f32_16x16x32_bf16 v[76:79], a[0:3], v[140:143], 0
 ds_read_b128 v[148:151], v3 offset:17408
 v_mfma_f32_16x16x32_bf16 v[92:95], a[4:7], v[140:143], 0
 ds_read_b128 v[152:155], v3 offset:20480
 buffer_load_dwordx4 v1, s[24:27], s91 offen offset:1024 sc1 lds
 v_mfma_f32_16x16x32_bf16 v[88:91], a[4:7], v[136:139], 0
 ds_read_b128 v[156:159], v3 offset:21504
 v_mfma_f32_16x16x32_bf16 v[84:87], a[4:7], v[132:135], 0
 ds_read_b64_tr_b16 a[20:21], v6 offset:8192
 s_add_u32 s92, s35, 655360
 s_add_u32 m0, s38, 0
 v_mfma_f32_16x16x32_bf16 v[80:83], a[4:7], v[128:131], 0
 ds_read_b64_tr_b16 a[22:23], v6 offset:10240
 buffer_load_dwordx4 v2, s[16:19], s92 offen lds
 v_mfma_f32_16x16x32_bf16 v[96:99], a[8:11], v[128:131], 0
 ds_read_b64_tr_b16 a[24:25], v7 offset:8192
 v_mfma_f32_16x16x32_bf16 v[100:103], a[8:11], v[132:135], 0
 ds_read_b64_tr_b16 a[26:27], v7 offset:10240
 s_add_u32 s92, s35, 671744
 s_add_u32 m0, s38, 1024
 v_mfma_f32_16x16x32_bf16 v[104:107], a[8:11], v[136:139], 0
 ds_read_b64_tr_b16 a[28:29], v8 offset:8192
 buffer_load_dwordx4 v2, s[16:19], s92 offen lds
 v_mfma_f32_16x16x32_bf16 v[108:111], a[8:11], v[140:143], 0
 ds_read_b64_tr_b16 a[30:31], v8 offset:10240
 v_mfma_f32_16x16x32_bf16 v[124:127], a[12:15], v[140:143], 0
 v_mfma_f32_16x16x32_bf16 v[120:123], a[12:15], v[136:139], 0
 v_mfma_f32_16x16x32_bf16 v[116:119], a[12:15], v[132:135], 0
 v_mfma_f32_16x16x32_bf16 v[112:115], a[12:15], v[128:131], 0
 s_waitcnt vmcnt(8)
 s_waitcnt lgkmcnt(0)
 s_barrier
 v_mfma_f32_16x16x32_bf16 v[64:67], a[16:19], v[144:147], v[64:67]
 ds_read_b128 v[128:131], v3 offset:32768
 s_add_u32 s91, s84, 24576
 s_add_u32 m0, s37, 16384
 v_mfma_f32_16x16x32_bf16 v[68:71], a[16:19], v[148:151], v[68:71]
 ds_read_b64_tr_b16 a[0:1], v5 offset:16384
 buffer_load_dwordx4 v1, s[24:27], s91 offen sc1 lds
 v_mfma_f32_16x16x32_bf16 v[72:75], a[16:19], v[152:155], v[72:75]
 ds_read_b64_tr_b16 a[2:3], v5 offset:18432
 v_mfma_f32_16x16x32_bf16 v[76:79], a[16:19], v[156:159], v[76:79]
 ds_read_b128 v[132:135], v3 offset:33792
 v_mfma_f32_16x16x32_bf16 v[92:95], a[20:23], v[156:159], v[92:95]
 ds_read_b128 v[136:139], v3 offset:36864
 buffer_load_dwordx4 v1, s[24:27], s91 offen offset:1024 sc1 lds
 v_mfma_f32_16x16x32_bf16 v[88:91], a[20:23], v[152:155], v[88:91]
 ds_read_b128 v[140:143], v3 offset:37888
 v_mfma_f32_16x16x32_bf16 v[84:87], a[20:23], v[148:151], v[84:87]
 ds_read_b64_tr_b16 a[4:5], v6 offset:16384
 s_add_u32 s92, s35, 786432
 s_add_u32 m0, s38, 8192
 v_mfma_f32_16x16x32_bf16 v[80:83], a[20:23], v[144:147], v[80:83]
 ds_read_b64_tr_b16 a[6:7], v6 offset:18432
 buffer_load_dwordx4 v2, s[16:19], s92 offen lds
 v_mfma_f32_16x16x32_bf16 v[96:99], a[24:27], v[144:147], v[96:99]
 ds_read_b64_tr_b16 a[8:9], v7 offset:16384
 v_mfma_f32_16x16x32_bf16 v[100:103], a[24:27], v[148:151], v[100:103]
 ds_read_b64_tr_b16 a[10:11], v7 offset:18432
 s_add_u32 s92, s35, 802816
 s_add_u32 m0, s38, 9216
 v_mfma_f32_16x16x32_bf16 v[104:107], a[24:27], v[152:155], v[104:107]
 ds_read_b64_tr_b16 a[12:13], v8 offset:16384
 buffer_load_dwordx4 v2, s[16:19], s92 offen lds
 v_mfma_f32_16x16x32_bf16 v[108:111], a[24:27], v[156:159], v[108:111]
 ds_read_b64_tr_b16 a[14:15], v8 offset:18432
 v_mfma_f32_16x16x32_bf16 v[124:127], a[28:31], v[156:159], v[124:127]
 v_mfma_f32_16x16x32_bf16 v[120:123], a[28:31], v[152:155], v[120:123]
 v_mfma_f32_16x16x32_bf16 v[116:119], a[28:31], v[148:151], v[116:119]
 v_mfma_f32_16x16x32_bf16 v[112:115], a[28:31], v[144:147], v[112:115]
 s_waitcnt vmcnt(10)
 s_waitcnt lgkmcnt(0)
 s_barrier
 v_mfma_f32_16x16x32_bf16 v[64:67], a[0:3], v[128:131], v[64:67]
 ds_read_b128 v[144:147], v4 offset:0
 s_add_u32 s91, s84, 28672
 s_add_u32 m0, s37, 32768
 v_mfma_f32_16x16x32_bf16 v[68:71], a[0:3], v[132:135], v[68:71]
 ds_read_b64_tr_b16 a[16:17], v5 offset:24576
 buffer_load_dwordx4 v1, s[24:27], s91 offen sc1 lds
 v_mfma_f32_16x16x32_bf16 v[72:75], a[0:3], v[136:139], v[72:75]
 ds_read_b64_tr_b16 a[18:19], v5 offset:26624
 v_mfma_f32_16x16x32_bf16 v[76:79], a[0:3], v[140:143], v[76:79]
 ds_read_b128 v[148:151], v4 offset:1024
 v_mfma_f32_16x16x32_bf16 v[92:95], a[4:7], v[140:143], v[92:95]
 ds_read_b128 v[152:155], v4 offset:4096
 buffer_load_dwordx4 v1, s[24:27], s91 offen offset:1024 sc1 lds
 v_mfma_f32_16x16x32_bf16 v[88:91], a[4:7], v[136:139], v[88:91]
 ds_read_b128 v[156:159], v4 offset:5120
 v_mfma_f32_16x16x32_bf16 v[84:87], a[4:7], v[132:135], v[84:87]
 ds_read_b64_tr_b16 a[20:21], v6 offset:24576
 s_add_u32 s92, s35, 917504
 s_add_u32 m0, s38, 16384
 v_mfma_f32_16x16x32_bf16 v[80:83], a[4:7], v[128:131], v[80:83]
 ds_read_b64_tr_b16 a[22:23], v6 offset:26624
 buffer_load_dwordx4 v2, s[16:19], s92 offen lds
 v_mfma_f32_16x16x32_bf16 v[96:99], a[8:11], v[128:131], v[96:99]
 ds_read_b64_tr_b16 a[24:25], v7 offset:24576
 v_mfma_f32_16x16x32_bf16 v[100:103], a[8:11], v[132:135], v[100:103]
 ds_read_b64_tr_b16 a[26:27], v7 offset:26624
 s_add_u32 s92, s35, 933888
 s_add_u32 m0, s38, 17408
 v_mfma_f32_16x16x32_bf16 v[104:107], a[8:11], v[136:139], v[104:107]
 ds_read_b64_tr_b16 a[28:29], v8 offset:24576
 buffer_load_dwordx4 v2, s[16:19], s92 offen lds
 v_mfma_f32_16x16x32_bf16 v[108:111], a[8:11], v[140:143], v[108:111]
 ds_read_b64_tr_b16 a[30:31], v8 offset:26624
 v_mfma_f32_16x16x32_bf16 v[124:127], a[12:15], v[140:143], v[124:127]
 v_mfma_f32_16x16x32_bf16 v[120:123], a[12:15], v[136:139], v[120:123]
 v_mfma_f32_16x16x32_bf16 v[116:119], a[12:15], v[132:135], v[116:119]
 v_mfma_f32_16x16x32_bf16 v[112:115], a[12:15], v[128:131], v[112:115]
 s_waitcnt vmcnt(12)
 s_waitcnt lgkmcnt(0)
 s_barrier
 v_mfma_f32_16x16x32_bf16 v[64:67], a[16:19], v[144:147], v[64:67]
 ds_read_b128 v[128:131], v4 offset:16384
 s_add_u32 s91, s85, 0
 s_add_u32 m0, s37, 49152
 v_mfma_f32_16x16x32_bf16 v[68:71], a[16:19], v[148:151], v[68:71]
 ds_read_b64_tr_b16 a[0:1], v5 offset:32768
 buffer_load_dwordx4 v1, s[24:27], s91 offen sc1 lds
 v_mfma_f32_16x16x32_bf16 v[72:75], a[16:19], v[152:155], v[72:75]
 ds_read_b64_tr_b16 a[2:3], v5 offset:34816
 v_mfma_f32_16x16x32_bf16 v[76:79], a[16:19], v[156:159], v[76:79]
 ds_read_b128 v[132:135], v4 offset:17408
 v_mfma_f32_16x16x32_bf16 v[92:95], a[20:23], v[156:159], v[92:95]
 ds_read_b128 v[136:139], v4 offset:20480
 buffer_load_dwordx4 v1, s[24:27], s91 offen offset:1024 sc1 lds
 v_mfma_f32_16x16x32_bf16 v[88:91], a[20:23], v[152:155], v[88:91]
 ds_read_b128 v[140:143], v4 offset:21504
 v_mfma_f32_16x16x32_bf16 v[84:87], a[20:23], v[148:151], v[84:87]
 ds_read_b64_tr_b16 a[4:5], v6 offset:32768
 s_add_u32 s92, s36, 0
 s_add_u32 m0, s38, 24576
 v_mfma_f32_16x16x32_bf16 v[80:83], a[20:23], v[144:147], v[80:83]
 ds_read_b64_tr_b16 a[6:7], v6 offset:34816
 buffer_load_dwordx4 v2, s[16:19], s92 offen lds
 v_mfma_f32_16x16x32_bf16 v[96:99], a[24:27], v[144:147], v[96:99]
 ds_read_b64_tr_b16 a[8:9], v7 offset:32768
 v_mfma_f32_16x16x32_bf16 v[100:103], a[24:27], v[148:151], v[100:103]
 ds_read_b64_tr_b16 a[10:11], v7 offset:34816
 s_add_u32 s92, s36, 16384
 s_add_u32 m0, s38, 25600
 v_mfma_f32_16x16x32_bf16 v[104:107], a[24:27], v[152:155], v[104:107]
 ds_read_b64_tr_b16 a[12:13], v8 offset:32768
 buffer_load_dwordx4 v2, s[16:19], s92 offen lds
 v_mfma_f32_16x16x32_bf16 v[108:111], a[24:27], v[156:159], v[108:111]
 ds_read_b64_tr_b16 a[14:15], v8 offset:34816
 v_mfma_f32_16x16x32_bf16 v[124:127], a[28:31], v[156:159], v[124:127]
 v_mfma_f32_16x16x32_bf16 v[120:123], a[28:31], v[152:155], v[120:123]
 v_mfma_f32_16x16x32_bf16 v[116:119], a[28:31], v[148:151], v[116:119]
 v_mfma_f32_16x16x32_bf16 v[112:115], a[28:31], v[144:147], v[112:115]
 s_waitcnt vmcnt(12)
 s_waitcnt lgkmcnt(0)
 s_barrier
 v_mfma_f32_16x16x32_bf16 v[64:67], a[0:3], v[128:131], v[64:67]
 ds_read_b128 v[144:147], v3 offset:0
 s_add_u32 s91, s85, 12288
 s_add_u32 m0, s37, 65536
 v_mfma_f32_16x16x32_bf16 v[68:71], a[0:3], v[132:135], v[68:71]
 ds_read_b64_tr_b16 a[16:17], v5 offset:0
 buffer_load_dwordx4 v1, s[24:27], s91 offen sc1 lds
 v_mfma_f32_16x16x32_bf16 v[72:75], a[0:3], v[136:139], v[72:75]
 ds_read_b64_tr_b16 a[18:19], v5 offset:2048
 v_mfma_f32_16x16x32_bf16 v[76:79], a[0:3], v[140:143], v[76:79]
 ds_read_b128 v[148:151], v3 offset:1024
 v_mfma_f32_16x16x32_bf16 v[92:95], a[4:7], v[140:143], v[92:95]
 ds_read_b128 v[152:155], v3 offset:4096
 buffer_load_dwordx4 v1, s[24:27], s91 offen offset:1024 sc1 lds
 v_mfma_f32_16x16x32_bf16 v[88:91], a[4:7], v[136:139], v[88:91]
 ds_read_b128 v[156:159], v3 offset:5120
 v_mfma_f32_16x16x32_bf16 v[84:87], a[4:7], v[132:135], v[84:87]
 ds_read_b64_tr_b16 a[20:21], v6 offset:0
 s_add_u32 s92, s36, 393216
 s_add_u32 m0, s38, 32768
 v_mfma_f32_16x16x32_bf16 v[80:83], a[4:7], v[128:131], v[80:83]
 ds_read_b64_tr_b16 a[22:23], v6 offset:2048
 buffer_load_dwordx4 v2, s[16:19], s92 offen lds
 v_mfma_f32_16x16x32_bf16 v[96:99], a[8:11], v[128:131], v[96:99]
 ds_read_b64_tr_b16 a[24:25], v7 offset:0
 v_mfma_f32_16x16x32_bf16 v[100:103], a[8:11], v[132:135], v[100:103]
 ds_read_b64_tr_b16 a[26:27], v7 offset:2048
 s_add_u32 s92, s36, 409600
 s_add_u32 m0, s38, 33792
 v_mfma_f32_16x16x32_bf16 v[104:107], a[8:11], v[136:139], v[104:107]
 ds_read_b64_tr_b16 a[28:29], v8 offset:0
 buffer_load_dwordx4 v2, s[16:19], s92 offen lds
 v_mfma_f32_16x16x32_bf16 v[108:111], a[8:11], v[140:143], v[108:111]
 ds_read_b64_tr_b16 a[30:31], v8 offset:2048
 v_mfma_f32_16x16x32_bf16 v[124:127], a[12:15], v[140:143], v[124:127]
 v_mfma_f32_16x16x32_bf16 v[120:123], a[12:15], v[136:139], v[120:123]
 v_mfma_f32_16x16x32_bf16 v[116:119], a[12:15], v[132:135], v[116:119]
 v_mfma_f32_16x16x32_bf16 v[112:115], a[12:15], v[128:131], v[112:115]
 s_waitcnt vmcnt(12)
 s_waitcnt lgkmcnt(0)
 s_barrier
 v_mfma_f32_16x16x32_bf16 v[64:67], a[16:19], v[144:147], v[64:67]
 ds_read_b128 v[128:131], v3 offset:16384
 s_add_u32 s91, s85, 20480
 s_add_u32 m0, s37, 0
 v_mfma_f32_16x16x32_bf16 v[68:71], a[16:19], v[148:151], v[68:71]
 ds_read_b64_tr_b16 a[0:1], v5 offset:8192
 buffer_load_dwordx4 v1, s[24:27], s91 offen sc1 lds
 v_mfma_f32_16x16x32_bf16 v[72:75], a[16:19], v[152:155], v[72:75]
 ds_read_b64_tr_b16 a[2:3], v5 offset:10240
 v_mfma_f32_16x16x32_bf16 v[76:79], a[16:19], v[156:159], v[76:79]
 ds_read_b128 v[132:135], v3 offset:17408
 v_mfma_f32_16x16x32_bf16 v[92:95], a[20:23], v[156:159], v[92:95]
 ds_read_b128 v[136:139], v3 offset:20480
 buffer_load_dwordx4 v1, s[24:27], s91 offen offset:1024 sc1 lds
 v_mfma_f32_16x16x32_bf16 v[88:91], a[20:23], v[152:155], v[88:91]
 ds_read_b128 v[140:143], v3 offset:21504
 v_mfma_f32_16x16x32_bf16 v[84:87], a[20:23], v[148:151], v[84:87]
 ds_read_b64_tr_b16 a[4:5], v6 offset:8192
 s_add_u32 s92, s36, 655360
 s_add_u32 m0, s38, 0
 v_mfma_f32_16x16x32_bf16 v[80:83], a[20:23], v[144:147], v[80:83]
 ds_read_b64_tr_b16 a[6:7], v6 offset:10240
 buffer_load_dwordx4 v2, s[16:19], s92 offen lds
 v_mfma_f32_16x16x32_bf16 v[96:99], a[24:27], v[144:147], v[96:99]
 ds_read_b64_tr_b16 a[8:9], v7 offset:8192
 v_mfma_f32_16x16x32_bf16 v[100:103], a[24:27], v[148:151], v[100:103]
 ds_read_b64_tr_b16 a[10:11], v7 offset:10240
 s_add_u32 s92, s36, 671744
 s_add_u32 m0, s38, 1024
 v_mfma_f32_16x16x32_bf16 v[104:107], a[24:27], v[152:155], v[104:107]
 ds_read_b64_tr_b16 a[12:13], v8 offset:8192
 buffer_load_dwordx4 v2, s[16:19], s92 offen lds
 v_mfma_f32_16x16x32_bf16 v[108:111], a[24:27], v[156:159], v[108:111]
 ds_read_b64_tr_b16 a[14:15], v8 offset:10240
 v_mfma_f32_16x16x32_bf16 v[124:127], a[28:31], v[156:159], v[124:127]
 v_mfma_f32_16x16x32_bf16 v[120:123], a[28:31], v[152:155], v[120:123]
 v_mfma_f32_16x16x32_bf16 v[116:119], a[28:31], v[148:151], v[116:119]
 v_mfma_f32_16x16x32_bf16 v[112:115], a[28:31], v[144:147], v[112:115]
 s_waitcnt vmcnt(12)
 s_waitcnt lgkmcnt(0)
 s_barrier
 v_mfma_f32_16x16x32_bf16 v[64:67], a[0:3], v[128:131], v[64:67]
 ds_read_b128 v[144:147], v3 offset:32768
 s_add_u32 s91, s85, 32768
 s_add_u32 m0, s37, 16384
 v_mfma_f32_16x16x32_bf16 v[68:71], a[0:3], v[132:135], v[68:71]
 ds_read_b64_tr_b16 a[16:17], v5 offset:16384
 buffer_load_dwordx4 v1, s[24:27], s91 offen sc1 lds
 v_mfma_f32_16x16x32_bf16 v[72:75], a[0:3], v[136:139], v[72:75]
 ds_read_b64_tr_b16 a[18:19], v5 offset:18432
 v_mfma_f32_16x16x32_bf16 v[76:79], a[0:3], v[140:143], v[76:79]
 ds_read_b128 v[148:151], v3 offset:33792
 v_mfma_f32_16x16x32_bf16 v[92:95], a[4:7], v[140:143], v[92:95]
 ds_read_b128 v[152:155], v3 offset:36864
 buffer_load_dwordx4 v1, s[24:27], s91 offen offset:1024 sc1 lds
 v_mfma_f32_16x16x32_bf16 v[88:91], a[4:7], v[136:139], v[88:91]
 ds_read_b128 v[156:159], v3 offset:37888
 v_mfma_f32_16x16x32_bf16 v[84:87], a[4:7], v[132:135], v[84:87]
 ds_read_b64_tr_b16 a[20:21], v6 offset:16384
 s_add_u32 s92, s36, 1048576
 s_add_u32 m0, s38, 8192
 v_mfma_f32_16x16x32_bf16 v[80:83], a[4:7], v[128:131], v[80:83]
 ds_read_b64_tr_b16 a[22:23], v6 offset:18432
 buffer_load_dwordx4 v2, s[16:19], s92 offen lds
 v_mfma_f32_16x16x32_bf16 v[96:99], a[8:11], v[128:131], v[96:99]
 ds_read_b64_tr_b16 a[24:25], v7 offset:16384
 v_mfma_f32_16x16x32_bf16 v[100:103], a[8:11], v[132:135], v[100:103]
 ds_read_b64_tr_b16 a[26:27], v7 offset:18432
 s_add_u32 s92, s36, 1064960
 s_add_u32 m0, s38, 9216
 v_mfma_f32_16x16x32_bf16 v[104:107], a[8:11], v[136:139], v[104:107]
 ds_read_b64_tr_b16 a[28:29], v8 offset:16384
 buffer_load_dwordx4 v2, s[16:19], s92 offen lds
 v_mfma_f32_16x16x32_bf16 v[108:111], a[8:11], v[140:143], v[108:111]
 ds_read_b64_tr_b16 a[30:31], v8 offset:18432
 v_mfma_f32_16x16x32_bf16 v[124:127], a[12:15], v[140:143], v[124:127]
 v_mfma_f32_16x16x32_bf16 v[120:123], a[12:15], v[136:139], v[120:123]
 v_mfma_f32_16x16x32_bf16 v[116:119], a[12:15], v[132:135], v[116:119]
 v_mfma_f32_16x16x32_bf16 v[112:115], a[12:15], v[128:131], v[112:115]
 s_waitcnt vmcnt(12)
 s_waitcnt lgkmcnt(0)
 s_barrier
 v_mfma_f32_16x16x32_bf16 v[64:67], a[16:19], v[144:147], v[64:67]
 ds_read_b128 v[128:131], v4 offset:0
 s_add_u32 s91, s85, 40960
 s_add_u32 m0, s37, 32768
 v_mfma_f32_16x16x32_bf16 v[68:71], a[16:19], v[148:151], v[68:71]
 ds_read_b64_tr_b16 a[0:1], v5 offset:24576
 buffer_load_dwordx4 v1, s[24:27], s91 offen sc1 lds
 v_mfma_f32_16x16x32_bf16 v[72:75], a[16:19], v[152:155], v[72:75]
 ds_read_b64_tr_b16 a[2:3], v5 offset:26624
 v_mfma_f32_16x16x32_bf16 v[76:79], a[16:19], v[156:159], v[76:79]
 ds_read_b128 v[132:135], v4 offset:1024
 v_mfma_f32_16x16x32_bf16 v[92:95], a[20:23], v[156:159], v[92:95]
 ds_read_b128 v[136:139], v4 offset:4096
 buffer_load_dwordx4 v1, s[24:27], s91 offen offset:1024 sc1 lds
 v_mfma_f32_16x16x32_bf16 v[88:91], a[20:23], v[152:155], v[88:91]
 ds_read_b128 v[140:143], v4 offset:5120
 v_mfma_f32_16x16x32_bf16 v[84:87], a[20:23], v[148:151], v[84:87]
 ds_read_b64_tr_b16 a[4:5], v6 offset:24576
 s_add_u32 s92, s36, 1310720
 s_add_u32 m0, s38, 16384
 v_mfma_f32_16x16x32_bf16 v[80:83], a[20:23], v[144:147], v[80:83]
 ds_read_b64_tr_b16 a[6:7], v6 offset:26624
 buffer_load_dwordx4 v2, s[16:19], s92 offen lds
 v_mfma_f32_16x16x32_bf16 v[96:99], a[24:27], v[144:147], v[96:99]
 ds_read_b64_tr_b16 a[8:9], v7 offset:24576
 v_mfma_f32_16x16x32_bf16 v[100:103], a[24:27], v[148:151], v[100:103]
 ds_read_b64_tr_b16 a[10:11], v7 offset:26624
 s_add_u32 s92, s36, 1327104
 s_add_u32 m0, s38, 17408
 v_mfma_f32_16x16x32_bf16 v[104:107], a[24:27], v[152:155], v[104:107]
 ds_read_b64_tr_b16 a[12:13], v8 offset:24576
 buffer_load_dwordx4 v2, s[16:19], s92 offen lds
 v_mfma_f32_16x16x32_bf16 v[108:111], a[24:27], v[156:159], v[108:111]
 ds_read_b64_tr_b16 a[14:15], v8 offset:26624
 v_mfma_f32_16x16x32_bf16 v[124:127], a[28:31], v[156:159], v[124:127]
 v_mfma_f32_16x16x32_bf16 v[120:123], a[28:31], v[152:155], v[120:123]
 buffer_load_dword v30, v29, s[96:99], 0 offen sc1
 v_mfma_f32_16x16x32_bf16 v[116:119], a[28:31], v[148:151], v[116:119]
 v_mfma_f32_16x16x32_bf16 v[112:115], a[28:31], v[144:147], v[112:115]
 s_waitcnt vmcnt(13)
 s_waitcnt lgkmcnt(0)
 s_barrier
 v_mfma_f32_16x16x32_bf16 v[64:67], a[0:3], v[128:131], v[64:67]
 ds_read_b128 v[144:147], v4 offset:16384
 s_add_u32 s91, s85, 53248
 s_add_u32 m0, s37, 49152
 v_mfma_f32_16x16x32_bf16 v[68:71], a[0:3], v[132:135], v[68:71]
 ds_read_b64_tr_b16 a[16:17], v5 offset:32768
 buffer_load_dwordx4 v1, s[24:27], s91 offen sc1 lds
 v_mfma_f32_16x16x32_bf16 v[72:75], a[0:3], v[136:139], v[72:75]
 ds_read_b64_tr_b16 a[18:19], v5 offset:34816
 v_mfma_f32_16x16x32_bf16 v[76:79], a[0:3], v[140:143], v[76:79]
 ds_read_b128 v[148:151], v4 offset:17408
 v_mfma_f32_16x16x32_bf16 v[92:95], a[4:7], v[140:143], v[92:95]
 ds_read_b128 v[152:155], v4 offset:20480
 buffer_load_dwordx4 v1, s[24:27], s91 offen offset:1024 sc1 lds
 v_mfma_f32_16x16x32_bf16 v[88:91], a[4:7], v[136:139], v[88:91]
 ds_read_b128 v[156:159], v4 offset:21504
 v_mfma_f32_16x16x32_bf16 v[84:87], a[4:7], v[132:135], v[84:87]
 ds_read_b64_tr_b16 a[20:21], v6 offset:32768
 s_add_u32 s92, s36, 1703936
 s_add_u32 m0, s38, 24576
 v_mfma_f32_16x16x32_bf16 v[80:83], a[4:7], v[128:131], v[80:83]
 ds_read_b64_tr_b16 a[22:23], v6 offset:34816
 buffer_load_dwordx4 v2, s[16:19], s92 offen lds
 v_mfma_f32_16x16x32_bf16 v[96:99], a[8:11], v[128:131], v[96:99]
 ds_read_b64_tr_b16 a[24:25], v7 offset:32768
 v_mfma_f32_16x16x32_bf16 v[100:103], a[8:11], v[132:135], v[100:103]
 ds_read_b64_tr_b16 a[26:27], v7 offset:34816
 s_add_u32 s92, s36, 1720320
 s_add_u32 m0, s38, 25600
 v_mfma_f32_16x16x32_bf16 v[104:107], a[8:11], v[136:139], v[104:107]
 ds_read_b64_tr_b16 a[28:29], v8 offset:32768
 buffer_load_dwordx4 v2, s[16:19], s92 offen lds
 v_mfma_f32_16x16x32_bf16 v[108:111], a[8:11], v[140:143], v[108:111]
 ds_read_b64_tr_b16 a[30:31], v8 offset:34816
 v_mfma_f32_16x16x32_bf16 v[124:127], a[12:15], v[140:143], v[124:127]
 v_mfma_f32_16x16x32_bf16 v[120:123], a[12:15], v[136:139], v[120:123]
 v_mfma_f32_16x16x32_bf16 v[116:119], a[12:15], v[132:135], v[116:119]
 v_mfma_f32_16x16x32_bf16 v[112:115], a[12:15], v[128:131], v[112:115]
 s_waitcnt vmcnt(13)
 s_waitcnt lgkmcnt(0)
 s_barrier
 v_mfma_f32_16x16x32_bf16 v[64:67], a[16:19], v[144:147], v[64:67]
 ds_read_b128 v[128:131], v3 offset:0
 s_add_u32 s91, s85, 61440
 s_add_u32 m0, s37, 65536
 v_mfma_f32_16x16x32_bf16 v[68:71], a[16:19], v[148:151], v[68:71]
 ds_read_b64_tr_b16 a[0:1], v5 offset:0
 buffer_load_dwordx4 v1, s[24:27], s91 offen sc1 lds
 v_mfma_f32_16x16x32_bf16 v[72:75], a[16:19], v[152:155], v[72:75]
 ds_read_b64_tr_b16 a[2:3], v5 offset:2048
 v_mfma_f32_16x16x32_bf16 v[76:79], a[16:19], v[156:159], v[76:79]
 ds_read_b128 v[132:135], v3 offset:1024
 v_mfma_f32_16x16x32_bf16 v[92:95], a[20:23], v[156:159], v[92:95]
 ds_read_b128 v[136:139], v3 offset:4096
 buffer_load_dwordx4 v1, s[24:27], s91 offen offset:1024 sc1 lds
 v_mfma_f32_16x16x32_bf16 v[88:91], a[20:23], v[152:155], v[88:91]
 ds_read_b128 v[140:143], v3 offset:5120
 v_mfma_f32_16x16x32_bf16 v[84:87], a[20:23], v[148:151], v[84:87]
 ds_read_b64_tr_b16 a[4:5], v6 offset:0
 s_add_u32 s92, s36, 1966080
 s_add_u32 m0, s38, 32768
 v_mfma_f32_16x16x32_bf16 v[80:83], a[20:23], v[144:147], v[80:83]
 ds_read_b64_tr_b16 a[6:7], v6 offset:2048
 buffer_load_dwordx4 v2, s[16:19], s92 offen lds
 v_mfma_f32_16x16x32_bf16 v[96:99], a[24:27], v[144:147], v[96:99]
 ds_read_b64_tr_b16 a[8:9], v7 offset:0
 v_mfma_f32_16x16x32_bf16 v[100:103], a[24:27], v[148:151], v[100:103]
 ds_read_b64_tr_b16 a[10:11], v7 offset:2048
 s_add_u32 s92, s36, 1982464
 s_add_u32 m0, s38, 33792
 v_mfma_f32_16x16x32_bf16 v[104:107], a[24:27], v[152:155], v[104:107]
 ds_read_b64_tr_b16 a[12:13], v8 offset:0
 buffer_load_dwordx4 v2, s[16:19], s92 offen lds
 v_mfma_f32_16x16x32_bf16 v[108:111], a[24:27], v[156:159], v[108:111]
 ds_read_b64_tr_b16 a[14:15], v8 offset:2048
 v_mfma_f32_16x16x32_bf16 v[124:127], a[28:31], v[156:159], v[124:127]
 v_mfma_f32_16x16x32_bf16 v[120:123], a[28:31], v[152:155], v[120:123]
 v_mfma_f32_16x16x32_bf16 v[116:119], a[28:31], v[148:151], v[116:119]
 v_mfma_f32_16x16x32_bf16 v[112:115], a[28:31], v[144:147], v[112:115]
 s_waitcnt vmcnt(13)
 s_waitcnt lgkmcnt(0)
 s_barrier
 v_mfma_f32_16x16x32_bf16 v[64:67], a[0:3], v[128:131], v[64:67]
 ds_read_b128 v[144:147], v3 offset:16384
 s_add_u32 s91, s85, 73728
 s_add_u32 m0, s37, 0
 v_mfma_f32_16x16x32_bf16 v[68:71], a[0:3], v[132:135], v[68:71]
 ds_read_b64_tr_b16 a[16:17], v5 offset:8192
 buffer_load_dwordx4 v1, s[24:27], s91 offen sc1 lds
 v_mfma_f32_16x16x32_bf16 v[72:75], a[0:3], v[136:139], v[72:75]
 ds_read_b64_tr_b16 a[18:19], v5 offset:10240
 v_mfma_f32_16x16x32_bf16 v[76:79], a[0:3], v[140:143], v[76:79]
 ds_read_b128 v[148:151], v3 offset:17408
 v_mfma_f32_16x16x32_bf16 v[92:95], a[4:7], v[140:143], v[92:95]
 ds_read_b128 v[152:155], v3 offset:20480
 buffer_load_dwordx4 v1, s[24:27], s91 offen offset:1024 sc1 lds
 v_mfma_f32_16x16x32_bf16 v[88:91], a[4:7], v[136:139], v[88:91]
 ds_read_b128 v[156:159], v3 offset:21504
 v_mfma_f32_16x16x32_bf16 v[84:87], a[4:7], v[132:135], v[84:87]
 ds_read_b64_tr_b16 a[20:21], v6 offset:8192
 s_add_u32 s92, s36, 2359296
 s_add_u32 m0, s38, 0
 v_mfma_f32_16x16x32_bf16 v[80:83], a[4:7], v[128:131], v[80:83]
 ds_read_b64_tr_b16 a[22:23], v6 offset:10240
 buffer_load_dwordx4 v2, s[16:19], s92 offen lds
 v_mfma_f32_16x16x32_bf16 v[96:99], a[8:11], v[128:131], v[96:99]
 ds_read_b64_tr_b16 a[24:25], v7 offset:8192
 v_mfma_f32_16x16x32_bf16 v[100:103], a[8:11], v[132:135], v[100:103]
 ds_read_b64_tr_b16 a[26:27], v7 offset:10240
 s_add_u32 s92, s36, 2375680
 s_add_u32 m0, s38, 1024
 v_mfma_f32_16x16x32_bf16 v[104:107], a[8:11], v[136:139], v[104:107]
 ds_read_b64_tr_b16 a[28:29], v8 offset:8192
 buffer_load_dwordx4 v2, s[16:19], s92 offen lds
 v_mfma_f32_16x16x32_bf16 v[108:111], a[8:11], v[140:143], v[108:111]
 ds_read_b64_tr_b16 a[30:31], v8 offset:10240
 v_mfma_f32_16x16x32_bf16 v[124:127], a[12:15], v[140:143], v[124:127]
 v_mfma_f32_16x16x32_bf16 v[120:123], a[12:15], v[136:139], v[120:123]
 v_mfma_f32_16x16x32_bf16 v[116:119], a[12:15], v[132:135], v[116:119]
 v_mfma_f32_16x16x32_bf16 v[112:115], a[12:15], v[128:131], v[112:115]
 s_waitcnt vmcnt(12)
 v_cmp_gt_u32 vcc, 32, v30
 s_nop 0
 s_cbranch_vccnz L_k2_late
L_k2_back:
 s_waitcnt lgkmcnt(0)
 s_barrier
 v_mfma_f32_16x16x32_bf16 v[64:67], a[16:19], v[144:147], v[64:67]
 ds_read_b128 v[128:131], v3 offset:32768
 s_add_u32 s91, s85, 2048
 s_add_u32 m0, s37, 16384
 v_mfma_f32_16x16x32_bf16 v[68:71], a[16:19], v[148:151], v[68:71]
 ds_read_b64_tr_b16 a[0:1], v5 offset:16384
 buffer_load_dwordx4 v1, s[24:27], s91 offen sc1 lds
 v_mfma_f32_16x16x32_bf16 v[72:75], a[16:19], v[152:155], v[72:75]
 ds_read_b64_tr_b16 a[2:3], v5 offset:18432
 v_mfma_f32_16x16x32_bf16 v[76:79], a[16:19], v[156:159], v[76:79]
 ds_read_b128 v[132:135], v3 offset:33792
 v_mfma_f32_16x16x32_bf16 v[92:95], a[20:23], v[156:159], v[92:95]
 ds_read_b128 v[136:139], v3 offset:36864
 buffer_load_dwordx4 v1, s[24:27], s91 offen offset:1024 sc1 lds
 v_mfma_f32_16x16x32_bf16 v[88:91], a[20:23], v[152:155], v[88:91]
 ds_read_b128 v[140:143], v3 offset:37888
 v_mfma_f32_16x16x32_bf16 v[84:87], a[20:23], v[148:151], v[84:87]
 ds_read_b64_tr_b16 a[4:5], v6 offset:16384
 s_add_u32 s92, s36, 65536
 s_add_u32 m0, s38, 8192
 v_mfma_f32_16x16x32_bf16 v[80:83], a[20:23], v[144:147], v[80:83]
 ds_read_b64_tr_b16 a[6:7], v6 offset:18432
 buffer_load_dwordx4 v2, s[16:19], s92 offen lds
 v_mfma_f32_16x16x32_bf16 v[96:99], a[24:27], v[144:147], v[96:99]
 ds_read_b64_tr_b16 a[8:9], v7 offset:16384
 v_mfma_f32_16x16x32_bf16 v[100:103], a[24:27], v[148:151], v[100:103]
 ds_read_b64_tr_b16 a[10:11], v7 offset:18432
 s_add_u32 s92, s36, 81920
 s_add_u32 m0, s38, 9216
 v_mfma_f32_16x16x32_bf16 v[104:107], a[24:27], v[152:155], v[104:107]
 ds_read_b64_tr_b16 a[12:13], v8 offset:16384
 buffer_load_dwordx4 v2, s[16:19], s92 offen lds
 v_mfma_f32_16x16x32_bf16 v[108:111], a[24:27], v[156:159], v[108:111]
 ds_read_b64_tr_b16 a[14:15], v8 offset:18432
 v_mfma_f32_16x16x32_bf16 v[124:127], a[28:31], v[156:159], v[124:127]
 v_mfma_f32_16x16x32_bf16 v[120:123], a[28:31], v[152:155], v[120:123]
 v_mfma_f32_16x16x32_bf16 v[116:119], a[28:31], v[148:151], v[116:119]
 v_mfma_f32_16x16x32_bf16 v[112:115], a[28:31], v[144:147], v[112:115]
 s_waitcnt vmcnt(12)
 s_waitcnt lgkmcnt(0)
 s_barrier
 v_mfma_f32_16x16x32_bf16 v[64:67], a[0:3], v[128:131], v[64:67]
 ds_read_b128 v[144:147], v4 offset:0
 s_add_u32 s91, s85, 14336
 s_add_u32 m0, s37, 32768
 v_mfma_f32_16x16x32_bf16 v[68:71], a[0:3], v[132:135], v[68:71]
 ds_read_b64_tr_b16 a[16:17], v5 offset:24576
 buffer_load_dwordx4 v1, s[24:27], s91 offen sc1 lds
 v_mfma_f32_16x16x32_bf16 v[72:75], a[0:3], v[136:139], v[72:75]
 ds_read_b64_tr_b16 a[18:19], v5 offset:26624
 v_mfma_f32_16x16x32_bf16 v[76:79], a[0:3], v[140:143], v[76:79]
 ds_read_b128 v[148:151], v4 offset:1024
 v_mfma_f32_16x16x32_bf16 v[92:95], a[4:7], v[140:143], v[92:95]
 ds_read_b128 v[152:155], v4 offset:4096
 buffer_load_dwordx4 v1, s[24:27], s91 offen offset:1024 sc1 lds
 v_mfma_f32_16x16x32_bf16 v[88:91], a[4:7], v[136:139], v[88:91]
 ds_read_b128 v[156:159], v4 offset:5120
 v_mfma_f32_16x16x32_bf16 v[84:87], a[4:7], v[132:135], v[84:87]
 ds_read_b64_tr_b16 a[20:21], v6 offset:24576
 s_add_u32 s92, s36, 458752
 s_add_u32 m0, s38, 16384
 v_mfma_f32_16x16x32_bf16 v[80:83], a[4:7], v[128:131], v[80:83]
 ds_read_b64_tr_b16 a[22:23], v6 offset:26624
 buffer_load_dwordx4 v2, s[16:19], s92 offen lds
 v_mfma_f32_16x16x32_bf16 v[96:99], a[8:11], v[128:131], v[96:99]
 ds_read_b64_tr_b16 a[24:25], v7 offset:24576
 v_mfma_f32_16x16x32_bf16 v[100:103], a[8:11], v[132:135], v[100:103]
 ds_read_b64_tr_b16 a[26:27], v7 offset:26624
 s_add_u32 s92, s36, 475136
 s_add_u32 m0, s38, 17408
 v_mfma_f32_16x16x32_bf16 v[104:107], a[8:11], v[136:139], v[104:107]
 ds_read_b64_tr_b16 a[28:29], v8 offset:24576
 buffer_load_dwordx4 v2, s[16:19], s92 offen lds
 v_mfma_f32_16x16x32_bf16 v[108:111], a[8:11], v[140:143], v[108:111]
 ds_read_b64_tr_b16 a[30:31], v8 offset:26624
 v_mfma_f32_16x16x32_bf16 v[124:127], a[12:15], v[140:143], v[124:127]
 v_mfma_f32_16x16x32_bf16 v[120:123], a[12:15], v[136:139], v[120:123]
 v_mfma_f32_16x16x32_bf16 v[116:119], a[12:15], v[132:135], v[116:119]
 v_mfma_f32_16x16x32_bf16 v[112:115], a[12:15], v[128:131], v[112:115]
 s_waitcnt vmcnt(12)
 s_waitcnt lgkmcnt(0)
 s_barrier
 v_mfma_f32_16x16x32_bf16 v[64:67], a[16:19], v[144:147], v[64:67]
 ds_read_b128 v[128:131], v4 offset:16384
 s_add_u32 s91, s85, 22528
 s_add_u32 m0, s37, 49152
 v_mfma_f32_16x16x32_bf16 v[68:71], a[16:19], v[148:151], v[68:71]
 ds_read_b64_tr_b16 a[0:1], v5 offset:32768
 buffer_load_dwordx4 v1, s[24:27], s91 offen sc1 lds
 v_mfma_f32_16x16x32_bf16 v[72:75], a[16:19], v[152:155], v[72:75]
 ds_read_b64_tr_b16 a[2:3], v5 offset:34816
 v_mfma_f32_16x16x32_bf16 v[76:79], a[16:19], v[156:159], v[76:79]
 ds_read_b128 v[132:135], v4 offset:17408
 v_mfma_f32_16x16x32_bf16 v[92:95], a[20:23], v[156:159], v[92:95]
 ds_read_b128 v[136:139], v4 offset:20480
 buffer_load_dwordx4 v1, s[24:27], s91 offen offset:1024 sc1 lds
 v_mfma_f32_16x16x32_bf16 v[88:91], a[20:23], v[152:155], v[88:91]
 ds_read_b128 v[140:143], v4 offset:21504
 v_mfma_f32_16x16x32_bf16 v[84:87], a[20:23], v[148:151], v[84:87]
 ds_read_b64_tr_b16 a[4:5], v6 offset:32768
 s_add_u32 s92, s36, 720896
 s_add_u32 m0, s38, 24576
 v_mfma_f32_16x16x32_bf16 v[80:83], a[20:23], v[144:147], v[80:83]
 ds_read_b64_tr_b16 a[6:7], v6 offset:34816
 buffer_load_dwordx4 v2, s[16:19], s92 offen lds
 v_mfma_f32_16x16x32_bf16 v[96:99], a[24:27], v[144:147], v[96:99]
 ds_read_b64_tr_b16 a[8:9], v7 offset:32768
 v_mfma_f32_16x16x32_bf16 v[100:103], a[24:27], v[148:151], v[100:103]
 ds_read_b64_tr_b16 a[10:11], v7 offset:34816
 s_add_u32 s92, s36, 737280
 s_add_u32 m0, s38, 25600
 v_mfma_f32_16x16x32_bf16 v[104:107], a[24:27], v[152:155], v[104:107]
 ds_read_b64_tr_b16 a[12:13], v8 offset:32768
 buffer_load_dwordx4 v2, s[16:19], s92 offen lds
 v_mfma_f32_16x16x32_bf16 v[108:111], a[24:27], v[156:159], v[108:111]
 ds_read_b64_tr_b16 a[14:15], v8 offset:34816
 v_mfma_f32_16x16x32_bf16 v[124:127], a[28:31], v[156:159], v[124:127]
 v_mfma_f32_16x16x32_bf16 v[120:123], a[28:31], v[152:155], v[120:123]
 v_mfma_f32_16x16x32_bf16 v[116:119], a[28:31], v[148:151], v[116:119]
 v_mfma_f32_16x16x32_bf16 v[112:115], a[28:31], v[144:147], v[112:115]
 s_waitcnt vmcnt(12)
 s_waitcnt lgkmcnt(0)
 s_barrier
 v_mfma_f32_16x16x32_bf16 v[64:67], a[0:3], v[128:131], v[64:67]
 ds_read_b128 v[144:147], v3 offset:0
 s_add_u32 s91, s85, 34816
 s_add_u32 m0, s37, 65536
 v_mfma_f32_16x16x32_bf16 v[68:71], a[0:3], v[132:135], v[68:71]
 ds_read_b64_tr_b16 a[16:17], v5 offset:0
 buffer_load_dwordx4 v1, s[24:27], s91 offen sc1 lds
 v_mfma_f32_16x16x32_bf16 v[72:75], a[0:3], v[136:139], v[72:75]
 ds_read_b64_tr_b16 a[18:19], v5 offset:2048
 v_mfma_f32_16x16x32_bf16 v[76:79], a[0:3], v[140:143], v[76:79]
 ds_read_b128 v[148:151], v3 offset:1024
 v_mfma_f32_16x16x32_bf16 v[92:95], a[4:7], v[140:143], v[92:95]
 ds_read_b128 v[152:155], v3 offset:4096
 buffer_load_dwordx4 v1, s[24:27], s91 offen offset:1024 sc1 lds
 v_mfma_f32_16x16x32_bf16 v[88:91], a[4:7], v[136:139], v[88:91]
 ds_read_b128 v[156:159], v3 offset:5120
 v_mfma_f32_16x16x32_bf16 v[84:87], a[4:7], v[132:135], v[84:87]
 ds_read_b64_tr_b16 a[20:21], v6 offset:0
 s_add_u32 s92, s36, 1114112
 s_add_u32 m0, s38, 32768
 v_mfma_f32_16x16x32_bf16 v[80:83], a[4:7], v[128:131], v[80:83]
 ds_read_b64_tr_b16 a[22:23], v6 offset:2048
 buffer_load_dwordx4 v2, s[16:19], s92 offen lds
 v_mfma_f32_16x16x32_bf16 v[96:99], a[8:11], v[128:131], v[96:99]
 ds_read_b64_tr_b16 a[24:25], v7 offset:0
 v_mfma_f32_16x16x32_bf16 v[100:103], a[8:11], v[132:135], v[100:103]
 ds_read_b64_tr_b16 a[26:27], v7 offset:2048
 s_add_u32 s92, s36, 1130496
 s_add_u32 m0, s38, 33792
 v_mfma_f32_16x16x32_bf16 v[104:107], a[8:11], v[136:139], v[104:107]
 ds_read_b64_tr_b16 a[28:29], v8 offset:0
 buffer_load_dwordx4 v2, s[16:19], s92 offen lds
 v_mfma_f32_16x16x32_bf16 v[108:111], a[8:11], v[140:143], v[108:111]
 ds_read_b64_tr_b16 a[30:31], v8 offset:2048
 v_mfma_f32_16x16x32_bf16 v[124:127], a[12:15], v[140:143], v[124:127]
 v_mfma_f32_16x16x32_bf16 v[120:123], a[12:15], v[136:139], v[120:123]
 v_mfma_f32_16x16x32_bf16 v[116:119], a[12:15], v[132:135], v[116:119]
 v_mfma_f32_16x16x32_bf16 v[112:115], a[12:15], v[128:131], v[112:115]
 s_waitcnt vmcnt(12)
 s_waitcnt lgkmcnt(0)
 s_barrier
 v_mfma_f32_16x16x32_bf16 v[64:67], a[16:19], v[144:147], v[64:67]
 ds_read_b128 v[128:131], v3 offset:16384
 s_add_u32 s91, s85, 43008
 s_add_u32 m0, s37, 0
 v_mfma_f32_16x16x32_bf16 v[68:71], a[16:19], v[148:151], v[68:71]
 ds_read_b64_tr_b16 a[0:1], v5 offset:8192
 buffer_load_dwordx4 v1, s[24:27], s91 offen sc1 lds
 v_mfma_f32_16x16x32_bf16 v[72:75], a[16:19], v[152:155], v[72:75]
 ds_read_b64_tr_b16 a[2:3], v5 offset:10240
 v_mfma_f32_16x16x32_bf16 v[76:79], a[16:19], v[156:159], v[76:79]
 ds_read_b128 v[132:135], v3 offset:17408
 v_mfma_f32_16x16x32_bf16 v[92:95], a[20:23], v[156:159], v[92:95]
 ds_read_b128 v[136:139], v3 offset:20480
 buffer_load_dwordx4 v1, s[24:27], s91 offen offset:1024 sc1 lds
 v_mfma_f32_16x16x32_bf16 v[88:91], a[20:23], v[152:155], v[88:91]
 ds_read_b128 v[140:143], v3 offset:21504
 v_mfma_f32_16x16x32_bf16 v[84:87], a[20:23], v[148:151], v[84:87]
 ds_read_b64_tr_b16 a[4:5], v6 offset:8192
 s_add_u32 s92, s36, 1376256
 s_add_u32 m0, s38, 0
 v_mfma_f32_16x16x32_bf16 v[80:83], a[20:23], v[144:147], v[80:83]
 ds_read_b64_tr_b16 a[6:7], v6 offset:10240
 buffer_load_dwordx4 v2, s[16:19], s92 offen lds
 v_mfma_f32_16x16x32_bf16 v[96:99], a[24:27], v[144:147], v[96:99]
 ds_read_b64_tr_b16 a[8:9], v7 offset:8192
 v_mfma_f32_16x16x32_bf16 v[100:103], a[24:27], v[148:151], v[100:103]
 ds_read_b64_tr_b16 a[10:11], v7 offset:10240
 s_add_u32 s92, s36, 1392640
 s_add_u32 m0, s38, 1024
 v_mfma_f32_16x16x32_bf16 v[104:107], a[24:27], v[152:155], v[104:107]
 ds_read_b64_tr_b16 a[12:13], v8 offset:8192
 buffer_load_dwordx4 v2, s[16:19], s92 offen lds
 v_mfma_f32_16x16x32_bf16 v[108:111], a[24:27], v[156:159], v[108:111]
 ds_read_b64_tr_b16 a[14:15], v8 offset:10240
 v_mfma_f32_16x16x32_bf16 v[124:127], a[28:31], v[156:159], v[124:127]
 v_mfma_f32_16x16x32_bf16 v[120:123], a[28:31], v[152:155], v[120:123]
 v_mfma_f32_16x16x32_bf16 v[116:119], a[28:31], v[148:151], v[116:119]
 v_mfma_f32_16x16x32_bf16 v[112:115], a[28:31], v[144:147], v[112:115]
 s_waitcnt vmcnt(12)
 s_waitcnt lgkmcnt(0)
 s_barrier
 v_mfma_f32_16x16x32_bf16 v[64:67], a[0:3], v[128:131], v[64:67]
 ds_read_b128 v[144:147], v3 offset:32768
 s_add_u32 s91, s85, 55296
 s_add_u32 m0, s37, 16384
 v_mfma_f32_16x16x32_bf16 v[68:71], a[0:3], v[132:135], v[68:71]
 ds_read_b64_tr_b16 a[16:17], v5 offset:16384
 buffer_load_dwordx4 v1, s[24:27], s91 offen sc1 lds
 v_mfma_f32_16x16x32_bf16 v[72:75], a[0:3], v[136:139], v[72:75]
 ds_read_b64_tr_b16 a[18:19], v5 offset:18432
 v_mfma_f32_16x16x32_bf16 v[76:79], a[0:3], v[140:143], v[76:79]
 ds_read_b128 v[148:151], v3 offset:33792
 v_mfma_f32_16x16x32_bf16 v[92:95], a[4:7], v[140:143], v[92:95]
 ds_read_b128 v[152:155], v3 offset:36864
 buffer_load_dwordx4 v1, s[24:27], s91 offen offset:1024 sc1 lds
 v_mfma_f32_16x16x32_bf16 v[88:91], a[4:7], v[136:139], v[88:91]
 ds_read_b128 v[156:159], v3 offset:37888
 v_mfma_f32_16x16x32_bf16 v[84:87], a[4:7], v[132:135], v[84:87]
 ds_read_b64_tr_b16 a[20:21], v6 offset:16384
 s_add_u32 s92, s36, 1769472
 s_add_u32 m0, s38, 8192
 v_mfma_f32_16x16x32_bf16 v[80:83], a[4:7], v[128:131], v[80:83]
 ds_read_b64_tr_b16 a[22:23], v6 offset:18432
 buffer_load_dwordx4 v2, s[16:19], s92 offen lds
 v_mfma_f32_16x16x32_bf16 v[96:99], a[8:11], v[128:131], v[96:99]
 ds_read_b64_tr_b16 a[24:25], v7 offset:16384
 v_mfma_f32_16x16x32_bf16 v[100:103], a[8:11], v[132:135], v[100:103]
 ds_read_b64_tr_b16 a[26:27], v7 offset:18432
 s_add_u32 s92, s36, 1785856
 s_add_u32 m0, s38, 9216
 v_mfma_f32_16x16x32_bf16 v[104:107], a[8:11], v[136:139], v[104:107]
 ds_read_b64_tr_b16 a[28:29], v8 offset:16384
 buffer_load_dwordx4 v2, s[16:19], s92 offen lds
 v_mfma_f32_16x16x32_bf16 v[108:111], a[8:11], v[140:143], v[108:111]
 ds_read_b64_tr_b16 a[30:31], v8 offset:18432
 v_mfma_f32_16x16x32_bf16 v[124:127], a[12:15], v[140:143], v[124:127]
 v_mfma_f32_16x16x32_bf16 v[120:123], a[12:15], v[136:139], v[120:123]
 v_mfma_f32_16x16x32_bf16 v[116:119], a[12:15], v[132:135], v[116:119]
 v_mfma_f32_16x16x32_bf16 v[112:115], a[12:15], v[128:131], v[112:115]
 s_waitcnt vmcnt(12)
 s_waitcnt lgkmcnt(0)
 s_barrier
 v_mfma_f32_16x16x32_bf16 v[64:67], a[16:19], v[144:147], v[64:67]
 ds_read_b128 v[128:131], v4 offset:0
 s_add_u32 s91, s85, 63488
 s_add_u32 m0, s37, 32768
 v_mfma_f32_16x16x32_bf16 v[68:71], a[16:19], v[148:151], v[68:71]
 ds_read_b64_tr_b16 a[0:1], v5 offset:24576
 buffer_load_dwordx4 v1, s[24:27], s91 offen sc1 lds
 v_mfma_f32_16x16x32_bf16 v[72:75], a[16:19], v[152:155], v[72:75]
 ds_read_b64_tr_b16 a[2:3], v5 offset:26624
 v_mfma_f32_16x16x32_bf16 v[76:79], a[16:19], v[156:159], v[76:79]
 ds_read_b128 v[132:135], v4 offset:1024
 v_mfma_f32_16x16x32_bf16 v[92:95], a[20:23], v[156:159], v[92:95]
 ds_read_b128 v[136:139], v4 offset:4096
 buffer_load_dwordx4 v1, s[24:27], s91 offen offset:1024 sc1 lds
 v_mfma_f32_16x16x32_bf16 v[88:91], a[20:23], v[152:155], v[88:91]
 ds_read_b128 v[140:143], v4 offset:5120
 v_mfma_f32_16x16x32_bf16 v[84:87], a[20:23], v[148:151], v[84:87]
 ds_read_b64_tr_b16 a[4:5], v6 offset:24576
 s_add_u32 s92, s36, 2031616
 s_add_u32 m0, s38, 16384
 v_mfma_f32_16x16x32_bf16 v[80:83], a[20:23], v[144:147], v[80:83]
 ds_read_b64_tr_b16 a[6:7], v6 offset:26624
 buffer_load_dwordx4 v2, s[16:19], s92 offen lds
 v_mfma_f32_16x16x32_bf16 v[96:99], a[24:27], v[144:147], v[96:99]
 ds_read_b64_tr_b16 a[8:9], v7 offset:24576
 v_mfma_f32_16x16x32_bf16 v[100:103], a[24:27], v[148:151], v[100:103]
 ds_read_b64_tr_b16 a[10:11], v7 offset:26624
 s_add_u32 s92, s36, 2048000
 s_add_u32 m0, s38, 17408
 v_mfma_f32_16x16x32_bf16 v[104:107], a[24:27], v[152:155], v[104:107]
 ds_read_b64_tr_b16 a[12:13], v8 offset:24576
 buffer_load_dwordx4 v2, s[16:19], s92 offen lds
 v_mfma_f32_16x16x32_bf16 v[108:111], a[24:27], v[156:159], v[108:111]
 ds_read_b64_tr_b16 a[14:15], v8 offset:26624
 v_mfma_f32_16x16x32_bf16 v[124:127], a[28:31], v[156:159], v[124:127]
 v_mfma_f32_16x16x32_bf16 v[120:123], a[28:31], v[152:155], v[120:123]
 v_mfma_f32_16x16x32_bf16 v[116:119], a[28:31], v[148:151], v[116:119]
 v_mfma_f32_16x16x32_bf16 v[112:115], a[28:31], v[144:147], v[112:115]
 s_waitcnt vmcnt(12)
 s_waitcnt lgkmcnt(0)
 s_barrier
 v_mfma_f32_16x16x32_bf16 v[64:67], a[0:3], v[128:131], v[64:67]
 ds_read_b128 v[144:147], v4 offset:16384
 s_add_u32 s91, s85, 75776
 s_add_u32 m0, s37, 49152
 v_mfma_f32_16x16x32_bf16 v[68:71], a[0:3], v[132:135], v[68:71]
 ds_read_b64_tr_b16 a[16:17], v5 offset:32768
 buffer_load_dwordx4 v1, s[24:27], s91 offen sc1 lds
 v_mfma_f32_16x16x32_bf16 v[72:75], a[0:3], v[136:139], v[72:75]
 ds_read_b64_tr_b16 a[18:19], v5 offset:34816
 v_mfma_f32_16x16x32_bf16 v[76:79], a[0:3], v[140:143], v[76:79]
 ds_read_b128 v[148:151], v4 offset:17408
 v_mfma_f32_16x16x32_bf16 v[92:95], a[4:7], v[140:143], v[92:95]
 ds_read_b128 v[152:155], v4 offset:20480
 buffer_load_dwordx4 v1, s[24:27], s91 offen offset:1024 sc1 lds
 v_mfma_f32_16x16x32_bf16 v[88:91], a[4:7], v[136:139], v[88:91]
 ds_read_b128 v[156:159], v4 offset:21504
 v_mfma_f32_16x16x32_bf16 v[84:87], a[4:7], v[132:135], v[84:87]
 ds_read_b64_tr_b16 a[20:21], v6 offset:32768
 s_add_u32 s92, s36, 2424832
 s_add_u32 m0, s38, 24576
 v_mfma_f32_16x16x32_bf16 v[80:83], a[4:7], v[128:131], v[80:83]
 ds_read_b64_tr_b16 a[22:23], v6 offset:34816
 buffer_load_dwordx4 v2, s[16:19], s92 offen lds
 v_mfma_f32_16x16x32_bf16 v[96:99], a[8:11], v[128:131], v[96:99]
 ds_read_b64_tr_b16 a[24:25], v7 offset:32768
 v_mfma_f32_16x16x32_bf16 v[100:103], a[8:11], v[132:135], v[100:103]
 ds_read_b64_tr_b16 a[26:27], v7 offset:34816
 s_add_u32 s92, s36, 2441216
 s_add_u32 m0, s38, 25600
 v_mfma_f32_16x16x32_bf16 v[104:107], a[8:11], v[136:139], v[104:107]
 ds_read_b64_tr_b16 a[28:29], v8 offset:32768
 buffer_load_dwordx4 v2, s[16:19], s92 offen lds
 v_mfma_f32_16x16x32_bf16 v[108:111], a[8:11], v[140:143], v[108:111]
 ds_read_b64_tr_b16 a[30:31], v8 offset:34816
 v_mfma_f32_16x16x32_bf16 v[124:127], a[12:15], v[140:143], v[124:127]
 v_mfma_f32_16x16x32_bf16 v[120:123], a[12:15], v[136:139], v[120:123]
 v_mfma_f32_16x16x32_bf16 v[116:119], a[12:15], v[132:135], v[116:119]
 v_mfma_f32_16x16x32_bf16 v[112:115], a[12:15], v[128:131], v[112:115]
 s_waitcnt vmcnt(12)
 s_waitcnt lgkmcnt(0)
 s_barrier
 v_mfma_f32_16x16x32_bf16 v[64:67], a[16:19], v[144:147], v[64:67]
 ds_read_b128 v[128:131], v3 offset:0
 s_add_u32 s91, s86, 0
 s_add_u32 m0, s37, 65536
 v_mfma_f32_16x16x32_bf16 v[68:71], a[16:19], v[148:151], v[68:71]
 ds_read_b64_tr_b16 a[0:1], v5 offset:0
 buffer_load_dwordx4 v1, s[24:27], s91 offen sc1 lds
 v_mfma_f32_16x16x32_bf16 v[72:75], a[16:19], v[152:155], v[72:75]
 ds_read_b64_tr_b16 a[2:3], v5 offset:2048
 v_mfma_f32_16x16x32_bf16 v[76:79], a[16:19], v[156:159], v[76:79]
 ds_read_b128 v[132:135], v3 offset:1024
 v_mfma_f32_16x16x32_bf16 v[92:95], a[20:23], v[156:159], v[92:95]
 ds_read_b128 v[136:139], v3 offset:4096
 buffer_load_dwordx4 v1, s[24:27], s91 offen offset:1024 sc1 lds
 v_mfma_f32_16x16x32_bf16 v[88:91], a[20:23], v[152:155], v[88:91]
 ds_read_b128 v[140:143], v3 offset:5120
 v_mfma_f32_16x16x32_bf16 v[84:87], a[20:23], v[148:151], v[84:87]
 ds_read_b64_tr_b16 a[4:5], v6 offset:0
 s_add_u32 s92, s44, 0
 s_add_u32 m0, s38, 32768
 v_mfma_f32_16x16x32_bf16 v[80:83], a[20:23], v[144:147], v[80:83]
 ds_read_b64_tr_b16 a[6:7], v6 offset:2048
 buffer_load_dwordx4 v2, s[16:19], s92 offen lds
 v_mfma_f32_16x16x32_bf16 v[96:99], a[24:27], v[144:147], v[96:99]
 ds_read_b64_tr_b16 a[8:9], v7 offset:0
 v_mfma_f32_16x16x32_bf16 v[100:103], a[24:27], v[148:151], v[100:103]
 ds_read_b64_tr_b16 a[10:11], v7 offset:2048
 s_add_u32 s92, s44, 16384
 s_add_u32 m0, s38, 33792
 v_mfma_f32_16x16x32_bf16 v[104:107], a[24:27], v[152:155], v[104:107]
 ds_read_b64_tr_b16 a[12:13], v8 offset:0
 buffer_load_dwordx4 v2, s[16:19], s92 offen lds
 v_mfma_f32_16x16x32_bf16 v[108:111], a[24:27], v[156:159], v[108:111]
 ds_read_b64_tr_b16 a[14:15], v8 offset:2048
 v_mfma_f32_16x16x32_bf16 v[124:127], a[28:31], v[156:159], v[124:127]
 v_mfma_f32_16x16x32_bf16 v[120:123], a[28:31], v[152:155], v[120:123]
 v_mfma_f32_16x16x32_bf16 v[116:119], a[28:31], v[148:151], v[116:119]
 v_mfma_f32_16x16x32_bf16 v[112:115], a[28:31], v[144:147], v[112:115]
 s_waitcnt vmcnt(12)
 s_waitcnt lgkmcnt(0)
 s_barrier
 v_mfma_f32_16x16x32_bf16 v[64:67], a[0:3], v[128:131], v[64:67]
 ds_read_b128 v[144:147], v3 offset:16384
 s_add_u32 s91, s86, 20480
 s_add_u32 m0, s37, 0
 v_mfma_f32_16x16x32_bf16 v[68:71], a[0:3], v[132:135], v[68:71]
 ds_read_b64_tr_b16 a[16:17], v5 offset:8192
 buffer_load_dwordx4 v1, s[24:27], s91 offen sc1 lds
 v_mfma_f32_16x16x32_bf16 v[72:75], a[0:3], v[136:139], v[72:75]
 ds_read_b64_tr_b16 a[18:19], v5 offset:10240
 v_mfma_f32_16x16x32_bf16 v[76:79], a[0:3], v[140:143], v[76:79]
 ds_read_b128 v[148:151], v3 offset:17408
 v_mfma_f32_16x16x32_bf16 v[92:95], a[4:7], v[140:143], v[92:95]
 ds_read_b128 v[152:155], v3 offset:20480
 buffer_load_dwordx4 v1, s[24:27], s91 offen offset:1024 sc1 lds
 v_mfma_f32_16x16x32_bf16 v[88:91], a[4:7], v[136:139], v[88:91]
 ds_read_b128 v[156:159], v3 offset:21504
 v_mfma_f32_16x16x32_bf16 v[84:87], a[4:7], v[132:135], v[84:87]
 ds_read_b64_tr_b16 a[20:21], v6 offset:8192
 s_add_u32 s92, s44, 655360
 s_add_u32 m0, s38, 0
 v_mfma_f32_16x16x32_bf16 v[80:83], a[4:7], v[128:131], v[80:83]
 ds_read_b64_tr_b16 a[22:23], v6 offset:10240
 buffer_load_dwordx4 v2, s[16:19], s92 offen lds
 v_mfma_f32_16x16x32_bf16 v[96:99], a[8:11], v[128:131], v[96:99]
 ds_read_b64_tr_b16 a[24:25], v7 offset:8192
 v_mfma_f32_16x16x32_bf16 v[100:103], a[8:11], v[132:135], v[100:103]
 ds_read_b64_tr_b16 a[26:27], v7 offset:10240
 s_add_u32 s92, s44, 671744
 s_add_u32 m0, s38, 1024
 v_mfma_f32_16x16x32_bf16 v[104:107], a[8:11], v[136:139], v[104:107]
 ds_read_b64_tr_b16 a[28:29], v8 offset:8192
 buffer_load_dwordx4 v2, s[16:19], s92 offen lds
 v_mfma_f32_16x16x32_bf16 v[108:111], a[8:11], v[140:143], v[108:111]
 ds_read_b64_tr_b16 a[30:31], v8 offset:10240
 v_mfma_f32_16x16x32_bf16 v[124:127], a[12:15], v[140:143], v[124:127]
 v_mfma_f32_16x16x32_bf16 v[120:123], a[12:15], v[136:139], v[120:123]
 v_mfma_f32_16x16x32_bf16 v[116:119], a[12:15], v[132:135], v[116:119]
 v_mfma_f32_16x16x32_bf16 v[112:115], a[12:15], v[128:131], v[112:115]
 s_waitcnt vmcnt(12)
 s_waitcnt lgkmcnt(0)
 s_barrier
 v_mfma_f32_16x16x32_bf16 v[64:67], a[16:19], v[144:147], v[64:67]
 ds_read_b128 v[128:131], v3 offset:32768
 s_add_u32 s91, s86, 40960
 s_add_u32 m0, s37, 16384
 v_mfma_f32_16x16x32_bf16 v[68:71], a[16:19], v[148:151], v[68:71]
 ds_read_b64_tr_b16 a[0:1], v5 offset:16384
 buffer_load_dwordx4 v1, s[24:27], s91 offen sc1 lds
 v_mfma_f32_16x16x32_bf16 v[72:75], a[16:19], v[152:155], v[72:75]
 ds_read_b64_tr_b16 a[2:3], v5 offset:18432
 v_mfma_f32_16x16x32_bf16 v[76:79], a[16:19], v[156:159], v[76:79]
 ds_read_b128 v[132:135], v3 offset:33792
 v_mfma_f32_16x16x32_bf16 v[92:95], a[20:23], v[156:159], v[92:95]
 ds_read_b128 v[136:139], v3 offset:36864
 buffer_load_dwordx4 v1, s[24:27], s91 offen offset:1024 sc1 lds
 v_mfma_f32_16x16x32_bf16 v[88:91], a[20:23], v[152:155], v[88:91]
 ds_read_b128 v[140:143], v3 offset:37888
 v_mfma_f32_16x16x32_bf16 v[84:87], a[20:23], v[148:151], v[84:87]
 ds_read_b64_tr_b16 a[4:5], v6 offset:16384
 s_add_u32 s92, s44, 1310720
 s_add_u32 m0, s38, 8192
 v_mfma_f32_16x16x32_bf16 v[80:83], a[20:23], v[144:147], v[80:83]
 ds_read_b64_tr_b16 a[6:7], v6 offset:18432
 buffer_load_dwordx4 v2, s[16:19], s92 offen lds
 v_mfma_f32_16x16x32_bf16 v[96:99], a[24:27], v[144:147], v[96:99]
 ds_read_b64_tr_b16 a[8:9], v7 offset:16384
 v_mfma_f32_16x16x32_bf16 v[100:103], a[24:27], v[148:151], v[100:103]
 ds_read_b64_tr_b16 a[10:11], v7 offset:18432
 s_add_u32 s92, s44, 1327104
 s_add_u32 m0, s38, 9216
 v_mfma_f32_16x16x32_bf16 v[104:107], a[24:27], v[152:155], v[104:107]
 ds_read_b64_tr_b16 a[12:13], v8 offset:16384
 buffer_load_dwordx4 v2, s[16:19], s92 offen lds
 v_mfma_f32_16x16x32_bf16 v[108:111], a[24:27], v[156:159], v[108:111]
 ds_read_b64_tr_b16 a[14:15], v8 offset:18432
 v_mfma_f32_16x16x32_bf16 v[124:127], a[28:31], v[156:159], v[124:127]
 v_mfma_f32_16x16x32_bf16 v[120:123], a[28:31], v[152:155], v[120:123]
 v_mfma_f32_16x16x32_bf16 v[116:119], a[28:31], v[148:151], v[116:119]
 v_mfma_f32_16x16x32_bf16 v[112:115], a[28:31], v[144:147], v[112:115]
 s_waitcnt vmcnt(12)
 s_waitcnt lgkmcnt(0)
 s_barrier
 v_mfma_f32_16x16x32_bf16 v[64:67], a[0:3], v[128:131], v[64:67]
 ds_read_b128 v[144:147], v4 offset:0
 s_add_u32 s91, s86, 61440
 s_add_u32 m0, s37, 32768
 v_mfma_f32_16x16x32_bf16 v[68:71], a[0:3], v[132:135], v[68:71]
 ds_read_b64_tr_b16 a[16:17], v5 offset:24576
 buffer_load_dwordx4 v1, s[24:27], s91 offen sc1 lds
 v_mfma_f32_16x16x32_bf16 v[72:75], a[0:3], v[136:139], v[72:75]
 ds_read_b64_tr_b16 a[18:19], v5 offset:26624
 v_mfma_f32_16x16x32_bf16 v[76:79], a[0:3], v[140:143], v[76:79]
 ds_read_b128 v[148:151], v4 offset:1024
 v_mfma_f32_16x16x32_bf16 v[92:95], a[4:7], v[140:143], v[92:95]
 ds_read_b128 v[152:155], v4 offset:4096
 buffer_load_dwordx4 v1, s[24:27], s91 offen offset:1024 sc1 lds
 v_mfma_f32_16x16x32_bf16 v[88:91], a[4:7], v[136:139], v[88:91]
 ds_read_b128 v[156:159], v4 offset:5120
 v_mfma_f32_16x16x32_bf16 v[84:87], a[4:7], v[132:135], v[84:87]
 ds_read_b64_tr_b16 a[20:21], v6 offset:24576
 s_add_u32 s92, s44, 1966080
 s_add_u32 m0, s38, 16384
 v_mfma_f32_16x16x32_bf16 v[80:83], a[4:7], v[128:131], v[80:83]
 ds_read_b64_tr_b16 a[22:23], v6 offset:26624
 buffer_load_dwordx4 v2, s[16:19], s92 offen lds
 v_mfma_f32_16x16x32_bf16 v[96:99], a[8:11], v[128:131], v[96:99]
 ds_read_b64_tr_b16 a[24:25], v7 offset:24576
 v_mfma_f32_16x16x32_bf16 v[100:103], a[8:11], v[132:135], v[100:103]
 ds_read_b64_tr_b16 a[26:27], v7 offset:26624
 s_add_u32 s92, s44, 1982464
 s_add_u32 m0, s38, 17408
 v_mfma_f32_16x16x32_bf16 v[104:107], a[8:11], v[136:139], v[104:107]
 ds_read_b64_tr_b16 a[28:29], v8 offset:24576
 buffer_load_dwordx4 v2, s[16:19], s92 offen lds
 v_mfma_f32_16x16x32_bf16 v[108:111], a[8:11], v[140:143], v[108:111]
 ds_read_b64_tr_b16 a[30:31], v8 offset:26624
 v_mfma_f32_16x16x32_bf16 v[124:127], a[12:15], v[140:143], v[124:127]
 v_mfma_f32_16x16x32_bf16 v[120:123], a[12:15], v[136:139], v[120:123]
 v_mfma_f32_16x16x32_bf16 v[116:119], a[12:15], v[132:135], v[116:119]
 v_mfma_f32_16x16x32_bf16 v[112:115], a[12:15], v[128:131], v[112:115]
 s_waitcnt vmcnt(12)
 s_waitcnt lgkmcnt(0)
 s_barrier
 v_mfma_f32_16x16x32_bf16 v[64:67], a[16:19], v[144:147], v[64:67]
 ds_read_b128 v[128:131], v4 offset:16384
 s_add_u32 s91, s87, 0
 s_add_u32 m0, s37, 49152
 v_mfma_f32_16x16x32_bf16 v[68:71], a[16:19], v[148:151], v[68:71]
 ds_read_b64_tr_b16 a[0:1], v5 offset:32768
 buffer_load_dwordx4 v1, s[24:27], s91 offen sc1 lds
 v_mfma_f32_16x16x32_bf16 v[72:75], a[16:19], v[152:155], v[72:75]
 ds_read_b64_tr_b16 a[2:3], v5 offset:34816
 v_mfma_f32_16x16x32_bf16 v[76:79], a[16:19], v[156:159], v[76:79]
 ds_read_b128 v[132:135], v4 offset:17408
 v_mfma_f32_16x16x32_bf16 v[92:95], a[20:23], v[156:159], v[92:95]
 ds_read_b128 v[136:139], v4 offset:20480
 buffer_load_dwordx4 v1, s[24:27], s91 offen offset:1024 sc1 lds
 v_mfma_f32_16x16x32_bf16 v[88:91], a[20:23], v[152:155], v[88:91]
 ds_read_b128 v[140:143], v4 offset:21504
 v_mfma_f32_16x16x32_bf16 v[84:87], a[20:23], v[148:151], v[84:87]
 ds_read_b64_tr_b16 a[4:5], v6 offset:32768
 s_add_u32 s92, s35, 0
 s_add_u32 m0, s38, 24576
 v_mfma_f32_16x16x32_bf16 v[80:83], a[20:23], v[144:147], v[80:83]
 ds_read_b64_tr_b16 a[6:7], v6 offset:34816
 buffer_load_dwordx4 v2, s[12:15], s92 offen lds
 v_mfma_f32_16x16x32_bf16 v[96:99], a[24:27], v[144:147], v[96:99]
 ds_read_b64_tr_b16 a[8:9], v7 offset:32768
 v_mfma_f32_16x16x32_bf16 v[100:103], a[24:27], v[148:151], v[100:103]
 ds_read_b64_tr_b16 a[10:11], v7 offset:34816
 s_add_u32 s92, s35, 16384
 s_add_u32 m0, s38, 25600
 v_mfma_f32_16x16x32_bf16 v[104:107], a[24:27], v[152:155], v[104:107]
 ds_read_b64_tr_b16 a[12:13], v8 offset:32768
 buffer_load_dwordx4 v2, s[12:15], s92 offen lds
 v_mfma_f32_16x16x32_bf16 v[108:111], a[24:27], v[156:159], v[108:111]
 ds_read_b64_tr_b16 a[14:15], v8 offset:34816
 v_mfma_f32_16x16x32_bf16 v[124:127], a[28:31], v[156:159], v[124:127]
 v_mfma_f32_16x16x32_bf16 v[120:123], a[28:31], v[152:155], v[120:123]
 v_mfma_f32_16x16x32_bf16 v[116:119], a[28:31], v[148:151], v[116:119]
 v_mfma_f32_16x16x32_bf16 v[112:115], a[28:31], v[144:147], v[112:115]
 s_waitcnt vmcnt(12)
 s_waitcnt lgkmcnt(0)
 s_barrier
 v_mfma_f32_16x16x32_bf16 v[64:67], a[0:3], v[128:131], v[64:67]
 ds_read_b128 v[144:147], v3 offset:0
 s_add_u32 s91, s87, 4096
 s_add_u32 m0, s37, 65536
 v_mfma_f32_16x16x32_bf16 v[68:71], a[0:3], v[132:135], v[68:71]
 ds_read_b64_tr_b16 a[16:17], v5 offset:0
 buffer_load_dwordx4 v1, s[24:27], s91 offen sc1 lds
 v_mfma_f32_16x16x32_bf16 v[72:75], a[0:3], v[136:139], v[72:75]
 ds_read_b64_tr_b16 a[18:19], v5 offset:2048
 v_mfma_f32_16x16x32_bf16 v[76:79], a[0:3], v[140:143], v[76:79]
 ds_read_b128 v[148:151], v3 offset:1024
 v_mfma_f32_16x16x32_bf16 v[92:95], a[4:7], v[140:143], v[92:95]
 ds_read_b128 v[152:155], v3 offset:4096
 buffer_load_dwordx4 v1, s[24:27], s91 offen offset:1024 sc1 lds
 v_mfma_f32_16x16x32_bf16 v[88:91], a[4:7], v[136:139], v[88:91]
 ds_read_b128 v[156:159], v3 offset:5120
 v_mfma_f32_16x16x32_bf16 v[84:87], a[4:7], v[132:135], v[84:87]
 ds_read_b64_tr_b16 a[20:21], v6 offset:0
 s_add_u32 s92, s35, 131072
 s_add_u32 m0, s38, 32768
 v_mfma_f32_16x16x32_bf16 v[80:83], a[4:7], v[128:131], v[80:83]
 ds_read_b64_tr_b16 a[22:23], v6 offset:2048
 buffer_load_dwordx4 v2, s[12:15], s92 offen lds
 v_mfma_f32_16x16x32_bf16 v[96:99], a[8:11], v[128:131], v[96:99]
 ds_read_b64_tr_b16 a[24:25], v7 offset:0
 v_mfma_f32_16x16x32_bf16 v[100:103], a[8:11], v[132:135], v[100:103]
 ds_read_b64_tr_b16 a[26:27], v7 offset:2048
 s_add_u32 s92, s35, 147456
 s_add_u32 m0, s38, 33792
 v_mfma_f32_16x16x32_bf16 v[104:107], a[8:11], v[136:139], v[104:107]
 ds_read_b64_tr_b16 a[28:29], v8 offset:0
 buffer_load_dwordx4 v2, s[12:15], s92 offen lds
 v_mfma_f32_16x16x32_bf16 v[108:111], a[8:11], v[140:143], v[108:111]
 ds_read_b64_tr_b16 a[30:31], v8 offset:2048
 v_mfma_f32_16x16x32_bf16 v[124:127], a[12:15], v[140:143], v[124:127]
 v_mfma_f32_16x16x32_bf16 v[120:123], a[12:15], v[136:139], v[120:123]
 v_mfma_f32_16x16x32_bf16 v[116:119], a[12:15], v[132:135], v[116:119]
 v_mfma_f32_16x16x32_bf16 v[112:115], a[12:15], v[128:131], v[112:115]
 s_waitcnt vmcnt(12)
 s_waitcnt lgkmcnt(0)
 s_barrier
 v_mfma_f32_16x16x32_bf16 v[64:67], a[16:19], v[144:147], v[64:67]
 ds_read_b128 v[128:131], v3 offset:16384
 s_add_u32 s91, s87, 8192
 s_add_u32 m0, s37, 0
 v_mfma_f32_16x16x32_bf16 v[68:71], a[16:19], v[148:151], v[68:71]
 ds_read_b64_tr_b16 a[0:1], v5 offset:8192
 buffer_load_dwordx4 v1, s[24:27], s91 offen sc1 lds
 v_mfma_f32_16x16x32_bf16 v[72:75], a[16:19], v[152:155], v[72:75]
 ds_read_b64_tr_b16 a[2:3], v5 offset:10240
 v_mfma_f32_16x16x32_bf16 v[76:79], a[16:19], v[156:159], v[76:79]
 ds_read_b128 v[132:135], v3 offset:17408
 v_mfma_f32_16x16x32_bf16 v[92:95], a[20:23], v[156:159], v[92:95]
 ds_read_b128 v[136:139], v3 offset:20480
 buffer_load_dwordx4 v1, s[24:27], s91 offen offset:1024 sc1 lds
 v_mfma_f32_16x16x32_bf16 v[88:91], a[20:23], v[152:155], v[88:91]
 ds_read_b128 v[140:143], v3 offset:21504
 v_mfma_f32_16x16x32_bf16 v[84:87], a[20:23], v[148:151], v[84:87]
 ds_read_b64_tr_b16 a[4:5], v6 offset:8192
 s_add_u32 s92, s35, 262144
 s_add_u32 m0, s38, 0
 v_mfma_f32_16x16x32_bf16 v[80:83], a[20:23], v[144:147], v[80:83]
 ds_read_b64_tr_b16 a[6:7], v6 offset:10240
 buffer_load_dwordx4 v2, s[12:15], s92 offen lds
 v_mfma_f32_16x16x32_bf16 v[96:99], a[24:27], v[144:147], v[96:99]
 ds_read_b64_tr_b16 a[8:9], v7 offset:8192
 v_mfma_f32_16x16x32_bf16 v[100:103], a[24:27], v[148:151], v[100:103]
 ds_read_b64_tr_b16 a[10:11], v7 offset:10240
 s_add_u32 s92, s35, 278528
 s_add_u32 m0, s38, 1024
 v_mfma_f32_16x16x32_bf16 v[104:107], a[24:27], v[152:155], v[104:107]
 ds_read_b64_tr_b16 a[12:13], v8 offset:8192
 buffer_load_dwordx4 v2, s[12:15], s92 offen lds
 v_mfma_f32_16x16x32_bf16 v[108:111], a[24:27], v[156:159], v[108:111]
 ds_read_b64_tr_b16 a[14:15], v8 offset:10240
 v_mfma_f32_16x16x32_bf16 v[124:127], a[28:31], v[156:159], v[124:127]
 v_mfma_f32_16x16x32_bf16 v[120:123], a[28:31], v[152:155], v[120:123]
 v_mfma_f32_16x16x32_bf16 v[116:119], a[28:31], v[148:151], v[116:119]
 v_mfma_f32_16x16x32_bf16 v[112:115], a[28:31], v[144:147], v[112:115]
 s_waitcnt vmcnt(12)
 s_waitcnt lgkmcnt(0)
 s_barrier
 v_mfma_f32_16x16x32_bf16 v[64:67], a[0:3], v[128:131], v[64:67]
 ds_read_b128 v[144:147], v3 offset:32768
 s_add_u32 s91, s87, 12288
 s_add_u32 m0, s37, 16384
 v_mfma_f32_16x16x32_bf16 v[68:71], a[0:3], v[132:135], v[68:71]
 ds_read_b64_tr_b16 a[16:17], v5 offset:16384
 buffer_load_dwordx4 v1, s[24:27], s91 offen sc1 lds
 v_mfma_f32_16x16x32_bf16 v[72:75], a[0:3], v[136:139], v[72:75]
 ds_read_b64_tr_b16 a[18:19], v5 offset:18432
 v_mfma_f32_16x16x32_bf16 v[76:79], a[0:3], v[140:143], v[76:79]
 ds_read_b128 v[148:151], v3 offset:33792
 v_mfma_f32_16x16x32_bf16 v[92:95], a[4:7], v[140:143], v[92:95]
 ds_read_b128 v[152:155], v3 offset:36864
 buffer_load_dwordx4 v1, s[24:27], s91 offen offset:1024 sc1 lds
 v_mfma_f32_16x16x32_bf16 v[88:91], a[4:7], v[136:139], v[88:91]
 ds_read_b128 v[156:159], v3 offset:37888
 v_mfma_f32_16x16x32_bf16 v[84:87], a[4:7], v[132:135], v[84:87]
 ds_read_b64_tr_b16 a[20:21], v6 offset:16384
 s_add_u32 s92, s35, 393216
 s_add_u32 m0, s38, 8192
 v_mfma_f32_16x16x32_bf16 v[80:83], a[4:7], v[128:131], v[80:83]
 ds_read_b64_tr_b16 a[22:23], v6 offset:18432
 buffer_load_dwordx4 v2, s[12:15], s92 offen lds
 v_mfma_f32_16x16x32_bf16 v[96:99], a[8:11], v[128:131], v[96:99]
 ds_read_b64_tr_b16 a[24:25], v7 offset:16384
 v_mfma_f32_16x16x32_bf16 v[100:103], a[8:11], v[132:135], v[100:103]
 ds_read_b64_tr_b16 a[26:27], v7 offset:18432
 s_add_u32 s92, s35, 409600
 s_add_u32 m0, s38, 9216
 v_mfma_f32_16x16x32_bf16 v[104:107], a[8:11], v[136:139], v[104:107]
 ds_read_b64_tr_b16 a[28:29], v8 offset:16384
 buffer_load_dwordx4 v2, s[12:15], s92 offen lds
 v_mfma_f32_16x16x32_bf16 v[108:111], a[8:11], v[140:143], v[108:111]
 ds_read_b64_tr_b16 a[30:31], v8 offset:18432
 v_mfma_f32_16x16x32_bf16 v[124:127], a[12:15], v[140:143], v[124:127]
 v_mfma_f32_16x16x32_bf16 v[120:123], a[12:15], v[136:139], v[120:123]
 v_mfma_f32_16x16x32_bf16 v[116:119], a[12:15], v[132:135], v[116:119]
 v_mfma_f32_16x16x32_bf16 v[112:115], a[12:15], v[128:131], v[112:115]
 s_waitcnt vmcnt(12)
 s_waitcnt lgkmcnt(0)
 s_barrier
 v_mfma_f32_16x16x32_bf16 v[64:67], a[16:19], v[144:147], v[64:67]
 ds_read_b128 v[128:131], v4 offset:0
 s_add_u32 s91, s87, 16384
 s_add_u32 m0, s37, 32768
 v_mfma_f32_16x16x32_bf16 v[68:71], a[16:19], v[148:151], v[68:71]
 ds_read_b64_tr_b16 a[0:1], v5 offset:24576
 buffer_load_dwordx4 v1, s[24:27], s91 offen sc1 lds
 v_mfma_f32_16x16x32_bf16 v[72:75], a[16:19], v[152:155], v[72:75]
 ds_read_b64_tr_b16 a[2:3], v5 offset:26624
 v_mfma_f32_16x16x32_bf16 v[76:79], a[16:19], v[156:159], v[76:79]
 ds_read_b128 v[132:135], v4 offset:1024
 v_mfma_f32_16x16x32_bf16 v[92:95], a[20:23], v[156:159], v[92:95]
 ds_read_b128 v[136:139], v4 offset:4096
 buffer_load_dwordx4 v1, s[24:27], s91 offen offset:1024 sc1 lds
 v_mfma_f32_16x16x32_bf16 v[88:91], a[20:23], v[152:155], v[88:91]
 ds_read_b128 v[140:143], v4 offset:5120
 v_mfma_f32_16x16x32_bf16 v[84:87], a[20:23], v[148:151], v[84:87]
 ds_read_b64_tr_b16 a[4:5], v6 offset:24576
 s_add_u32 s92, s35, 524288
 s_add_u32 m0, s38, 16384
 v_mfma_f32_16x16x32_bf16 v[80:83], a[20:23], v[144:147], v[80:83]
 ds_read_b64_tr_b16 a[6:7], v6 offset:26624
 buffer_load_dwordx4 v2, s[12:15], s92 offen lds
 v_mfma_f32_16x16x32_bf16 v[96:99], a[24:27], v[144:147], v[96:99]
 ds_read_b64_tr_b16 a[8:9], v7 offset:24576
 v_mfma_f32_16x16x32_bf16 v[100:103], a[24:27], v[148:151], v[100:103]
 ds_read_b64_tr_b16 a[10:11], v7 offset:26624
 s_add_u32 s92, s35, 540672
 s_add_u32 m0, s38, 17408
 v_mfma_f32_16x16x32_bf16 v[104:107], a[24:27], v[152:155], v[104:107]
 ds_read_b64_tr_b16 a[12:13], v8 offset:24576
 buffer_load_dwordx4 v2, s[12:15], s92 offen lds
 v_mfma_f32_16x16x32_bf16 v[108:111], a[24:27], v[156:159], v[108:111]
 ds_read_b64_tr_b16 a[14:15], v8 offset:26624
 v_mfma_f32_16x16x32_bf16 v[124:127], a[28:31], v[156:159], v[124:127]
 v_mfma_f32_16x16x32_bf16 v[120:123], a[28:31], v[152:155], v[120:123]
 v_mfma_f32_16x16x32_bf16 v[116:119], a[28:31], v[148:151], v[116:119]
 v_mfma_f32_16x16x32_bf16 v[112:115], a[28:31], v[144:147], v[112:115]
 s_waitcnt vmcnt(12)
 s_waitcnt lgkmcnt(0)
 s_barrier
 v_mfma_f32_16x16x32_bf16 v[64:67], a[0:3], v[128:131], v[64:67]
 ds_read_b128 v[144:147], v4 offset:16384
 s_add_u32 s91, s87, 20480
 s_add_u32 m0, s37, 49152
 v_mfma_f32_16x16x32_bf16 v[68:71], a[0:3], v[132:135], v[68:71]
 ds_read_b64_tr_b16 a[16:17], v5 offset:32768
 buffer_load_dwordx4 v1, s[24:27], s91 offen sc1 lds
 v_mfma_f32_16x16x32_bf16 v[72:75], a[0:3], v[136:139], v[72:75]
 ds_read_b64_tr_b16 a[18:19], v5 offset:34816
 v_mfma_f32_16x16x32_bf16 v[76:79], a[0:3], v[140:143], v[76:79]
 ds_read_b128 v[148:151], v4 offset:17408
 v_mfma_f32_16x16x32_bf16 v[92:95], a[4:7], v[140:143], v[92:95]
 ds_read_b128 v[152:155], v4 offset:20480
 buffer_load_dwordx4 v1, s[24:27], s91 offen offset:1024 sc1 lds
 v_mfma_f32_16x16x32_bf16 v[88:91], a[4:7], v[136:139], v[88:91]
 ds_read_b128 v[156:159], v4 offset:21504
 v_mfma_f32_16x16x32_bf16 v[84:87], a[4:7], v[132:135], v[84:87]
 ds_read_b64_tr_b16 a[20:21], v6 offset:32768
 s_add_u32 s92, s35, 655360
 s_add_u32 m0, s38, 24576
 v_mfma_f32_16x16x32_bf16 v[80:83], a[4:7], v[128:131], v[80:83]
 ds_read_b64_tr_b16 a[22:23], v6 offset:34816
 buffer_load_dwordx4 v2, s[12:15], s92 offen lds
 v_mfma_f32_16x16x32_bf16 v[96:99], a[8:11], v[128:131], v[96:99]
 ds_read_b64_tr_b16 a[24:25], v7 offset:32768
 v_mfma_f32_16x16x32_bf16 v[100:103], a[8:11], v[132:135], v[100:103]
 ds_read_b64_tr_b16 a[26:27], v7 offset:34816
 s_add_u32 s92, s35, 671744
 s_add_u32 m0, s38, 25600
 v_mfma_f32_16x16x32_bf16 v[104:107], a[8:11], v[136:139], v[104:107]
 ds_read_b64_tr_b16 a[28:29], v8 offset:32768
 buffer_load_dwordx4 v2, s[12:15], s92 offen lds
 v_mfma_f32_16x16x32_bf16 v[108:111], a[8:11], v[140:143], v[108:111]
 ds_read_b64_tr_b16 a[30:31], v8 offset:34816
 v_mfma_f32_16x16x32_bf16 v[124:127], a[12:15], v[140:143], v[124:127]
 v_mfma_f32_16x16x32_bf16 v[120:123], a[12:15], v[136:139], v[120:123]
 v_mfma_f32_16x16x32_bf16 v[116:119], a[12:15], v[132:135], v[116:119]
 v_mfma_f32_16x16x32_bf16 v[112:115], a[12:15], v[128:131], v[112:115]
 s_waitcnt vmcnt(12)
 s_waitcnt lgkmcnt(0)
 s_barrier
 v_mfma_f32_16x16x32_bf16 v[64:67], a[16:19], v[144:147], v[64:67]
 ds_read_b128 v[128:131], v3 offset:0
 s_add_u32 s91, s87, 24576
 s_add_u32 m0, s37, 65536
 v_mfma_f32_16x16x32_bf16 v[68:71], a[16:19], v[148:151], v[68:71]
 ds_read_b64_tr_b16 a[0:1], v5 offset:0
 buffer_load_dwordx4 v1, s[24:27], s91 offen sc1 lds
 v_mfma_f32_16x16x32_bf16 v[72:75], a[16:19], v[152:155], v[72:75]
 ds_read_b64_tr_b16 a[2:3], v5 offset:2048
 v_mfma_f32_16x16x32_bf16 v[76:79], a[16:19], v[156:159], v[76:79]
 ds_read_b128 v[132:135], v3 offset:1024
 v_mfma_f32_16x16x32_bf16 v[92:95], a[20:23], v[156:159], v[92:95]
 ds_read_b128 v[136:139], v3 offset:4096
 buffer_load_dwordx4 v1, s[24:27], s91 offen offset:1024 sc1 lds
 v_mfma_f32_16x16x32_bf16 v[88:91], a[20:23], v[152:155], v[88:91]
 ds_read_b128 v[140:143], v3 offset:5120
 v_mfma_f32_16x16x32_bf16 v[84:87], a[20:23], v[148:151], v[84:87]
 ds_read_b64_tr_b16 a[4:5], v6 offset:0
 s_add_u32 s92, s35, 786432
 s_add_u32 m0, s38, 32768
 v_mfma_f32_16x16x32_bf16 v[80:83], a[20:23], v[144:147], v[80:83]
 ds_read_b64_tr_b16 a[6:7], v6 offset:2048
 buffer_load_dwordx4 v2, s[12:15], s92 offen lds
 v_mfma_f32_16x16x32_bf16 v[96:99], a[24:27], v[144:147], v[96:99]
 ds_read_b64_tr_b16 a[8:9], v7 offset:0
 v_mfma_f32_16x16x32_bf16 v[100:103], a[24:27], v[148:151], v[100:103]
 ds_read_b64_tr_b16 a[10:11], v7 offset:2048
 s_add_u32 s92, s35, 802816
 s_add_u32 m0, s38, 33792
 v_mfma_f32_16x16x32_bf16 v[104:107], a[24:27], v[152:155], v[104:107]
 ds_read_b64_tr_b16 a[12:13], v8 offset:0
 buffer_load_dwordx4 v2, s[12:15], s92 offen lds
 v_mfma_f32_16x16x32_bf16 v[108:111], a[24:27], v[156:159], v[108:111]
 ds_read_b64_tr_b16 a[14:15], v8 offset:2048
 v_mfma_f32_16x16x32_bf16 v[124:127], a[28:31], v[156:159], v[124:127]
 v_mfma_f32_16x16x32_bf16 v[120:123], a[28:31], v[152:155], v[120:123]
 v_mfma_f32_16x16x32_bf16 v[116:119], a[28:31], v[148:151], v[116:119]
 v_mfma_f32_16x16x32_bf16 v[112:115], a[28:31], v[144:147], v[112:115]
 s_waitcnt vmcnt(12)
 s_waitcnt lgkmcnt(0)
 s_barrier
 v_mfma_f32_16x16x32_bf16 v[64:67], a[0:3], v[128:131], v[64:67]
 ds_read_b128 v[144:147], v3 offset:16384
 s_add_u32 s91, s87, 28672
 s_add_u32 m0, s37, 0
 v_mfma_f32_16x16x32_bf16 v[68:71], a[0:3], v[132:135], v[68:71]
 ds_read_b64_tr_b16 a[16:17], v5 offset:8192
 buffer_load_dwordx4 v1, s[24:27], s91 offen sc1 lds
 v_mfma_f32_16x16x32_bf16 v[72:75], a[0:3], v[136:139], v[72:75]
 ds_read_b64_tr_b16 a[18:19], v5 offset:10240
 v_mfma_f32_16x16x32_bf16 v[76:79], a[0:3], v[140:143], v[76:79]
 ds_read_b128 v[148:151], v3 offset:17408
 v_mfma_f32_16x16x32_bf16 v[92:95], a[4:7], v[140:143], v[92:95]
 ds_read_b128 v[152:155], v3 offset:20480
 buffer_load_dwordx4 v1, s[24:27], s91 offen offset:1024 sc1 lds
 v_mfma_f32_16x16x32_bf16 v[88:91], a[4:7], v[136:139], v[88:91]
 ds_read_b128 v[156:159], v3 offset:21504
 v_mfma_f32_16x16x32_bf16 v[84:87], a[4:7], v[132:135], v[84:87]
 ds_read_b64_tr_b16 a[20:21], v6 offset:8192
 s_add_u32 s92, s35, 917504
 s_add_u32 m0, s38, 0
 v_mfma_f32_16x16x32_bf16 v[80:83], a[4:7], v[128:131], v[80:83]
 ds_read_b64_tr_b16 a[22:23], v6 offset:10240
 buffer_load_dwordx4 v2, s[12:15], s92 offen lds
 v_mfma_f32_16x16x32_bf16 v[96:99], a[8:11], v[128:131], v[96:99]
 ds_read_b64_tr_b16 a[24:25], v7 offset:8192
 v_mfma_f32_16x16x32_bf16 v[100:103], a[8:11], v[132:135], v[100:103]
 ds_read_b64_tr_b16 a[26:27], v7 offset:10240
 s_add_u32 s92, s35, 933888
 s_add_u32 m0, s38, 1024
 v_mfma_f32_16x16x32_bf16 v[104:107], a[8:11], v[136:139], v[104:107]
 ds_read_b64_tr_b16 a[28:29], v8 offset:8192
 buffer_load_dwordx4 v2, s[12:15], s92 offen lds
 v_mfma_f32_16x16x32_bf16 v[108:111], a[8:11], v[140:143], v[108:111]
 ds_read_b64_tr_b16 a[30:31], v8 offset:10240
 v_mfma_f32_16x16x32_bf16 v[124:127], a[12:15], v[140:143], v[124:127]
 v_mfma_f32_16x16x32_bf16 v[120:123], a[12:15], v[136:139], v[120:123]
 v_mfma_f32_16x16x32_bf16 v[116:119], a[12:15], v[132:135], v[116:119]
 v_mfma_f32_16x16x32_bf16 v[112:115], a[12:15], v[128:131], v[112:115]
 s_waitcnt vmcnt(12)
 s_waitcnt lgkmcnt(0)
 s_barrier
 v_mfma_f32_16x16x32_bf16 v[64:67], a[16:19], v[144:147], v[64:67]
 ds_read_b128 v[128:131], v3 offset:32768
 v_mfma_f32_16x16x32_bf16 v[68:71], a[16:19], v[148:151], v[68:71]
 ds_read_b64_tr_b16 a[0:1], v5 offset:16384
 v_mfma_f32_16x16x32_bf16 v[72:75], a[16:19], v[152:155], v[72:75]
 ds_read_b64_tr_b16 a[2:3], v5 offset:18432
 v_mfma_f32_16x16x32_bf16 v[76:79], a[16:19], v[156:159], v[76:79]
 ds_read_b128 v[132:135], v3 offset:33792
 v_mfma_f32_16x16x32_bf16 v[92:95], a[20:23], v[156:159], v[92:95]
 ds_read_b128 v[136:139], v3 offset:36864
 v_mfma_f32_16x16x32_bf16 v[88:91], a[20:23], v[152:155], v[88:91]
 ds_read_b128 v[140:143], v3 offset:37888
 v_mfma_f32_16x16x32_bf16 v[84:87], a[20:23], v[148:151], v[84:87]
 ds_read_b64_tr_b16 a[4:5], v6 offset:16384
 v_mfma_f32_16x16x32_bf16 v[80:83], a[20:23], v[144:147], v[80:83]
 ds_read_b64_tr_b16 a[6:7], v6 offset:18432
 v_mfma_f32_16x16x32_bf16 v[96:99], a[24:27], v[144:147], v[96:99]
 ds_read_b64_tr_b16 a[8:9], v7 offset:16384
 v_mfma_f32_16x16x32_bf16 v[100:103], a[24:27], v[148:151], v[100:103]
 ds_read_b64_tr_b16 a[10:11], v7 offset:18432
 v_mfma_f32_16x16x32_bf16 v[104:107], a[24:27], v[152:155], v[104:107]
 ds_read_b64_tr_b16 a[12:13], v8 offset:16384
 v_mfma_f32_16x16x32_bf16 v[108:111], a[24:27], v[156:159], v[108:111]
 ds_read_b64_tr_b16 a[14:15], v8 offset:18432
 v_mfma_f32_16x16x32_bf16 v[124:127], a[28:31], v[156:159], v[124:127]
 v_mfma_f32_16x16x32_bf16 v[120:123], a[28:31], v[152:155], v[120:123]
 v_mfma_f32_16x16x32_bf16 v[116:119], a[28:31], v[148:151], v[116:119]
 v_mfma_f32_16x16x32_bf16 v[112:115], a[28:31], v[144:147], v[112:115]
 s_waitcnt vmcnt(8)
 s_waitcnt lgkmcnt(0)
 s_barrier
 v_mfma_f32_16x16x32_bf16 v[64:67], a[0:3], v[128:131], v[64:67]
 ds_read_b128 v[144:147], v4 offset:0
 v_mfma_f32_16x16x32_bf16 v[68:71], a[0:3], v[132:135], v[68:71]
 ds_read_b64_tr_b16 a[16:17], v5 offset:24576
 v_mfma_f32_16x16x32_bf16 v[72:75], a[0:3], v[136:139], v[72:75]
 ds_read_b64_tr_b16 a[18:19], v5 offset:26624
 v_mfma_f32_16x16x32_bf16 v[76:79], a[0:3], v[140:143], v[76:79]
 ds_read_b128 v[148:151], v4 offset:1024
 v_mfma_f32_16x16x32_bf16 v[92:95], a[4:7], v[140:143], v[92:95]
 ds_read_b128 v[152:155], v4 offset:4096
 v_mfma_f32_16x16x32_bf16 v[88:91], a[4:7], v[136:139], v[88:91]
 ds_read_b128 v[156:159], v4 offset:5120
 v_mfma_f32_16x16x32_bf16 v[84:87], a[4:7], v[132:135], v[84:87]
 ds_read_b64_tr_b16 a[20:21], v6 offset:24576
 v_mfma_f32_16x16x32_bf16 v[80:83], a[4:7], v[128:131], v[80:83]
 ds_read_b64_tr_b16 a[22:23], v6 offset:26624
 v_mfma_f32_16x16x32_bf16 v[96:99], a[8:11], v[128:131], v[96:99]
 ds_read_b64_tr_b16 a[24:25], v7 offset:24576
 v_mfma_f32_16x16x32_bf16 v[100:103], a[8:11], v[132:135], v[100:103]
 ds_read_b64_tr_b16 a[26:27], v7 offset:26624
 v_mfma_f32_16x16x32_bf16 v[104:107], a[8:11], v[136:139], v[104:107]
 ds_read_b64_tr_b16 a[28:29], v8 offset:24576
 v_mfma_f32_16x16x32_bf16 v[108:111], a[8:11], v[140:143], v[108:111]
 ds_read_b64_tr_b16 a[30:31], v8 offset:26624
 v_mfma_f32_16x16x32_bf16 v[124:127], a[12:15], v[140:143], v[124:127]
 v_mfma_f32_16x16x32_bf16 v[120:123], a[12:15], v[136:139], v[120:123]
 v_mfma_f32_16x16x32_bf16 v[116:119], a[12:15], v[132:135], v[116:119]
 v_mfma_f32_16x16x32_bf16 v[112:115], a[12:15], v[128:131], v[112:115]
 s_waitcnt vmcnt(4)
 s_waitcnt lgkmcnt(0)
 s_barrier
 v_mfma_f32_16x16x32_bf16 v[64:67], a[16:19], v[144:147], v[64:67]
 ds_read_b128 v[128:131], v4 offset:16384
 v_mfma_f32_16x16x32_bf16 v[68:71], a[16:19], v[148:151], v[68:71]
 ds_read_b64_tr_b16 a[0:1], v5 offset:32768
 v_mfma_f32_16x16x32_bf16 v[72:75], a[16:19], v[152:155], v[72:75]
 ds_read_b64_tr_b16 a[2:3], v5 offset:34816
 v_mfma_f32_16x16x32_bf16 v[76:79], a[16:19], v[156:159], v[76:79]
 ds_read_b128 v[132:135], v4 offset:17408
 v_mfma_f32_16x16x32_bf16 v[92:95], a[20:23], v[156:159], v[92:95]
 ds_read_b128 v[136:139], v4 offset:20480
 v_mfma_f32_16x16x32_bf16 v[88:91], a[20:23], v[152:155], v[88:91]
 ds_read_b128 v[140:143], v4 offset:21504
 v_mfma_f32_16x16x32_bf16 v[84:87], a[20:23], v[148:151], v[84:87]
 ds_read_b64_tr_b16 a[4:5], v6 offset:32768
 v_mfma_f32_16x16x32_bf16 v[80:83], a[20:23], v[144:147], v[80:83]
 ds_read_b64_tr_b16 a[6:7], v6 offset:34816
 v_mfma_f32_16x16x32_bf16 v[96:99], a[24:27], v[144:147], v[96:99]
 ds_read_b64_tr_b16 a[8:9], v7 offset:32768
 v_mfma_f32_16x16x32_bf16 v[100:103], a[24:27], v[148:151], v[100:103]
 ds_read_b64_tr_b16 a[10:11], v7 offset:34816
 v_mfma_f32_16x16x32_bf16 v[104:107], a[24:27], v[152:155], v[104:107]
 ds_read_b64_tr_b16 a[12:13], v8 offset:32768
 v_mfma_f32_16x16x32_bf16 v[108:111], a[24:27], v[156:159], v[108:111]
 ds_read_b64_tr_b16 a[14:15], v8 offset:34816
 v_mfma_f32_16x16x32_bf16 v[124:127], a[28:31], v[156:159], v[124:127]
 v_mfma_f32_16x16x32_bf16 v[120:123], a[28:31], v[152:155], v[120:123]
 v_mfma_f32_16x16x32_bf16 v[116:119], a[28:31], v[148:151], v[116:119]
 v_mfma_f32_16x16x32_bf16 v[112:115], a[28:31], v[144:147], v[112:115]
 s_waitcnt vmcnt(0)
 s_waitcnt lgkmcnt(0)
 s_barrier
 v_and_b32 v10, 15, v0
 s_lshl_b32 s56, s39, 7
 s_bfe_u32 s57, s28, 0x10001
 s_lshl_b32 s57, s57, 6
 s_add_u32 s56, s56, s57
 s_lshl_b32 s57, s34, 5
 s_add_u32 s56, s56, s57
 v_add_u32 v10, s56, v10
 v_lshlrev_b32 v10, 11, v10
 v_bfe_u32 v11, v0, 4, 1
 v_lshl_add_u32 v10, v11, 5, v10
 v_lshrrev_b32 v11, 5, v0
 v_lshl_add_u32 v10, v11, 4, v10
 s_lshl_b32 s56, s33, 8
 s_and_b32 s57, s28, 1
 s_lshl_b32 s57, s57, 7
 s_add_u32 s56, s56, s57
 s_lshl_b32 s57, s30, 6
 s_add_u32 s56, s56, s57
 v_add_u32 v9, s56, v10
 buffer_load_dwordx4 v[48:51], v9, s[8:11], 0 offen
 s_mov_b32 s88, 32768
 buffer_load_dwordx4 v[52:55], v9, s[8:11], s88 offen
 v_lshlrev_b32 v11, 4, v0
 s_lshl_b32 s56, s28, 13
 v_add_u32 v12, s56, v11
 v_xor_b32 v13, 0x8000, v12
 s_lshl_b32 s56, s39, 3
 s_add_u32 s56, s56, s33
 s_lshl_b32 s56, s56, 15
 s_lshl_b32 s57, s28, 11
 s_add_u32 s56, s56, s57
 s_lshl_b32 s57, s34, 14
 s_add_u32 s91, s56, s57
 s_xor_b32 s57, s57, 16384
 s_add_u32 s90, s56, s57
 v_mfma_f32_16x16x32_bf16 v[64:67], a[0:3], v[128:131], v[64:67]
 ds_read_b128 v[144:147], v3 offset:0
 v_mfma_f32_16x16x32_bf16 v[68:71], a[0:3], v[132:135], v[68:71]
 ds_read_b64_tr_b16 a[16:17], v5 offset:0
 v_mfma_f32_16x16x32_bf16 v[72:75], a[0:3], v[136:139], v[72:75]
 ds_read_b64_tr_b16 a[18:19], v5 offset:2048
 v_mfma_f32_16x16x32_bf16 v[76:79], a[0:3], v[140:143], v[76:79]
 ds_read_b128 v[148:151], v3 offset:1024
 v_mfma_f32_16x16x32_bf16 v[92:95], a[4:7], v[140:143], v[92:95]
 ds_read_b128 v[152:155], v3 offset:4096
 v_mfma_f32_16x16x32_bf16 v[88:91], a[4:7], v[136:139], v[88:91]
 ds_read_b128 v[156:159], v3 offset:5120
 v_mfma_f32_16x16x32_bf16 v[84:87], a[4:7], v[132:135], v[84:87]
 ds_read_b64_tr_b16 a[20:21], v6 offset:0
 v_mfma_f32_16x16x32_bf16 v[80:83], a[4:7], v[128:131], v[80:83]
 ds_read_b64_tr_b16 a[22:23], v6 offset:2048
 v_mfma_f32_16x16x32_bf16 v[96:99], a[8:11], v[128:131], v[96:99]
 ds_read_b64_tr_b16 a[24:25], v7 offset:0
 v_mfma_f32_16x16x32_bf16 v[100:103], a[8:11], v[132:135], v[100:103]
 ds_read_b64_tr_b16 a[26:27], v7 offset:2048
 v_mfma_f32_16x16x32_bf16 v[104:107], a[8:11], v[136:139], v[104:107]
 ds_read_b64_tr_b16 a[28:29], v8 offset:0
 v_mfma_f32_16x16x32_bf16 v[108:111], a[8:11], v[140:143], v[108:111]
 ds_read_b64_tr_b16 a[30:31], v8 offset:2048
 v_mfma_f32_16x16x32_bf16 v[124:127], a[12:15], v[140:143], v[124:127]
 v_mfma_f32_16x16x32_bf16 v[120:123], a[12:15], v[136:139], v[120:123]
 v_mfma_f32_16x16x32_bf16 v[116:119], a[12:15], v[132:135], v[116:119]
 v_mfma_f32_16x16x32_bf16 v[112:115], a[12:15], v[128:131], v[112:115]
 s_waitcnt lgkmcnt(0)
 s_barrier
 v_mfma_f32_16x16x32_bf16 v[64:67], a[16:19], v[144:147], v[64:67]
 v_mfma_f32_16x16x32_bf16 v[68:71], a[16:19], v[148:151], v[68:71]
 v_mfma_f32_16x16x32_bf16 v[72:75], a[16:19], v[152:155], v[72:75]
 v_mfma_f32_16x16x32_bf16 v[76:79], a[16:19], v[156:159], v[76:79]
 v_mfma_f32_16x16x32_bf16 v[92:95], a[20:23], v[156:159], v[92:95]
 v_mfma_f32_16x16x32_bf16 v[88:91], a[20:23], v[152:155], v[88:91]
 v_mfma_f32_16x16x32_bf16 v[84:87], a[20:23], v[148:151], v[84:87]
 v_mfma_f32_16x16x32_bf16 v[80:83], a[20:23], v[144:147], v[80:83]
 v_mfma_f32_16x16x32_bf16 v[96:99], a[24:27], v[144:147], v[96:99]
 v_mfma_f32_16x16x32_bf16 v[100:103], a[24:27], v[148:151], v[100:103]
 v_mfma_f32_16x16x32_bf16 v[104:107], a[24:27], v[152:155], v[104:107]
 v_mfma_f32_16x16x32_bf16 v[108:111], a[24:27], v[156:159], v[108:111]
 v_mfma_f32_16x16x32_bf16 v[124:127], a[28:31], v[156:159], v[124:127]
 v_mfma_f32_16x16x32_bf16 v[120:123], a[28:31], v[152:155], v[120:123]
 v_mfma_f32_16x16x32_bf16 v[116:119], a[28:31], v[148:151], v[116:119]
 v_mfma_f32_16x16x32_bf16 v[112:115], a[28:31], v[144:147], v[112:115]
 s_nop 7
 s_cmp_eq_u32 s30, 0
 s_cbranch_scc1 L_k2_g0
 ds_write_b128 v12, v[64:67] offset:0
 ds_write_b128 v12, v[68:71] offset:1024
 ds_write_b128 v12, v[72:75] offset:2048
 ds_write_b128 v12, v[76:79] offset:3072
 ds_write_b128 v12, v[80:83] offset:4096
 ds_write_b128 v12, v[84:87] offset:5120
 ds_write_b128 v12, v[88:91] offset:6144
 ds_write_b128 v12, v[92:95] offset:7168
 s_waitcnt lgkmcnt(0)
 v_mov_b32 v64, v96
 v_mov_b32 v65, v97
 v_mov_b32 v66, v98
 v_mov_b32 v67, v99
 v_mov_b32 v68, v100
 v_mov_b32 v69, v101
 v_mov_b32 v70, v102
 v_mov_b32 v71, v103
 v_mov_b32 v72, v104
 v_mov_b32 v73, v105
 v_mov_b32 v74, v106
 v_mov_b32 v75, v107
 v_mov_b32 v76, v108
 v_mov_b32 v77, v109
 v_mov_b32 v78, v110
 v_mov_b32 v79, v111
 v_mov_b32 v80, v112
 v_mov_b32 v81, v113
 v_mov_b32 v82, v114
 v_mov_b32 v83, v115
 v_mov_b32 v84, v116
 v_mov_b32 v85, v117
 v_mov_b32 v86, v118
 v_mov_b32 v87, v119
 v_mov_b32 v88, v120
 v_mov_b32 v89, v121
 v_mov_b32 v90, v122
 v_mov_b32 v91, v123
 v_mov_b32 v92, v124
 v_mov_b32 v93, v125
 v_mov_b32 v94, v126
 v_mov_b32 v95, v127
 s_branch L_k2_g1
L_k2_g0:
 ds_write_b128 v12, v[96:99] offset:0
 ds_write_b128 v12, v[100:103] offset:1024
 ds_write_b128 v12, v[104:107] offset:2048
 ds_write_b128 v12, v[108:111] offset:3072
 ds_write_b128 v12, v[112:115] offset:4096
 ds_write_b128 v12, v[116:119] offset:5120
 ds_write_b128 v12, v[120:123] offset:6144
 ds_write_b128 v12, v[124:127] offset:7168
 s_waitcnt lgkmcnt(0)
L_k2_g1:
 s_barrier
 s_cmp_eq_u32 s34, 0
 s_cbranch_scc1 L_k2_s0
 ds_read_b128 v[96:99], v13 offset:0
 ds_read_b128 v[112:115], v13 offset:4096
 ds_read_b128 v[100:103], v13 offset:1024
 ds_read_b128 v[116:119], v13 offset:5120
 ds_read_b128 v[104:107], v13 offset:2048
 ds_read_b128 v[120:123], v13 offset:6144
 ds_read_b128 v[108:111], v13 offset:3072
 ds_read_b128 v[124:127], v13 offset:7168
 s_waitcnt lgkmcnt(7)
 v_pk_add_f32 v[64:65], v[64:65], v[96:97]
 v_pk_add_f32 v[66:67], v[66:67], v[98:99]
 v_cvt_pk_bf16_f32 v16, v64, v65
 v_cvt_pk_bf16_f32 v17, v66, v67
 s_waitcnt lgkmcnt(6)
 v_pk_add_f32 v[80:81], v[80:81], v[112:113]
 v_pk_add_f32 v[82:83], v[82:83], v[114:115]
 v_cvt_pk_bf16_f32 v18, v80, v81
 v_cvt_pk_bf16_f32 v19, v82, v83
 s_waitcnt lgkmcnt(5)
 v_pk_add_f32 v[68:69], v[68:69], v[100:101]
 v_pk_add_f32 v[70:71], v[70:71], v[102:103]
 v_cvt_pk_bf16_f32 v20, v68, v69
 v_cvt_pk_bf16_f32 v21, v70, v71
 s_waitcnt lgkmcnt(4)
 v_pk_add_f32 v[84:85], v[84:85], v[116:117]
 v_pk_add_f32 v[86:87], v[86:87], v[118:119]
 v_cvt_pk_bf16_f32 v22, v84, v85
 v_cvt_pk_bf16_f32 v23, v86, v87
 buffer_store_dwordx4 v[16:19], v11, s[20:23], s90 offen sc1
 buffer_store_dwordx4 v[20:23], v11, s[20:23], s90 offen offset:1024 sc1
 s_waitcnt lgkmcnt(3)
 v_pk_add_f32 v[32:33], v[72:73], v[104:105]
 v_pk_add_f32 v[34:35], v[74:75], v[106:107]
 s_waitcnt lgkmcnt(2)
 v_pk_add_f32 v[36:37], v[88:89], v[120:121]
 v_pk_add_f32 v[38:39], v[90:91], v[122:123]
 s_waitcnt lgkmcnt(1)
 v_pk_add_f32 v[40:41], v[76:77], v[108:109]
 v_pk_add_f32 v[42:43], v[78:79], v[110:111]
 s_waitcnt lgkmcnt(0)
 v_pk_add_f32 v[44:45], v[92:93], v[124:125]
 v_pk_add_f32 v[46:47], v[94:95], v[126:127]
 s_branch L_k2_s1
L_k2_s0:
 ds_read_b128 v[104:107], v13 offset:2048
 ds_read_b128 v[120:123], v13 offset:6144
 ds_read_b128 v[108:111], v13 offset:3072
 ds_read_b128 v[124:127], v13 offset:7168
 ds_read_b128 v[96:99], v13 offset:0
 ds_read_b128 v[112:115], v13 offset:4096
 ds_read_b128 v[100:103], v13 offset:1024
 ds_read_b128 v[116:119], v13 offset:5120
 s_waitcnt lgkmcnt(7)
 v_pk_add_f32 v[72:73], v[72:73], v[104:105]
 v_pk_add_f32 v[74:75], v[74:75], v[106:107]
 v_cvt_pk_bf16_f32 v16, v72, v73
 v_cvt_pk_bf16_f32 v17, v74, v75
 s_waitcnt lgkmcnt(6)
 v_pk_add_f32 v[88:89], v[88:89], v[120:121]
 v_pk_add_f32 v[90:91], v[90:91], v[122:123]
 v_cvt_pk_bf16_f32 v18, v88, v89
 v_cvt_pk_bf16_f32 v19, v90, v91
 s_waitcnt lgkmcnt(5)
 v_pk_add_f32 v[76:77], v[76:77], v[108:109]
 v_pk_add_f32 v[78:79], v[78:79], v[110:111]
 v_cvt_pk_bf16_f32 v20, v76, v77
 v_cvt_pk_bf16_f32 v21, v78, v79
 s_waitcnt lgkmcnt(4)
 v_pk_add_f32 v[92:93], v[92:93], v[124:125]
 v_pk_add_f32 v[94:95], v[94:95], v[126:127]
 v_cvt_pk_bf16_f32 v22, v92, v93
 v_cvt_pk_bf16_f32 v23, v94, v95
 buffer_store_dwordx4 v[16:19], v11, s[20:23], s90 offen sc1
 buffer_store_dwordx4 v[20:23], v11, s[20:23], s90 offen offset:1024 sc1
 s_waitcnt lgkmcnt(3)
 v_pk_add_f32 v[32:33], v[64:65], v[96:97]
 v_pk_add_f32 v[34:35], v[66:67], v[98:99]
 s_waitcnt lgkmcnt(2)
 v_pk_add_f32 v[36:37], v[80:81], v[112:113]
 v_pk_add_f32 v[38:39], v[82:83], v[114:115]
 s_waitcnt lgkmcnt(1)
 v_pk_add_f32 v[40:41], v[68:69], v[100:101]
 v_pk_add_f32 v[42:43], v[70:71], v[102:103]
 s_waitcnt lgkmcnt(0)
 v_pk_add_f32 v[44:45], v[84:85], v[116:117]
 v_pk_add_f32 v[46:47], v[86:87], v[118:119]
L_k2_s1:
 s_mov_b32 s58, 0
L_k2_poll:
 buffer_load_dwordx4 v[64:67], v11, s[20:23], s91 offen sc1
 buffer_load_dwordx4 v[68:71], v11, s[20:23], s91 offen offset:1024 sc1
 s_waitcnt vmcnt(0)
 v_max3_u32 v12, v64, v65, v66
 v_max3_u32 v12, v12, v67, v68
 v_max3_u32 v12, v12, v69, v70
 v_max_u32 v12, v12, v71
 v_cmp_eq_u32 vcc, -1, v12
 s_add_u32 s58, s58, 1
 s_cbranch_vccz L_k2_wait_done
 s_cmp_lt_u32 s58, 0x4000
 s_cbranch_scc0 L_k2_wait_done
 s_sleep 2
 s_branch L_k2_poll
L_k2_wait_done:
 v_lshlrev_b32 v12, 16, v64
 v_and_b32 v13, 0xffff0000, v64
 v_pk_add_f32 v[32:33], v[32:33], v[12:13]
 v_lshlrev_b32 v12, 16, v65
 v_and_b32 v13, 0xffff0000, v65
 v_pk_add_f32 v[34:35], v[34:35], v[12:13]
 v_lshlrev_b32 v12, 16, v66
 v_and_b32 v13, 0xffff0000, v66
 v_pk_add_f32 v[36:37], v[36:37], v[12:13]
 v_lshlrev_b32 v12, 16, v67
 v_and_b32 v13, 0xffff0000, v67
 v_pk_add_f32 v[38:39], v[38:39], v[12:13]
 v_lshlrev_b32 v12, 16, v68
 v_and_b32 v13, 0xffff0000, v68
 v_pk_add_f32 v[40:41], v[40:41], v[12:13]
 v_lshlrev_b32 v12, 16, v69
 v_and_b32 v13, 0xffff0000, v69
 v_pk_add_f32 v[42:43], v[42:43], v[12:13]
 v_lshlrev_b32 v12, 16, v70
 v_and_b32 v13, 0xffff0000, v70
 v_pk_add_f32 v[44:45], v[44:45], v[12:13]
 v_lshlrev_b32 v12, 16, v71
 v_and_b32 v13, 0xffff0000, v71
 v_pk_add_f32 v[46:47], v[46:47], v[12:13]
 s_nop 1
 v_permlane16_swap_b32 v32, v36
 v_permlane16_swap_b32 v33, v37
 v_permlane16_swap_b32 v34, v38
 v_permlane16_swap_b32 v35, v39
 v_permlane16_swap_b32 v40, v44
 v_permlane16_swap_b32 v41, v45
 v_permlane16_swap_b32 v42, v46
 v_permlane16_swap_b32 v43, v47
 s_nop 1
 v_lshlrev_b32 v12, 16, v48
 v_and_b32 v13, 0xffff0000, v48
 v_add_f32 v32, v32, v12
 v_add_f32 v33, v33, v13
 v_lshlrev_b32 v12, 16, v49
 v_and_b32 v13, 0xffff0000, v49
 v_add_f32 v34, v34, v12
 v_add_f32 v35, v35, v13
 v_lshlrev_b32 v12, 16, v50
 v_and_b32 v13, 0xffff0000, v50
 v_add_f32 v36, v36, v12
 v_add_f32 v37, v37, v13
 v_lshlrev_b32 v12, 16, v51
 v_and_b32 v13, 0xffff0000, v51
 v_add_f32 v38, v38, v12
 v_add_f32 v39, v39, v13
 v_cvt_pk_bf16_f32 v16, v32, v33
 v_cvt_pk_bf16_f32 v17, v34, v35
 v_cvt_pk_bf16_f32 v18, v36, v37
 v_cvt_pk_bf16_f32 v19, v38, v39
 v_lshlrev_b32 v12, 16, v52
 v_and_b32 v13, 0xffff0000, v52
 v_add_f32 v40, v40, v12
 v_add_f32 v41, v41, v13
 v_lshlrev_b32 v12, 16, v53
 v_and_b32 v13, 0xffff0000, v53
 v_add_f32 v42, v42, v12
 v_add_f32 v43, v43, v13
 v_lshlrev_b32 v12, 16, v54
 v_and_b32 v13, 0xffff0000, v54
 v_add_f32 v44, v44, v12
 v_add_f32 v45, v45, v13
 v_lshlrev_b32 v12, 16, v55
 v_and_b32 v13, 0xffff0000, v55
 v_add_f32 v46, v46, v12
 v_add_f32 v47, v47, v13
 v_cvt_pk_bf16_f32 v20, v40, v41
 v_cvt_pk_bf16_f32 v21, v42, v43
 v_cvt_pk_bf16_f32 v22, v44, v45
 v_cvt_pk_bf16_f32 v23, v46, v47
 buffer_store_dwordx4 v[16:19], v9, s[40:43], 0 offen
 buffer_store_dwordx4 v[20:23], v9, s[40:43], s88 offen
 s_endpgm
L_k2_late:
 s_mov_b32 s58, 0
L_k2_late_poll:
 buffer_load_dword v30, v29, s[96:99], 0 offen offset:0 sc1
 s_waitcnt vmcnt(0)
 v_cmp_gt_u32 vcc, 32, v30
 s_add_u32 s58, s58, 1
 s_cbranch_vccz L_k2_back
 s_cmp_lt_u32 s58, 0x20000
 s_cbranch_scc0 L_k2_back
 s_sleep 8
 s_branch L_k2_late_poll
L_k1_end:
 s_endpgm
.section .rodata,"a"
.p2align 6
.amdhsa_kernel parallel_sum__sliding_local_dilated__geglu_ffn__prompt_kernel
  .amdhsa_next_free_vgpr 256
  .amdhsa_next_free_sgpr 102
  .amdhsa_accum_offset 200
  .amdhsa_group_segment_fixed_size 0
  .amdhsa_kernarg_size 80
  .amdhsa_user_sgpr_count 2
  .amdhsa_user_sgpr_kernarg_segment_ptr 1
  .amdhsa_system_sgpr_workgroup_id_x 1
  .amdhsa_float_denorm_mode_32 3
.end_amdhsa_kernel
```
